```python
import torch

def _softmax(x, axis=-1):
    return torch.softmax(x, dim=axis)

def _gelu(x):
    return torch.nn.functional.gelu(x, approximate='tanh')

def _silu(x):
    return torch.nn.functional.silu(x)

def _sigmoid(x):
    return torch.sigmoid(x)

def _layernorm(x, axis=-1, eps=1e-05):
    m = x.mean(dim=axis, keepdim=True)
    v = x.var(dim=axis, keepdim=True, unbiased=False)
    return (x - m) / torch.sqrt(v + eps)

def _scatter_add(tgt, idx, src, axis=0):
    return tgt.clone().index_add_(axis, idx, src)

def _segment_sum(src, seg, n):
    out = torch.zeros((n,) + src.shape[1:], dtype=src.dtype)
    return out.index_add_(0, seg, src)

def _pad(x, pw):
    flat = tuple((v for pair in reversed(pw) for v in pair))
    return torch.nn.functional.pad(x, flat)
kernel_name = 'adaLN_cond__gqa_block_cached__dense_activation_relu__prompt'

def setup_inputs():

    _w = lambda a: (lambda t: t.to(torch.bfloat16) if t.is_floating_point() else t)(torch.as_tensor(a))

    def _A_setup():
        B, Sq, D = (1, 2048, 512)
        Hq, Hkv, Sk, Dh = (32, 8, 2048, 128)
        assert Hq % Hkv == 0, (Hq, Hkv)
        return {'x': _w((lambda *s: torch.randn(*s, dtype=torch.bfloat16) * 0.05)(B, Sq, D)), 'k_cache': _w((lambda *s: torch.randn(*s, dtype=torch.bfloat16) * 3.2)(B, Hkv, Sk, Dh)), 'v_cache': _w((lambda *s: torch.randn(*s, dtype=torch.bfloat16) * 0.4)(B, Hkv, Sk, Dh)), 'wq': _w((lambda *s: torch.randn(*s, dtype=torch.bfloat16) * 3.2)(D, Hq * Dh) * D ** (-0.5)), 'wo': _w((lambda *s: torch.randn(*s, dtype=torch.bfloat16) * 0.4)(Hq * Dh, D) * (Hq * Dh) ** (-0.5))}
    _A_in = _A_setup()

    def _B_setup():
        B, S, D, Dff = (1, 2048, 512, 1792)
        return {'x': _w((lambda *s: torch.randn(*s, dtype=torch.bfloat16) * 0.05)(B, S, D)), 'w1': _w((lambda *s: torch.randn(*s, dtype=torch.bfloat16) * 0.05)(D, Dff)), 'w2': _w((lambda *s: torch.randn(*s, dtype=torch.bfloat16) * 0.05)(Dff, D))}
    _B_in = _B_setup()
    return {'A_x': _A_in['x'], 'A_k_cache': _A_in['k_cache'], 'A_v_cache': _A_in['v_cache'], 'A_wq': _A_in['wq'], 'A_wo': _A_in['wo'], 'B_x': _B_in['x'], 'B_w1': _B_in['w1'], 'B_w2': _B_in['w2'], 'c': _w((lambda *s: torch.randn(*s, dtype=torch.bfloat16) * 0.1)(1, 512) * 8.0), 'w_mod': _w((lambda *s: torch.randn(*s, dtype=torch.bfloat16) * 0.1)(512, 6 * 512) * 512 ** (-0.5) * 8.0)}

def reference(A_x, A_k_cache, A_v_cache, A_wq, A_wo, B_x, B_w1, B_w2, c, w_mod):

    def _A_ref(x, k_cache, v_cache, wq, wo):
        B, Sq, D = x.shape
        Hq, Dh = (32, 128)
        Hkv = k_cache.shape[1]
        rep = Hq // Hkv
        q = (lambda x, *d: x.permute(*d))((x @ wq).reshape(B, Sq, Hq, Dh), 0, 2, 1, 3)
        k = (lambda x, n, axis: torch.repeat_interleave(x, n, dim=axis))(k_cache, rep, axis=1)
        v = (lambda x, n, axis: torch.repeat_interleave(x, n, dim=axis))(v_cache, rep, axis=1)
        scores = torch.einsum('bhqd,bhkd->bhqk', q, k) * Dh ** (-0.5)
        p = _softmax(scores, axis=-1)
        o = torch.einsum('bhqk,bhkd->bhqd', p, v)
        return (lambda x, *d: x.permute(*d))(o, 0, 2, 1, 3).reshape(B, Sq, Hq * Dh) @ wo

    def _B_ref(x, w1, w2):
        h = torch.einsum('bsd,df->bsf', x, w1)
        zero = torch.zeros_like(h)
        h = torch.maximum(h, zero)
        return torch.einsum('bsf,fd->bsd', h, w2)
    x = A_x
    mod = (_silu(c) @ w_mod).reshape(c.shape[0], 6, 1, -1)
    sa, ca, ga, sb, cb, gb = (mod[:, 0].clone(), mod[:, 1].clone(), mod[:, 2].clone(), mod[:, 3].clone(), mod[:, 4].clone(), mod[:, 5].clone())
    h = _layernorm(x, axis=-1) * (1 + ca) + sa
    x = x + ga * _A_ref(h, A_k_cache, A_v_cache, A_wq, A_wo)
    h = _layernorm(x, axis=-1) * (1 + cb) + sb
    x = x + gb * _B_ref(h, B_w1, B_w2)
    return x
```

```asm
; @launch grid=(256,1,1) block=(256,1,1) lds=163840
.amdgcn_target "amdgcn-amd-amdhsa--gfx950"
.text
.globl adaLN_cond__gqa_block_cached__dense_activation_relu__prompt_kernel
.p2align 8
.type adaLN_cond__gqa_block_cached__dense_activation_relu__prompt_kernel,@function
adaLN_cond__gqa_block_cached__dense_activation_relu__prompt_kernel:
 s_cmp_ge_u32 s2, 256
 s_cbranch_scc1 L_end
 s_load_dwordx16 s[64:79], s[0:1], 0
 s_load_dwordx8 s[80:87], s[0:1], 64
 s_load_dwordx2 s[88:89], s[0:1], 96
 v_lshrrev_b32 v2, 6, v0
 v_and_b32 v1, 63, v0
 v_readfirstlane_b32 s3, v2
 s_getpc_b64 s[46:47]
 s_lshr_b32 s42, s2, 3
 s_lshl_b32 s42, s42, 2
 s_add_u32 s42, s42, s3
 v_and_b32 v22, 3, v1
 v_lshl_add_u32 v22, s42, 2, v22
 v_lshlrev_b32 v22, 7, v22
 global_load_dword v14, v22, s[46:47]
 s_bfe_u32 s32, s2, 0x20001
 s_lshl_b32 s32, s32, 1
 s_bfe_u32 s41, s2, 0x10003
 s_add_u32 s32, s32, s41
 s_lshr_b32 s101, s2, 4
 s_and_b32 s33, s2, 1
 s_lshl_b32 s33, s33, 4
 s_add_u32 s33, s33, s101
 v_mov_b32 v17, v0
 s_lshl_b32 s36, s3, 12
 s_lshl_b32 s39, s3, 13
 s_add_u32 s39, s39, 131072
 s_lshl_b32 s40, s3, 13
 s_lshl_b32 s41, s33, 16
 s_lshl_b32 s42, s3, 14
 s_add_u32 s41, s41, s42
 v_lshrrev_b32 v18, 4, v1
 v_and_b32 v19, 15, v1
 v_lshlrev_b32 v20, 10, v18
 v_lshl_add_u32 v20, v19, 4, v20
 v_lshlrev_b32 v21, 5, v19
 s_add_u32 s97, s33, 0
 s_and_b32 s97, s97, 3
 s_lshl_b32 s97, s97, 2
 s_add_u32 s98, s33, 1
 s_and_b32 s98, s98, 3
 s_lshl_b32 s98, s98, 2
 s_add_u32 s99, s33, 2
 s_and_b32 s99, s99, 3
 s_lshl_b32 s99, s99, 2
 s_add_u32 s100, s33, 3
 s_and_b32 s100, s100, 3
 s_lshl_b32 s100, s100, 2
 s_memrealtime s[90:91]
 s_waitcnt lgkmcnt(0)
 s_mov_b32 s56, s86
 s_mov_b32 s57, s87
 s_mov_b32 s58, 256
 s_mov_b32 s59, 0x20000
 s_or_b32 s42, s2, s3
 s_cbranch_scc1 L_nonce_set
 s_or_b32 s90, s90, 1
 v_mov_b32 v23, s90
  buffer_store_dword v23, off, s[56:59], 0 sc0 sc1
L_nonce_set:
 s_mov_b32 s4, s64
 s_mov_b32 s5, s65
 s_mov_b32 s6, 2097152
 s_mov_b32 s7, 0x20000
 s_mov_b32 s24, s88
 s_mov_b32 s25, s89
 s_mov_b32 s26, 268435456
 s_mov_b32 s27, 0x20000
 s_cmp_ge_u32 s2, 64
 s_cbranch_scc1 L_noown0
  s_and_b32 s95, s2, 7
  s_lshl_b32 s95, s95, 1
  s_bfe_u32 s44, s2, 0x10003
  s_or_b32 s95, s95, s44
  s_and_b32 s44, s2, 0x10
  s_or_b32 s95, s95, s44
  s_bfe_u32 s96, s2, 0x10005
  s_lshl_b32 s44, s96, 2
  s_add_u32 s44, s44, s3
  v_lshrrev_b32 v24, 2, v1
  v_and_b32 v25, 3, v1
  v_lshl_add_u32 v24, s44, 6, v24
  v_mul_u32_u24 v26, 6144, v24
  v_lshl_add_u32 v26, v25, 4, v26
  v_lshlrev_b32 v27, 1, v24
  s_lshl_b32 s44, s95, 6
 s_mov_b32 s60, s82
 s_mov_b32 s61, s83
 s_mov_b32 s62, 3145728
 s_mov_b32 s63, 0x20000
  buffer_load_dwordx4 v[132:135], v26, s[60:63], s44 offen
  s_add_u32 s44, s44, 98304
  buffer_load_dwordx4 v[136:139], v26, s[60:63], s44 offen
  s_add_u32 s44, s44, 98304
  buffer_load_dwordx4 v[140:143], v26, s[60:63], s44 offen
  s_add_u32 s44, s44, 98304
  buffer_load_dwordx4 v[144:147], v26, s[60:63], s44 offen
 s_mov_b32 s60, s80
 s_mov_b32 s61, s81
 s_mov_b32 s62, 1024
 s_mov_b32 s63, 0x20000
  buffer_load_ushort v128, v27, s[60:63], 0 offen offset:0
  buffer_load_ushort v129, v27, s[60:63], 0 offen offset:32
  buffer_load_ushort v130, v27, s[60:63], 0 offen offset:64
  buffer_load_ushort v131, v27, s[60:63], 0 offen offset:96
L_noown0:
 s_cmp_ge_u32 s2, 64
 s_cbranch_scc1 L_noown1
  s_waitcnt vmcnt(8)
  buffer_load_dword v16, off, s[56:59], 0 sc0 sc1
L_noown1:
 s_lshl_b32 s42, s97, 10
 s_add_u32 s42, s42, s41
 buffer_load_dwordx4 v[64:67], v20, s[4:7], s42 offen offset:0
 buffer_load_dwordx4 v[68:71], v20, s[4:7], s42 offen offset:256
 buffer_load_dwordx4 v[72:75], v20, s[4:7], s42 offen offset:512
 buffer_load_dwordx4 v[76:79], v20, s[4:7], s42 offen offset:768
 s_lshl_b32 s42, s98, 10
 s_add_u32 s42, s42, s41
 buffer_load_dwordx4 v[80:83], v20, s[4:7], s42 offen offset:0
 buffer_load_dwordx4 v[84:87], v20, s[4:7], s42 offen offset:256
 buffer_load_dwordx4 v[88:91], v20, s[4:7], s42 offen offset:512
 buffer_load_dwordx4 v[92:95], v20, s[4:7], s42 offen offset:768
 s_cmp_lt_u32 s2, 64
 s_cbranch_scc1 L_own
 s_lshl_b32 s42, s99, 10
 s_add_u32 s42, s42, s41
 buffer_load_dwordx4 v[96:99], v20, s[4:7], s42 offen offset:0
 buffer_load_dwordx4 v[100:103], v20, s[4:7], s42 offen offset:256
 buffer_load_dwordx4 v[104:107], v20, s[4:7], s42 offen offset:512
 buffer_load_dwordx4 v[108:111], v20, s[4:7], s42 offen offset:768
 s_lshl_b32 s42, s100, 10
 s_add_u32 s42, s42, s41
 buffer_load_dwordx4 v[112:115], v20, s[4:7], s42 offen offset:0
 buffer_load_dwordx4 v[116:119], v20, s[4:7], s42 offen offset:256
 buffer_load_dwordx4 v[120:123], v20, s[4:7], s42 offen offset:512
 buffer_load_dwordx4 v[124:127], v20, s[4:7], s42 offen offset:768
 s_branch L_own_done_e
L_own:
  s_waitcnt vmcnt(9)
  v_lshlrev_b32 v128, 16, v128
  v_lshlrev_b32 v129, 16, v129
  v_lshlrev_b32 v130, 16, v130
  v_lshlrev_b32 v131, 16, v131
  v_mul_f32 v160, 3216550459, v128
  v_mul_f32 v161, 3216550459, v129
  v_mul_f32 v162, 3216550459, v130
  v_mul_f32 v163, 3216550459, v131
  v_exp_f32 v160, v160
  v_exp_f32 v161, v161
  v_exp_f32 v162, v162
  v_exp_f32 v163, v163
  v_add_f32 v160, 1.0, v160
  v_add_f32 v161, 1.0, v161
  v_add_f32 v162, 1.0, v162
  v_add_f32 v163, 1.0, v163
  v_rcp_f32 v160, v160
  v_rcp_f32 v161, v161
  v_rcp_f32 v162, v162
  v_rcp_f32 v163, v163
  v_mul_f32 v128, v128, v160
  v_mul_f32 v129, v129, v161
  v_mul_f32 v130, v130, v162
  v_mul_f32 v131, v131, v163
  v_cvt_pk_bf16_f32 v128, v128, v128
  v_cvt_pk_bf16_f32 v129, v129, v129
  v_cvt_pk_bf16_f32 v130, v130, v130
  v_cvt_pk_bf16_f32 v131, v131, v131
  v_and_b32 v128, 0xffff0000, v128
  v_and_b32 v129, 0xffff0000, v129
  v_and_b32 v130, 0xffff0000, v130
  v_and_b32 v131, 0xffff0000, v131
  v_lshlrev_b32 v168, 16, v132
  v_and_b32 v169, 0xffff0000, v132
  v_lshlrev_b32 v170, 16, v133
  v_and_b32 v171, 0xffff0000, v133
  v_lshlrev_b32 v172, 16, v134
  v_and_b32 v173, 0xffff0000, v134
  v_lshlrev_b32 v174, 16, v135
  v_and_b32 v175, 0xffff0000, v135
  v_pk_mul_f32 v[160:161], v[168:169], v[128:129] op_sel_hi:[1,0]
  v_pk_mul_f32 v[162:163], v[170:171], v[128:129] op_sel_hi:[1,0]
  v_pk_mul_f32 v[164:165], v[172:173], v[128:129] op_sel_hi:[1,0]
  v_pk_mul_f32 v[166:167], v[174:175], v[128:129] op_sel_hi:[1,0]
  v_lshlrev_b32 v168, 16, v136
  v_and_b32 v169, 0xffff0000, v136
  v_lshlrev_b32 v170, 16, v137
  v_and_b32 v171, 0xffff0000, v137
  v_lshlrev_b32 v172, 16, v138
  v_and_b32 v173, 0xffff0000, v138
  v_lshlrev_b32 v174, 16, v139
  v_and_b32 v175, 0xffff0000, v139
  v_pk_fma_f32 v[160:161], v[168:169], v[128:129], v[160:161] op_sel:[0,1,0] op_sel_hi:[1,1,1]
  v_pk_fma_f32 v[162:163], v[170:171], v[128:129], v[162:163] op_sel:[0,1,0] op_sel_hi:[1,1,1]
  v_pk_fma_f32 v[164:165], v[172:173], v[128:129], v[164:165] op_sel:[0,1,0] op_sel_hi:[1,1,1]
  v_pk_fma_f32 v[166:167], v[174:175], v[128:129], v[166:167] op_sel:[0,1,0] op_sel_hi:[1,1,1]
  v_lshlrev_b32 v168, 16, v140
  v_and_b32 v169, 0xffff0000, v140
  v_lshlrev_b32 v170, 16, v141
  v_and_b32 v171, 0xffff0000, v141
  v_lshlrev_b32 v172, 16, v142
  v_and_b32 v173, 0xffff0000, v142
  v_lshlrev_b32 v174, 16, v143
  v_and_b32 v175, 0xffff0000, v143
  v_pk_fma_f32 v[160:161], v[168:169], v[130:131], v[160:161] op_sel:[0,0,0] op_sel_hi:[1,0,1]
  v_pk_fma_f32 v[162:163], v[170:171], v[130:131], v[162:163] op_sel:[0,0,0] op_sel_hi:[1,0,1]
  v_pk_fma_f32 v[164:165], v[172:173], v[130:131], v[164:165] op_sel:[0,0,0] op_sel_hi:[1,0,1]
  v_pk_fma_f32 v[166:167], v[174:175], v[130:131], v[166:167] op_sel:[0,0,0] op_sel_hi:[1,0,1]
  v_lshlrev_b32 v168, 16, v144
  v_and_b32 v169, 0xffff0000, v144
  v_lshlrev_b32 v170, 16, v145
  v_and_b32 v171, 0xffff0000, v145
  v_lshlrev_b32 v172, 16, v146
  v_and_b32 v173, 0xffff0000, v146
  v_lshlrev_b32 v174, 16, v147
  v_and_b32 v175, 0xffff0000, v147
  v_pk_fma_f32 v[160:161], v[168:169], v[130:131], v[160:161] op_sel:[0,1,0] op_sel_hi:[1,1,1]
  v_pk_fma_f32 v[162:163], v[170:171], v[130:131], v[162:163] op_sel:[0,1,0] op_sel_hi:[1,1,1]
  v_pk_fma_f32 v[164:165], v[172:173], v[130:131], v[164:165] op_sel:[0,1,0] op_sel_hi:[1,1,1]
  v_pk_fma_f32 v[166:167], v[174:175], v[130:131], v[166:167] op_sel:[0,1,0] op_sel_hi:[1,1,1]
 s_nop 0
  v_add_f32_dpp v160, v160, v160 row_ror:4 row_mask:0xf bank_mask:0xf
  v_add_f32_dpp v161, v161, v161 row_ror:4 row_mask:0xf bank_mask:0xf
  v_add_f32_dpp v162, v162, v162 row_ror:4 row_mask:0xf bank_mask:0xf
  v_add_f32_dpp v163, v163, v163 row_ror:4 row_mask:0xf bank_mask:0xf
  v_add_f32_dpp v164, v164, v164 row_ror:4 row_mask:0xf bank_mask:0xf
  v_add_f32_dpp v165, v165, v165 row_ror:4 row_mask:0xf bank_mask:0xf
  v_add_f32_dpp v166, v166, v166 row_ror:4 row_mask:0xf bank_mask:0xf
  v_add_f32_dpp v167, v167, v167 row_ror:4 row_mask:0xf bank_mask:0xf
 s_nop 0
  v_add_f32_dpp v160, v160, v160 row_ror:8 row_mask:0xf bank_mask:0xf
  v_add_f32_dpp v161, v161, v161 row_ror:8 row_mask:0xf bank_mask:0xf
  v_add_f32_dpp v162, v162, v162 row_ror:8 row_mask:0xf bank_mask:0xf
  v_add_f32_dpp v163, v163, v163 row_ror:8 row_mask:0xf bank_mask:0xf
  v_add_f32_dpp v164, v164, v164 row_ror:8 row_mask:0xf bank_mask:0xf
  v_add_f32_dpp v165, v165, v165 row_ror:8 row_mask:0xf bank_mask:0xf
  v_add_f32_dpp v166, v166, v166 row_ror:8 row_mask:0xf bank_mask:0xf
  v_add_f32_dpp v167, v167, v167 row_ror:8 row_mask:0xf bank_mask:0xf
  v_mov_b32 v168, v160
  v_mov_b32 v169, v161
  v_mov_b32 v170, v162
  v_mov_b32 v171, v163
  v_mov_b32 v172, v164
  v_mov_b32 v173, v165
  v_mov_b32 v174, v166
  v_mov_b32 v175, v167
 s_nop 0
  v_permlane16_swap_b32 v168, v160
  v_permlane16_swap_b32 v169, v161
  v_permlane16_swap_b32 v170, v162
  v_permlane16_swap_b32 v171, v163
  v_permlane16_swap_b32 v172, v164
  v_permlane16_swap_b32 v173, v165
  v_permlane16_swap_b32 v174, v166
  v_permlane16_swap_b32 v175, v167
  v_add_f32 v160, v160, v168
  v_add_f32 v161, v161, v169
  v_add_f32 v162, v162, v170
  v_add_f32 v163, v163, v171
  v_add_f32 v164, v164, v172
  v_add_f32 v165, v165, v173
  v_add_f32 v166, v166, v174
  v_add_f32 v167, v167, v175
  v_mov_b32 v168, v160
  v_mov_b32 v169, v161
  v_mov_b32 v170, v162
  v_mov_b32 v171, v163
  v_mov_b32 v172, v164
  v_mov_b32 v173, v165
  v_mov_b32 v174, v166
  v_mov_b32 v175, v167
 s_nop 0
  v_permlane32_swap_b32 v168, v160
  v_permlane32_swap_b32 v169, v161
  v_permlane32_swap_b32 v170, v162
  v_permlane32_swap_b32 v171, v163
  v_permlane32_swap_b32 v172, v164
  v_permlane32_swap_b32 v173, v165
  v_permlane32_swap_b32 v174, v166
  v_permlane32_swap_b32 v175, v167
  v_add_f32 v160, v160, v168
  v_add_f32 v161, v161, v169
  v_add_f32 v162, v162, v170
  v_add_f32 v163, v163, v171
  v_add_f32 v164, v164, v172
  v_add_f32 v165, v165, v173
  v_add_f32 v166, v166, v174
  v_add_f32 v167, v167, v175
  v_and_b32 v25, 3, v1
  v_lshlrev_b32 v24, 5, v25
  v_lshl_add_u32 v24, s3, 7, v24
  v_add_u32 v24, 65536, v24
  ds_write_b128 v24, v[160:163]
  ds_write_b128 v24, v[164:167] offset:16
  s_lshl_b32 s42, s99, 10
  s_add_u32 s42, s42, s41
  buffer_load_dwordx4 v[96:99], v20, s[4:7], s42 offen offset:0
  buffer_load_dwordx4 v[100:103], v20, s[4:7], s42 offen offset:256
  buffer_load_dwordx4 v[104:107], v20, s[4:7], s42 offen offset:512
  buffer_load_dwordx4 v[108:111], v20, s[4:7], s42 offen offset:768
  s_lshl_b32 s42, s100, 10
  s_add_u32 s42, s42, s41
  buffer_load_dwordx4 v[112:115], v20, s[4:7], s42 offen offset:0
  buffer_load_dwordx4 v[116:119], v20, s[4:7], s42 offen offset:256
  buffer_load_dwordx4 v[120:123], v20, s[4:7], s42 offen offset:512
  buffer_load_dwordx4 v[124:127], v20, s[4:7], s42 offen offset:768
  s_waitcnt lgkmcnt(0)
  s_barrier
  s_cmp_lg_u32 s3, 0
  s_cbranch_scc1 L_own_done_e
  v_and_b32 v24, 31, v1
  v_lshlrev_b32 v25, 2, v24
  v_add_u32 v25, 65536, v25
  ds_read_b32 v168, v25 offset:0
  ds_read_b32 v169, v25 offset:128
  ds_read_b32 v170, v25 offset:256
  ds_read_b32 v171, v25 offset:384
  s_lshl_b32 s44, s95, 8
  s_mul_i32 s45, s96, 8192
  s_add_u32 s44, s44, s45
  v_lshlrev_b32 v24, 3, v24
  v_cmp_gt_u32 vcc, 32, v1
  v_mov_b32 v25, 0x40000000
  s_waitcnt lgkmcnt(0)
  v_add_f32 v168, v168, v169
  v_add_f32 v170, v170, v171
  v_cndmask_b32 v24, v25, v24, vcc
  v_add_f32 v168, v168, v170
  s_waitcnt vmcnt(16)
  v_readfirstlane_b32 s94, v16
  s_nop 0
  s_cmp_lg_u32 s94, 0
  s_cbranch_scc1 L_nx_o
  s_mov_b32 s38, 0x100000
L_nn_o:
  s_waitcnt vmcnt(0)
  v_readfirstlane_b32 s94, v16
  s_sub_u32 s38, s38, 1
  s_cbranch_scc1 L_nx_o
  s_cmp_lg_u32 s94, 0
  s_cbranch_scc1 L_nx_o
  buffer_load_dword v16, off, s[56:59], 0 sc0 sc1
  s_branch L_nn_o
L_nx_o:
  v_mov_b32 v169, s94
  buffer_store_dwordx2 v[168:169], v24, s[24:27], s44 offen offset:0 sc0 sc1
L_own_done_e:
 s_mov_b32 s16, s70
 s_mov_b32 s17, s71
 s_mov_b32 s18, 4194304
 s_mov_b32 s19, 0x20000
 s_lshl_b32 s41, s32, 19
 s_add_u32 s8, s66, s41
 s_addc_u32 s9, s67, 0
 s_mov_b32 s10, 524288
 s_mov_b32 s11, 0x20000
 s_add_u32 s12, s68, s41
 s_addc_u32 s13, s69, 0
 s_mov_b32 s14, 524288
 s_mov_b32 s15, 0x20000
 s_lshl_b32 s42, s32, 2
 s_add_u32 s42, s42, s3
 s_lshl_b32 s42, s42, 18
 s_add_u32 s42, s42, 117440512
 s_add_u32 s20, s88, s42
 s_addc_u32 s21, s89, 0
 s_mov_b32 s22, 262144
 s_mov_b32 s23, 0x20000
 s_cmp_eq_u32 s3, 3
 s_cselect_b32 s22, 229376, s22
 s_mul_i32 s41, s32, 229376
 s_add_u32 s28, s78, s41
 s_addc_u32 s29, s79, 0
 s_mov_b32 s30, 229376
 s_mov_b32 s31, 0x20000
 s_lshl_b32 s43, s32, 2
 s_add_u32 s43, s43, s3
 s_lshl_b32 s43, s43, 8
 v_lshrrev_b32 v24, 4, v1
 v_and_b32 v25, 15, v1
 v_lshlrev_b32 v26, 1, v24
 v_xor_b32 v25, v25, v26
 v_mul_u32_u24 v24, 8192, v24
 v_add_u32 v24, s43, v24
 v_lshl_add_u32 v26, v25, 4, v24
 v_xor_b32 v25, 8, v25
 v_lshl_add_u32 v27, v25, 4, v24
 v_add_u32 v6, 0, v26
 v_add_u32 v7, 31744, v26
 v_add_u32 v8, 63488, v27
 v_add_u32 v9, 95232, v27
 v_add_u32 v10, 131072, v26
 v_add_u32 v11, 162816, v26
 v_add_u32 v12, 194560, v27
 v_add_u32 v13, 226304, v27
 s_and_b32 s95, s2, 7
 s_lshl_b32 s95, s95, 1
 s_bfe_u32 s44, s2, 0x10003
 s_or_b32 s95, s95, s44
 s_and_b32 s44, s2, 0x30
 s_or_b32 s95, s95, s44
 s_lshl_b32 s96, s95, 6
 s_add_u32 s96, s96, 2048
 s_lshr_b32 s44, s2, 6
 s_cmp_eq_u32 s44, 1
 s_cselect_b32 s96, s96, 0x40000000
 s_waitcnt vmcnt(9)
 s_lshr_b32 s44, s2, 6
 s_or_b32 s44, s44, s3
 s_cbranch_scc0 L_xw0
 s_waitcnt vmcnt(8)
L_xw0:
 v_lshlrev_b32 v128, 16, v64
 v_and_b32 v129, 0xffff0000, v64
 v_lshlrev_b32 v130, 16, v65
 v_and_b32 v131, 0xffff0000, v65
 v_lshlrev_b32 v132, 16, v66
 v_and_b32 v133, 0xffff0000, v66
 v_lshlrev_b32 v134, 16, v67
 v_and_b32 v135, 0xffff0000, v67
 v_lshlrev_b32 v136, 16, v68
 v_and_b32 v137, 0xffff0000, v68
 v_lshlrev_b32 v138, 16, v69
 v_and_b32 v139, 0xffff0000, v69
 v_lshlrev_b32 v140, 16, v70
 v_and_b32 v141, 0xffff0000, v70
 v_lshlrev_b32 v142, 16, v71
 v_and_b32 v143, 0xffff0000, v71
 v_lshlrev_b32 v144, 16, v72
 v_and_b32 v145, 0xffff0000, v72
 v_lshlrev_b32 v146, 16, v73
 v_and_b32 v147, 0xffff0000, v73
 v_lshlrev_b32 v148, 16, v74
 v_and_b32 v149, 0xffff0000, v74
 v_lshlrev_b32 v150, 16, v75
 v_and_b32 v151, 0xffff0000, v75
 v_lshlrev_b32 v152, 16, v76
 v_and_b32 v153, 0xffff0000, v76
 v_lshlrev_b32 v154, 16, v77
 v_and_b32 v155, 0xffff0000, v77
 v_lshlrev_b32 v156, 16, v78
 v_and_b32 v157, 0xffff0000, v78
 v_lshlrev_b32 v158, 16, v79
 v_and_b32 v159, 0xffff0000, v79
 v_lshlrev_b32 v160, 16, v80
 v_and_b32 v161, 0xffff0000, v80
 v_lshlrev_b32 v162, 16, v81
 v_and_b32 v163, 0xffff0000, v81
 v_lshlrev_b32 v164, 16, v82
 v_and_b32 v165, 0xffff0000, v82
 v_lshlrev_b32 v166, 16, v83
 v_and_b32 v167, 0xffff0000, v83
 v_lshlrev_b32 v168, 16, v84
 v_and_b32 v169, 0xffff0000, v84
 v_lshlrev_b32 v170, 16, v85
 v_and_b32 v171, 0xffff0000, v85
 v_lshlrev_b32 v172, 16, v86
 v_and_b32 v173, 0xffff0000, v86
 v_lshlrev_b32 v174, 16, v87
 v_and_b32 v175, 0xffff0000, v87
 v_lshlrev_b32 v176, 16, v88
 v_and_b32 v177, 0xffff0000, v88
 v_lshlrev_b32 v178, 16, v89
 v_and_b32 v179, 0xffff0000, v89
 v_lshlrev_b32 v180, 16, v90
 v_and_b32 v181, 0xffff0000, v90
 v_lshlrev_b32 v182, 16, v91
 v_and_b32 v183, 0xffff0000, v91
 v_lshlrev_b32 v184, 16, v92
 v_and_b32 v185, 0xffff0000, v92
 v_lshlrev_b32 v186, 16, v93
 v_and_b32 v187, 0xffff0000, v93
 v_lshlrev_b32 v188, 16, v94
 v_and_b32 v189, 0xffff0000, v94
 v_lshlrev_b32 v190, 16, v95
 v_and_b32 v191, 0xffff0000, v95
 v_pk_add_f32 v[24:25], v[128:129], v[130:131]
 v_pk_add_f32 v[26:27], v[132:133], v[134:135]
 v_pk_add_f32 v[28:29], v[160:161], v[162:163]
 v_pk_add_f32 v[30:31], v[164:165], v[166:167]
 v_pk_add_f32 v[24:25], v[24:25], v[136:137]
 v_pk_add_f32 v[28:29], v[28:29], v[168:169]
 v_pk_add_f32 v[26:27], v[26:27], v[138:139]
 v_pk_add_f32 v[30:31], v[30:31], v[170:171]
 v_pk_add_f32 v[24:25], v[24:25], v[140:141]
 v_pk_add_f32 v[28:29], v[28:29], v[172:173]
 v_pk_add_f32 v[26:27], v[26:27], v[142:143]
 v_pk_add_f32 v[30:31], v[30:31], v[174:175]
 v_pk_add_f32 v[24:25], v[24:25], v[144:145]
 v_pk_add_f32 v[28:29], v[28:29], v[176:177]
 v_pk_add_f32 v[26:27], v[26:27], v[146:147]
 v_pk_add_f32 v[30:31], v[30:31], v[178:179]
 v_pk_add_f32 v[24:25], v[24:25], v[148:149]
 v_pk_add_f32 v[28:29], v[28:29], v[180:181]
 v_pk_add_f32 v[26:27], v[26:27], v[150:151]
 v_pk_add_f32 v[30:31], v[30:31], v[182:183]
 v_pk_add_f32 v[24:25], v[24:25], v[152:153]
 v_pk_add_f32 v[28:29], v[28:29], v[184:185]
 v_pk_add_f32 v[26:27], v[26:27], v[154:155]
 v_pk_add_f32 v[30:31], v[30:31], v[186:187]
 v_pk_add_f32 v[24:25], v[24:25], v[156:157]
 v_pk_add_f32 v[28:29], v[28:29], v[188:189]
 v_pk_add_f32 v[26:27], v[26:27], v[158:159]
 v_pk_add_f32 v[30:31], v[30:31], v[190:191]
 v_pk_add_f32 v[24:25], v[24:25], v[26:27]
 v_pk_add_f32 v[28:29], v[28:29], v[30:31]
 v_add_f32 v24, v24, v25
 v_add_f32 v28, v28, v29
 s_nop 0
 v_add_f32_dpp v24, v24, v24 row_ror:8 row_mask:0xf bank_mask:0xf
 v_add_f32_dpp v28, v28, v28 row_ror:8 row_mask:0xf bank_mask:0xf
 s_nop 0
 v_add_f32_dpp v24, v24, v24 row_ror:4 row_mask:0xf bank_mask:0xf
 v_add_f32_dpp v28, v28, v28 row_ror:4 row_mask:0xf bank_mask:0xf
 s_nop 0
 v_add_f32_dpp v24, v24, v24 row_ror:2 row_mask:0xf bank_mask:0xf
 v_add_f32_dpp v28, v28, v28 row_ror:2 row_mask:0xf bank_mask:0xf
 s_nop 0
 v_add_f32_dpp v24, v24, v24 row_ror:1 row_mask:0xf bank_mask:0xf
 v_add_f32_dpp v28, v28, v28 row_ror:1 row_mask:0xf bank_mask:0xf
 v_mul_f32 v24, 3137339392, v24
 v_mul_f32 v28, 3137339392, v28
 v_pk_add_f32 v[128:129], v[128:129], v[24:25] op_sel_hi:[1,0]
 v_pk_add_f32 v[160:161], v[160:161], v[28:29] op_sel_hi:[1,0]
 v_pk_add_f32 v[130:131], v[130:131], v[24:25] op_sel_hi:[1,0]
 v_pk_add_f32 v[162:163], v[162:163], v[28:29] op_sel_hi:[1,0]
 v_pk_add_f32 v[132:133], v[132:133], v[24:25] op_sel_hi:[1,0]
 v_pk_add_f32 v[164:165], v[164:165], v[28:29] op_sel_hi:[1,0]
 v_pk_add_f32 v[134:135], v[134:135], v[24:25] op_sel_hi:[1,0]
 v_pk_add_f32 v[166:167], v[166:167], v[28:29] op_sel_hi:[1,0]
 v_pk_add_f32 v[136:137], v[136:137], v[24:25] op_sel_hi:[1,0]
 v_pk_add_f32 v[168:169], v[168:169], v[28:29] op_sel_hi:[1,0]
 v_pk_add_f32 v[138:139], v[138:139], v[24:25] op_sel_hi:[1,0]
 v_pk_add_f32 v[170:171], v[170:171], v[28:29] op_sel_hi:[1,0]
 v_pk_add_f32 v[140:141], v[140:141], v[24:25] op_sel_hi:[1,0]
 v_pk_add_f32 v[172:173], v[172:173], v[28:29] op_sel_hi:[1,0]
 v_pk_add_f32 v[142:143], v[142:143], v[24:25] op_sel_hi:[1,0]
 v_pk_add_f32 v[174:175], v[174:175], v[28:29] op_sel_hi:[1,0]
 v_pk_add_f32 v[144:145], v[144:145], v[24:25] op_sel_hi:[1,0]
 v_pk_add_f32 v[176:177], v[176:177], v[28:29] op_sel_hi:[1,0]
 v_pk_add_f32 v[146:147], v[146:147], v[24:25] op_sel_hi:[1,0]
 v_pk_add_f32 v[178:179], v[178:179], v[28:29] op_sel_hi:[1,0]
 v_pk_add_f32 v[148:149], v[148:149], v[24:25] op_sel_hi:[1,0]
 v_pk_add_f32 v[180:181], v[180:181], v[28:29] op_sel_hi:[1,0]
 v_pk_add_f32 v[150:151], v[150:151], v[24:25] op_sel_hi:[1,0]
 v_pk_add_f32 v[182:183], v[182:183], v[28:29] op_sel_hi:[1,0]
 v_pk_add_f32 v[152:153], v[152:153], v[24:25] op_sel_hi:[1,0]
 v_pk_add_f32 v[184:185], v[184:185], v[28:29] op_sel_hi:[1,0]
 v_pk_add_f32 v[154:155], v[154:155], v[24:25] op_sel_hi:[1,0]
 v_pk_add_f32 v[186:187], v[186:187], v[28:29] op_sel_hi:[1,0]
 v_pk_add_f32 v[156:157], v[156:157], v[24:25] op_sel_hi:[1,0]
 v_pk_add_f32 v[188:189], v[188:189], v[28:29] op_sel_hi:[1,0]
 v_pk_add_f32 v[158:159], v[158:159], v[24:25] op_sel_hi:[1,0]
 v_pk_add_f32 v[190:191], v[190:191], v[28:29] op_sel_hi:[1,0]
 v_pk_mul_f32 v[24:25], v[128:129], v[128:129]
 v_pk_mul_f32 v[28:29], v[160:161], v[160:161]
 v_pk_mul_f32 v[26:27], v[130:131], v[130:131]
 v_pk_mul_f32 v[30:31], v[162:163], v[162:163]
 v_pk_fma_f32 v[24:25], v[132:133], v[132:133], v[24:25]
 v_pk_fma_f32 v[28:29], v[164:165], v[164:165], v[28:29]
 v_pk_fma_f32 v[26:27], v[134:135], v[134:135], v[26:27]
 v_pk_fma_f32 v[30:31], v[166:167], v[166:167], v[30:31]
 v_pk_fma_f32 v[24:25], v[136:137], v[136:137], v[24:25]
 v_pk_fma_f32 v[28:29], v[168:169], v[168:169], v[28:29]
 v_pk_fma_f32 v[26:27], v[138:139], v[138:139], v[26:27]
 v_pk_fma_f32 v[30:31], v[170:171], v[170:171], v[30:31]
 v_pk_fma_f32 v[24:25], v[140:141], v[140:141], v[24:25]
 v_pk_fma_f32 v[28:29], v[172:173], v[172:173], v[28:29]
 v_pk_fma_f32 v[26:27], v[142:143], v[142:143], v[26:27]
 v_pk_fma_f32 v[30:31], v[174:175], v[174:175], v[30:31]
 v_pk_fma_f32 v[24:25], v[144:145], v[144:145], v[24:25]
 v_pk_fma_f32 v[28:29], v[176:177], v[176:177], v[28:29]
 v_pk_fma_f32 v[26:27], v[146:147], v[146:147], v[26:27]
 v_pk_fma_f32 v[30:31], v[178:179], v[178:179], v[30:31]
 v_pk_fma_f32 v[24:25], v[148:149], v[148:149], v[24:25]
 v_pk_fma_f32 v[28:29], v[180:181], v[180:181], v[28:29]
 v_pk_fma_f32 v[26:27], v[150:151], v[150:151], v[26:27]
 v_pk_fma_f32 v[30:31], v[182:183], v[182:183], v[30:31]
 v_pk_fma_f32 v[24:25], v[152:153], v[152:153], v[24:25]
 v_pk_fma_f32 v[28:29], v[184:185], v[184:185], v[28:29]
 v_pk_fma_f32 v[26:27], v[154:155], v[154:155], v[26:27]
 v_pk_fma_f32 v[30:31], v[186:187], v[186:187], v[30:31]
 v_pk_fma_f32 v[24:25], v[156:157], v[156:157], v[24:25]
 v_pk_fma_f32 v[28:29], v[188:189], v[188:189], v[28:29]
 v_pk_fma_f32 v[26:27], v[158:159], v[158:159], v[26:27]
 v_pk_fma_f32 v[30:31], v[190:191], v[190:191], v[30:31]
 v_pk_add_f32 v[24:25], v[24:25], v[26:27]
 v_pk_add_f32 v[28:29], v[28:29], v[30:31]
 v_add_f32 v24, v24, v25
 v_add_f32 v28, v28, v29
 s_nop 0
 v_add_f32_dpp v24, v24, v24 row_ror:8 row_mask:0xf bank_mask:0xf
 v_add_f32_dpp v28, v28, v28 row_ror:8 row_mask:0xf bank_mask:0xf
 s_nop 0
 v_add_f32_dpp v24, v24, v24 row_ror:4 row_mask:0xf bank_mask:0xf
 v_add_f32_dpp v28, v28, v28 row_ror:4 row_mask:0xf bank_mask:0xf
 s_nop 0
 v_add_f32_dpp v24, v24, v24 row_ror:2 row_mask:0xf bank_mask:0xf
 v_add_f32_dpp v28, v28, v28 row_ror:2 row_mask:0xf bank_mask:0xf
 s_nop 0
 v_add_f32_dpp v24, v24, v24 row_ror:1 row_mask:0xf bank_mask:0xf
 v_add_f32_dpp v28, v28, v28 row_ror:1 row_mask:0xf bank_mask:0xf
 v_mov_b32 v23, 925353388
 v_fmac_f32 v23, 989855744, v24
 v_rsq_f32 v24, v23
 v_mov_b32 v23, 925353388
 v_fmac_f32 v23, 989855744, v28
 v_rsq_f32 v28, v23
 s_nop 0
 v_pk_mul_f32 v[128:129], v[128:129], v[24:25] op_sel_hi:[1,0]
 v_pk_mul_f32 v[130:131], v[130:131], v[24:25] op_sel_hi:[1,0]
 v_pk_mul_f32 v[132:133], v[132:133], v[24:25] op_sel_hi:[1,0]
 v_pk_mul_f32 v[134:135], v[134:135], v[24:25] op_sel_hi:[1,0]
 v_pk_mul_f32 v[136:137], v[136:137], v[24:25] op_sel_hi:[1,0]
 v_pk_mul_f32 v[138:139], v[138:139], v[24:25] op_sel_hi:[1,0]
 v_pk_mul_f32 v[140:141], v[140:141], v[24:25] op_sel_hi:[1,0]
 v_pk_mul_f32 v[142:143], v[142:143], v[24:25] op_sel_hi:[1,0]
 v_pk_mul_f32 v[144:145], v[144:145], v[24:25] op_sel_hi:[1,0]
 v_pk_mul_f32 v[146:147], v[146:147], v[24:25] op_sel_hi:[1,0]
 v_pk_mul_f32 v[148:149], v[148:149], v[24:25] op_sel_hi:[1,0]
 v_pk_mul_f32 v[150:151], v[150:151], v[24:25] op_sel_hi:[1,0]
 v_pk_mul_f32 v[152:153], v[152:153], v[24:25] op_sel_hi:[1,0]
 v_pk_mul_f32 v[154:155], v[154:155], v[24:25] op_sel_hi:[1,0]
 v_pk_mul_f32 v[156:157], v[156:157], v[24:25] op_sel_hi:[1,0]
 v_pk_mul_f32 v[158:159], v[158:159], v[24:25] op_sel_hi:[1,0]
 v_pk_mul_f32 v[160:161], v[160:161], v[28:29] op_sel_hi:[1,0]
 v_pk_mul_f32 v[162:163], v[162:163], v[28:29] op_sel_hi:[1,0]
 v_pk_mul_f32 v[164:165], v[164:165], v[28:29] op_sel_hi:[1,0]
 v_pk_mul_f32 v[166:167], v[166:167], v[28:29] op_sel_hi:[1,0]
 v_pk_mul_f32 v[168:169], v[168:169], v[28:29] op_sel_hi:[1,0]
 v_pk_mul_f32 v[170:171], v[170:171], v[28:29] op_sel_hi:[1,0]
 v_pk_mul_f32 v[172:173], v[172:173], v[28:29] op_sel_hi:[1,0]
 v_pk_mul_f32 v[174:175], v[174:175], v[28:29] op_sel_hi:[1,0]
 v_pk_mul_f32 v[176:177], v[176:177], v[28:29] op_sel_hi:[1,0]
 v_pk_mul_f32 v[178:179], v[178:179], v[28:29] op_sel_hi:[1,0]
 v_pk_mul_f32 v[180:181], v[180:181], v[28:29] op_sel_hi:[1,0]
 v_pk_mul_f32 v[182:183], v[182:183], v[28:29] op_sel_hi:[1,0]
 v_pk_mul_f32 v[184:185], v[184:185], v[28:29] op_sel_hi:[1,0]
 v_pk_mul_f32 v[186:187], v[186:187], v[28:29] op_sel_hi:[1,0]
 v_pk_mul_f32 v[188:189], v[188:189], v[28:29] op_sel_hi:[1,0]
 v_pk_mul_f32 v[190:191], v[190:191], v[28:29] op_sel_hi:[1,0]
 s_waitcnt vmcnt(1)
 s_lshr_b32 s44, s2, 6
 s_or_b32 s44, s44, s3
 s_cbranch_scc0 L_xw1
 s_waitcnt vmcnt(0)
L_xw1:
 v_lshlrev_b32 v192, 16, v96
 v_and_b32 v193, 0xffff0000, v96
 v_lshlrev_b32 v194, 16, v97
 v_and_b32 v195, 0xffff0000, v97
 v_lshlrev_b32 v196, 16, v98
 v_and_b32 v197, 0xffff0000, v98
 v_lshlrev_b32 v198, 16, v99
 v_and_b32 v199, 0xffff0000, v99
 v_lshlrev_b32 v200, 16, v100
 v_and_b32 v201, 0xffff0000, v100
 v_lshlrev_b32 v202, 16, v101
 v_and_b32 v203, 0xffff0000, v101
 v_lshlrev_b32 v204, 16, v102
 v_and_b32 v205, 0xffff0000, v102
 v_lshlrev_b32 v206, 16, v103
 v_and_b32 v207, 0xffff0000, v103
 v_lshlrev_b32 v208, 16, v104
 v_and_b32 v209, 0xffff0000, v104
 v_lshlrev_b32 v210, 16, v105
 v_and_b32 v211, 0xffff0000, v105
 v_lshlrev_b32 v212, 16, v106
 v_and_b32 v213, 0xffff0000, v106
 v_lshlrev_b32 v214, 16, v107
 v_and_b32 v215, 0xffff0000, v107
 v_lshlrev_b32 v216, 16, v108
 v_and_b32 v217, 0xffff0000, v108
 v_lshlrev_b32 v218, 16, v109
 v_and_b32 v219, 0xffff0000, v109
 v_lshlrev_b32 v220, 16, v110
 v_and_b32 v221, 0xffff0000, v110
 v_lshlrev_b32 v222, 16, v111
 v_and_b32 v223, 0xffff0000, v111
 v_lshlrev_b32 v224, 16, v112
 v_and_b32 v225, 0xffff0000, v112
 v_lshlrev_b32 v226, 16, v113
 v_and_b32 v227, 0xffff0000, v113
 v_lshlrev_b32 v228, 16, v114
 v_and_b32 v229, 0xffff0000, v114
 v_lshlrev_b32 v230, 16, v115
 v_and_b32 v231, 0xffff0000, v115
 v_lshlrev_b32 v232, 16, v116
 v_and_b32 v233, 0xffff0000, v116
 v_lshlrev_b32 v234, 16, v117
 v_and_b32 v235, 0xffff0000, v117
 v_lshlrev_b32 v236, 16, v118
 v_and_b32 v237, 0xffff0000, v118
 v_lshlrev_b32 v238, 16, v119
 v_and_b32 v239, 0xffff0000, v119
 v_lshlrev_b32 v240, 16, v120
 v_and_b32 v241, 0xffff0000, v120
 v_lshlrev_b32 v242, 16, v121
 v_and_b32 v243, 0xffff0000, v121
 v_lshlrev_b32 v244, 16, v122
 v_and_b32 v245, 0xffff0000, v122
 v_lshlrev_b32 v246, 16, v123
 v_and_b32 v247, 0xffff0000, v123
 v_lshlrev_b32 v248, 16, v124
 v_and_b32 v249, 0xffff0000, v124
 v_lshlrev_b32 v250, 16, v125
 v_and_b32 v251, 0xffff0000, v125
 v_lshlrev_b32 v252, 16, v126
 v_and_b32 v253, 0xffff0000, v126
 v_lshlrev_b32 v254, 16, v127
 v_and_b32 v255, 0xffff0000, v127
 v_lshrrev_b32 v24, 2, v1
 v_lshl_add_u32 v24, s3, 7, v24
 v_lshlrev_b32 v24, 1, v24
 s_mov_b32 s60, s80
 s_mov_b32 s61, s81
 s_mov_b32 s62, 1024
 s_mov_b32 s63, 0x20000
 buffer_load_ushort v36, v24, s[60:63], 0 offen offset:0
 buffer_load_ushort v37, v24, s[60:63], 0 offen offset:32
 buffer_load_ushort v38, v24, s[60:63], 0 offen offset:64
 buffer_load_ushort v39, v24, s[60:63], 0 offen offset:96
 buffer_load_ushort v40, v24, s[60:63], 0 offen offset:128
 buffer_load_ushort v41, v24, s[60:63], 0 offen offset:160
 buffer_load_ushort v42, v24, s[60:63], 0 offen offset:192
 buffer_load_ushort v43, v24, s[60:63], 0 offen offset:224
 s_lshl_b32 s42, s32, 10
 s_and_b32 s43, s3, 1
 v_lshl_add_u32 v24, s43, 6, v1
 s_cmp_ge_u32 s3, 2
 s_cselect_b32 s42, s42, 0x40000000
 v_and_b32 v25, 7, v24
 v_lshrrev_b32 v24, 3, v24
 s_mul_i32 s43, s101, 32
 v_add_u32 v24, s43, v24
 v_mul_u32_u24 v24, 8192, v24
 v_lshl_add_u32 v24, v25, 7, v24
 buffer_load_dword v14, v24, s[16:19], s42 offen
 v_add_u32 v24, 131072, v24
 buffer_load_dword v14, v24, s[16:19], s42 offen
 s_and_b32 s43, s3, 1
 v_lshl_add_u32 v24, s43, 6, v1
 v_lshlrev_b32 v24, 7, v24
 s_mul_i32 s41, s101, 4096
 s_cmp_ge_u32 s3, 2
 s_cselect_b32 s41, s41, 0x40000000
 v_min_u32 v24, 3968, v24
 buffer_load_dword v14, v24, s[8:11], s41 offen
 s_and_b32 s43, s3, 1
 v_lshl_add_u32 v24, s43, 6, v1
 v_lshlrev_b32 v24, 7, v24
 s_mul_i32 s41, s101, 3072
 s_cmp_ge_u32 s3, 2
 s_cselect_b32 s41, s41, 0x40000000
 v_min_u32 v24, 2944, v24
 buffer_load_dword v14, v24, s[12:15], s41 offen
 v_pk_add_f32 v[24:25], v[192:193], v[194:195]
 v_pk_add_f32 v[26:27], v[196:197], v[198:199]
 v_pk_add_f32 v[28:29], v[224:225], v[226:227]
 v_pk_add_f32 v[30:31], v[228:229], v[230:231]
 v_pk_add_f32 v[24:25], v[24:25], v[200:201]
 v_pk_add_f32 v[28:29], v[28:29], v[232:233]
 v_pk_add_f32 v[26:27], v[26:27], v[202:203]
 v_pk_add_f32 v[30:31], v[30:31], v[234:235]
 v_pk_add_f32 v[24:25], v[24:25], v[204:205]
 v_pk_add_f32 v[28:29], v[28:29], v[236:237]
 v_pk_add_f32 v[26:27], v[26:27], v[206:207]
 v_pk_add_f32 v[30:31], v[30:31], v[238:239]
 v_pk_add_f32 v[24:25], v[24:25], v[208:209]
 v_pk_add_f32 v[28:29], v[28:29], v[240:241]
 v_pk_add_f32 v[26:27], v[26:27], v[210:211]
 v_pk_add_f32 v[30:31], v[30:31], v[242:243]
 v_pk_add_f32 v[24:25], v[24:25], v[212:213]
 v_pk_add_f32 v[28:29], v[28:29], v[244:245]
 v_pk_add_f32 v[26:27], v[26:27], v[214:215]
 v_pk_add_f32 v[30:31], v[30:31], v[246:247]
 v_pk_add_f32 v[24:25], v[24:25], v[216:217]
 v_pk_add_f32 v[28:29], v[28:29], v[248:249]
 v_pk_add_f32 v[26:27], v[26:27], v[218:219]
 v_pk_add_f32 v[30:31], v[30:31], v[250:251]
 v_pk_add_f32 v[24:25], v[24:25], v[220:221]
 v_pk_add_f32 v[28:29], v[28:29], v[252:253]
 v_pk_add_f32 v[26:27], v[26:27], v[222:223]
 v_pk_add_f32 v[30:31], v[30:31], v[254:255]
 v_pk_add_f32 v[24:25], v[24:25], v[26:27]
 v_pk_add_f32 v[28:29], v[28:29], v[30:31]
 v_add_f32 v24, v24, v25
 v_add_f32 v28, v28, v29
 s_nop 0
 v_add_f32_dpp v24, v24, v24 row_ror:8 row_mask:0xf bank_mask:0xf
 v_add_f32_dpp v28, v28, v28 row_ror:8 row_mask:0xf bank_mask:0xf
 s_nop 0
 v_add_f32_dpp v24, v24, v24 row_ror:4 row_mask:0xf bank_mask:0xf
 v_add_f32_dpp v28, v28, v28 row_ror:4 row_mask:0xf bank_mask:0xf
 s_nop 0
 v_add_f32_dpp v24, v24, v24 row_ror:2 row_mask:0xf bank_mask:0xf
 v_add_f32_dpp v28, v28, v28 row_ror:2 row_mask:0xf bank_mask:0xf
 s_nop 0
 v_add_f32_dpp v24, v24, v24 row_ror:1 row_mask:0xf bank_mask:0xf
 v_add_f32_dpp v28, v28, v28 row_ror:1 row_mask:0xf bank_mask:0xf
 v_mul_f32 v24, 3137339392, v24
 v_mul_f32 v28, 3137339392, v28
 v_pk_add_f32 v[192:193], v[192:193], v[24:25] op_sel_hi:[1,0]
 v_pk_add_f32 v[224:225], v[224:225], v[28:29] op_sel_hi:[1,0]
 v_pk_add_f32 v[194:195], v[194:195], v[24:25] op_sel_hi:[1,0]
 v_pk_add_f32 v[226:227], v[226:227], v[28:29] op_sel_hi:[1,0]
 v_pk_add_f32 v[196:197], v[196:197], v[24:25] op_sel_hi:[1,0]
 v_pk_add_f32 v[228:229], v[228:229], v[28:29] op_sel_hi:[1,0]
 v_pk_add_f32 v[198:199], v[198:199], v[24:25] op_sel_hi:[1,0]
 v_pk_add_f32 v[230:231], v[230:231], v[28:29] op_sel_hi:[1,0]
 v_pk_add_f32 v[200:201], v[200:201], v[24:25] op_sel_hi:[1,0]
 v_pk_add_f32 v[232:233], v[232:233], v[28:29] op_sel_hi:[1,0]
 v_pk_add_f32 v[202:203], v[202:203], v[24:25] op_sel_hi:[1,0]
 v_pk_add_f32 v[234:235], v[234:235], v[28:29] op_sel_hi:[1,0]
 v_pk_add_f32 v[204:205], v[204:205], v[24:25] op_sel_hi:[1,0]
 v_pk_add_f32 v[236:237], v[236:237], v[28:29] op_sel_hi:[1,0]
 v_pk_add_f32 v[206:207], v[206:207], v[24:25] op_sel_hi:[1,0]
 v_pk_add_f32 v[238:239], v[238:239], v[28:29] op_sel_hi:[1,0]
 v_pk_add_f32 v[208:209], v[208:209], v[24:25] op_sel_hi:[1,0]
 v_pk_add_f32 v[240:241], v[240:241], v[28:29] op_sel_hi:[1,0]
 v_pk_add_f32 v[210:211], v[210:211], v[24:25] op_sel_hi:[1,0]
 v_pk_add_f32 v[242:243], v[242:243], v[28:29] op_sel_hi:[1,0]
 v_pk_add_f32 v[212:213], v[212:213], v[24:25] op_sel_hi:[1,0]
 v_pk_add_f32 v[244:245], v[244:245], v[28:29] op_sel_hi:[1,0]
 v_pk_add_f32 v[214:215], v[214:215], v[24:25] op_sel_hi:[1,0]
 v_pk_add_f32 v[246:247], v[246:247], v[28:29] op_sel_hi:[1,0]
 v_pk_add_f32 v[216:217], v[216:217], v[24:25] op_sel_hi:[1,0]
 v_pk_add_f32 v[248:249], v[248:249], v[28:29] op_sel_hi:[1,0]
 v_pk_add_f32 v[218:219], v[218:219], v[24:25] op_sel_hi:[1,0]
 v_pk_add_f32 v[250:251], v[250:251], v[28:29] op_sel_hi:[1,0]
 v_pk_add_f32 v[220:221], v[220:221], v[24:25] op_sel_hi:[1,0]
 v_pk_add_f32 v[252:253], v[252:253], v[28:29] op_sel_hi:[1,0]
 v_pk_add_f32 v[222:223], v[222:223], v[24:25] op_sel_hi:[1,0]
 v_pk_add_f32 v[254:255], v[254:255], v[28:29] op_sel_hi:[1,0]
 v_pk_mul_f32 v[24:25], v[192:193], v[192:193]
 v_pk_mul_f32 v[28:29], v[224:225], v[224:225]
 v_pk_mul_f32 v[26:27], v[194:195], v[194:195]
 v_pk_mul_f32 v[30:31], v[226:227], v[226:227]
 v_pk_fma_f32 v[24:25], v[196:197], v[196:197], v[24:25]
 v_pk_fma_f32 v[28:29], v[228:229], v[228:229], v[28:29]
 v_pk_fma_f32 v[26:27], v[198:199], v[198:199], v[26:27]
 v_pk_fma_f32 v[30:31], v[230:231], v[230:231], v[30:31]
 v_pk_fma_f32 v[24:25], v[200:201], v[200:201], v[24:25]
 v_pk_fma_f32 v[28:29], v[232:233], v[232:233], v[28:29]
 v_pk_fma_f32 v[26:27], v[202:203], v[202:203], v[26:27]
 v_pk_fma_f32 v[30:31], v[234:235], v[234:235], v[30:31]
 v_pk_fma_f32 v[24:25], v[204:205], v[204:205], v[24:25]
 v_pk_fma_f32 v[28:29], v[236:237], v[236:237], v[28:29]
 v_pk_fma_f32 v[26:27], v[206:207], v[206:207], v[26:27]
 v_pk_fma_f32 v[30:31], v[238:239], v[238:239], v[30:31]
 v_pk_fma_f32 v[24:25], v[208:209], v[208:209], v[24:25]
 v_pk_fma_f32 v[28:29], v[240:241], v[240:241], v[28:29]
 v_pk_fma_f32 v[26:27], v[210:211], v[210:211], v[26:27]
 v_pk_fma_f32 v[30:31], v[242:243], v[242:243], v[30:31]
 v_pk_fma_f32 v[24:25], v[212:213], v[212:213], v[24:25]
 v_pk_fma_f32 v[28:29], v[244:245], v[244:245], v[28:29]
 v_pk_fma_f32 v[26:27], v[214:215], v[214:215], v[26:27]
 v_pk_fma_f32 v[30:31], v[246:247], v[246:247], v[30:31]
 v_pk_fma_f32 v[24:25], v[216:217], v[216:217], v[24:25]
 v_pk_fma_f32 v[28:29], v[248:249], v[248:249], v[28:29]
 v_pk_fma_f32 v[26:27], v[218:219], v[218:219], v[26:27]
 v_pk_fma_f32 v[30:31], v[250:251], v[250:251], v[30:31]
 v_pk_fma_f32 v[24:25], v[220:221], v[220:221], v[24:25]
 v_pk_fma_f32 v[28:29], v[252:253], v[252:253], v[28:29]
 v_pk_fma_f32 v[26:27], v[222:223], v[222:223], v[26:27]
 v_pk_fma_f32 v[30:31], v[254:255], v[254:255], v[30:31]
 v_lshlrev_b32 v22, 6, v17
 s_cmp_ge_u32 s3, 2
 s_cbranch_scc1 L_nospec
  buffer_load_dword v16, off, s[56:59], 0 sc0 sc1
L_nospec:
 v_pk_add_f32 v[24:25], v[24:25], v[26:27]
 v_pk_add_f32 v[28:29], v[28:29], v[30:31]
 v_add_f32 v24, v24, v25
 v_add_f32 v28, v28, v29
 s_nop 0
 v_add_f32_dpp v24, v24, v24 row_ror:8 row_mask:0xf bank_mask:0xf
 v_add_f32_dpp v28, v28, v28 row_ror:8 row_mask:0xf bank_mask:0xf
 s_nop 0
 v_add_f32_dpp v24, v24, v24 row_ror:4 row_mask:0xf bank_mask:0xf
 v_add_f32_dpp v28, v28, v28 row_ror:4 row_mask:0xf bank_mask:0xf
 s_nop 0
 v_add_f32_dpp v24, v24, v24 row_ror:2 row_mask:0xf bank_mask:0xf
 v_add_f32_dpp v28, v28, v28 row_ror:2 row_mask:0xf bank_mask:0xf
 s_nop 0
 v_add_f32_dpp v24, v24, v24 row_ror:1 row_mask:0xf bank_mask:0xf
 v_add_f32_dpp v28, v28, v28 row_ror:1 row_mask:0xf bank_mask:0xf
 v_mov_b32 v23, 925353388
 v_fmac_f32 v23, 989855744, v24
 v_rsq_f32 v24, v23
 v_mov_b32 v23, 925353388
 v_fmac_f32 v23, 989855744, v28
 v_rsq_f32 v28, v23
 s_nop 0
 v_pk_mul_f32 v[192:193], v[192:193], v[24:25] op_sel_hi:[1,0]
 v_pk_mul_f32 v[194:195], v[194:195], v[24:25] op_sel_hi:[1,0]
 v_pk_mul_f32 v[196:197], v[196:197], v[24:25] op_sel_hi:[1,0]
 v_pk_mul_f32 v[198:199], v[198:199], v[24:25] op_sel_hi:[1,0]
 v_pk_mul_f32 v[200:201], v[200:201], v[24:25] op_sel_hi:[1,0]
 v_pk_mul_f32 v[202:203], v[202:203], v[24:25] op_sel_hi:[1,0]
 v_pk_mul_f32 v[204:205], v[204:205], v[24:25] op_sel_hi:[1,0]
 v_pk_mul_f32 v[206:207], v[206:207], v[24:25] op_sel_hi:[1,0]
 v_pk_mul_f32 v[208:209], v[208:209], v[24:25] op_sel_hi:[1,0]
 v_pk_mul_f32 v[210:211], v[210:211], v[24:25] op_sel_hi:[1,0]
 v_pk_mul_f32 v[212:213], v[212:213], v[24:25] op_sel_hi:[1,0]
 v_pk_mul_f32 v[214:215], v[214:215], v[24:25] op_sel_hi:[1,0]
 v_pk_mul_f32 v[216:217], v[216:217], v[24:25] op_sel_hi:[1,0]
 v_pk_mul_f32 v[218:219], v[218:219], v[24:25] op_sel_hi:[1,0]
 v_pk_mul_f32 v[220:221], v[220:221], v[24:25] op_sel_hi:[1,0]
 v_pk_mul_f32 v[222:223], v[222:223], v[24:25] op_sel_hi:[1,0]
 v_pk_mul_f32 v[224:225], v[224:225], v[28:29] op_sel_hi:[1,0]
 v_pk_mul_f32 v[226:227], v[226:227], v[28:29] op_sel_hi:[1,0]
 v_pk_mul_f32 v[228:229], v[228:229], v[28:29] op_sel_hi:[1,0]
 v_pk_mul_f32 v[230:231], v[230:231], v[28:29] op_sel_hi:[1,0]
 v_pk_mul_f32 v[232:233], v[232:233], v[28:29] op_sel_hi:[1,0]
 v_pk_mul_f32 v[234:235], v[234:235], v[28:29] op_sel_hi:[1,0]
 v_pk_mul_f32 v[236:237], v[236:237], v[28:29] op_sel_hi:[1,0]
 v_pk_mul_f32 v[238:239], v[238:239], v[28:29] op_sel_hi:[1,0]
 v_pk_mul_f32 v[240:241], v[240:241], v[28:29] op_sel_hi:[1,0]
 v_pk_mul_f32 v[242:243], v[242:243], v[28:29] op_sel_hi:[1,0]
 v_pk_mul_f32 v[244:245], v[244:245], v[28:29] op_sel_hi:[1,0]
 v_pk_mul_f32 v[246:247], v[246:247], v[28:29] op_sel_hi:[1,0]
 v_pk_mul_f32 v[248:249], v[248:249], v[28:29] op_sel_hi:[1,0]
 v_pk_mul_f32 v[250:251], v[250:251], v[28:29] op_sel_hi:[1,0]
 v_pk_mul_f32 v[252:253], v[252:253], v[28:29] op_sel_hi:[1,0]
 v_pk_mul_f32 v[254:255], v[254:255], v[28:29] op_sel_hi:[1,0]
 s_waitcnt vmcnt(4)
 v_lshlrev_b32 v36, 16, v36
 v_lshlrev_b32 v37, 16, v37
 v_lshlrev_b32 v38, 16, v38
 v_lshlrev_b32 v39, 16, v39
 v_lshlrev_b32 v40, 16, v40
 v_lshlrev_b32 v41, 16, v41
 v_lshlrev_b32 v42, 16, v42
 v_lshlrev_b32 v43, 16, v43
 v_mul_f32 v24, 3216550459, v36
 v_mul_f32 v25, 3216550459, v37
 v_mul_f32 v26, 3216550459, v38
 v_mul_f32 v27, 3216550459, v39
 v_mul_f32 v28, 3216550459, v40
 v_mul_f32 v29, 3216550459, v41
 v_mul_f32 v30, 3216550459, v42
 v_mul_f32 v31, 3216550459, v43
 v_exp_f32 v24, v24
 v_exp_f32 v25, v25
 v_exp_f32 v26, v26
 v_exp_f32 v27, v27
 v_exp_f32 v28, v28
 v_exp_f32 v29, v29
 v_exp_f32 v30, v30
 v_exp_f32 v31, v31
 v_add_f32 v24, 1.0, v24
 v_add_f32 v25, 1.0, v25
 v_add_f32 v26, 1.0, v26
 v_add_f32 v27, 1.0, v27
 v_add_f32 v28, 1.0, v28
 v_add_f32 v29, 1.0, v29
 v_add_f32 v30, 1.0, v30
 v_add_f32 v31, 1.0, v31
 v_rcp_f32 v24, v24
 v_rcp_f32 v25, v25
 v_rcp_f32 v26, v26
 v_rcp_f32 v27, v27
 v_rcp_f32 v28, v28
 v_rcp_f32 v29, v29
 v_rcp_f32 v30, v30
 v_rcp_f32 v31, v31
 v_mul_f32 v36, v36, v24
 v_mul_f32 v37, v37, v25
 v_mul_f32 v38, v38, v26
 v_mul_f32 v39, v39, v27
 v_mul_f32 v40, v40, v28
 v_mul_f32 v41, v41, v29
 v_mul_f32 v42, v42, v30
 v_mul_f32 v43, v43, v31
 v_cvt_pk_bf16_f32 v36, v36, v36
 v_cvt_pk_bf16_f32 v37, v37, v37
 v_cvt_pk_bf16_f32 v38, v38, v38
 v_cvt_pk_bf16_f32 v39, v39, v39
 v_cvt_pk_bf16_f32 v40, v40, v40
 v_cvt_pk_bf16_f32 v41, v41, v41
 v_cvt_pk_bf16_f32 v42, v42, v42
 v_cvt_pk_bf16_f32 v43, v43, v43
 v_and_b32 v36, 0xffff0000, v36
 v_and_b32 v37, 0xffff0000, v37
 v_and_b32 v38, 0xffff0000, v38
 v_and_b32 v39, 0xffff0000, v39
 v_and_b32 v40, 0xffff0000, v40
 v_and_b32 v41, 0xffff0000, v41
 v_and_b32 v42, 0xffff0000, v42
 v_and_b32 v43, 0xffff0000, v43
 v_accvgpr_write_b32 a0, v36
 v_accvgpr_write_b32 a1, v37
 v_accvgpr_write_b32 a2, v38
 v_accvgpr_write_b32 a3, v39
 v_accvgpr_write_b32 a4, v40
 v_accvgpr_write_b32 a5, v41
 v_accvgpr_write_b32 a6, v42
 v_accvgpr_write_b32 a7, v43
 v_and_b32 v24, 15, v1
 v_lshrrev_b32 v25, 4, v1
 v_xor_b32 v25, v25, v24
 v_lshlrev_b32 v24, 10, v24
 v_lshl_add_u32 v24, v25, 4, v24
 v_add_u32 v24, 65536, v24
 v_xor_b32 v2, 0, v24
 v_xor_b32 v3, 64, v24
 v_xor_b32 v4, 128, v24
 v_xor_b32 v5, 192, v24
 v_lshrrev_b32 v24, 4, v1
 v_bfe_u32 v25, v1, 2, 2
 v_lshlrev_b32 v26, 11, v24
 v_lshl_add_u32 v26, v25, 8, v26
 v_and_b32 v24, 1, v24
 v_lshl_add_u32 v24, v24, 2, v25
 v_bfe_u32 v25, v1, 1, 1
 v_lshl_add_u32 v24, v24, 1, v25
 v_lshl_add_u32 v26, v24, 4, v26
 v_and_b32 v24, 1, v1
 v_lshl_add_u32 v26, v24, 3, v26
 v_xor_b32 v24, 0, v26
 v_add_u32 v48, s39, v24
 v_add_u32 v56, s40, v24
 v_xor_b32 v24, 32, v26
 v_add_u32 v49, s39, v24
 v_add_u32 v57, s40, v24
 v_xor_b32 v24, 64, v26
 v_add_u32 v50, s39, v24
 v_add_u32 v58, s40, v24
 v_xor_b32 v24, 96, v26
 v_add_u32 v51, s39, v24
 v_add_u32 v59, s40, v24
 v_xor_b32 v24, 128, v26
 v_add_u32 v52, s39, v24
 v_add_u32 v60, s40, v24
 v_xor_b32 v24, 160, v26
 v_add_u32 v53, s39, v24
 v_add_u32 v61, s40, v24
 v_xor_b32 v24, 192, v26
 v_add_u32 v54, s39, v24
 v_add_u32 v62, s40, v24
 v_xor_b32 v24, 224, v26
 v_add_u32 v55, s39, v24
 v_add_u32 v63, s40, v24
 s_lshl_b32 s47, s3, 14
 s_add_u32 s47, s47, 65536
 v_add_u32 v24, s97, v18
 v_xor_b32 v25, v24, v19
 v_lshlrev_b32 v24, 10, v24
 v_lshl_add_u32 v24, v25, 4, v24
 v_add_u32 v32, s47, v24
 v_add_u32 v24, s98, v18
 v_xor_b32 v25, v24, v19
 v_lshlrev_b32 v24, 10, v24
 v_lshl_add_u32 v24, v25, 4, v24
 v_add_u32 v33, s47, v24
 v_add_u32 v24, s99, v18
 v_xor_b32 v25, v24, v19
 v_lshlrev_b32 v24, 10, v24
 v_lshl_add_u32 v24, v25, 4, v24
 v_add_u32 v34, s47, v24
 v_add_u32 v24, s100, v18
 v_xor_b32 v25, v24, v19
 v_lshlrev_b32 v24, 10, v24
 v_lshl_add_u32 v24, v25, 4, v24
 v_add_u32 v35, s47, v24
 v_accvgpr_write_b32 a8, 0
 v_accvgpr_write_b32 a9, 0
 v_accvgpr_write_b32 a10, 0
 v_accvgpr_write_b32 a11, 0
 v_accvgpr_write_b32 a12, 0
 v_accvgpr_write_b32 a13, 0
 v_accvgpr_write_b32 a14, 0
 v_accvgpr_write_b32 a15, 0
 v_accvgpr_write_b32 a16, 0
 v_accvgpr_write_b32 a17, 0
 v_accvgpr_write_b32 a18, 0
 v_accvgpr_write_b32 a19, 0
 v_accvgpr_write_b32 a20, 0
 v_accvgpr_write_b32 a21, 0
 v_accvgpr_write_b32 a22, 0
 v_accvgpr_write_b32 a23, 0
 v_accvgpr_write_b32 a24, 0
 v_accvgpr_write_b32 a25, 0
 v_accvgpr_write_b32 a26, 0
 v_accvgpr_write_b32 a27, 0
 v_accvgpr_write_b32 a28, 0
 v_accvgpr_write_b32 a29, 0
 v_accvgpr_write_b32 a30, 0
 v_accvgpr_write_b32 a31, 0
 v_accvgpr_write_b32 a32, 0
 v_accvgpr_write_b32 a33, 0
 v_accvgpr_write_b32 a34, 0
 v_accvgpr_write_b32 a35, 0
 v_accvgpr_write_b32 a36, 0
 v_accvgpr_write_b32 a37, 0
 v_accvgpr_write_b32 a38, 0
 v_accvgpr_write_b32 a39, 0
 v_accvgpr_write_b32 a40, 0
 v_accvgpr_write_b32 a41, 0
 v_accvgpr_write_b32 a42, 0
 v_accvgpr_write_b32 a43, 0
 v_accvgpr_write_b32 a44, 0
 v_accvgpr_write_b32 a45, 0
 v_accvgpr_write_b32 a46, 0
 v_accvgpr_write_b32 a47, 0
 v_accvgpr_write_b32 a48, 0
 v_accvgpr_write_b32 a49, 0
 v_accvgpr_write_b32 a50, 0
 v_accvgpr_write_b32 a51, 0
 v_accvgpr_write_b32 a52, 0
 v_accvgpr_write_b32 a53, 0
 v_accvgpr_write_b32 a54, 0
 v_accvgpr_write_b32 a55, 0
 v_accvgpr_write_b32 a56, 0
 v_accvgpr_write_b32 a57, 0
 v_accvgpr_write_b32 a58, 0
 v_accvgpr_write_b32 a59, 0
 v_accvgpr_write_b32 a60, 0
 v_accvgpr_write_b32 a61, 0
 v_accvgpr_write_b32 a62, 0
 v_accvgpr_write_b32 a63, 0
 v_accvgpr_write_b32 a64, 0
 v_accvgpr_write_b32 a65, 0
 v_accvgpr_write_b32 a66, 0
 v_accvgpr_write_b32 a67, 0
 v_accvgpr_write_b32 a68, 0
 v_accvgpr_write_b32 a69, 0
 v_accvgpr_write_b32 a70, 0
 v_accvgpr_write_b32 a71, 0
 v_accvgpr_write_b32 a72, 0
 v_accvgpr_write_b32 a73, 0
 v_accvgpr_write_b32 a74, 0
 v_accvgpr_write_b32 a75, 0
 v_accvgpr_write_b32 a76, 0
 v_accvgpr_write_b32 a77, 0
 v_accvgpr_write_b32 a78, 0
 v_accvgpr_write_b32 a79, 0
 v_accvgpr_write_b32 a80, 0
 v_accvgpr_write_b32 a81, 0
 v_accvgpr_write_b32 a82, 0
 v_accvgpr_write_b32 a83, 0
 v_accvgpr_write_b32 a84, 0
 v_accvgpr_write_b32 a85, 0
 v_accvgpr_write_b32 a86, 0
 v_accvgpr_write_b32 a87, 0
 v_accvgpr_write_b32 a88, 0
 v_accvgpr_write_b32 a89, 0
 v_accvgpr_write_b32 a90, 0
 v_accvgpr_write_b32 a91, 0
 v_accvgpr_write_b32 a92, 0
 v_accvgpr_write_b32 a93, 0
 v_accvgpr_write_b32 a94, 0
 v_accvgpr_write_b32 a95, 0
 v_accvgpr_write_b32 a96, 0
 v_accvgpr_write_b32 a97, 0
 v_accvgpr_write_b32 a98, 0
 v_accvgpr_write_b32 a99, 0
 v_accvgpr_write_b32 a100, 0
 v_accvgpr_write_b32 a101, 0
 v_accvgpr_write_b32 a102, 0
 v_accvgpr_write_b32 a103, 0
 v_accvgpr_write_b32 a104, 0
 v_accvgpr_write_b32 a105, 0
 v_accvgpr_write_b32 a106, 0
 v_accvgpr_write_b32 a107, 0
 v_accvgpr_write_b32 a108, 0
 v_accvgpr_write_b32 a109, 0
 v_accvgpr_write_b32 a110, 0
 v_accvgpr_write_b32 a111, 0
 v_accvgpr_write_b32 a112, 0
 v_accvgpr_write_b32 a113, 0
 v_accvgpr_write_b32 a114, 0
 v_accvgpr_write_b32 a115, 0
 v_accvgpr_write_b32 a116, 0
 v_accvgpr_write_b32 a117, 0
 v_accvgpr_write_b32 a118, 0
 v_accvgpr_write_b32 a119, 0
 v_accvgpr_write_b32 a120, 0
 v_accvgpr_write_b32 a121, 0
 v_accvgpr_write_b32 a122, 0
 v_accvgpr_write_b32 a123, 0
 v_accvgpr_write_b32 a124, 0
 v_accvgpr_write_b32 a125, 0
 v_accvgpr_write_b32 a126, 0
 v_accvgpr_write_b32 a127, 0
 s_cmp_ge_u32 s3, 2
 s_cbranch_scc1 L_twave
  s_mov_b32 s38, 0x100000
L_nn_p:
  s_waitcnt vmcnt(0)
  v_readfirstlane_b32 s94, v16
  s_sub_u32 s38, s38, 1
  s_cbranch_scc1 L_nx_p
  s_cmp_lg_u32 s94, 0
  s_cbranch_scc1 L_nx_p
  buffer_load_dword v16, off, s[56:59], 0 sc0 sc1
  s_branch L_nn_p
L_nx_p:
 s_mov_b32 s38, 0x100000
L_pm:
  s_mov_b32 s43, 0
  buffer_load_dwordx4 v[64:67], v22, s[24:27], s43 offen offset:0 sc0 sc1
  buffer_load_dwordx4 v[68:71], v22, s[24:27], s43 offen offset:16 sc0 sc1
  buffer_load_dwordx4 v[72:75], v22, s[24:27], s43 offen offset:32 sc0 sc1
  buffer_load_dwordx4 v[76:79], v22, s[24:27], s43 offen offset:48 sc0 sc1
  s_mov_b32 s43, 8192
  buffer_load_dwordx4 v[80:83], v22, s[24:27], s43 offen offset:0 sc0 sc1
  buffer_load_dwordx4 v[84:87], v22, s[24:27], s43 offen offset:16 sc0 sc1
  buffer_load_dwordx4 v[88:91], v22, s[24:27], s43 offen offset:32 sc0 sc1
  buffer_load_dwordx4 v[92:95], v22, s[24:27], s43 offen offset:48 sc0 sc1
L_pm1:
 s_sub_u32 s38, s38, 1
 s_cbranch_scc1 L_pmx
  s_waitcnt vmcnt(0)
 v_xor_b32 v25, v16, v65
 v_xor_b32 v26, v16, v67
 v_or_b32 v24, v25, v26
 v_xor_b32 v25, v16, v69
 v_xor_b32 v26, v16, v71
 v_or3_b32 v24, v24, v25, v26
 v_xor_b32 v25, v16, v73
 v_xor_b32 v26, v16, v75
 v_or3_b32 v24, v24, v25, v26
 v_xor_b32 v25, v16, v77
 v_xor_b32 v26, v16, v79
 v_or3_b32 v24, v24, v25, v26
 v_xor_b32 v25, v16, v81
 v_xor_b32 v26, v16, v83
 v_or3_b32 v24, v24, v25, v26
 v_xor_b32 v25, v16, v85
 v_xor_b32 v26, v16, v87
 v_or3_b32 v24, v24, v25, v26
 v_xor_b32 v25, v16, v89
 v_xor_b32 v26, v16, v91
 v_or3_b32 v24, v24, v25, v26
 v_xor_b32 v25, v16, v93
 v_xor_b32 v26, v16, v95
 v_or3_b32 v24, v24, v25, v26
 v_cmp_ne_u32 vcc, 0, v24
 s_cbranch_vccnz L_pm
L_pmx:
  s_mov_b32 s52, 0
  s_add_u32 m0, s39, 0
  s_nop 0
  buffer_load_dwordx4 v6, s[16:19], s52 offen offset:0 lds
  buffer_load_dwordx4 v7, s[16:19], s52 offen offset:1024 lds
  buffer_load_dwordx4 v8, s[16:19], s52 offen offset:2048 lds
  buffer_load_dwordx4 v9, s[16:19], s52 offen offset:3072 lds
  s_add_u32 m0, s39, 4096
  s_nop 0
  buffer_load_dwordx4 v10, s[16:19], s52 offen offset:0 lds
  buffer_load_dwordx4 v11, s[16:19], s52 offen offset:1024 lds
  buffer_load_dwordx4 v12, s[16:19], s52 offen offset:2048 lds
  buffer_load_dwordx4 v13, s[16:19], s52 offen offset:3072 lds
 s_cmp_eq_u32 s3, 1
 s_cselect_b32 s42, 1.0, 0
 v_add_f32 v64, v64, v80
 v_add_f32 v66, v66, v82
 v_cvt_pk_bf16_f32 v64, v64, v66
 v_and_b32 v66, 0xffff0000, v64
 v_lshlrev_b32 v64, 16, v64
 v_add_f32 v64, s42, v64
 v_add_f32 v66, s42, v66
 v_cvt_pk_bf16_f32 v64, v64, v66
 v_and_b32 v25, 0xffff0000, v64
 v_lshlrev_b32 v24, 16, v64
 v_add_f32 v68, v68, v84
 v_add_f32 v70, v70, v86
 v_cvt_pk_bf16_f32 v68, v68, v70
 v_and_b32 v70, 0xffff0000, v68
 v_lshlrev_b32 v68, 16, v68
 v_add_f32 v68, s42, v68
 v_add_f32 v70, s42, v70
 v_cvt_pk_bf16_f32 v68, v68, v70
 v_and_b32 v27, 0xffff0000, v68
 v_lshlrev_b32 v26, 16, v68
 v_add_f32 v72, v72, v88
 v_add_f32 v74, v74, v90
 v_cvt_pk_bf16_f32 v72, v72, v74
 v_and_b32 v74, 0xffff0000, v72
 v_lshlrev_b32 v72, 16, v72
 v_add_f32 v72, s42, v72
 v_add_f32 v74, s42, v74
 v_cvt_pk_bf16_f32 v72, v72, v74
 v_and_b32 v29, 0xffff0000, v72
 v_lshlrev_b32 v28, 16, v72
 v_add_f32 v76, v76, v92
 v_add_f32 v78, v78, v94
 v_cvt_pk_bf16_f32 v76, v76, v78
 v_and_b32 v78, 0xffff0000, v76
 v_lshlrev_b32 v76, 16, v76
 v_add_f32 v76, s42, v76
 v_add_f32 v78, s42, v78
 v_cvt_pk_bf16_f32 v76, v76, v78
 v_and_b32 v31, 0xffff0000, v76
 v_lshlrev_b32 v30, 16, v76
 s_mov_b32 s41, 1040356334
 v_mul_f32 v24, s41, v24
 v_mul_f32 v25, s41, v25
 v_mul_f32 v26, s41, v26
 v_mul_f32 v27, s41, v27
 v_mul_f32 v28, s41, v28
 v_mul_f32 v29, s41, v29
 v_mul_f32 v30, s41, v30
 v_mul_f32 v31, s41, v31
 v_lshrrev_b32 v22, 1, v22
 v_add_u32 v22, 32768, v22
  ds_write_b128 v22, v[24:27]
  ds_write_b128 v22, v[28:31] offset:16
  v_mov_b32 v22, 32768
  ds_write_b32 v22, v16 offset:4096
  s_waitcnt lgkmcnt(0)
 s_branch L_pjoin
L_twave:
 s_mov_b32 s52, 0
 s_add_u32 m0, s39, 0
 s_nop 0
 buffer_load_dwordx4 v6, s[16:19], s52 offen offset:0 lds
 buffer_load_dwordx4 v7, s[16:19], s52 offen offset:1024 lds
 buffer_load_dwordx4 v8, s[16:19], s52 offen offset:2048 lds
 buffer_load_dwordx4 v9, s[16:19], s52 offen offset:3072 lds
 s_add_u32 m0, s39, 4096
 s_nop 0
 buffer_load_dwordx4 v10, s[16:19], s52 offen offset:0 lds
 buffer_load_dwordx4 v11, s[16:19], s52 offen offset:1024 lds
 buffer_load_dwordx4 v12, s[16:19], s52 offen offset:2048 lds
 buffer_load_dwordx4 v13, s[16:19], s52 offen offset:3072 lds
L_pjoin:
 s_barrier
 v_mov_b32 v22, 32768
 ds_read_b32 v16, v22 offset:4096
 v_add_u32 v21, 32768, v21
 ds_read_b128 v[64:67], v21 offset:0
 ds_read_b128 v[68:71], v21 offset:16
 ds_read_b128 v[96:99], v21 offset:2048
 ds_read_b128 v[100:103], v21 offset:2064
 ds_read_b128 v[72:75], v21 offset:512
 ds_read_b128 v[76:79], v21 offset:528
 ds_read_b128 v[104:107], v21 offset:2560
 ds_read_b128 v[108:111], v21 offset:2576
 ds_read_b128 v[80:83], v21 offset:1024
 ds_read_b128 v[84:87], v21 offset:1040
 ds_read_b128 v[112:115], v21 offset:3072
 ds_read_b128 v[116:119], v21 offset:3088
 s_waitcnt lgkmcnt(8)
 v_readfirstlane_b32 s94, v16
 ds_read_b128 v[88:91], v21 offset:1536
 ds_read_b128 v[92:95], v21 offset:1552
 ds_read_b128 v[120:123], v21 offset:3584
 ds_read_b128 v[124:127], v21 offset:3600
 v_pk_fma_f32 v[128:129], v[128:129], v[96:97], v[64:65]
 v_pk_fma_f32 v[130:131], v[130:131], v[98:99], v[66:67]
 v_pk_fma_f32 v[132:133], v[132:133], v[100:101], v[68:69]
 v_pk_fma_f32 v[134:135], v[134:135], v[102:103], v[70:71]
 s_mov_b32 s53, 262144
 s_add_u32 m0, s40, 0
 s_nop 0
 v_cvt_pk_bf16_f32 v36, v128, v129
 v_cvt_pk_bf16_f32 v37, v130, v131
 v_cvt_pk_bf16_f32 v38, v132, v133
 v_cvt_pk_bf16_f32 v39, v134, v135
 ds_write_b128 v32, v[36:39] offset:0
 v_pk_fma_f32 v[160:161], v[160:161], v[96:97], v[64:65]
 v_pk_fma_f32 v[162:163], v[162:163], v[98:99], v[66:67]
 v_pk_fma_f32 v[164:165], v[164:165], v[100:101], v[68:69]
 v_pk_fma_f32 v[166:167], v[166:167], v[102:103], v[70:71]
 buffer_load_dwordx4 v6, s[16:19], s53 offen offset:0 lds
 v_cvt_pk_bf16_f32 v40, v160, v161
 v_cvt_pk_bf16_f32 v41, v162, v163
 v_cvt_pk_bf16_f32 v42, v164, v165
 v_cvt_pk_bf16_f32 v43, v166, v167
 ds_write_b128 v33, v[40:43] offset:0
 v_pk_fma_f32 v[192:193], v[192:193], v[96:97], v[64:65]
 v_pk_fma_f32 v[194:195], v[194:195], v[98:99], v[66:67]
 v_pk_fma_f32 v[196:197], v[196:197], v[100:101], v[68:69]
 v_pk_fma_f32 v[198:199], v[198:199], v[102:103], v[70:71]
 buffer_load_dwordx4 v7, s[16:19], s53 offen offset:1024 lds
 v_cvt_pk_bf16_f32 v44, v192, v193
 v_cvt_pk_bf16_f32 v45, v194, v195
 v_cvt_pk_bf16_f32 v46, v196, v197
 v_cvt_pk_bf16_f32 v47, v198, v199
 ds_write_b128 v34, v[44:47] offset:0
 v_pk_fma_f32 v[224:225], v[224:225], v[96:97], v[64:65]
 v_pk_fma_f32 v[226:227], v[226:227], v[98:99], v[66:67]
 v_pk_fma_f32 v[228:229], v[228:229], v[100:101], v[68:69]
 v_pk_fma_f32 v[230:231], v[230:231], v[102:103], v[70:71]
 buffer_load_dwordx4 v8, s[16:19], s53 offen offset:2048 lds
 v_cvt_pk_bf16_f32 v36, v224, v225
 v_cvt_pk_bf16_f32 v37, v226, v227
 v_cvt_pk_bf16_f32 v38, v228, v229
 v_cvt_pk_bf16_f32 v39, v230, v231
 ds_write_b128 v35, v[36:39] offset:0
 s_waitcnt lgkmcnt(12)
 v_pk_fma_f32 v[136:137], v[136:137], v[104:105], v[72:73]
 v_pk_fma_f32 v[138:139], v[138:139], v[106:107], v[74:75]
 v_pk_fma_f32 v[140:141], v[140:141], v[108:109], v[76:77]
 v_pk_fma_f32 v[142:143], v[142:143], v[110:111], v[78:79]
 buffer_load_dwordx4 v9, s[16:19], s53 offen offset:3072 lds
 s_add_u32 m0, s40, 4096
 s_nop 0
 v_cvt_pk_bf16_f32 v40, v136, v137
 v_cvt_pk_bf16_f32 v41, v138, v139
 v_cvt_pk_bf16_f32 v42, v140, v141
 v_cvt_pk_bf16_f32 v43, v142, v143
 ds_write_b128 v32, v[40:43] offset:256
 v_pk_fma_f32 v[168:169], v[168:169], v[104:105], v[72:73]
 v_pk_fma_f32 v[170:171], v[170:171], v[106:107], v[74:75]
 v_pk_fma_f32 v[172:173], v[172:173], v[108:109], v[76:77]
 v_pk_fma_f32 v[174:175], v[174:175], v[110:111], v[78:79]
 buffer_load_dwordx4 v10, s[16:19], s53 offen offset:0 lds
 v_cvt_pk_bf16_f32 v44, v168, v169
 v_cvt_pk_bf16_f32 v45, v170, v171
 v_cvt_pk_bf16_f32 v46, v172, v173
 v_cvt_pk_bf16_f32 v47, v174, v175
 ds_write_b128 v33, v[44:47] offset:256
 v_pk_fma_f32 v[200:201], v[200:201], v[104:105], v[72:73]
 v_pk_fma_f32 v[202:203], v[202:203], v[106:107], v[74:75]
 v_pk_fma_f32 v[204:205], v[204:205], v[108:109], v[76:77]
 v_pk_fma_f32 v[206:207], v[206:207], v[110:111], v[78:79]
 buffer_load_dwordx4 v11, s[16:19], s53 offen offset:1024 lds
 v_cvt_pk_bf16_f32 v36, v200, v201
 v_cvt_pk_bf16_f32 v37, v202, v203
 v_cvt_pk_bf16_f32 v38, v204, v205
 v_cvt_pk_bf16_f32 v39, v206, v207
 ds_write_b128 v34, v[36:39] offset:256
 v_pk_fma_f32 v[232:233], v[232:233], v[104:105], v[72:73]
 v_pk_fma_f32 v[234:235], v[234:235], v[106:107], v[74:75]
 v_pk_fma_f32 v[236:237], v[236:237], v[108:109], v[76:77]
 v_pk_fma_f32 v[238:239], v[238:239], v[110:111], v[78:79]
 buffer_load_dwordx4 v12, s[16:19], s53 offen offset:2048 lds
 v_cvt_pk_bf16_f32 v40, v232, v233
 v_cvt_pk_bf16_f32 v41, v234, v235
 v_cvt_pk_bf16_f32 v42, v236, v237
 v_cvt_pk_bf16_f32 v43, v238, v239
 ds_write_b128 v35, v[40:43] offset:256
 s_waitcnt lgkmcnt(12)
 v_pk_fma_f32 v[144:145], v[144:145], v[112:113], v[80:81]
 v_pk_fma_f32 v[146:147], v[146:147], v[114:115], v[82:83]
 v_pk_fma_f32 v[148:149], v[148:149], v[116:117], v[84:85]
 v_pk_fma_f32 v[150:151], v[150:151], v[118:119], v[86:87]
 buffer_load_dwordx4 v13, s[16:19], s53 offen offset:3072 lds
 v_cvt_pk_bf16_f32 v44, v144, v145
 v_cvt_pk_bf16_f32 v45, v146, v147
 v_cvt_pk_bf16_f32 v46, v148, v149
 v_cvt_pk_bf16_f32 v47, v150, v151
 ds_write_b128 v32, v[44:47] offset:512
 v_pk_fma_f32 v[176:177], v[176:177], v[112:113], v[80:81]
 v_pk_fma_f32 v[178:179], v[178:179], v[114:115], v[82:83]
 v_pk_fma_f32 v[180:181], v[180:181], v[116:117], v[84:85]
 v_pk_fma_f32 v[182:183], v[182:183], v[118:119], v[86:87]
 v_cvt_pk_bf16_f32 v36, v176, v177
 v_cvt_pk_bf16_f32 v37, v178, v179
 v_cvt_pk_bf16_f32 v38, v180, v181
 v_cvt_pk_bf16_f32 v39, v182, v183
 ds_write_b128 v33, v[36:39] offset:512
 v_pk_fma_f32 v[208:209], v[208:209], v[112:113], v[80:81]
 v_pk_fma_f32 v[210:211], v[210:211], v[114:115], v[82:83]
 v_pk_fma_f32 v[212:213], v[212:213], v[116:117], v[84:85]
 v_pk_fma_f32 v[214:215], v[214:215], v[118:119], v[86:87]
 v_cvt_pk_bf16_f32 v40, v208, v209
 v_cvt_pk_bf16_f32 v41, v210, v211
 v_cvt_pk_bf16_f32 v42, v212, v213
 v_cvt_pk_bf16_f32 v43, v214, v215
 ds_write_b128 v34, v[40:43] offset:512
 v_pk_fma_f32 v[240:241], v[240:241], v[112:113], v[80:81]
 v_pk_fma_f32 v[242:243], v[242:243], v[114:115], v[82:83]
 v_pk_fma_f32 v[244:245], v[244:245], v[116:117], v[84:85]
 v_pk_fma_f32 v[246:247], v[246:247], v[118:119], v[86:87]
 s_waitcnt vmcnt(8)
 ds_read_b64_tr_b16 a[128:129], v48 offset:0
 ds_read_b64_tr_b16 a[130:131], v48 offset:1024
 ds_read_b64_tr_b16 a[132:133], v49 offset:0
 ds_read_b64_tr_b16 a[134:135], v49 offset:1024
 v_cvt_pk_bf16_f32 v44, v240, v241
 v_cvt_pk_bf16_f32 v45, v242, v243
 v_cvt_pk_bf16_f32 v46, v244, v245
 v_cvt_pk_bf16_f32 v47, v246, v247
 ds_write_b128 v35, v[44:47] offset:512
 s_waitcnt lgkmcnt(15)
 v_pk_fma_f32 v[152:153], v[152:153], v[120:121], v[88:89]
 v_pk_fma_f32 v[154:155], v[154:155], v[122:123], v[90:91]
 v_pk_fma_f32 v[156:157], v[156:157], v[124:125], v[92:93]
 v_pk_fma_f32 v[158:159], v[158:159], v[126:127], v[94:95]
 ds_read_b64_tr_b16 a[136:137], v50 offset:0
 ds_read_b64_tr_b16 a[138:139], v50 offset:1024
 ds_read_b64_tr_b16 a[140:141], v51 offset:0
 ds_read_b64_tr_b16 a[142:143], v51 offset:1024
 v_cvt_pk_bf16_f32 v36, v152, v153
 v_cvt_pk_bf16_f32 v37, v154, v155
 v_cvt_pk_bf16_f32 v38, v156, v157
 v_cvt_pk_bf16_f32 v39, v158, v159
 ds_write_b128 v32, v[36:39] offset:768
 v_pk_fma_f32 v[184:185], v[184:185], v[120:121], v[88:89]
 v_pk_fma_f32 v[186:187], v[186:187], v[122:123], v[90:91]
 v_pk_fma_f32 v[188:189], v[188:189], v[124:125], v[92:93]
 v_pk_fma_f32 v[190:191], v[190:191], v[126:127], v[94:95]
 ds_read_b64_tr_b16 a[144:145], v52 offset:0
 ds_read_b64_tr_b16 a[146:147], v52 offset:1024
 ds_read_b64_tr_b16 a[148:149], v53 offset:0
 ds_read_b64_tr_b16 a[150:151], v53 offset:1024
 v_cvt_pk_bf16_f32 v40, v184, v185
 v_cvt_pk_bf16_f32 v41, v186, v187
 v_cvt_pk_bf16_f32 v42, v188, v189
 v_cvt_pk_bf16_f32 v43, v190, v191
 ds_write_b128 v33, v[40:43] offset:768
 v_pk_fma_f32 v[216:217], v[216:217], v[120:121], v[88:89]
 v_pk_fma_f32 v[218:219], v[218:219], v[122:123], v[90:91]
 v_pk_fma_f32 v[220:221], v[220:221], v[124:125], v[92:93]
 v_pk_fma_f32 v[222:223], v[222:223], v[126:127], v[94:95]
 ds_read_b64_tr_b16 a[152:153], v54 offset:0
 ds_read_b64_tr_b16 a[154:155], v54 offset:1024
 ds_read_b64_tr_b16 a[156:157], v55 offset:0
 ds_read_b64_tr_b16 a[158:159], v55 offset:1024
 v_cvt_pk_bf16_f32 v44, v216, v217
 v_cvt_pk_bf16_f32 v45, v218, v219
 v_cvt_pk_bf16_f32 v46, v220, v221
 v_cvt_pk_bf16_f32 v47, v222, v223
 ds_write_b128 v34, v[44:47] offset:768
 v_pk_fma_f32 v[248:249], v[248:249], v[120:121], v[88:89]
 v_pk_fma_f32 v[250:251], v[250:251], v[122:123], v[90:91]
 v_pk_fma_f32 v[252:253], v[252:253], v[124:125], v[92:93]
 v_pk_fma_f32 v[254:255], v[254:255], v[126:127], v[94:95]
 v_cvt_pk_bf16_f32 v36, v248, v249
 v_cvt_pk_bf16_f32 v37, v250, v251
 v_cvt_pk_bf16_f32 v38, v252, v253
 v_cvt_pk_bf16_f32 v39, v254, v255
 ds_write_b128 v35, v[36:39] offset:768
 s_waitcnt lgkmcnt(0)
 s_barrier
 ds_read_b128 a[224:227], v2 offset:0
 ds_read_b128 a[228:231], v2 offset:16384
 ds_read_b128 a[232:235], v2 offset:32768
 ds_read_b128 a[236:239], v2 offset:49152
 s_waitcnt lgkmcnt(0)
 v_mfma_f32_16x16x32_bf16 v[64:67], a[128:131], a[224:227], 0
 s_mov_b32 s52, 524288
 s_add_u32 m0, s40, 32768
 s_waitcnt vmcnt(0)
 ds_read_b64_tr_b16 a[160:161], v56 offset:0
 v_lshrrev_b32 v208, 2, v1
 v_mfma_f32_16x16x32_bf16 v[68:71], a[128:131], a[228:231], 0
 ds_read_b64_tr_b16 a[162:163], v56 offset:1024
 buffer_load_dwordx4 v6, s[16:19], s52 offen offset:0 lds
 v_and_b32 v209, 3, v1
 v_mfma_f32_16x16x32_bf16 v[72:75], a[128:131], a[232:235], 0
 ds_read_b64_tr_b16 a[164:165], v57 offset:0
 v_lshl_add_u32 v208, s3, 7, v208
 v_mfma_f32_16x16x32_bf16 v[76:79], a[128:131], a[236:239], 0
 buffer_load_dwordx4 v7, s[16:19], s52 offen offset:1024 lds
 v_mfma_f32_16x16x32_bf16 v[80:83], a[132:135], a[224:227], 0
 ds_read_b64_tr_b16 a[166:167], v57 offset:1024
 v_mul_u32_u24 v210, 6144, v208
 v_mfma_f32_16x16x32_bf16 v[84:87], a[132:135], a[228:231], 0
 ds_read_b64_tr_b16 a[168:169], v58 offset:0
 buffer_load_dwordx4 v8, s[16:19], s52 offen offset:2048 lds
 v_lshl_add_u32 v210, v209, 4, v210
 v_mfma_f32_16x16x32_bf16 v[88:91], a[132:135], a[232:235], 0
 ds_read_b64_tr_b16 a[170:171], v58 offset:1024
 s_mov_b32 s44, s96
 v_mfma_f32_16x16x32_bf16 v[92:95], a[132:135], a[236:239], 0
 buffer_load_dwordx4 v9, s[16:19], s52 offen offset:3072 lds
 s_add_u32 m0, s40, 36864
 v_mfma_f32_16x16x32_bf16 v[96:99], a[136:139], a[224:227], 0
 ds_read_b64_tr_b16 a[172:173], v59 offset:0
 s_mov_b32 s60, s82
 v_mfma_f32_16x16x32_bf16 v[100:103], a[136:139], a[228:231], 0
 ds_read_b64_tr_b16 a[174:175], v59 offset:1024
 buffer_load_dwordx4 v10, s[16:19], s52 offen offset:0 lds
 s_mov_b32 s61, s83
 v_mfma_f32_16x16x32_bf16 v[104:107], a[136:139], a[232:235], 0
 ds_read_b64_tr_b16 a[176:177], v60 offset:0
 s_mov_b32 s62, 3145728
 v_mfma_f32_16x16x32_bf16 v[108:111], a[136:139], a[236:239], 0
 buffer_load_dwordx4 v11, s[16:19], s52 offen offset:1024 lds
 v_mfma_f32_16x16x32_bf16 v[112:115], a[140:143], a[224:227], 0
 ds_read_b64_tr_b16 a[178:179], v60 offset:1024
 s_mov_b32 s63, 0x20000
 v_mfma_f32_16x16x32_bf16 v[116:119], a[140:143], a[228:231], 0
 ds_read_b64_tr_b16 a[180:181], v61 offset:0
 buffer_load_dwordx4 v[16:19], v210, s[60:63], s44 offen
 v_mfma_f32_16x16x32_bf16 v[120:123], a[140:143], a[232:235], 0
 ds_read_b64_tr_b16 a[182:183], v61 offset:1024
 s_add_u32 s44, s44, 98304
 v_mfma_f32_16x16x32_bf16 v[124:127], a[140:143], a[236:239], 0
 buffer_load_dwordx4 v12, s[16:19], s52 offen offset:2048 lds
 v_mfma_f32_16x16x32_bf16 v[128:131], a[144:147], a[224:227], 0
 ds_read_b64_tr_b16 a[184:185], v62 offset:0
 buffer_load_dwordx4 v[20:23], v210, s[60:63], s44 offen
 v_mfma_f32_16x16x32_bf16 v[132:135], a[144:147], a[228:231], 0
 ds_read_b64_tr_b16 a[186:187], v62 offset:1024
 s_add_u32 s44, s44, 98304
 v_mfma_f32_16x16x32_bf16 v[136:139], a[144:147], a[232:235], 0
 ds_read_b64_tr_b16 a[188:189], v63 offset:0
 buffer_load_dwordx4 v[24:27], v210, s[60:63], s44 offen
 v_mfma_f32_16x16x32_bf16 v[140:143], a[144:147], a[236:239], 0
 buffer_load_dwordx4 v13, s[16:19], s52 offen offset:3072 lds
 v_mfma_f32_16x16x32_bf16 v[144:147], a[148:151], a[224:227], 0
 s_mov_b32 s53, 786432
 s_add_u32 m0, s39, 0
 ds_read_b64_tr_b16 a[190:191], v63 offset:1024
 s_add_u32 s44, s44, 98304
 v_mfma_f32_16x16x32_bf16 v[148:151], a[148:151], a[228:231], 0
 ds_read_b128 a[240:243], v3 offset:0
 buffer_load_dwordx4 v[28:31], v210, s[60:63], s44 offen
 v_mfma_f32_16x16x32_bf16 v[152:155], a[148:151], a[232:235], 0
 ds_read_b128 a[244:247], v3 offset:16384
 s_add_u32 s44, s44, 98304
 v_mfma_f32_16x16x32_bf16 v[156:159], a[148:151], a[236:239], 0
 buffer_load_dwordx4 v6, s[16:19], s53 offen offset:0 lds
 v_mfma_f32_16x16x32_bf16 v[160:163], a[152:155], a[224:227], 0
 ds_read_b128 a[248:251], v3 offset:32768
 buffer_load_dwordx4 v[32:35], v210, s[60:63], s44 offen
 v_mfma_f32_16x16x32_bf16 v[164:167], a[152:155], a[228:231], 0
 ds_read_b128 a[252:255], v3 offset:49152
 buffer_load_dwordx4 v7, s[16:19], s53 offen offset:1024 lds
 s_add_u32 s44, s44, 98304
 v_mfma_f32_16x16x32_bf16 v[168:171], a[152:155], a[232:235], 0
 buffer_load_dwordx4 v[36:39], v210, s[60:63], s44 offen
 s_add_u32 s44, s44, 98304
 v_mfma_f32_16x16x32_bf16 v[172:175], a[152:155], a[236:239], 0
 buffer_load_dwordx4 v8, s[16:19], s53 offen offset:2048 lds
 v_mfma_f32_16x16x32_bf16 v[176:179], a[156:159], a[224:227], 0
 buffer_load_dwordx4 v[40:43], v210, s[60:63], s44 offen
 s_add_u32 s44, s44, 98304
 v_mfma_f32_16x16x32_bf16 v[180:183], a[156:159], a[228:231], 0
 buffer_load_dwordx4 v9, s[16:19], s53 offen offset:3072 lds
 s_add_u32 m0, s39, 4096
 buffer_load_dwordx4 v[44:47], v210, s[60:63], s44 offen
 v_lshrrev_b32 v216, 4, v1
 v_mfma_f32_16x16x32_bf16 v[184:187], a[156:159], a[232:235], 0
 v_and_b32 v217, 15, v1
 v_lshlrev_b32 v219, 8, v216
 v_mfma_f32_16x16x32_bf16 v[188:191], a[156:159], a[236:239], 0
 s_waitcnt lgkmcnt(0)
 buffer_load_dwordx4 v10, s[16:19], s53 offen offset:0 lds
 v_mfma_f32_16x16x32_bf16 v[64:67], a[160:163], a[240:243], v[64:67]
 s_waitcnt vmcnt(10)
 ds_read_b64_tr_b16 a[192:193], v56 offset:32768
 v_add_u32 v219, s36, v219
 v_mfma_f32_16x16x32_bf16 v[68:71], a[160:163], a[244:247], v[68:71]
 ds_read_b64_tr_b16 a[194:195], v56 offset:33792
 buffer_load_dwordx4 v11, s[16:19], s53 offen offset:1024 lds
 v_lshl_add_u32 v218, s3, 2, v216
 v_mfma_f32_16x16x32_bf16 v[72:75], a[160:163], a[248:251], v[72:75]
 ds_read_b64_tr_b16 a[196:197], v57 offset:32768
 v_xor_b32 v218, v218, v217
 v_mfma_f32_16x16x32_bf16 v[76:79], a[160:163], a[252:255], v[76:79]
 buffer_load_dwordx4 v12, s[16:19], s53 offen offset:2048 lds
 v_mfma_f32_16x16x32_bf16 v[80:83], a[164:167], a[240:243], v[80:83]
 ds_read_b64_tr_b16 a[198:199], v57 offset:33792
 v_lshl_add_u32 v236, v218, 4, v219
 v_mfma_f32_16x16x32_bf16 v[84:87], a[164:167], a[244:247], v[84:87]
 ds_read_b64_tr_b16 a[200:201], v58 offset:32768
 v_mov_b32 v218, s3
 v_mfma_f32_16x16x32_bf16 v[88:91], a[164:167], a[248:251], v[88:91]
 ds_read_b64_tr_b16 a[202:203], v58 offset:33792
 v_and_b32 v218, 1, v218
 v_mfma_f32_16x16x32_bf16 v[92:95], a[164:167], a[252:255], v[92:95]
 buffer_load_dwordx4 v13, s[16:19], s53 offen offset:3072 lds
 v_mfma_f32_16x16x32_bf16 v[96:99], a[168:171], a[240:243], v[96:99]
 s_waitcnt lgkmcnt(10)
 s_mov_b32 s52, 1048576
 s_add_u32 m0, s40, 0
 ds_read_b64_tr_b16 a[204:205], v59 offset:32768
 v_lshlrev_b32 v218, 2, v218
 v_mfma_f32_16x16x32_bf16 v[100:103], a[168:171], a[244:247], v[100:103]
 ds_read_b64_tr_b16 a[206:207], v59 offset:33792
 v_add_lshl_u32 v218, v218, v216, 1
 v_mfma_f32_16x16x32_bf16 v[104:107], a[168:171], a[248:251], v[104:107]
 ds_read_b64_tr_b16 a[208:209], v60 offset:32768
 v_xor_b32 v218, v218, v217
 v_mfma_f32_16x16x32_bf16 v[108:111], a[168:171], a[252:255], v[108:111]
 buffer_load_dwordx4 v6, s[16:19], s52 offen offset:0 lds
 v_mfma_f32_16x16x32_bf16 v[112:115], a[172:175], a[240:243], v[112:115]
 ds_read_b64_tr_b16 a[210:211], v60 offset:33792
 v_lshl_add_u32 v237, v218, 4, v219
 v_mfma_f32_16x16x32_bf16 v[116:119], a[172:175], a[244:247], v[116:119]
 ds_read_b64_tr_b16 a[212:213], v61 offset:32768
 v_and_b32 v218, 3, v1
 v_mfma_f32_16x16x32_bf16 v[120:123], a[172:175], a[248:251], v[120:123]
 ds_read_b64_tr_b16 a[214:215], v61 offset:33792
 v_bfe_u32 v219, v1, 2, 2
 v_mfma_f32_16x16x32_bf16 v[124:127], a[172:175], a[252:255], v[124:127]
 buffer_load_dwordx4 v7, s[16:19], s52 offen offset:1024 lds
 v_mfma_f32_16x16x32_bf16 v[128:131], a[176:179], a[240:243], v[128:131]
 ds_read_b64_tr_b16 a[216:217], v62 offset:32768
 v_lshl_add_u32 v220, v219, 4, v218
 v_mfma_f32_16x16x32_bf16 v[132:135], a[176:179], a[244:247], v[132:135]
 ds_read_b64_tr_b16 a[218:219], v62 offset:33792
 v_xor_b32 v217, v217, v216
 v_mfma_f32_16x16x32_bf16 v[136:139], a[176:179], a[248:251], v[136:139]
 ds_read_b64_tr_b16 a[220:221], v63 offset:32768
 v_lshlrev_b32 v220, 8, v220
 v_mfma_f32_16x16x32_bf16 v[140:143], a[176:179], a[252:255], v[140:143]
 buffer_load_dwordx4 v8, s[16:19], s52 offen offset:2048 lds
 v_mfma_f32_16x16x32_bf16 v[144:147], a[180:183], a[240:243], v[144:147]
 ds_read_b64_tr_b16 a[222:223], v63 offset:33792
 v_lshl_add_u32 v220, v217, 4, v220
 v_mfma_f32_16x16x32_bf16 v[148:151], a[180:183], a[244:247], v[148:151]
 ds_read_b128 a[224:227], v4 offset:0
 v_xor_b32 v224, 0, v220
 v_mfma_f32_16x16x32_bf16 v[152:155], a[180:183], a[248:251], v[152:155]
 ds_read_b128 a[228:231], v4 offset:16384
 v_xor_b32 v225, 64, v220
 v_mfma_f32_16x16x32_bf16 v[156:159], a[180:183], a[252:255], v[156:159]
 buffer_load_dwordx4 v9, s[16:19], s52 offen offset:3072 lds
 s_add_u32 m0, s40, 4096
 v_mfma_f32_16x16x32_bf16 v[160:163], a[184:187], a[240:243], v[160:163]
 ds_read_b128 a[232:235], v4 offset:32768
 v_xor_b32 v226, 128, v220
 v_mfma_f32_16x16x32_bf16 v[164:167], a[184:187], a[244:247], v[164:167]
 ds_read_b128 a[236:239], v4 offset:49152
 buffer_load_dwordx4 v10, s[16:19], s52 offen offset:0 lds
 v_xor_b32 v227, 192, v220
 v_mfma_f32_16x16x32_bf16 v[168:171], a[184:187], a[248:251], v[168:171]
 v_lshl_add_u32 v220, v216, 4, v219
 v_lshlrev_b32 v220, 8, v220
 v_mfma_f32_16x16x32_bf16 v[172:175], a[184:187], a[252:255], v[172:175]
 buffer_load_dwordx4 v11, s[16:19], s52 offen offset:1024 lds
 v_mfma_f32_16x16x32_bf16 v[176:179], a[188:191], a[240:243], v[176:179]
 v_and_b32 v216, 1, v216
 v_lshl_add_u32 v216, v216, 2, v219
 v_mfma_f32_16x16x32_bf16 v[180:183], a[188:191], a[244:247], v[180:183]
 v_lshrrev_b32 v217, 1, v218
 v_lshl_add_u32 v216, v216, 1, v217
 v_mfma_f32_16x16x32_bf16 v[184:187], a[188:191], a[248:251], v[184:187]
 v_lshl_add_u32 v220, v216, 4, v220
 v_and_b32 v216, 1, v218
 v_mfma_f32_16x16x32_bf16 v[188:191], a[188:191], a[252:255], v[188:191]
 s_waitcnt lgkmcnt(0)
 buffer_load_dwordx4 v12, s[16:19], s52 offen offset:2048 lds
 v_mfma_f32_16x16x32_bf16 v[64:67], a[192:195], a[224:227], v[64:67]
 s_waitcnt vmcnt(7)
 ds_read_b64_tr_b16 a[128:129], v48 offset:0
 v_lshl_add_u32 v220, v216, 3, v220
 v_mfma_f32_16x16x32_bf16 v[68:71], a[192:195], a[228:231], v[68:71]
 ds_read_b64_tr_b16 a[130:131], v48 offset:1024
 v_add_u32 v220, 65536, v220
 v_mfma_f32_16x16x32_bf16 v[72:75], a[192:195], a[232:235], v[72:75]
 ds_read_b64_tr_b16 a[132:133], v49 offset:0
 v_xor_b32 v228, 0, v220
 v_mfma_f32_16x16x32_bf16 v[76:79], a[192:195], a[236:239], v[76:79]
 buffer_load_dwordx4 v13, s[16:19], s52 offen offset:3072 lds
 v_mfma_f32_16x16x32_bf16 v[80:83], a[196:199], a[224:227], v[80:83]
 s_waitcnt lgkmcnt(7)
 s_mov_b32 s53, 1310720
 s_add_u32 m0, s40, 32768
 ds_read_b64_tr_b16 a[134:135], v49 offset:1024
 v_xor_b32 v229, 32, v220
 v_mfma_f32_16x16x32_bf16 v[84:87], a[196:199], a[228:231], v[84:87]
 ds_read_b64_tr_b16 a[136:137], v50 offset:0
 v_xor_b32 v230, 64, v220
 v_mfma_f32_16x16x32_bf16 v[88:91], a[196:199], a[232:235], v[88:91]
 ds_read_b64_tr_b16 a[138:139], v50 offset:1024
 v_xor_b32 v231, 96, v220
 v_mfma_f32_16x16x32_bf16 v[92:95], a[196:199], a[236:239], v[92:95]
 buffer_load_dwordx4 v6, s[16:19], s53 offen offset:0 lds
 v_mfma_f32_16x16x32_bf16 v[96:99], a[200:203], a[224:227], v[96:99]
 ds_read_b64_tr_b16 a[140:141], v51 offset:0
 v_xor_b32 v232, 128, v220
 v_mfma_f32_16x16x32_bf16 v[100:103], a[200:203], a[228:231], v[100:103]
 ds_read_b64_tr_b16 a[142:143], v51 offset:1024
 v_xor_b32 v233, 160, v220
 v_mfma_f32_16x16x32_bf16 v[104:107], a[200:203], a[232:235], v[104:107]
 ds_read_b64_tr_b16 a[144:145], v52 offset:0
 v_xor_b32 v234, 192, v220
 v_mfma_f32_16x16x32_bf16 v[108:111], a[200:203], a[236:239], v[108:111]
 buffer_load_dwordx4 v7, s[16:19], s53 offen offset:1024 lds
 v_mfma_f32_16x16x32_bf16 v[112:115], a[204:207], a[224:227], v[112:115]
 ds_read_b64_tr_b16 a[146:147], v52 offset:1024
 v_xor_b32 v235, 224, v220
 v_mfma_f32_16x16x32_bf16 v[116:119], a[204:207], a[228:231], v[116:119]
 ds_read_b64_tr_b16 a[148:149], v53 offset:0
 v_bfe_u32 v216, v1, 3, 1
 v_mfma_f32_16x16x32_bf16 v[120:123], a[204:207], a[232:235], v[120:123]
 ds_read_b64_tr_b16 a[150:151], v53 offset:1024
 v_lshlrev_b32 v216, 13, v216
 v_mfma_f32_16x16x32_bf16 v[124:127], a[204:207], a[236:239], v[124:127]
 buffer_load_dwordx4 v8, s[16:19], s53 offen offset:2048 lds
 v_mfma_f32_16x16x32_bf16 v[128:131], a[208:211], a[224:227], v[128:131]
 ds_read_b64_tr_b16 a[152:153], v54 offset:0
 v_and_b32 v217, 7, v1
 v_mfma_f32_16x16x32_bf16 v[132:135], a[208:211], a[228:231], v[132:135]
 ds_read_b64_tr_b16 a[154:155], v54 offset:1024
 v_lshl_add_u32 v216, v217, 4, v216
 v_mfma_f32_16x16x32_bf16 v[136:139], a[208:211], a[232:235], v[136:139]
 ds_read_b64_tr_b16 a[156:157], v55 offset:0
 v_lshrrev_b32 v217, 4, v1
 v_mfma_f32_16x16x32_bf16 v[140:143], a[208:211], a[236:239], v[140:143]
 buffer_load_dwordx4 v9, s[16:19], s53 offen offset:3072 lds
 s_add_u32 m0, s40, 36864
 v_mfma_f32_16x16x32_bf16 v[144:147], a[212:215], a[224:227], v[144:147]
 ds_read_b64_tr_b16 a[158:159], v55 offset:1024
 v_lshl_add_u32 v216, v217, 7, v216
 v_mfma_f32_16x16x32_bf16 v[148:151], a[212:215], a[228:231], v[148:151]
 ds_read_b128 a[240:243], v5 offset:0
 v_add_u32 v213, 65536, v216
 v_mfma_f32_16x16x32_bf16 v[152:155], a[212:215], a[232:235], v[152:155]
 ds_read_b128 a[244:247], v5 offset:16384
 s_lshl_b32 s41, s3, 8
 v_mfma_f32_16x16x32_bf16 v[156:159], a[212:215], a[236:239], v[156:159]
 buffer_load_dwordx4 v10, s[16:19], s53 offen offset:0 lds
 v_mfma_f32_16x16x32_bf16 v[160:163], a[216:219], a[224:227], v[160:163]
 ds_read_b128 a[248:251], v5 offset:32768
 v_lshrrev_b32 v216, 4, v1
 v_mfma_f32_16x16x32_bf16 v[164:167], a[216:219], a[228:231], v[164:167]
 ds_read_b128 a[252:255], v5 offset:49152
 buffer_load_dwordx4 v11, s[16:19], s53 offen offset:1024 lds
 v_and_b32 v217, 15, v1
 v_mfma_f32_16x16x32_bf16 v[168:171], a[216:219], a[232:235], v[168:171]
 v_lshlrev_b32 v218, 1, v216
 v_xor_b32 v217, v217, v218
 v_mfma_f32_16x16x32_bf16 v[172:175], a[216:219], a[236:239], v[172:175]
 buffer_load_dwordx4 v12, s[16:19], s53 offen offset:2048 lds
 v_mfma_f32_16x16x32_bf16 v[176:179], a[220:223], a[224:227], v[176:179]
 v_mul_u32_u24 v216, 1024, v216
 v_add_u32 v216, s41, v216
 v_mfma_f32_16x16x32_bf16 v[180:183], a[220:223], a[228:231], v[180:183]
 v_lshl_add_u32 v218, v217, 4, v216
 v_xor_b32 v217, 8, v217
 v_mfma_f32_16x16x32_bf16 v[184:187], a[220:223], a[232:235], v[184:187]
 v_lshl_add_u32 v219, v217, 4, v216
 v_add_u32 v244, 0, v218
 v_mfma_f32_16x16x32_bf16 v[188:191], a[220:223], a[236:239], v[188:191]
 s_waitcnt lgkmcnt(0)
 buffer_load_dwordx4 v13, s[16:19], s53 offen offset:3072 lds
 v_mfma_f32_16x16x32_bf16 v[64:67], a[128:131], a[240:243], v[64:67]
 s_waitcnt lgkmcnt(4)
 s_mov_b32 s52, 1572864
 s_add_u32 m0, s39, 0
 s_waitcnt vmcnt(8)
 ds_read_b64_tr_b16 a[160:161], v56 offset:0
 v_add_u32 v245, 15360, v218
 v_mfma_f32_16x16x32_bf16 v[68:71], a[128:131], a[244:247], v[68:71]
 ds_read_b64_tr_b16 a[162:163], v56 offset:1024
 v_add_u32 v246, 2048, v219
 v_mfma_f32_16x16x32_bf16 v[72:75], a[128:131], a[248:251], v[72:75]
 ds_read_b64_tr_b16 a[164:165], v57 offset:0
 v_add_u32 v247, 17408, v219
 v_mfma_f32_16x16x32_bf16 v[76:79], a[128:131], a[252:255], v[76:79]
 buffer_load_dwordx4 v6, s[16:19], s52 offen offset:0 lds
 v_mfma_f32_16x16x32_bf16 v[80:83], a[132:135], a[240:243], v[80:83]
 ds_read_b64_tr_b16 a[166:167], v57 offset:1024
 v_add_u32 v248, 8192, v218
 v_mfma_f32_16x16x32_bf16 v[84:87], a[132:135], a[244:247], v[84:87]
 ds_read_b64_tr_b16 a[168:169], v58 offset:0
 v_add_u32 v249, 23552, v218
 v_mfma_f32_16x16x32_bf16 v[88:91], a[132:135], a[248:251], v[88:91]
 ds_read_b64_tr_b16 a[170:171], v58 offset:1024
 v_add_u32 v250, 10240, v219
 v_mfma_f32_16x16x32_bf16 v[92:95], a[132:135], a[252:255], v[92:95]
 buffer_load_dwordx4 v7, s[16:19], s52 offen offset:1024 lds
 v_mfma_f32_16x16x32_bf16 v[96:99], a[136:139], a[240:243], v[96:99]
 ds_read_b64_tr_b16 a[172:173], v59 offset:0
 v_add_u32 v251, 25600, v219
 v_mfma_f32_16x16x32_bf16 v[100:103], a[136:139], a[244:247], v[100:103]
 ds_read_b64_tr_b16 a[174:175], v59 offset:1024
 v_lshrrev_b32 v216, 3, v1
 v_mfma_f32_16x16x32_bf16 v[104:107], a[136:139], a[248:251], v[104:107]
 ds_read_b64_tr_b16 a[176:177], v60 offset:0
 v_and_b32 v217, 6, v216
 v_mfma_f32_16x16x32_bf16 v[108:111], a[136:139], a[252:255], v[108:111]
 buffer_load_dwordx4 v8, s[16:19], s52 offen offset:2048 lds
 v_mfma_f32_16x16x32_bf16 v[112:115], a[140:143], a[240:243], v[112:115]
 ds_read_b64_tr_b16 a[178:179], v60 offset:1024
 v_and_b32 v218, 7, v1
 v_mfma_f32_16x16x32_bf16 v[116:119], a[140:143], a[244:247], v[116:119]
 ds_read_b64_tr_b16 a[180:181], v61 offset:0
 v_xor_b32 v217, v217, v218
 v_mfma_f32_16x16x32_bf16 v[120:123], a[140:143], a[248:251], v[120:123]
 ds_read_b64_tr_b16 a[182:183], v61 offset:1024
 v_mul_u32_u24 v216, 3584, v216
 v_mfma_f32_16x16x32_bf16 v[124:127], a[140:143], a[252:255], v[124:127]
 buffer_load_dwordx4 v9, s[16:19], s52 offen offset:3072 lds
 s_add_u32 m0, s39, 4096
 v_mfma_f32_16x16x32_bf16 v[128:131], a[144:147], a[240:243], v[128:131]
 ds_read_b64_tr_b16 a[184:185], v62 offset:0
 v_lshl_add_u32 v216, v217, 4, v216
 v_mfma_f32_16x16x32_bf16 v[132:135], a[144:147], a[244:247], v[132:135]
 ds_read_b64_tr_b16 a[186:187], v62 offset:1024
 s_mul_i32 s41, s32, 448
 v_mfma_f32_16x16x32_bf16 v[136:139], a[144:147], a[248:251], v[136:139]
 ds_read_b64_tr_b16 a[188:189], v63 offset:0
 s_lshl_b32 s42, s3, 7
 v_mfma_f32_16x16x32_bf16 v[140:143], a[144:147], a[252:255], v[140:143]
 buffer_load_dwordx4 v10, s[16:19], s52 offen offset:0 lds
 v_mfma_f32_16x16x32_bf16 v[144:147], a[148:151], a[240:243], v[144:147]
 ds_read_b64_tr_b16 a[190:191], v63 offset:1024
 s_add_u32 s41, s41, s42
 v_mfma_f32_16x16x32_bf16 v[148:151], a[148:151], a[244:247], v[148:151]
 ds_read_b128 a[224:227], v2 offset:256
 v_add_u32 v216, s41, v216
 v_mfma_f32_16x16x32_bf16 v[152:155], a[148:151], a[248:251], v[152:155]
 ds_read_b128 a[228:231], v2 offset:16640
 s_cmp_eq_u32 s3, 3
 s_cselect_b32 s41, 4, 8
 v_mfma_f32_16x16x32_bf16 v[156:159], a[148:151], a[252:255], v[156:159]
 buffer_load_dwordx4 v11, s[16:19], s52 offen offset:1024 lds
 v_mfma_f32_16x16x32_bf16 v[160:163], a[152:155], a[240:243], v[160:163]
 ds_read_b128 a[232:235], v2 offset:33024
 v_cmp_gt_u32 vcc, s41, v217
 v_mfma_f32_16x16x32_bf16 v[164:167], a[152:155], a[244:247], v[164:167]
 ds_read_b128 a[236:239], v2 offset:49408
 v_mov_b32 v218, 0x40000000
 v_mfma_f32_16x16x32_bf16 v[168:171], a[152:155], a[248:251], v[168:171]
 s_nop 0
 v_cndmask_b32 v216, v218, v216, vcc
 v_mfma_f32_16x16x32_bf16 v[172:175], a[152:155], a[252:255], v[172:175]
 buffer_load_dwordx4 v12, s[16:19], s52 offen offset:2048 lds
 v_mfma_f32_16x16x32_bf16 v[176:179], a[156:159], a[240:243], v[176:179]
 v_add_u32 v208, 0, v216
 v_add_u32 v209, 56320, v216
 v_mfma_f32_16x16x32_bf16 v[180:183], a[156:159], a[244:247], v[180:183]
 v_add_u32 v210, 26624, v216
 v_add_u32 v211, 82944, v216
 v_mfma_f32_16x16x32_bf16 v[184:187], a[156:159], a[248:251], v[184:187]
 s_cmp_ge_u32 s33, 23
 s_cselect_b64 vcc, -1, 0
 v_cndmask_b32 v244, v244, v208, vcc
 v_mfma_f32_16x16x32_bf16 v[188:191], a[156:159], a[252:255], v[188:191]
 s_waitcnt lgkmcnt(0)
 buffer_load_dwordx4 v13, s[16:19], s52 offen offset:3072 lds
 v_mfma_f32_16x16x32_bf16 v[64:67], a[160:163], a[224:227], v[64:67]
 s_waitcnt lgkmcnt(4)
 s_mov_b32 s53, 1835008
 s_add_u32 m0, s40, 0
 s_waitcnt vmcnt(8)
 ds_read_b64_tr_b16 a[192:193], v56 offset:32768
 v_cndmask_b32 v245, v245, v209, vcc
 v_mfma_f32_16x16x32_bf16 v[68:71], a[160:163], a[228:231], v[68:71]
 ds_read_b64_tr_b16 a[194:195], v56 offset:33792
 v_cndmask_b32 v246, v246, v210, vcc
 v_mfma_f32_16x16x32_bf16 v[72:75], a[160:163], a[232:235], v[72:75]
 ds_read_b64_tr_b16 a[196:197], v57 offset:32768
 v_cndmask_b32 v247, v247, v211, vcc
 v_mfma_f32_16x16x32_bf16 v[76:79], a[160:163], a[236:239], v[76:79]
 buffer_load_dwordx4 v6, s[16:19], s53 offen offset:0 lds
 v_mfma_f32_16x16x32_bf16 v[80:83], a[164:167], a[224:227], v[80:83]
 ds_read_b64_tr_b16 a[198:199], v57 offset:33792
 v_cndmask_b32 v248, v248, v208, vcc
 v_mfma_f32_16x16x32_bf16 v[84:87], a[164:167], a[228:231], v[84:87]
 ds_read_b64_tr_b16 a[200:201], v58 offset:32768
 v_cndmask_b32 v249, v249, v209, vcc
 v_mfma_f32_16x16x32_bf16 v[88:91], a[164:167], a[232:235], v[88:91]
 ds_read_b64_tr_b16 a[202:203], v58 offset:33792
 v_cndmask_b32 v250, v250, v210, vcc
 v_mfma_f32_16x16x32_bf16 v[92:95], a[164:167], a[236:239], v[92:95]
 buffer_load_dwordx4 v7, s[16:19], s53 offen offset:1024 lds
 v_mfma_f32_16x16x32_bf16 v[96:99], a[168:171], a[224:227], v[96:99]
 ds_read_b64_tr_b16 a[204:205], v59 offset:32768
 v_cndmask_b32 v251, v251, v211, vcc
 v_mfma_f32_16x16x32_bf16 v[100:103], a[168:171], a[228:231], v[100:103]
 ds_read_b64_tr_b16 a[206:207], v59 offset:33792
 v_mov_b32 v240, 0x3f803f80
 v_mfma_f32_16x16x32_bf16 v[104:107], a[168:171], a[232:235], v[104:107]
 ds_read_b64_tr_b16 a[208:209], v60 offset:32768
 v_mov_b32 v241, 0x3f803f80
 v_mfma_f32_16x16x32_bf16 v[108:111], a[168:171], a[236:239], v[108:111]
 buffer_load_dwordx4 v8, s[16:19], s53 offen offset:2048 lds
 v_mfma_f32_16x16x32_bf16 v[112:115], a[172:175], a[224:227], v[112:115]
 ds_read_b64_tr_b16 a[210:211], v60 offset:33792
 v_mov_b32 v242, 0x3f803f80
 v_mfma_f32_16x16x32_bf16 v[116:119], a[172:175], a[228:231], v[116:119]
 ds_read_b64_tr_b16 a[212:213], v61 offset:32768
 v_mov_b32 v243, 0x3f803f80
 v_mfma_f32_16x16x32_bf16 v[120:123], a[172:175], a[232:235], v[120:123]
 ds_read_b64_tr_b16 a[214:215], v61 offset:33792
 v_lshlrev_b32 v252, 4, v1
 v_mfma_f32_16x16x32_bf16 v[124:127], a[172:175], a[236:239], v[124:127]
 buffer_load_dwordx4 v9, s[16:19], s53 offen offset:3072 lds
 s_add_u32 m0, s40, 4096
 v_mfma_f32_16x16x32_bf16 v[128:131], a[176:179], a[224:227], v[128:131]
 ds_read_b64_tr_b16 a[216:217], v62 offset:32768
 s_waitcnt vmcnt(32)
 v_mfma_f32_16x16x32_bf16 v[132:135], a[176:179], a[228:231], v[132:135]
 ds_read_b64_tr_b16 a[218:219], v62 offset:33792
 v_accvgpr_read_b32 v192, a0
 v_mfma_f32_16x16x32_bf16 v[136:139], a[176:179], a[232:235], v[136:139]
 ds_read_b64_tr_b16 a[220:221], v63 offset:32768
 v_accvgpr_read_b32 v193, a1
 v_mfma_f32_16x16x32_bf16 v[140:143], a[176:179], a[236:239], v[140:143]
 buffer_load_dwordx4 v10, s[16:19], s53 offen offset:0 lds
 v_mfma_f32_16x16x32_bf16 v[144:147], a[180:183], a[224:227], v[144:147]
 ds_read_b64_tr_b16 a[222:223], v63 offset:33792
 v_accvgpr_read_b32 v194, a2
 v_mfma_f32_16x16x32_bf16 v[148:151], a[180:183], a[228:231], v[148:151]
 ds_read_b128 a[240:243], v3 offset:256
 v_accvgpr_read_b32 v195, a3
 v_mfma_f32_16x16x32_bf16 v[152:155], a[180:183], a[232:235], v[152:155]
 ds_read_b128 a[244:247], v3 offset:16640
 v_accvgpr_read_b32 v196, a4
 v_mfma_f32_16x16x32_bf16 v[156:159], a[180:183], a[236:239], v[156:159]
 buffer_load_dwordx4 v11, s[16:19], s53 offen offset:1024 lds
 v_mfma_f32_16x16x32_bf16 v[160:163], a[184:187], a[224:227], v[160:163]
 ds_read_b128 a[248:251], v3 offset:33024
 v_accvgpr_read_b32 v197, a5
 v_mfma_f32_16x16x32_bf16 v[164:167], a[184:187], a[228:231], v[164:167]
 ds_read_b128 a[252:255], v3 offset:49408
 v_accvgpr_read_b32 v198, a6
 v_mfma_f32_16x16x32_bf16 v[168:171], a[184:187], a[232:235], v[168:171]
 v_accvgpr_read_b32 v199, a7
 v_accvgpr_write_b32 a0, 0
 v_mfma_f32_16x16x32_bf16 v[172:175], a[184:187], a[236:239], v[172:175]
 buffer_load_dwordx4 v12, s[16:19], s53 offen offset:2048 lds
 v_mfma_f32_16x16x32_bf16 v[176:179], a[188:191], a[224:227], v[176:179]
 v_accvgpr_write_b32 a1, 0
 v_accvgpr_write_b32 a2, 0
 v_mfma_f32_16x16x32_bf16 v[180:183], a[188:191], a[228:231], v[180:183]
 v_accvgpr_write_b32 a3, 0
 v_accvgpr_write_b32 a4, 0
 v_mfma_f32_16x16x32_bf16 v[184:187], a[188:191], a[232:235], v[184:187]
 v_accvgpr_write_b32 a5, 0
 v_accvgpr_write_b32 a6, 0
 v_mfma_f32_16x16x32_bf16 v[188:191], a[188:191], a[236:239], v[188:191]
 s_waitcnt lgkmcnt(0)
 buffer_load_dwordx4 v13, s[16:19], s53 offen offset:3072 lds
 v_mfma_f32_16x16x32_bf16 v[64:67], a[192:195], a[240:243], v[64:67]
 s_waitcnt lgkmcnt(4)
 s_mov_b32 s52, 2097152
 s_add_u32 m0, s40, 32768
 s_waitcnt vmcnt(8)
 ds_read_b64_tr_b16 a[128:129], v48 offset:0
 v_accvgpr_write_b32 a7, 0
 v_mfma_f32_16x16x32_bf16 v[68:71], a[192:195], a[244:247], v[68:71]
 ds_read_b64_tr_b16 a[130:131], v48 offset:1024
 v_lshlrev_b32 v216, 16, v16
 v_mfma_f32_16x16x32_bf16 v[72:75], a[192:195], a[248:251], v[72:75]
 ds_read_b64_tr_b16 a[132:133], v49 offset:0
 v_and_b32 v217, 0xffff0000, v16
 v_mfma_f32_16x16x32_bf16 v[76:79], a[192:195], a[252:255], v[76:79]
 buffer_load_dwordx4 v6, s[16:19], s52 offen offset:0 lds
 v_mfma_f32_16x16x32_bf16 v[80:83], a[196:199], a[240:243], v[80:83]
 ds_read_b64_tr_b16 a[134:135], v49 offset:1024
 v_mul_f32 v200, v216, v192
 v_mfma_f32_16x16x32_bf16 v[84:87], a[196:199], a[244:247], v[84:87]
 ds_read_b64_tr_b16 a[136:137], v50 offset:0
 v_mul_f32 v201, v217, v192
 v_mfma_f32_16x16x32_bf16 v[88:91], a[196:199], a[248:251], v[88:91]
 ds_read_b64_tr_b16 a[138:139], v50 offset:1024
 v_lshlrev_b32 v216, 16, v17
 v_mfma_f32_16x16x32_bf16 v[92:95], a[196:199], a[252:255], v[92:95]
 buffer_load_dwordx4 v7, s[16:19], s52 offen offset:1024 lds
 v_mfma_f32_16x16x32_bf16 v[96:99], a[200:203], a[240:243], v[96:99]
 ds_read_b64_tr_b16 a[140:141], v51 offset:0
 v_and_b32 v217, 0xffff0000, v17
 v_mfma_f32_16x16x32_bf16 v[100:103], a[200:203], a[244:247], v[100:103]
 ds_read_b64_tr_b16 a[142:143], v51 offset:1024
 v_mul_f32 v202, v216, v192
 v_mfma_f32_16x16x32_bf16 v[104:107], a[200:203], a[248:251], v[104:107]
 ds_read_b64_tr_b16 a[144:145], v52 offset:0
 v_mul_f32 v203, v217, v192
 v_mfma_f32_16x16x32_bf16 v[108:111], a[200:203], a[252:255], v[108:111]
 buffer_load_dwordx4 v8, s[16:19], s52 offen offset:2048 lds
 v_mfma_f32_16x16x32_bf16 v[112:115], a[204:207], a[240:243], v[112:115]
 ds_read_b64_tr_b16 a[146:147], v52 offset:1024
 v_lshlrev_b32 v216, 16, v18
 v_mfma_f32_16x16x32_bf16 v[116:119], a[204:207], a[244:247], v[116:119]
 ds_read_b64_tr_b16 a[148:149], v53 offset:0
 v_and_b32 v217, 0xffff0000, v18
 v_mfma_f32_16x16x32_bf16 v[120:123], a[204:207], a[248:251], v[120:123]
 ds_read_b64_tr_b16 a[150:151], v53 offset:1024
 v_mul_f32 v204, v216, v192
 v_mfma_f32_16x16x32_bf16 v[124:127], a[204:207], a[252:255], v[124:127]
 buffer_load_dwordx4 v9, s[16:19], s52 offen offset:3072 lds
 s_add_u32 m0, s40, 36864
 v_mfma_f32_16x16x32_bf16 v[128:131], a[208:211], a[240:243], v[128:131]
 ds_read_b64_tr_b16 a[152:153], v54 offset:0
 v_mul_f32 v205, v217, v192
 v_mfma_f32_16x16x32_bf16 v[132:135], a[208:211], a[244:247], v[132:135]
 ds_read_b64_tr_b16 a[154:155], v54 offset:1024
 v_lshlrev_b32 v216, 16, v19
 v_mfma_f32_16x16x32_bf16 v[136:139], a[208:211], a[248:251], v[136:139]
 ds_read_b64_tr_b16 a[156:157], v55 offset:0
 v_and_b32 v217, 0xffff0000, v19
 v_mfma_f32_16x16x32_bf16 v[140:143], a[208:211], a[252:255], v[140:143]
 buffer_load_dwordx4 v10, s[16:19], s52 offen offset:0 lds
 v_mfma_f32_16x16x32_bf16 v[144:147], a[212:215], a[240:243], v[144:147]
 ds_read_b64_tr_b16 a[158:159], v55 offset:1024
 v_mul_f32 v206, v216, v192
 v_mfma_f32_16x16x32_bf16 v[148:151], a[212:215], a[244:247], v[148:151]
 ds_read_b128 a[224:227], v4 offset:256
 v_mul_f32 v207, v217, v192
 v_mfma_f32_16x16x32_bf16 v[152:155], a[212:215], a[248:251], v[152:155]
 ds_read_b128 a[228:231], v4 offset:16640
 v_lshlrev_b32 v216, 16, v20
 v_mfma_f32_16x16x32_bf16 v[156:159], a[212:215], a[252:255], v[156:159]
 buffer_load_dwordx4 v11, s[16:19], s52 offen offset:1024 lds
 v_mfma_f32_16x16x32_bf16 v[160:163], a[216:219], a[240:243], v[160:163]
 ds_read_b128 a[232:235], v4 offset:33024
 v_and_b32 v217, 0xffff0000, v20
 v_mfma_f32_16x16x32_bf16 v[164:167], a[216:219], a[244:247], v[164:167]
 ds_read_b128 a[236:239], v4 offset:49408
 v_fmac_f32 v200, v216, v193
 v_mfma_f32_16x16x32_bf16 v[168:171], a[216:219], a[248:251], v[168:171]
 v_fmac_f32 v201, v217, v193
 v_lshlrev_b32 v216, 16, v21
 v_mfma_f32_16x16x32_bf16 v[172:175], a[216:219], a[252:255], v[172:175]
 buffer_load_dwordx4 v12, s[16:19], s52 offen offset:2048 lds
 v_mfma_f32_16x16x32_bf16 v[176:179], a[220:223], a[240:243], v[176:179]
 v_and_b32 v217, 0xffff0000, v21
 v_fmac_f32 v202, v216, v193
 v_mfma_f32_16x16x32_bf16 v[180:183], a[220:223], a[244:247], v[180:183]
 v_fmac_f32 v203, v217, v193
 v_lshlrev_b32 v216, 16, v22
 v_mfma_f32_16x16x32_bf16 v[184:187], a[220:223], a[248:251], v[184:187]
 v_and_b32 v217, 0xffff0000, v22
 v_fmac_f32 v204, v216, v193
 v_mfma_f32_16x16x32_bf16 v[188:191], a[220:223], a[252:255], v[188:191]
 s_waitcnt lgkmcnt(0)
 buffer_load_dwordx4 v13, s[16:19], s52 offen offset:3072 lds
 v_mfma_f32_16x16x32_bf16 v[64:67], a[128:131], a[224:227], v[64:67]
 s_waitcnt lgkmcnt(4)
 s_mov_b32 s53, 2359296
 s_add_u32 m0, s39, 0
 s_waitcnt vmcnt(8)
 ds_read_b64_tr_b16 a[160:161], v56 offset:0
 v_fmac_f32 v205, v217, v193
 v_mfma_f32_16x16x32_bf16 v[68:71], a[128:131], a[228:231], v[68:71]
 ds_read_b64_tr_b16 a[162:163], v56 offset:1024
 v_lshlrev_b32 v216, 16, v23
 v_mfma_f32_16x16x32_bf16 v[72:75], a[128:131], a[232:235], v[72:75]
 ds_read_b64_tr_b16 a[164:165], v57 offset:0
 v_and_b32 v217, 0xffff0000, v23
 v_mfma_f32_16x16x32_bf16 v[76:79], a[128:131], a[236:239], v[76:79]
 buffer_load_dwordx4 v6, s[16:19], s53 offen offset:0 lds
 v_mfma_f32_16x16x32_bf16 v[80:83], a[132:135], a[224:227], v[80:83]
 ds_read_b64_tr_b16 a[166:167], v57 offset:1024
 v_fmac_f32 v206, v216, v193
 v_mfma_f32_16x16x32_bf16 v[84:87], a[132:135], a[228:231], v[84:87]
 ds_read_b64_tr_b16 a[168:169], v58 offset:0
 v_fmac_f32 v207, v217, v193
 v_mfma_f32_16x16x32_bf16 v[88:91], a[132:135], a[232:235], v[88:91]
 ds_read_b64_tr_b16 a[170:171], v58 offset:1024
 v_lshlrev_b32 v216, 16, v24
 v_mfma_f32_16x16x32_bf16 v[92:95], a[132:135], a[236:239], v[92:95]
 buffer_load_dwordx4 v7, s[16:19], s53 offen offset:1024 lds
 v_mfma_f32_16x16x32_bf16 v[96:99], a[136:139], a[224:227], v[96:99]
 ds_read_b64_tr_b16 a[172:173], v59 offset:0
 v_and_b32 v217, 0xffff0000, v24
 v_mfma_f32_16x16x32_bf16 v[100:103], a[136:139], a[228:231], v[100:103]
 ds_read_b64_tr_b16 a[174:175], v59 offset:1024
 v_fmac_f32 v200, v216, v194
 v_mfma_f32_16x16x32_bf16 v[104:107], a[136:139], a[232:235], v[104:107]
 ds_read_b64_tr_b16 a[176:177], v60 offset:0
 v_fmac_f32 v201, v217, v194
 v_mfma_f32_16x16x32_bf16 v[108:111], a[136:139], a[236:239], v[108:111]
 buffer_load_dwordx4 v8, s[16:19], s53 offen offset:2048 lds
 v_mfma_f32_16x16x32_bf16 v[112:115], a[140:143], a[224:227], v[112:115]
 ds_read_b64_tr_b16 a[178:179], v60 offset:1024
 v_lshlrev_b32 v216, 16, v25
 v_mfma_f32_16x16x32_bf16 v[116:119], a[140:143], a[228:231], v[116:119]
 ds_read_b64_tr_b16 a[180:181], v61 offset:0
 v_and_b32 v217, 0xffff0000, v25
 v_mfma_f32_16x16x32_bf16 v[120:123], a[140:143], a[232:235], v[120:123]
 ds_read_b64_tr_b16 a[182:183], v61 offset:1024
 v_fmac_f32 v202, v216, v194
 v_mfma_f32_16x16x32_bf16 v[124:127], a[140:143], a[236:239], v[124:127]
 buffer_load_dwordx4 v9, s[16:19], s53 offen offset:3072 lds
 s_add_u32 m0, s39, 4096
 v_mfma_f32_16x16x32_bf16 v[128:131], a[144:147], a[224:227], v[128:131]
 ds_read_b64_tr_b16 a[184:185], v62 offset:0
 v_fmac_f32 v203, v217, v194
 v_mfma_f32_16x16x32_bf16 v[132:135], a[144:147], a[228:231], v[132:135]
 ds_read_b64_tr_b16 a[186:187], v62 offset:1024
 v_lshlrev_b32 v216, 16, v26
 v_mfma_f32_16x16x32_bf16 v[136:139], a[144:147], a[232:235], v[136:139]
 ds_read_b64_tr_b16 a[188:189], v63 offset:0
 v_and_b32 v217, 0xffff0000, v26
 v_mfma_f32_16x16x32_bf16 v[140:143], a[144:147], a[236:239], v[140:143]
 buffer_load_dwordx4 v10, s[16:19], s53 offen offset:0 lds
 v_mfma_f32_16x16x32_bf16 v[144:147], a[148:151], a[224:227], v[144:147]
 ds_read_b64_tr_b16 a[190:191], v63 offset:1024
 v_fmac_f32 v204, v216, v194
 v_mfma_f32_16x16x32_bf16 v[148:151], a[148:151], a[228:231], v[148:151]
 ds_read_b128 a[240:243], v5 offset:256
 v_fmac_f32 v205, v217, v194
 v_mfma_f32_16x16x32_bf16 v[152:155], a[148:151], a[232:235], v[152:155]
 ds_read_b128 a[244:247], v5 offset:16640
 v_lshlrev_b32 v216, 16, v27
 v_mfma_f32_16x16x32_bf16 v[156:159], a[148:151], a[236:239], v[156:159]
 buffer_load_dwordx4 v11, s[16:19], s53 offen offset:1024 lds
 v_mfma_f32_16x16x32_bf16 v[160:163], a[152:155], a[224:227], v[160:163]
 ds_read_b128 a[248:251], v5 offset:33024
 v_and_b32 v217, 0xffff0000, v27
 v_mfma_f32_16x16x32_bf16 v[164:167], a[152:155], a[228:231], v[164:167]
 ds_read_b128 a[252:255], v5 offset:49408
 v_fmac_f32 v206, v216, v194
 v_mfma_f32_16x16x32_bf16 v[168:171], a[152:155], a[232:235], v[168:171]
 v_fmac_f32 v207, v217, v194
 v_lshlrev_b32 v216, 16, v28
 v_mfma_f32_16x16x32_bf16 v[172:175], a[152:155], a[236:239], v[172:175]
 buffer_load_dwordx4 v12, s[16:19], s53 offen offset:2048 lds
 v_mfma_f32_16x16x32_bf16 v[176:179], a[156:159], a[224:227], v[176:179]
 v_and_b32 v217, 0xffff0000, v28
 v_fmac_f32 v200, v216, v195
 v_mfma_f32_16x16x32_bf16 v[180:183], a[156:159], a[228:231], v[180:183]
 v_fmac_f32 v201, v217, v195
 v_lshlrev_b32 v216, 16, v29
 v_mfma_f32_16x16x32_bf16 v[184:187], a[156:159], a[232:235], v[184:187]
 v_and_b32 v217, 0xffff0000, v29
 v_fmac_f32 v202, v216, v195
 v_mfma_f32_16x16x32_bf16 v[188:191], a[156:159], a[236:239], v[188:191]
 s_waitcnt lgkmcnt(0)
 buffer_load_dwordx4 v13, s[16:19], s53 offen offset:3072 lds
 v_mfma_f32_16x16x32_bf16 v[64:67], a[160:163], a[240:243], v[64:67]
 s_waitcnt lgkmcnt(4)
 s_mov_b32 s52, 2621440
 s_add_u32 m0, s40, 0
 s_waitcnt vmcnt(8)
 ds_read_b64_tr_b16 a[192:193], v56 offset:32768
 v_fmac_f32 v203, v217, v195
 v_mfma_f32_16x16x32_bf16 v[68:71], a[160:163], a[244:247], v[68:71]
 ds_read_b64_tr_b16 a[194:195], v56 offset:33792
 v_lshlrev_b32 v216, 16, v30
 v_mfma_f32_16x16x32_bf16 v[72:75], a[160:163], a[248:251], v[72:75]
 ds_read_b64_tr_b16 a[196:197], v57 offset:32768
 v_and_b32 v217, 0xffff0000, v30
 v_mfma_f32_16x16x32_bf16 v[76:79], a[160:163], a[252:255], v[76:79]
 buffer_load_dwordx4 v6, s[16:19], s52 offen offset:0 lds
 v_mfma_f32_16x16x32_bf16 v[80:83], a[164:167], a[240:243], v[80:83]
 ds_read_b64_tr_b16 a[198:199], v57 offset:33792
 v_fmac_f32 v204, v216, v195
 v_mfma_f32_16x16x32_bf16 v[84:87], a[164:167], a[244:247], v[84:87]
 ds_read_b64_tr_b16 a[200:201], v58 offset:32768
 v_fmac_f32 v205, v217, v195
 v_mfma_f32_16x16x32_bf16 v[88:91], a[164:167], a[248:251], v[88:91]
 ds_read_b64_tr_b16 a[202:203], v58 offset:33792
 v_lshlrev_b32 v216, 16, v31
 v_mfma_f32_16x16x32_bf16 v[92:95], a[164:167], a[252:255], v[92:95]
 buffer_load_dwordx4 v7, s[16:19], s52 offen offset:1024 lds
 v_mfma_f32_16x16x32_bf16 v[96:99], a[168:171], a[240:243], v[96:99]
 ds_read_b64_tr_b16 a[204:205], v59 offset:32768
 v_and_b32 v217, 0xffff0000, v31
 v_mfma_f32_16x16x32_bf16 v[100:103], a[168:171], a[244:247], v[100:103]
 ds_read_b64_tr_b16 a[206:207], v59 offset:33792
 v_fmac_f32 v206, v216, v195
 v_mfma_f32_16x16x32_bf16 v[104:107], a[168:171], a[248:251], v[104:107]
 ds_read_b64_tr_b16 a[208:209], v60 offset:32768
 v_fmac_f32 v207, v217, v195
 v_mfma_f32_16x16x32_bf16 v[108:111], a[168:171], a[252:255], v[108:111]
 buffer_load_dwordx4 v8, s[16:19], s52 offen offset:2048 lds
 v_mfma_f32_16x16x32_bf16 v[112:115], a[172:175], a[240:243], v[112:115]
 ds_read_b64_tr_b16 a[210:211], v60 offset:33792
 v_lshlrev_b32 v216, 16, v32
 v_mfma_f32_16x16x32_bf16 v[116:119], a[172:175], a[244:247], v[116:119]
 ds_read_b64_tr_b16 a[212:213], v61 offset:32768
 v_and_b32 v217, 0xffff0000, v32
 v_mfma_f32_16x16x32_bf16 v[120:123], a[172:175], a[248:251], v[120:123]
 ds_read_b64_tr_b16 a[214:215], v61 offset:33792
 v_fmac_f32 v200, v216, v196
 v_mfma_f32_16x16x32_bf16 v[124:127], a[172:175], a[252:255], v[124:127]
 buffer_load_dwordx4 v9, s[16:19], s52 offen offset:3072 lds
 s_add_u32 m0, s40, 4096
 v_mfma_f32_16x16x32_bf16 v[128:131], a[176:179], a[240:243], v[128:131]
 ds_read_b64_tr_b16 a[216:217], v62 offset:32768
 v_fmac_f32 v201, v217, v196
 v_mfma_f32_16x16x32_bf16 v[132:135], a[176:179], a[244:247], v[132:135]
 ds_read_b64_tr_b16 a[218:219], v62 offset:33792
 v_lshlrev_b32 v216, 16, v33
 v_mfma_f32_16x16x32_bf16 v[136:139], a[176:179], a[248:251], v[136:139]
 ds_read_b64_tr_b16 a[220:221], v63 offset:32768
 v_and_b32 v217, 0xffff0000, v33
 v_mfma_f32_16x16x32_bf16 v[140:143], a[176:179], a[252:255], v[140:143]
 buffer_load_dwordx4 v10, s[16:19], s52 offen offset:0 lds
 v_mfma_f32_16x16x32_bf16 v[144:147], a[180:183], a[240:243], v[144:147]
 ds_read_b64_tr_b16 a[222:223], v63 offset:33792
 v_fmac_f32 v202, v216, v196
 v_mfma_f32_16x16x32_bf16 v[148:151], a[180:183], a[244:247], v[148:151]
 ds_read_b128 a[224:227], v2 offset:512
 v_fmac_f32 v203, v217, v196
 v_mfma_f32_16x16x32_bf16 v[152:155], a[180:183], a[248:251], v[152:155]
 ds_read_b128 a[228:231], v2 offset:16896
 v_lshlrev_b32 v216, 16, v34
 v_mfma_f32_16x16x32_bf16 v[156:159], a[180:183], a[252:255], v[156:159]
 buffer_load_dwordx4 v11, s[16:19], s52 offen offset:1024 lds
 v_mfma_f32_16x16x32_bf16 v[160:163], a[184:187], a[240:243], v[160:163]
 ds_read_b128 a[232:235], v2 offset:33280
 v_and_b32 v217, 0xffff0000, v34
 v_mfma_f32_16x16x32_bf16 v[164:167], a[184:187], a[244:247], v[164:167]
 ds_read_b128 a[236:239], v2 offset:49664
 v_fmac_f32 v204, v216, v196
 v_mfma_f32_16x16x32_bf16 v[168:171], a[184:187], a[248:251], v[168:171]
 v_fmac_f32 v205, v217, v196
 v_lshlrev_b32 v216, 16, v35
 v_mfma_f32_16x16x32_bf16 v[172:175], a[184:187], a[252:255], v[172:175]
 buffer_load_dwordx4 v12, s[16:19], s52 offen offset:2048 lds
 v_mfma_f32_16x16x32_bf16 v[176:179], a[188:191], a[240:243], v[176:179]
 v_and_b32 v217, 0xffff0000, v35
 v_fmac_f32 v206, v216, v196
 v_mfma_f32_16x16x32_bf16 v[180:183], a[188:191], a[244:247], v[180:183]
 v_fmac_f32 v207, v217, v196
 v_lshlrev_b32 v216, 16, v36
 v_mfma_f32_16x16x32_bf16 v[184:187], a[188:191], a[248:251], v[184:187]
 v_and_b32 v217, 0xffff0000, v36
 v_fmac_f32 v200, v216, v197
 v_mfma_f32_16x16x32_bf16 v[188:191], a[188:191], a[252:255], v[188:191]
 s_waitcnt lgkmcnt(0)
 buffer_load_dwordx4 v13, s[16:19], s52 offen offset:3072 lds
 v_mfma_f32_16x16x32_bf16 v[64:67], a[192:195], a[224:227], v[64:67]
 s_waitcnt lgkmcnt(4)
 s_mov_b32 s53, 2883584
 s_add_u32 m0, s40, 32768
 s_waitcnt vmcnt(8)
 ds_read_b64_tr_b16 a[128:129], v48 offset:0
 v_fmac_f32 v201, v217, v197
 v_mfma_f32_16x16x32_bf16 v[68:71], a[192:195], a[228:231], v[68:71]
 ds_read_b64_tr_b16 a[130:131], v48 offset:1024
 v_lshlrev_b32 v216, 16, v37
 v_mfma_f32_16x16x32_bf16 v[72:75], a[192:195], a[232:235], v[72:75]
 ds_read_b64_tr_b16 a[132:133], v49 offset:0
 v_and_b32 v217, 0xffff0000, v37
 v_mfma_f32_16x16x32_bf16 v[76:79], a[192:195], a[236:239], v[76:79]
 buffer_load_dwordx4 v6, s[16:19], s53 offen offset:0 lds
 v_mfma_f32_16x16x32_bf16 v[80:83], a[196:199], a[224:227], v[80:83]
 ds_read_b64_tr_b16 a[134:135], v49 offset:1024
 v_fmac_f32 v202, v216, v197
 v_mfma_f32_16x16x32_bf16 v[84:87], a[196:199], a[228:231], v[84:87]
 ds_read_b64_tr_b16 a[136:137], v50 offset:0
 v_fmac_f32 v203, v217, v197
 v_mfma_f32_16x16x32_bf16 v[88:91], a[196:199], a[232:235], v[88:91]
 ds_read_b64_tr_b16 a[138:139], v50 offset:1024
 v_lshlrev_b32 v216, 16, v38
 v_mfma_f32_16x16x32_bf16 v[92:95], a[196:199], a[236:239], v[92:95]
 buffer_load_dwordx4 v7, s[16:19], s53 offen offset:1024 lds
 v_mfma_f32_16x16x32_bf16 v[96:99], a[200:203], a[224:227], v[96:99]
 ds_read_b64_tr_b16 a[140:141], v51 offset:0
 v_and_b32 v217, 0xffff0000, v38
 v_mfma_f32_16x16x32_bf16 v[100:103], a[200:203], a[228:231], v[100:103]
 ds_read_b64_tr_b16 a[142:143], v51 offset:1024
 v_fmac_f32 v204, v216, v197
 v_mfma_f32_16x16x32_bf16 v[104:107], a[200:203], a[232:235], v[104:107]
 ds_read_b64_tr_b16 a[144:145], v52 offset:0
 v_fmac_f32 v205, v217, v197
 v_mfma_f32_16x16x32_bf16 v[108:111], a[200:203], a[236:239], v[108:111]
 buffer_load_dwordx4 v8, s[16:19], s53 offen offset:2048 lds
 v_mfma_f32_16x16x32_bf16 v[112:115], a[204:207], a[224:227], v[112:115]
 ds_read_b64_tr_b16 a[146:147], v52 offset:1024
 v_lshlrev_b32 v216, 16, v39
 v_mfma_f32_16x16x32_bf16 v[116:119], a[204:207], a[228:231], v[116:119]
 ds_read_b64_tr_b16 a[148:149], v53 offset:0
 v_and_b32 v217, 0xffff0000, v39
 v_mfma_f32_16x16x32_bf16 v[120:123], a[204:207], a[232:235], v[120:123]
 ds_read_b64_tr_b16 a[150:151], v53 offset:1024
 v_fmac_f32 v206, v216, v197
 v_mfma_f32_16x16x32_bf16 v[124:127], a[204:207], a[236:239], v[124:127]
 buffer_load_dwordx4 v9, s[16:19], s53 offen offset:3072 lds
 s_add_u32 m0, s40, 36864
 v_mfma_f32_16x16x32_bf16 v[128:131], a[208:211], a[224:227], v[128:131]
 ds_read_b64_tr_b16 a[152:153], v54 offset:0
 v_fmac_f32 v207, v217, v197
 v_mfma_f32_16x16x32_bf16 v[132:135], a[208:211], a[228:231], v[132:135]
 ds_read_b64_tr_b16 a[154:155], v54 offset:1024
 v_lshlrev_b32 v216, 16, v40
 v_mfma_f32_16x16x32_bf16 v[136:139], a[208:211], a[232:235], v[136:139]
 ds_read_b64_tr_b16 a[156:157], v55 offset:0
 v_and_b32 v217, 0xffff0000, v40
 v_mfma_f32_16x16x32_bf16 v[140:143], a[208:211], a[236:239], v[140:143]
 buffer_load_dwordx4 v10, s[16:19], s53 offen offset:0 lds
 v_mfma_f32_16x16x32_bf16 v[144:147], a[212:215], a[224:227], v[144:147]
 ds_read_b64_tr_b16 a[158:159], v55 offset:1024
 v_fmac_f32 v200, v216, v198
 v_mfma_f32_16x16x32_bf16 v[148:151], a[212:215], a[228:231], v[148:151]
 ds_read_b128 a[240:243], v3 offset:512
 v_fmac_f32 v201, v217, v198
 v_mfma_f32_16x16x32_bf16 v[152:155], a[212:215], a[232:235], v[152:155]
 ds_read_b128 a[244:247], v3 offset:16896
 v_lshlrev_b32 v216, 16, v41
 v_mfma_f32_16x16x32_bf16 v[156:159], a[212:215], a[236:239], v[156:159]
 buffer_load_dwordx4 v11, s[16:19], s53 offen offset:1024 lds
 v_mfma_f32_16x16x32_bf16 v[160:163], a[216:219], a[224:227], v[160:163]
 ds_read_b128 a[248:251], v3 offset:33280
 v_and_b32 v217, 0xffff0000, v41
 v_mfma_f32_16x16x32_bf16 v[164:167], a[216:219], a[228:231], v[164:167]
 ds_read_b128 a[252:255], v3 offset:49664
 v_fmac_f32 v202, v216, v198
 v_mfma_f32_16x16x32_bf16 v[168:171], a[216:219], a[232:235], v[168:171]
 v_fmac_f32 v203, v217, v198
 v_lshlrev_b32 v216, 16, v42
 v_mfma_f32_16x16x32_bf16 v[172:175], a[216:219], a[236:239], v[172:175]
 buffer_load_dwordx4 v12, s[16:19], s53 offen offset:2048 lds
 v_mfma_f32_16x16x32_bf16 v[176:179], a[220:223], a[224:227], v[176:179]
 v_and_b32 v217, 0xffff0000, v42
 v_fmac_f32 v204, v216, v198
 v_mfma_f32_16x16x32_bf16 v[180:183], a[220:223], a[228:231], v[180:183]
 v_fmac_f32 v205, v217, v198
 v_lshlrev_b32 v216, 16, v43
 v_mfma_f32_16x16x32_bf16 v[184:187], a[220:223], a[232:235], v[184:187]
 v_and_b32 v217, 0xffff0000, v43
 v_fmac_f32 v206, v216, v198
 v_mfma_f32_16x16x32_bf16 v[188:191], a[220:223], a[236:239], v[188:191]
 s_waitcnt lgkmcnt(0)
 buffer_load_dwordx4 v13, s[16:19], s53 offen offset:3072 lds
 v_mfma_f32_16x16x32_bf16 v[64:67], a[128:131], a[240:243], v[64:67]
 s_waitcnt lgkmcnt(4)
 s_mov_b32 s52, 3145728
 s_add_u32 m0, s39, 0
 s_waitcnt vmcnt(8)
 ds_read_b64_tr_b16 a[160:161], v56 offset:0
 v_fmac_f32 v207, v217, v198
 v_mfma_f32_16x16x32_bf16 v[68:71], a[128:131], a[244:247], v[68:71]
 ds_read_b64_tr_b16 a[162:163], v56 offset:1024
 v_lshlrev_b32 v216, 16, v44
 v_mfma_f32_16x16x32_bf16 v[72:75], a[128:131], a[248:251], v[72:75]
 ds_read_b64_tr_b16 a[164:165], v57 offset:0
 v_and_b32 v217, 0xffff0000, v44
 v_mfma_f32_16x16x32_bf16 v[76:79], a[128:131], a[252:255], v[76:79]
 buffer_load_dwordx4 v6, s[16:19], s52 offen offset:0 lds
 v_mfma_f32_16x16x32_bf16 v[80:83], a[132:135], a[240:243], v[80:83]
 ds_read_b64_tr_b16 a[166:167], v57 offset:1024
 v_fmac_f32 v200, v216, v199
 v_mfma_f32_16x16x32_bf16 v[84:87], a[132:135], a[244:247], v[84:87]
 ds_read_b64_tr_b16 a[168:169], v58 offset:0
 v_fmac_f32 v201, v217, v199
 v_mfma_f32_16x16x32_bf16 v[88:91], a[132:135], a[248:251], v[88:91]
 ds_read_b64_tr_b16 a[170:171], v58 offset:1024
 v_lshlrev_b32 v216, 16, v45
 v_mfma_f32_16x16x32_bf16 v[92:95], a[132:135], a[252:255], v[92:95]
 buffer_load_dwordx4 v7, s[16:19], s52 offen offset:1024 lds
 v_mfma_f32_16x16x32_bf16 v[96:99], a[136:139], a[240:243], v[96:99]
 ds_read_b64_tr_b16 a[172:173], v59 offset:0
 v_and_b32 v217, 0xffff0000, v45
 v_mfma_f32_16x16x32_bf16 v[100:103], a[136:139], a[244:247], v[100:103]
 ds_read_b64_tr_b16 a[174:175], v59 offset:1024
 v_fmac_f32 v202, v216, v199
 v_mfma_f32_16x16x32_bf16 v[104:107], a[136:139], a[248:251], v[104:107]
 ds_read_b64_tr_b16 a[176:177], v60 offset:0
 v_fmac_f32 v203, v217, v199
 v_mfma_f32_16x16x32_bf16 v[108:111], a[136:139], a[252:255], v[108:111]
 buffer_load_dwordx4 v8, s[16:19], s52 offen offset:2048 lds
 v_mfma_f32_16x16x32_bf16 v[112:115], a[140:143], a[240:243], v[112:115]
 ds_read_b64_tr_b16 a[178:179], v60 offset:1024
 v_lshlrev_b32 v216, 16, v46
 v_mfma_f32_16x16x32_bf16 v[116:119], a[140:143], a[244:247], v[116:119]
 ds_read_b64_tr_b16 a[180:181], v61 offset:0
 v_and_b32 v217, 0xffff0000, v46
 v_mfma_f32_16x16x32_bf16 v[120:123], a[140:143], a[248:251], v[120:123]
 ds_read_b64_tr_b16 a[182:183], v61 offset:1024
 v_fmac_f32 v204, v216, v199
 v_mfma_f32_16x16x32_bf16 v[124:127], a[140:143], a[252:255], v[124:127]
 buffer_load_dwordx4 v9, s[16:19], s52 offen offset:3072 lds
 s_add_u32 m0, s39, 4096
 v_mfma_f32_16x16x32_bf16 v[128:131], a[144:147], a[240:243], v[128:131]
 ds_read_b64_tr_b16 a[184:185], v62 offset:0
 v_fmac_f32 v205, v217, v199
 v_mfma_f32_16x16x32_bf16 v[132:135], a[144:147], a[244:247], v[132:135]
 ds_read_b64_tr_b16 a[186:187], v62 offset:1024
 v_lshlrev_b32 v216, 16, v47
 v_mfma_f32_16x16x32_bf16 v[136:139], a[144:147], a[248:251], v[136:139]
 ds_read_b64_tr_b16 a[188:189], v63 offset:0
 v_and_b32 v217, 0xffff0000, v47
 v_mfma_f32_16x16x32_bf16 v[140:143], a[144:147], a[252:255], v[140:143]
 buffer_load_dwordx4 v10, s[16:19], s52 offen offset:0 lds
 v_mfma_f32_16x16x32_bf16 v[144:147], a[148:151], a[240:243], v[144:147]
 ds_read_b64_tr_b16 a[190:191], v63 offset:1024
 v_fmac_f32 v206, v216, v199
 v_mfma_f32_16x16x32_bf16 v[148:151], a[148:151], a[244:247], v[148:151]
 ds_read_b128 a[224:227], v4 offset:512
 v_fmac_f32 v207, v217, v199
 v_mfma_f32_16x16x32_bf16 v[152:155], a[148:151], a[248:251], v[152:155]
 ds_read_b128 a[228:231], v4 offset:16896
 v_add_f32_dpp v200, v200, v200 row_ror:4 row_mask:0xf bank_mask:0xf
 v_mfma_f32_16x16x32_bf16 v[156:159], a[148:151], a[252:255], v[156:159]
 buffer_load_dwordx4 v11, s[16:19], s52 offen offset:1024 lds
 v_mfma_f32_16x16x32_bf16 v[160:163], a[152:155], a[240:243], v[160:163]
 ds_read_b128 a[232:235], v4 offset:33280
 v_add_f32_dpp v201, v201, v201 row_ror:4 row_mask:0xf bank_mask:0xf
 v_mfma_f32_16x16x32_bf16 v[164:167], a[152:155], a[244:247], v[164:167]
 ds_read_b128 a[236:239], v4 offset:49664
 v_add_f32_dpp v202, v202, v202 row_ror:4 row_mask:0xf bank_mask:0xf
 v_mfma_f32_16x16x32_bf16 v[168:171], a[152:155], a[248:251], v[168:171]
 v_add_f32_dpp v203, v203, v203 row_ror:4 row_mask:0xf bank_mask:0xf
 v_add_f32_dpp v204, v204, v204 row_ror:4 row_mask:0xf bank_mask:0xf
 v_mfma_f32_16x16x32_bf16 v[172:175], a[152:155], a[252:255], v[172:175]
 buffer_load_dwordx4 v12, s[16:19], s52 offen offset:2048 lds
 v_mfma_f32_16x16x32_bf16 v[176:179], a[156:159], a[240:243], v[176:179]
 v_add_f32_dpp v205, v205, v205 row_ror:4 row_mask:0xf bank_mask:0xf
 v_add_f32_dpp v206, v206, v206 row_ror:4 row_mask:0xf bank_mask:0xf
 v_mfma_f32_16x16x32_bf16 v[180:183], a[156:159], a[244:247], v[180:183]
 v_add_f32_dpp v207, v207, v207 row_ror:4 row_mask:0xf bank_mask:0xf
 v_add_f32_dpp v200, v200, v200 row_ror:8 row_mask:0xf bank_mask:0xf
 v_mfma_f32_16x16x32_bf16 v[184:187], a[156:159], a[248:251], v[184:187]
 v_add_f32_dpp v201, v201, v201 row_ror:8 row_mask:0xf bank_mask:0xf
 v_add_f32_dpp v202, v202, v202 row_ror:8 row_mask:0xf bank_mask:0xf
 v_mfma_f32_16x16x32_bf16 v[188:191], a[156:159], a[252:255], v[188:191]
 s_waitcnt lgkmcnt(0)
 buffer_load_dwordx4 v13, s[16:19], s52 offen offset:3072 lds
 v_mfma_f32_16x16x32_bf16 v[64:67], a[160:163], a[224:227], v[64:67]
 s_waitcnt lgkmcnt(4)
 s_mov_b32 s53, 3407872
 s_add_u32 m0, s40, 0
 s_waitcnt vmcnt(8)
 ds_read_b64_tr_b16 a[192:193], v56 offset:32768
 v_add_f32_dpp v203, v203, v203 row_ror:8 row_mask:0xf bank_mask:0xf
 v_mfma_f32_16x16x32_bf16 v[68:71], a[160:163], a[228:231], v[68:71]
 ds_read_b64_tr_b16 a[194:195], v56 offset:33792
 v_add_f32_dpp v204, v204, v204 row_ror:8 row_mask:0xf bank_mask:0xf
 v_mfma_f32_16x16x32_bf16 v[72:75], a[160:163], a[232:235], v[72:75]
 ds_read_b64_tr_b16 a[196:197], v57 offset:32768
 v_add_f32_dpp v205, v205, v205 row_ror:8 row_mask:0xf bank_mask:0xf
 v_mfma_f32_16x16x32_bf16 v[76:79], a[160:163], a[236:239], v[76:79]
 buffer_load_dwordx4 v6, s[16:19], s53 offen offset:0 lds
 v_mfma_f32_16x16x32_bf16 v[80:83], a[164:167], a[224:227], v[80:83]
 ds_read_b64_tr_b16 a[198:199], v57 offset:33792
 v_add_f32_dpp v206, v206, v206 row_ror:8 row_mask:0xf bank_mask:0xf
 v_mfma_f32_16x16x32_bf16 v[84:87], a[164:167], a[228:231], v[84:87]
 ds_read_b64_tr_b16 a[200:201], v58 offset:32768
 v_add_f32_dpp v207, v207, v207 row_ror:8 row_mask:0xf bank_mask:0xf
 v_mfma_f32_16x16x32_bf16 v[88:91], a[164:167], a[232:235], v[88:91]
 ds_read_b64_tr_b16 a[202:203], v58 offset:33792
 v_mov_b32 v216, v200
 v_mfma_f32_16x16x32_bf16 v[92:95], a[164:167], a[236:239], v[92:95]
 buffer_load_dwordx4 v7, s[16:19], s53 offen offset:1024 lds
 v_mfma_f32_16x16x32_bf16 v[96:99], a[168:171], a[224:227], v[96:99]
 ds_read_b64_tr_b16 a[204:205], v59 offset:32768
 v_mov_b32 v217, v201
 v_mfma_f32_16x16x32_bf16 v[100:103], a[168:171], a[228:231], v[100:103]
 ds_read_b64_tr_b16 a[206:207], v59 offset:33792
 v_mov_b32 v218, v202
 v_mfma_f32_16x16x32_bf16 v[104:107], a[168:171], a[232:235], v[104:107]
 ds_read_b64_tr_b16 a[208:209], v60 offset:32768
 v_mov_b32 v219, v203
 v_mfma_f32_16x16x32_bf16 v[108:111], a[168:171], a[236:239], v[108:111]
 buffer_load_dwordx4 v8, s[16:19], s53 offen offset:2048 lds
 v_mfma_f32_16x16x32_bf16 v[112:115], a[172:175], a[224:227], v[112:115]
 ds_read_b64_tr_b16 a[210:211], v60 offset:33792
 v_mov_b32 v220, v204
 v_mfma_f32_16x16x32_bf16 v[116:119], a[172:175], a[228:231], v[116:119]
 ds_read_b64_tr_b16 a[212:213], v61 offset:32768
 v_mov_b32 v221, v205
 v_mfma_f32_16x16x32_bf16 v[120:123], a[172:175], a[232:235], v[120:123]
 ds_read_b64_tr_b16 a[214:215], v61 offset:33792
 v_mov_b32 v222, v206
 v_mfma_f32_16x16x32_bf16 v[124:127], a[172:175], a[236:239], v[124:127]
 buffer_load_dwordx4 v9, s[16:19], s53 offen offset:3072 lds
 s_add_u32 m0, s40, 4096
 v_mfma_f32_16x16x32_bf16 v[128:131], a[176:179], a[224:227], v[128:131]
 ds_read_b64_tr_b16 a[216:217], v62 offset:32768
 v_mov_b32 v223, v207
 v_mfma_f32_16x16x32_bf16 v[132:135], a[176:179], a[228:231], v[132:135]
 ds_read_b64_tr_b16 a[218:219], v62 offset:33792
 v_permlane16_swap_b32 v216, v200
 v_mfma_f32_16x16x32_bf16 v[136:139], a[176:179], a[232:235], v[136:139]
 ds_read_b64_tr_b16 a[220:221], v63 offset:32768
 v_permlane16_swap_b32 v217, v201
 v_mfma_f32_16x16x32_bf16 v[140:143], a[176:179], a[236:239], v[140:143]
 buffer_load_dwordx4 v10, s[16:19], s53 offen offset:0 lds
 v_mfma_f32_16x16x32_bf16 v[144:147], a[180:183], a[224:227], v[144:147]
 ds_read_b64_tr_b16 a[222:223], v63 offset:33792
 v_permlane16_swap_b32 v218, v202
 v_mfma_f32_16x16x32_bf16 v[148:151], a[180:183], a[228:231], v[148:151]
 ds_read_b128 a[240:243], v5 offset:512
 v_permlane16_swap_b32 v219, v203
 v_mfma_f32_16x16x32_bf16 v[152:155], a[180:183], a[232:235], v[152:155]
 ds_read_b128 a[244:247], v5 offset:16896
 v_permlane16_swap_b32 v220, v204
 v_mfma_f32_16x16x32_bf16 v[156:159], a[180:183], a[236:239], v[156:159]
 buffer_load_dwordx4 v11, s[16:19], s53 offen offset:1024 lds
 v_mfma_f32_16x16x32_bf16 v[160:163], a[184:187], a[224:227], v[160:163]
 ds_read_b128 a[248:251], v5 offset:33280
 v_permlane16_swap_b32 v221, v205
 v_mfma_f32_16x16x32_bf16 v[164:167], a[184:187], a[228:231], v[164:167]
 ds_read_b128 a[252:255], v5 offset:49664
 v_permlane16_swap_b32 v222, v206
 v_mfma_f32_16x16x32_bf16 v[168:171], a[184:187], a[232:235], v[168:171]
 v_permlane16_swap_b32 v223, v207
 v_add_f32 v200, v200, v216
 v_mfma_f32_16x16x32_bf16 v[172:175], a[184:187], a[236:239], v[172:175]
 buffer_load_dwordx4 v12, s[16:19], s53 offen offset:2048 lds
 v_mfma_f32_16x16x32_bf16 v[176:179], a[188:191], a[224:227], v[176:179]
 v_add_f32 v201, v201, v217
 v_add_f32 v202, v202, v218
 v_mfma_f32_16x16x32_bf16 v[180:183], a[188:191], a[228:231], v[180:183]
 v_add_f32 v203, v203, v219
 v_add_f32 v204, v204, v220
 v_mfma_f32_16x16x32_bf16 v[184:187], a[188:191], a[232:235], v[184:187]
 v_add_f32 v205, v205, v221
 v_add_f32 v206, v206, v222
 v_mfma_f32_16x16x32_bf16 v[188:191], a[188:191], a[236:239], v[188:191]
 s_waitcnt lgkmcnt(0)
 buffer_load_dwordx4 v13, s[16:19], s53 offen offset:3072 lds
 v_mfma_f32_16x16x32_bf16 v[64:67], a[192:195], a[240:243], v[64:67]
 s_waitcnt lgkmcnt(4)
 s_mov_b32 s52, 3670016
 s_add_u32 m0, s40, 32768
 s_waitcnt vmcnt(8)
 ds_read_b64_tr_b16 a[128:129], v48 offset:0
 v_add_f32 v207, v207, v223
 v_mfma_f32_16x16x32_bf16 v[68:71], a[192:195], a[244:247], v[68:71]
 ds_read_b64_tr_b16 a[130:131], v48 offset:1024
 v_mov_b32 v216, v200
 v_mfma_f32_16x16x32_bf16 v[72:75], a[192:195], a[248:251], v[72:75]
 ds_read_b64_tr_b16 a[132:133], v49 offset:0
 v_mov_b32 v217, v201
 v_mfma_f32_16x16x32_bf16 v[76:79], a[192:195], a[252:255], v[76:79]
 buffer_load_dwordx4 v6, s[16:19], s52 offen offset:0 lds
 v_mfma_f32_16x16x32_bf16 v[80:83], a[196:199], a[240:243], v[80:83]
 ds_read_b64_tr_b16 a[134:135], v49 offset:1024
 v_mov_b32 v218, v202
 v_mfma_f32_16x16x32_bf16 v[84:87], a[196:199], a[244:247], v[84:87]
 ds_read_b64_tr_b16 a[136:137], v50 offset:0
 v_mov_b32 v219, v203
 v_mfma_f32_16x16x32_bf16 v[88:91], a[196:199], a[248:251], v[88:91]
 ds_read_b64_tr_b16 a[138:139], v50 offset:1024
 v_mov_b32 v220, v204
 v_mfma_f32_16x16x32_bf16 v[92:95], a[196:199], a[252:255], v[92:95]
 buffer_load_dwordx4 v7, s[16:19], s52 offen offset:1024 lds
 v_mfma_f32_16x16x32_bf16 v[96:99], a[200:203], a[240:243], v[96:99]
 ds_read_b64_tr_b16 a[140:141], v51 offset:0
 v_mov_b32 v221, v205
 v_mfma_f32_16x16x32_bf16 v[100:103], a[200:203], a[244:247], v[100:103]
 ds_read_b64_tr_b16 a[142:143], v51 offset:1024
 v_mov_b32 v222, v206
 v_mfma_f32_16x16x32_bf16 v[104:107], a[200:203], a[248:251], v[104:107]
 ds_read_b64_tr_b16 a[144:145], v52 offset:0
 v_mov_b32 v223, v207
 v_mfma_f32_16x16x32_bf16 v[108:111], a[200:203], a[252:255], v[108:111]
 buffer_load_dwordx4 v8, s[16:19], s52 offen offset:2048 lds
 v_mfma_f32_16x16x32_bf16 v[112:115], a[204:207], a[240:243], v[112:115]
 ds_read_b64_tr_b16 a[146:147], v52 offset:1024
 v_permlane32_swap_b32 v216, v200
 v_mfma_f32_16x16x32_bf16 v[116:119], a[204:207], a[244:247], v[116:119]
 ds_read_b64_tr_b16 a[148:149], v53 offset:0
 v_permlane32_swap_b32 v217, v201
 v_mfma_f32_16x16x32_bf16 v[120:123], a[204:207], a[248:251], v[120:123]
 ds_read_b64_tr_b16 a[150:151], v53 offset:1024
 v_permlane32_swap_b32 v218, v202
 v_mfma_f32_16x16x32_bf16 v[124:127], a[204:207], a[252:255], v[124:127]
 buffer_load_dwordx4 v9, s[16:19], s52 offen offset:3072 lds
 s_add_u32 m0, s40, 36864
 v_mfma_f32_16x16x32_bf16 v[128:131], a[208:211], a[240:243], v[128:131]
 ds_read_b64_tr_b16 a[152:153], v54 offset:0
 v_permlane32_swap_b32 v219, v203
 v_mfma_f32_16x16x32_bf16 v[132:135], a[208:211], a[244:247], v[132:135]
 ds_read_b64_tr_b16 a[154:155], v54 offset:1024
 v_permlane32_swap_b32 v220, v204
 v_mfma_f32_16x16x32_bf16 v[136:139], a[208:211], a[248:251], v[136:139]
 ds_read_b64_tr_b16 a[156:157], v55 offset:0
 v_permlane32_swap_b32 v221, v205
 v_mfma_f32_16x16x32_bf16 v[140:143], a[208:211], a[252:255], v[140:143]
 buffer_load_dwordx4 v10, s[16:19], s52 offen offset:0 lds
 v_mfma_f32_16x16x32_bf16 v[144:147], a[212:215], a[240:243], v[144:147]
 ds_read_b64_tr_b16 a[158:159], v55 offset:1024
 v_permlane32_swap_b32 v222, v206
 v_mfma_f32_16x16x32_bf16 v[148:151], a[212:215], a[244:247], v[148:151]
 ds_read_b128 a[224:227], v2 offset:768
 v_permlane32_swap_b32 v223, v207
 v_mfma_f32_16x16x32_bf16 v[152:155], a[212:215], a[248:251], v[152:155]
 ds_read_b128 a[228:231], v2 offset:17152
 v_add_f32 v200, v200, v216
 v_mfma_f32_16x16x32_bf16 v[156:159], a[212:215], a[252:255], v[156:159]
 buffer_load_dwordx4 v11, s[16:19], s52 offen offset:1024 lds
 v_mfma_f32_16x16x32_bf16 v[160:163], a[216:219], a[240:243], v[160:163]
 ds_read_b128 a[232:235], v2 offset:33536
 v_add_f32 v201, v201, v217
 v_mfma_f32_16x16x32_bf16 v[164:167], a[216:219], a[244:247], v[164:167]
 ds_read_b128 a[236:239], v2 offset:49920
 v_add_f32 v202, v202, v218
 v_mfma_f32_16x16x32_bf16 v[168:171], a[216:219], a[248:251], v[168:171]
 v_add_f32 v203, v203, v219
 v_add_f32 v204, v204, v220
 v_mfma_f32_16x16x32_bf16 v[172:175], a[216:219], a[252:255], v[172:175]
 buffer_load_dwordx4 v12, s[16:19], s52 offen offset:2048 lds
 v_mfma_f32_16x16x32_bf16 v[176:179], a[220:223], a[240:243], v[176:179]
 v_add_f32 v205, v205, v221
 v_add_f32 v206, v206, v222
 v_mfma_f32_16x16x32_bf16 v[180:183], a[220:223], a[244:247], v[180:183]
 v_add_f32 v207, v207, v223
 v_and_b32 v216, 3, v1
 v_mfma_f32_16x16x32_bf16 v[184:187], a[220:223], a[248:251], v[184:187]
 v_lshl_add_u32 v216, v216, 5, s39
 v_mov_b32 v214, 0x40000000
 v_mfma_f32_16x16x32_bf16 v[188:191], a[220:223], a[252:255], v[188:191]
 s_waitcnt lgkmcnt(0)
 buffer_load_dwordx4 v13, s[16:19], s52 offen offset:3072 lds
 v_mfma_f32_16x16x32_bf16 v[64:67], a[128:131], a[224:227], v[64:67]
 s_waitcnt lgkmcnt(4)
 s_mov_b32 s53, 3932160
 s_add_u32 m0, s39, 0
 s_waitcnt vmcnt(8)
 ds_read_b64_tr_b16 a[160:161], v56 offset:0
 v_mfma_f32_16x16x32_bf16 v[68:71], a[128:131], a[228:231], v[68:71]
 ds_read_b64_tr_b16 a[162:163], v56 offset:1024
 v_mfma_f32_16x16x32_bf16 v[72:75], a[128:131], a[232:235], v[72:75]
 ds_read_b64_tr_b16 a[164:165], v57 offset:0
 v_mfma_f32_16x16x32_bf16 v[76:79], a[128:131], a[236:239], v[76:79]
 buffer_load_dwordx4 v6, s[16:19], s53 offen offset:0 lds
 v_mfma_f32_16x16x32_bf16 v[80:83], a[132:135], a[224:227], v[80:83]
 ds_read_b64_tr_b16 a[166:167], v57 offset:1024
 v_mfma_f32_16x16x32_bf16 v[84:87], a[132:135], a[228:231], v[84:87]
 ds_read_b64_tr_b16 a[168:169], v58 offset:0
 v_mfma_f32_16x16x32_bf16 v[88:91], a[132:135], a[232:235], v[88:91]
 ds_read_b64_tr_b16 a[170:171], v58 offset:1024
 v_mfma_f32_16x16x32_bf16 v[92:95], a[132:135], a[236:239], v[92:95]
 buffer_load_dwordx4 v7, s[16:19], s53 offen offset:1024 lds
 v_mfma_f32_16x16x32_bf16 v[96:99], a[136:139], a[224:227], v[96:99]
 ds_read_b64_tr_b16 a[172:173], v59 offset:0
 v_mfma_f32_16x16x32_bf16 v[100:103], a[136:139], a[228:231], v[100:103]
 ds_read_b64_tr_b16 a[174:175], v59 offset:1024
 v_mfma_f32_16x16x32_bf16 v[104:107], a[136:139], a[232:235], v[104:107]
 ds_read_b64_tr_b16 a[176:177], v60 offset:0
 v_mfma_f32_16x16x32_bf16 v[108:111], a[136:139], a[236:239], v[108:111]
 buffer_load_dwordx4 v8, s[16:19], s53 offen offset:2048 lds
 v_mfma_f32_16x16x32_bf16 v[112:115], a[140:143], a[224:227], v[112:115]
 ds_read_b64_tr_b16 a[178:179], v60 offset:1024
 v_mfma_f32_16x16x32_bf16 v[116:119], a[140:143], a[228:231], v[116:119]
 ds_read_b64_tr_b16 a[180:181], v61 offset:0
 v_mfma_f32_16x16x32_bf16 v[120:123], a[140:143], a[232:235], v[120:123]
 ds_read_b64_tr_b16 a[182:183], v61 offset:1024
 v_mfma_f32_16x16x32_bf16 v[124:127], a[140:143], a[236:239], v[124:127]
 buffer_load_dwordx4 v9, s[16:19], s53 offen offset:3072 lds
 s_add_u32 m0, s39, 4096
 v_mfma_f32_16x16x32_bf16 v[128:131], a[144:147], a[224:227], v[128:131]
 ds_read_b64_tr_b16 a[184:185], v62 offset:0
 v_mfma_f32_16x16x32_bf16 v[132:135], a[144:147], a[228:231], v[132:135]
 ds_read_b64_tr_b16 a[186:187], v62 offset:1024
 v_mfma_f32_16x16x32_bf16 v[136:139], a[144:147], a[232:235], v[136:139]
 ds_read_b64_tr_b16 a[188:189], v63 offset:0
 v_mfma_f32_16x16x32_bf16 v[140:143], a[144:147], a[236:239], v[140:143]
 buffer_load_dwordx4 v10, s[16:19], s53 offen offset:0 lds
 v_mfma_f32_16x16x32_bf16 v[144:147], a[148:151], a[224:227], v[144:147]
 ds_read_b64_tr_b16 a[190:191], v63 offset:1024
 v_mfma_f32_16x16x32_bf16 v[148:151], a[148:151], a[228:231], v[148:151]
 ds_read_b128 a[240:243], v3 offset:768
 v_mfma_f32_16x16x32_bf16 v[152:155], a[148:151], a[232:235], v[152:155]
 ds_read_b128 a[244:247], v3 offset:17152
 v_mfma_f32_16x16x32_bf16 v[156:159], a[148:151], a[236:239], v[156:159]
 buffer_load_dwordx4 v11, s[16:19], s53 offen offset:1024 lds
 v_mfma_f32_16x16x32_bf16 v[160:163], a[152:155], a[224:227], v[160:163]
 ds_read_b128 a[248:251], v3 offset:33536
 v_mfma_f32_16x16x32_bf16 v[164:167], a[152:155], a[228:231], v[164:167]
 ds_read_b128 a[252:255], v3 offset:49920
 v_mfma_f32_16x16x32_bf16 v[168:171], a[152:155], a[232:235], v[168:171]
 v_mfma_f32_16x16x32_bf16 v[172:175], a[152:155], a[236:239], v[172:175]
 buffer_load_dwordx4 v12, s[16:19], s53 offen offset:2048 lds
 v_mfma_f32_16x16x32_bf16 v[176:179], a[156:159], a[224:227], v[176:179]
 v_mfma_f32_16x16x32_bf16 v[180:183], a[156:159], a[228:231], v[180:183]
 v_mfma_f32_16x16x32_bf16 v[184:187], a[156:159], a[232:235], v[184:187]
 v_mfma_f32_16x16x32_bf16 v[188:191], a[156:159], a[236:239], v[188:191]
 s_waitcnt lgkmcnt(0)
 buffer_load_dwordx4 v13, s[16:19], s53 offen offset:3072 lds
 v_mfma_f32_16x16x32_bf16 v[64:67], a[160:163], a[240:243], v[64:67]
 s_waitcnt vmcnt(8)
 ds_read_b64_tr_b16 a[192:193], v56 offset:32768
 v_mfma_f32_16x16x32_bf16 v[68:71], a[160:163], a[244:247], v[68:71]
 ds_read_b64_tr_b16 a[194:195], v56 offset:33792
 v_mfma_f32_16x16x32_bf16 v[72:75], a[160:163], a[248:251], v[72:75]
 ds_read_b64_tr_b16 a[196:197], v57 offset:32768
 v_mfma_f32_16x16x32_bf16 v[76:79], a[160:163], a[252:255], v[76:79]
 v_mfma_f32_16x16x32_bf16 v[80:83], a[164:167], a[240:243], v[80:83]
 ds_read_b64_tr_b16 a[198:199], v57 offset:33792
 v_mfma_f32_16x16x32_bf16 v[84:87], a[164:167], a[244:247], v[84:87]
 ds_read_b64_tr_b16 a[200:201], v58 offset:32768
 v_mfma_f32_16x16x32_bf16 v[88:91], a[164:167], a[248:251], v[88:91]
 ds_read_b64_tr_b16 a[202:203], v58 offset:33792
 v_mfma_f32_16x16x32_bf16 v[92:95], a[164:167], a[252:255], v[92:95]
 v_mfma_f32_16x16x32_bf16 v[96:99], a[168:171], a[240:243], v[96:99]
 ds_read_b64_tr_b16 a[204:205], v59 offset:32768
 v_mfma_f32_16x16x32_bf16 v[100:103], a[168:171], a[244:247], v[100:103]
 ds_read_b64_tr_b16 a[206:207], v59 offset:33792
 v_mfma_f32_16x16x32_bf16 v[104:107], a[168:171], a[248:251], v[104:107]
 ds_read_b64_tr_b16 a[208:209], v60 offset:32768
 v_mfma_f32_16x16x32_bf16 v[108:111], a[168:171], a[252:255], v[108:111]
 v_mfma_f32_16x16x32_bf16 v[112:115], a[172:175], a[240:243], v[112:115]
 ds_read_b64_tr_b16 a[210:211], v60 offset:33792
 v_mfma_f32_16x16x32_bf16 v[116:119], a[172:175], a[244:247], v[116:119]
 ds_read_b64_tr_b16 a[212:213], v61 offset:32768
 v_mfma_f32_16x16x32_bf16 v[120:123], a[172:175], a[248:251], v[120:123]
 ds_read_b64_tr_b16 a[214:215], v61 offset:33792
 v_mfma_f32_16x16x32_bf16 v[124:127], a[172:175], a[252:255], v[124:127]
 v_mfma_f32_16x16x32_bf16 v[128:131], a[176:179], a[240:243], v[128:131]
 ds_read_b64_tr_b16 a[216:217], v62 offset:32768
 v_mfma_f32_16x16x32_bf16 v[132:135], a[176:179], a[244:247], v[132:135]
 ds_read_b64_tr_b16 a[218:219], v62 offset:33792
 v_mfma_f32_16x16x32_bf16 v[136:139], a[176:179], a[248:251], v[136:139]
 ds_read_b64_tr_b16 a[220:221], v63 offset:32768
 v_mfma_f32_16x16x32_bf16 v[140:143], a[176:179], a[252:255], v[140:143]
 v_mfma_f32_16x16x32_bf16 v[144:147], a[180:183], a[240:243], v[144:147]
 ds_read_b64_tr_b16 a[222:223], v63 offset:33792
 v_mfma_f32_16x16x32_bf16 v[148:151], a[180:183], a[244:247], v[148:151]
 ds_read_b128 a[224:227], v4 offset:768
 v_mfma_f32_16x16x32_bf16 v[152:155], a[180:183], a[248:251], v[152:155]
 ds_read_b128 a[228:231], v4 offset:17152
 v_mfma_f32_16x16x32_bf16 v[156:159], a[180:183], a[252:255], v[156:159]
 v_mfma_f32_16x16x32_bf16 v[160:163], a[184:187], a[240:243], v[160:163]
 ds_read_b128 a[232:235], v4 offset:33536
 v_mfma_f32_16x16x32_bf16 v[164:167], a[184:187], a[244:247], v[164:167]
 ds_read_b128 a[236:239], v4 offset:49920
 v_mfma_f32_16x16x32_bf16 v[168:171], a[184:187], a[248:251], v[168:171]
 v_mfma_f32_16x16x32_bf16 v[172:175], a[184:187], a[252:255], v[172:175]
 v_mfma_f32_16x16x32_bf16 v[176:179], a[188:191], a[240:243], v[176:179]
 v_mfma_f32_16x16x32_bf16 v[180:183], a[188:191], a[244:247], v[180:183]
 v_mfma_f32_16x16x32_bf16 v[184:187], a[188:191], a[248:251], v[184:187]
 v_mfma_f32_16x16x32_bf16 v[188:191], a[188:191], a[252:255], v[188:191]
 s_waitcnt lgkmcnt(0)
 v_mfma_f32_16x16x32_bf16 v[64:67], a[192:195], a[224:227], v[64:67]
 s_waitcnt vmcnt(0)
 ds_read_b64_tr_b16 a[128:129], v48 offset:0
 v_mfma_f32_16x16x32_bf16 v[68:71], a[192:195], a[228:231], v[68:71]
 ds_read_b64_tr_b16 a[130:131], v48 offset:1024
 v_mfma_f32_16x16x32_bf16 v[72:75], a[192:195], a[232:235], v[72:75]
 ds_read_b64_tr_b16 a[132:133], v49 offset:0
 v_mfma_f32_16x16x32_bf16 v[76:79], a[192:195], a[236:239], v[76:79]
 v_mfma_f32_16x16x32_bf16 v[80:83], a[196:199], a[224:227], v[80:83]
 ds_read_b64_tr_b16 a[134:135], v49 offset:1024
 v_mfma_f32_16x16x32_bf16 v[84:87], a[196:199], a[228:231], v[84:87]
 ds_read_b64_tr_b16 a[136:137], v50 offset:0
 v_mfma_f32_16x16x32_bf16 v[88:91], a[196:199], a[232:235], v[88:91]
 ds_read_b64_tr_b16 a[138:139], v50 offset:1024
 v_mfma_f32_16x16x32_bf16 v[92:95], a[196:199], a[236:239], v[92:95]
 v_mfma_f32_16x16x32_bf16 v[96:99], a[200:203], a[224:227], v[96:99]
 ds_read_b64_tr_b16 a[140:141], v51 offset:0
 v_mfma_f32_16x16x32_bf16 v[100:103], a[200:203], a[228:231], v[100:103]
 ds_read_b64_tr_b16 a[142:143], v51 offset:1024
 v_mfma_f32_16x16x32_bf16 v[104:107], a[200:203], a[232:235], v[104:107]
 ds_read_b64_tr_b16 a[144:145], v52 offset:0
 v_mfma_f32_16x16x32_bf16 v[108:111], a[200:203], a[236:239], v[108:111]
 v_mfma_f32_16x16x32_bf16 v[112:115], a[204:207], a[224:227], v[112:115]
 ds_read_b64_tr_b16 a[146:147], v52 offset:1024
 v_mfma_f32_16x16x32_bf16 v[116:119], a[204:207], a[228:231], v[116:119]
 ds_read_b64_tr_b16 a[148:149], v53 offset:0
 v_mfma_f32_16x16x32_bf16 v[120:123], a[204:207], a[232:235], v[120:123]
 ds_read_b64_tr_b16 a[150:151], v53 offset:1024
 v_mfma_f32_16x16x32_bf16 v[124:127], a[204:207], a[236:239], v[124:127]
 v_mfma_f32_16x16x32_bf16 v[128:131], a[208:211], a[224:227], v[128:131]
 ds_read_b64_tr_b16 a[152:153], v54 offset:0
 v_mfma_f32_16x16x32_bf16 v[132:135], a[208:211], a[228:231], v[132:135]
 ds_read_b64_tr_b16 a[154:155], v54 offset:1024
 v_mfma_f32_16x16x32_bf16 v[136:139], a[208:211], a[232:235], v[136:139]
 ds_read_b64_tr_b16 a[156:157], v55 offset:0
 v_mfma_f32_16x16x32_bf16 v[140:143], a[208:211], a[236:239], v[140:143]
 v_mfma_f32_16x16x32_bf16 v[144:147], a[212:215], a[224:227], v[144:147]
 ds_read_b64_tr_b16 a[158:159], v55 offset:1024
 v_mfma_f32_16x16x32_bf16 v[148:151], a[212:215], a[228:231], v[148:151]
 ds_read_b128 a[240:243], v5 offset:768
 v_mfma_f32_16x16x32_bf16 v[152:155], a[212:215], a[232:235], v[152:155]
 ds_read_b128 a[244:247], v5 offset:17152
 v_mfma_f32_16x16x32_bf16 v[156:159], a[212:215], a[236:239], v[156:159]
 v_mfma_f32_16x16x32_bf16 v[160:163], a[216:219], a[224:227], v[160:163]
 ds_read_b128 a[248:251], v5 offset:33536
 v_mfma_f32_16x16x32_bf16 v[164:167], a[216:219], a[228:231], v[164:167]
 ds_read_b128 a[252:255], v5 offset:49920
 v_mfma_f32_16x16x32_bf16 v[168:171], a[216:219], a[232:235], v[168:171]
 v_mfma_f32_16x16x32_bf16 v[172:175], a[216:219], a[236:239], v[172:175]
 v_mfma_f32_16x16x32_bf16 v[176:179], a[220:223], a[224:227], v[176:179]
 v_mfma_f32_16x16x32_bf16 v[180:183], a[220:223], a[228:231], v[180:183]
 v_mfma_f32_16x16x32_bf16 v[184:187], a[220:223], a[232:235], v[184:187]
 v_mfma_f32_16x16x32_bf16 v[188:191], a[220:223], a[236:239], v[188:191]
 s_waitcnt lgkmcnt(0)
 v_mfma_f32_16x16x32_bf16 v[64:67], a[128:131], a[240:243], v[64:67]
 v_lshrrev_b32 v220, 5, v1
 v_bfe_u32 v221, v1, 2, 3
 v_mfma_f32_16x16x32_bf16 v[68:71], a[128:131], a[244:247], v[68:71]
 v_lshlrev_b32 v220, 11, v220
 v_lshl_add_u32 v220, v221, 7, v220
 v_mfma_f32_16x16x32_bf16 v[72:75], a[128:131], a[248:251], v[72:75]
 v_and_b32 v221, 6, v221
 v_bfe_u32 v222, v1, 1, 1
 v_mfma_f32_16x16x32_bf16 v[76:79], a[128:131], a[252:255], v[76:79]
 v_mfma_f32_16x16x32_bf16 v[80:83], a[132:135], a[240:243], v[80:83]
 v_or_b32 v221, v221, v222
 v_lshl_add_u32 v220, v221, 4, v220
 v_mfma_f32_16x16x32_bf16 v[84:87], a[132:135], a[244:247], v[84:87]
 v_and_b32 v221, 1, v1
 v_lshl_add_u32 v220, v221, 3, v220
 v_mfma_f32_16x16x32_bf16 v[88:91], a[132:135], a[248:251], v[88:91]
 v_xor_b32 v221, 0, v220
 v_add_u32 v56, s39, v221
 v_mfma_f32_16x16x32_bf16 v[92:95], a[132:135], a[252:255], v[92:95]
 v_mfma_f32_16x16x32_bf16 v[96:99], a[136:139], a[240:243], v[96:99]
 v_xor_b32 v221, 32, v220
 v_add_u32 v57, s39, v221
 v_mfma_f32_16x16x32_bf16 v[100:103], a[136:139], a[244:247], v[100:103]
 v_xor_b32 v221, 64, v220
 v_add_u32 v58, s39, v221
 v_mfma_f32_16x16x32_bf16 v[104:107], a[136:139], a[248:251], v[104:107]
 v_xor_b32 v221, 96, v220
 v_add_u32 v59, s39, v221
 v_mfma_f32_16x16x32_bf16 v[108:111], a[136:139], a[252:255], v[108:111]
 v_mfma_f32_16x16x32_bf16 v[112:115], a[140:143], a[240:243], v[112:115]
 v_cndmask_b32 v48, v48, v56, vcc
 v_cndmask_b32 v49, v49, v57, vcc
 v_mfma_f32_16x16x32_bf16 v[116:119], a[140:143], a[244:247], v[116:119]
 v_cndmask_b32 v50, v50, v58, vcc
 v_cndmask_b32 v51, v51, v59, vcc
 v_mfma_f32_16x16x32_bf16 v[120:123], a[140:143], a[248:251], v[120:123]
 v_add_u32 v56, 4096, v56
 v_cndmask_b32 v52, v52, v56, vcc
 v_mfma_f32_16x16x32_bf16 v[124:127], a[140:143], a[252:255], v[124:127]
 v_mfma_f32_16x16x32_bf16 v[128:131], a[144:147], a[240:243], v[128:131]
 v_add_u32 v57, 4096, v57
 v_cndmask_b32 v53, v53, v57, vcc
 v_mfma_f32_16x16x32_bf16 v[132:135], a[144:147], a[244:247], v[132:135]
 v_add_u32 v58, 4096, v58
 v_cndmask_b32 v54, v54, v58, vcc
 v_mfma_f32_16x16x32_bf16 v[136:139], a[144:147], a[248:251], v[136:139]
 v_add_u32 v59, 4096, v59
 v_cndmask_b32 v55, v55, v59, vcc
 v_mfma_f32_16x16x32_bf16 v[140:143], a[144:147], a[252:255], v[140:143]
 v_mfma_f32_16x16x32_bf16 v[144:147], a[148:151], a[240:243], v[144:147]
 v_mfma_f32_16x16x32_bf16 v[148:151], a[148:151], a[244:247], v[148:151]
 v_mfma_f32_16x16x32_bf16 v[152:155], a[148:151], a[248:251], v[152:155]
 v_mfma_f32_16x16x32_bf16 v[156:159], a[148:151], a[252:255], v[156:159]
 v_mfma_f32_16x16x32_bf16 v[160:163], a[152:155], a[240:243], v[160:163]
 v_mfma_f32_16x16x32_bf16 v[164:167], a[152:155], a[244:247], v[164:167]
 v_mfma_f32_16x16x32_bf16 v[168:171], a[152:155], a[248:251], v[168:171]
 v_mfma_f32_16x16x32_bf16 v[172:175], a[152:155], a[252:255], v[172:175]
 v_mfma_f32_16x16x32_bf16 v[176:179], a[156:159], a[240:243], v[176:179]
 v_mfma_f32_16x16x32_bf16 v[180:183], a[156:159], a[244:247], v[180:183]
 v_mfma_f32_16x16x32_bf16 v[184:187], a[156:159], a[248:251], v[184:187]
 v_mfma_f32_16x16x32_bf16 v[188:191], a[156:159], a[252:255], v[188:191]
 ds_write_b128 v216, v[200:203]
 ds_write_b128 v216, v[204:207] offset:16
 s_waitcnt lgkmcnt(0)
 s_barrier
  s_lshr_b32 s44, s2, 6
  s_lshl_b32 s44, s44, 2
  s_or_b32 s44, s44, s3
  s_cmp_lg_u32 s44, 7
  s_cbranch_scc1 L_late_done
  v_and_b32 v22, 15, v1
  v_lshlrev_b32 v22, 3, v22
  v_add_u32 v23, 131072, v22
  ds_read_b64 v[24:25], v23 offset:0
  ds_read_b64 v[26:27], v23 offset:8192
  ds_read_b64 v[28:29], v23 offset:16384
  ds_read_b64 v[30:31], v23 offset:24576
  s_lshr_b32 s44, s95, 4
  s_cmp_eq_u32 s44, 2
  s_cselect_b32 s45, 1.0, 0
  s_lshl_b32 s44, s95, 7
  s_add_u32 s44, s44, 16384
  v_add_u32 v22, s44, v22
  v_cmp_gt_u32 vcc, 16, v1
  s_waitcnt lgkmcnt(0)
  v_pk_add_f32 v[24:25], v[24:25], v[26:27]
  v_pk_add_f32 v[28:29], v[28:29], v[30:31]
  v_cndmask_b32 v214, v214, v22, vcc
  v_pk_add_f32 v[24:25], v[24:25], v[28:29]
  v_cvt_pk_bf16_f32 v26, v24, v25
  v_lshlrev_b32 v24, 16, v26
  v_and_b32 v25, 0xffff0000, v26
  v_add_f32 v24, s45, v24
  v_add_f32 v25, s45, v25
  v_cvt_pk_bf16_f32 v238, v24, v25
  v_mov_b32 v239, s94
L_late_done:
 s_mov_b32 s34, 0
 s_mov_b32 s35, 0
 s_add_u32 m0, s36, 0
 s_nop 0
 buffer_load_dwordx4 v236, s[8:11], s34 offen offset:0 lds
 buffer_load_dwordx4 v236, s[8:11], s34 offen offset:1024 lds
 buffer_load_dwordx4 v236, s[8:11], s34 offen offset:2048 lds
 buffer_load_dwordx4 v236, s[8:11], s34 offen offset:3072 lds
 s_add_u32 s34, s34, 16384
 s_lshl_b32 s41, s32, 19
 s_add_u32 s16, s72, s41
 s_addc_u32 s17, s73, 0
 s_mov_b32 s18, 524288
 s_lshl_b32 s97, s33, 15
 s_lshl_b32 s98, s33, 11
 s_mov_b32 s99, 32768
 s_mov_b32 s100, 65536
 s_mov_b32 s42, 0
 s_cmp_lt_u32 s33, 16
 s_cbranch_scc1 L_pk_role
 s_mov_b32 s16, s28
 s_mov_b32 s17, s29
 s_mov_b32 s18, 229376
 s_sub_u32 s41, s33, 16
 s_lshl_b32 s97, s41, 15
 s_lshl_b32 s98, s41, 13
 s_add_u32 s98, s98, 131072
 s_mov_b32 s99, 2048
 s_mov_b32 s100, 4096
 s_cmp_lt_u32 s33, 23
 s_cbranch_scc1 L_pk_role
 s_mov_b32 s16, s76
 s_mov_b32 s17, s77
 s_mov_b32 s18, 1835008
 s_sub_u32 s41, s33, 23
 s_mul_i32 s97, s41, 229376
 s_lshl_b32 s98, s41, 12
 s_add_u32 s98, s98, 196608
 s_mov_b32 s99, 32768
 s_mov_b32 s100, 2048
 s_mov_b32 s42, 114688
 s_cmp_lt_u32 s33, 31
 s_cbranch_scc1 L_pk_role
 s_mov_b32 s98, 0x40000000
L_pk_role:
 s_add_u32 s42, s42, s97
 s_lshl_b32 s96, s32, 2
 s_add_u32 s96, s96, s3
 s_lshl_b32 s96, s96, 7
 s_add_u32 s96, s96, 786432
 v_cvt_pk_bf16_f32 v192, v64, v65
 v_cvt_pk_bf16_f32 v193, v66, v67
 v_cvt_pk_bf16_f32 v194, v80, v81
 v_cvt_pk_bf16_f32 v195, v82, v83
 s_add_u32 m0, s36, 16384
 s_nop 0
 buffer_load_dwordx4 v236, s[8:11], s34 offen offset:0 lds
 v_cvt_pk_bf16_f32 v196, v96, v97
 v_cvt_pk_bf16_f32 v197, v98, v99
 v_cvt_pk_bf16_f32 v198, v112, v113
 v_cvt_pk_bf16_f32 v199, v114, v115
 buffer_load_dwordx4 v236, s[8:11], s34 offen offset:1024 lds
 v_permlane32_swap_b32 v192, v194
 v_permlane32_swap_b32 v193, v195
 v_permlane32_swap_b32 v196, v198
 v_permlane32_swap_b32 v197, v199
 buffer_load_dwordx4 v236, s[8:11], s34 offen offset:2048 lds
 v_permlane16_swap_b32 v192, v194
 v_permlane16_swap_b32 v193, v195
 v_permlane16_swap_b32 v196, v198
 v_permlane16_swap_b32 v197, v199
 buffer_load_dwordx4 v236, s[8:11], s34 offen offset:3072 lds
 s_add_u32 s34, s34, 16384
 v_accvgpr_write_b32 a128, v192
 v_accvgpr_write_b32 a129, v193
 v_accvgpr_write_b32 a130, v194
 v_accvgpr_write_b32 a131, v195
 s_add_u32 m0, s36, 65536
 s_nop 0
 buffer_load_dwordx4 v237, s[12:15], s35 offen offset:0 lds
 v_accvgpr_write_b32 a132, v196
 v_accvgpr_write_b32 a133, v197
 v_accvgpr_write_b32 a134, v198
 v_accvgpr_write_b32 a135, v199
 buffer_load_dwordx4 v237, s[12:15], s35 offen offset:1024 lds
 v_cvt_pk_bf16_f32 v200, v128, v129
 v_cvt_pk_bf16_f32 v201, v130, v131
 v_cvt_pk_bf16_f32 v202, v144, v145
 v_cvt_pk_bf16_f32 v203, v146, v147
 buffer_load_dwordx4 v237, s[12:15], s35 offen offset:2048 lds
 v_cvt_pk_bf16_f32 v204, v160, v161
 v_cvt_pk_bf16_f32 v205, v162, v163
 v_cvt_pk_bf16_f32 v206, v176, v177
 v_cvt_pk_bf16_f32 v207, v178, v179
 buffer_load_dwordx4 v237, s[12:15], s35 offen offset:3072 lds
 s_add_u32 s35, s35, 16384
 v_permlane32_swap_b32 v200, v202
 v_permlane32_swap_b32 v201, v203
 v_permlane32_swap_b32 v204, v206
 v_permlane32_swap_b32 v205, v207
 s_add_u32 m0, s36, 32768
 s_nop 0
 buffer_load_dwordx4 v236, s[8:11], s34 offen offset:0 lds
 v_permlane16_swap_b32 v200, v202
 v_permlane16_swap_b32 v201, v203
 v_permlane16_swap_b32 v204, v206
 v_permlane16_swap_b32 v205, v207
 buffer_load_dwordx4 v236, s[8:11], s34 offen offset:1024 lds
 v_accvgpr_write_b32 a136, v200
 v_accvgpr_write_b32 a137, v201
 v_accvgpr_write_b32 a138, v202
 v_accvgpr_write_b32 a139, v203
 buffer_load_dwordx4 v236, s[8:11], s34 offen offset:2048 lds
 v_accvgpr_write_b32 a140, v204
 v_accvgpr_write_b32 a141, v205
 v_accvgpr_write_b32 a142, v206
 v_accvgpr_write_b32 a143, v207
 buffer_load_dwordx4 v236, s[8:11], s34 offen offset:3072 lds
 s_add_u32 s34, s34, 16384
 v_cvt_pk_bf16_f32 v192, v68, v69
 v_cvt_pk_bf16_f32 v193, v70, v71
 v_cvt_pk_bf16_f32 v194, v84, v85
 v_cvt_pk_bf16_f32 v195, v86, v87
 s_add_u32 m0, s36, 81920
 s_nop 0
 buffer_load_dwordx4 v237, s[12:15], s35 offen offset:0 lds
 v_cvt_pk_bf16_f32 v196, v100, v101
 v_cvt_pk_bf16_f32 v197, v102, v103
 v_cvt_pk_bf16_f32 v198, v116, v117
 v_cvt_pk_bf16_f32 v199, v118, v119
 buffer_load_dwordx4 v237, s[12:15], s35 offen offset:1024 lds
 v_permlane32_swap_b32 v192, v194
 v_permlane32_swap_b32 v193, v195
 v_permlane32_swap_b32 v196, v198
 v_permlane32_swap_b32 v197, v199
 buffer_load_dwordx4 v237, s[12:15], s35 offen offset:2048 lds
 v_permlane16_swap_b32 v192, v194
 v_permlane16_swap_b32 v193, v195
 v_permlane16_swap_b32 v196, v198
 v_permlane16_swap_b32 v197, v199
 buffer_load_dwordx4 v237, s[12:15], s35 offen offset:3072 lds
 s_add_u32 s35, s35, 16384
 s_waitcnt vmcnt(16)
 s_barrier
 ds_read_b128 a[192:195], v224 offset:0
 ds_read_b128 a[196:199], v225 offset:0
 ds_read_b128 a[200:203], v226 offset:0
 ds_read_b128 a[204:207], v227 offset:0
 ds_read_b128 a[208:211], v224 offset:1024
 ds_read_b128 a[212:215], v225 offset:1024
 ds_read_b128 a[216:219], v226 offset:1024
 ds_read_b128 a[220:223], v227 offset:1024
 ds_read_b128 a[224:227], v224 offset:2048
 ds_read_b128 a[228:231], v225 offset:2048
 ds_read_b128 a[232:235], v226 offset:2048
 ds_read_b128 a[236:239], v227 offset:2048
 s_waitcnt lgkmcnt(8)
 ds_read_b128 a[240:243], v224 offset:3072
 ds_read_b128 a[244:247], v225 offset:3072
 ds_read_b128 a[248:251], v226 offset:3072
 ds_read_b128 a[252:255], v227 offset:3072
 v_accvgpr_write_b32 a144, v192
 v_accvgpr_write_b32 a145, v193
 v_accvgpr_write_b32 a146, v194
 v_accvgpr_write_b32 a147, v195
 s_add_u32 m0, s39, 0
 s_nop 0
 buffer_load_dwordx4 v244, s[16:19], s97 offen offset:0 lds
 v_accvgpr_write_b32 a148, v196
 v_accvgpr_write_b32 a149, v197
 v_accvgpr_write_b32 a150, v198
 v_accvgpr_write_b32 a151, v199
 buffer_load_dwordx4 v245, s[16:19], s97 offen offset:1024 lds
 v_cvt_pk_bf16_f32 v200, v132, v133
 v_cvt_pk_bf16_f32 v201, v134, v135
 v_cvt_pk_bf16_f32 v202, v148, v149
 v_cvt_pk_bf16_f32 v203, v150, v151
 buffer_load_dwordx4 v246, s[16:19], s97 offen offset:2048 lds
 v_cvt_pk_bf16_f32 v204, v164, v165
 v_cvt_pk_bf16_f32 v205, v166, v167
 v_cvt_pk_bf16_f32 v206, v180, v181
 v_cvt_pk_bf16_f32 v207, v182, v183
 buffer_load_dwordx4 v247, s[16:19], s97 offen offset:3072 lds
 s_add_u32 m0, s39, 4096
 s_nop 0
 v_permlane32_swap_b32 v200, v202
 v_permlane32_swap_b32 v201, v203
 v_permlane32_swap_b32 v204, v206
 v_permlane32_swap_b32 v205, v207
 buffer_load_dwordx4 v248, s[16:19], s42 offen offset:0 lds
 v_permlane16_swap_b32 v200, v202
 v_permlane16_swap_b32 v201, v203
 v_permlane16_swap_b32 v204, v206
 v_permlane16_swap_b32 v205, v207
 buffer_load_dwordx4 v249, s[16:19], s42 offen offset:1024 lds
 v_accvgpr_write_b32 a152, v200
 v_accvgpr_write_b32 a153, v201
 v_accvgpr_write_b32 a154, v202
 v_accvgpr_write_b32 a155, v203
 buffer_load_dwordx4 v250, s[16:19], s42 offen offset:2048 lds
 v_accvgpr_write_b32 a156, v204
 v_accvgpr_write_b32 a157, v205
 v_accvgpr_write_b32 a158, v206
 v_accvgpr_write_b32 a159, v207
 buffer_load_dwordx4 v251, s[16:19], s42 offen offset:3072 lds
 s_mov_b32 s37, 0x3f800000
 s_waitcnt lgkmcnt(0)
 v_mfma_f32_16x16x32_bf16 v[64:67], a[192:195], a[128:131], 0
 v_cvt_pk_bf16_f32 v192, v72, v73
 v_cvt_pk_bf16_f32 v193, v74, v75
 v_cvt_pk_bf16_f32 v194, v88, v89
 v_mfma_f32_16x16x32_bf16 v[64:67], a[196:199], a[132:135], v[64:67]
 v_cvt_pk_bf16_f32 v195, v90, v91
 v_cvt_pk_bf16_f32 v196, v104, v105
 v_cvt_pk_bf16_f32 v197, v106, v107
 v_mfma_f32_16x16x32_bf16 v[64:67], a[200:203], a[136:139], v[64:67]
 v_cvt_pk_bf16_f32 v198, v120, v121
 v_cvt_pk_bf16_f32 v199, v122, v123
 v_permlane32_swap_b32 v192, v194
 v_mfma_f32_16x16x32_bf16 v[64:67], a[204:207], a[140:143], v[64:67]
 v_permlane32_swap_b32 v193, v195
 v_permlane32_swap_b32 v196, v198
 v_permlane32_swap_b32 v197, v199
 v_mfma_f32_16x16x32_bf16 v[80:83], a[208:211], a[128:131], 0
 v_permlane16_swap_b32 v192, v194
 v_permlane16_swap_b32 v193, v195
 v_permlane16_swap_b32 v196, v198
 v_mfma_f32_16x16x32_bf16 v[80:83], a[212:215], a[132:135], v[80:83]
 v_permlane16_swap_b32 v197, v199
 v_accvgpr_write_b32 a160, v192
 v_accvgpr_write_b32 a161, v193
 v_mfma_f32_16x16x32_bf16 v[80:83], a[216:219], a[136:139], v[80:83]
 v_accvgpr_write_b32 a162, v194
 v_accvgpr_write_b32 a163, v195
 v_accvgpr_write_b32 a164, v196
 v_mfma_f32_16x16x32_bf16 v[80:83], a[220:223], a[140:143], v[80:83]
 v_accvgpr_write_b32 a165, v197
 v_accvgpr_write_b32 a166, v198
 v_accvgpr_write_b32 a167, v199
 v_mfma_f32_16x16x32_bf16 v[96:99], a[224:227], a[128:131], 0
 v_cvt_pk_bf16_f32 v200, v136, v137
 v_cvt_pk_bf16_f32 v201, v138, v139
 v_cvt_pk_bf16_f32 v202, v152, v153
 v_mfma_f32_16x16x32_bf16 v[96:99], a[228:231], a[132:135], v[96:99]
 v_cvt_pk_bf16_f32 v203, v154, v155
 v_cvt_pk_bf16_f32 v204, v168, v169
 v_cvt_pk_bf16_f32 v205, v170, v171
 v_mfma_f32_16x16x32_bf16 v[96:99], a[232:235], a[136:139], v[96:99]
 v_cvt_pk_bf16_f32 v206, v184, v185
 v_cvt_pk_bf16_f32 v207, v186, v187
 v_permlane32_swap_b32 v200, v202
 v_mfma_f32_16x16x32_bf16 v[96:99], a[236:239], a[140:143], v[96:99]
 v_permlane32_swap_b32 v201, v203
 v_permlane32_swap_b32 v204, v206
 v_permlane32_swap_b32 v205, v207
 v_mfma_f32_16x16x32_bf16 v[112:115], a[240:243], a[128:131], 0
 v_permlane16_swap_b32 v200, v202
 v_permlane16_swap_b32 v201, v203
 v_permlane16_swap_b32 v204, v206
 v_mfma_f32_16x16x32_bf16 v[112:115], a[244:247], a[132:135], v[112:115]
 v_permlane16_swap_b32 v205, v207
 v_accvgpr_write_b32 a168, v200
 v_accvgpr_write_b32 a169, v201
 v_mfma_f32_16x16x32_bf16 v[112:115], a[248:251], a[136:139], v[112:115]
 v_accvgpr_write_b32 a170, v202
 v_accvgpr_write_b32 a171, v203
 v_accvgpr_write_b32 a172, v204
 v_mfma_f32_16x16x32_bf16 v[112:115], a[252:255], a[140:143], v[112:115]
 v_accvgpr_write_b32 a173, v205
 v_accvgpr_write_b32 a174, v206
 v_accvgpr_write_b32 a175, v207
 v_mfma_f32_16x16x32_bf16 v[68:71], a[192:195], a[144:147], 0
 v_cvt_pk_bf16_f32 v192, v76, v77
 v_cvt_pk_bf16_f32 v193, v78, v79
 v_cvt_pk_bf16_f32 v194, v92, v93
 v_mfma_f32_16x16x32_bf16 v[68:71], a[196:199], a[148:151], v[68:71]
 v_cvt_pk_bf16_f32 v195, v94, v95
 v_cvt_pk_bf16_f32 v196, v108, v109
 v_cvt_pk_bf16_f32 v197, v110, v111
 v_mfma_f32_16x16x32_bf16 v[68:71], a[200:203], a[152:155], v[68:71]
 v_cvt_pk_bf16_f32 v198, v124, v125
 v_cvt_pk_bf16_f32 v199, v126, v127
 v_permlane32_swap_b32 v192, v194
 v_mfma_f32_16x16x32_bf16 v[68:71], a[204:207], a[156:159], v[68:71]
 v_permlane32_swap_b32 v193, v195
 v_permlane32_swap_b32 v196, v198
 v_permlane32_swap_b32 v197, v199
 v_mfma_f32_16x16x32_bf16 v[84:87], a[208:211], a[144:147], 0
 v_permlane16_swap_b32 v192, v194
 v_permlane16_swap_b32 v193, v195
 v_permlane16_swap_b32 v196, v198
 v_mfma_f32_16x16x32_bf16 v[84:87], a[212:215], a[148:151], v[84:87]
 v_permlane16_swap_b32 v197, v199
 v_accvgpr_write_b32 a176, v192
 v_accvgpr_write_b32 a177, v193
 v_mfma_f32_16x16x32_bf16 v[84:87], a[216:219], a[152:155], v[84:87]
 v_accvgpr_write_b32 a178, v194
 v_accvgpr_write_b32 a179, v195
 v_accvgpr_write_b32 a180, v196
 v_mfma_f32_16x16x32_bf16 v[84:87], a[220:223], a[156:159], v[84:87]
 v_accvgpr_write_b32 a181, v197
 v_accvgpr_write_b32 a182, v198
 v_accvgpr_write_b32 a183, v199
 v_mfma_f32_16x16x32_bf16 v[100:103], a[224:227], a[144:147], 0
 v_cvt_pk_bf16_f32 v200, v140, v141
 v_cvt_pk_bf16_f32 v201, v142, v143
 v_cvt_pk_bf16_f32 v202, v156, v157
 v_mfma_f32_16x16x32_bf16 v[100:103], a[228:231], a[148:151], v[100:103]
 v_cvt_pk_bf16_f32 v203, v158, v159
 v_cvt_pk_bf16_f32 v204, v172, v173
 v_cvt_pk_bf16_f32 v205, v174, v175
 v_mfma_f32_16x16x32_bf16 v[100:103], a[232:235], a[152:155], v[100:103]
 v_cvt_pk_bf16_f32 v206, v188, v189
 v_cvt_pk_bf16_f32 v207, v190, v191
 v_permlane32_swap_b32 v200, v202
 v_mfma_f32_16x16x32_bf16 v[100:103], a[236:239], a[156:159], v[100:103]
 v_permlane32_swap_b32 v201, v203
 v_permlane32_swap_b32 v204, v206
 v_permlane32_swap_b32 v205, v207
 v_mfma_f32_16x16x32_bf16 v[116:119], a[240:243], a[144:147], 0
 v_permlane16_swap_b32 v200, v202
 v_permlane16_swap_b32 v201, v203
 v_permlane16_swap_b32 v204, v206
 v_mfma_f32_16x16x32_bf16 v[116:119], a[244:247], a[148:151], v[116:119]
 v_permlane16_swap_b32 v205, v207
 v_accvgpr_write_b32 a184, v200
 v_accvgpr_write_b32 a185, v201
 v_mfma_f32_16x16x32_bf16 v[116:119], a[248:251], a[152:155], v[116:119]
 v_accvgpr_write_b32 a186, v202
 v_accvgpr_write_b32 a187, v203
 v_accvgpr_write_b32 a188, v204
 v_mfma_f32_16x16x32_bf16 v[116:119], a[252:255], a[156:159], v[116:119]
 v_accvgpr_write_b32 a189, v205
 v_accvgpr_write_b32 a190, v206
 v_accvgpr_write_b32 a191, v207
 v_mfma_f32_16x16x32_bf16 v[72:75], a[192:195], a[160:163], 0
 v_mov_b32 v253, 0
 v_mov_b32 v255, 0
 v_mov_b32 v36, 0
 v_mfma_f32_16x16x32_bf16 v[72:75], a[196:199], a[164:167], v[72:75]
 v_mov_b32 v37, 0
 v_mov_b32 v38, 0
 v_mov_b32 v39, 0
 v_mfma_f32_16x16x32_bf16 v[72:75], a[200:203], a[168:171], v[72:75]
 v_max3_f32 v216, v64, v65, v66
 v_max3_f32 v216, v216, v67, v80
 v_max3_f32 v216, v216, v81, v82
 v_mfma_f32_16x16x32_bf16 v[72:75], a[204:207], a[172:175], v[72:75]
 v_max3_f32 v216, v216, v83, v96
 v_max3_f32 v216, v216, v97, v98
 v_max3_f32 v216, v216, v99, v112
 v_mfma_f32_16x16x32_bf16 v[88:91], a[208:211], a[160:163], 0
 v_max3_f32 v216, v216, v113, v114
 v_max_f32 v216, v216, v115
 v_mov_b32 v217, v216
 v_mfma_f32_16x16x32_bf16 v[88:91], a[212:215], a[164:167], v[88:91]
 s_nop 0
 v_permlane32_swap_b32 v217, v216
 v_max_f32 v216, v216, v217
 v_mov_b32 v217, v216
 v_mfma_f32_16x16x32_bf16 v[88:91], a[216:219], a[168:171], v[88:91]
 s_nop 0
 v_permlane16_swap_b32 v217, v216
 v_max_f32 v216, v216, v217
 v_ceil_f32 v216, v216
 v_mfma_f32_16x16x32_bf16 v[88:91], a[220:223], a[172:175], v[88:91]
 v_sub_f32 v192, 3268018176, v216
 v_sub_f32 v193, 3268018176, v216
 v_sub_f32 v194, 3268018176, v216
 v_mfma_f32_16x16x32_bf16 v[104:107], a[224:227], a[160:163], 0
 v_sub_f32 v195, 3268018176, v216
 v_add_f32 v64, v64, v192
 v_add_f32 v65, v65, v192
 v_mfma_f32_16x16x32_bf16 v[104:107], a[228:231], a[164:167], v[104:107]
 v_add_f32 v66, v66, v192
 v_add_f32 v67, v67, v192
 v_add_f32 v80, v80, v192
 v_mfma_f32_16x16x32_bf16 v[104:107], a[232:235], a[168:171], v[104:107]
 v_add_f32 v81, v81, v192
 v_add_f32 v82, v82, v192
 v_add_f32 v83, v83, v192
 v_mfma_f32_16x16x32_bf16 v[104:107], a[236:239], a[172:175], v[104:107]
 v_add_f32 v96, v96, v192
 v_add_f32 v97, v97, v192
 v_add_f32 v98, v98, v192
 v_mfma_f32_16x16x32_bf16 v[120:123], a[240:243], a[160:163], 0
 v_add_f32 v99, v99, v192
 v_add_f32 v112, v112, v192
 v_add_f32 v113, v113, v192
 v_mfma_f32_16x16x32_bf16 v[120:123], a[244:247], a[164:167], v[120:123]
 v_add_f32 v114, v114, v192
 v_add_f32 v115, v115, v192
 v_mfma_f32_16x16x32_bf16 v[120:123], a[248:251], a[168:171], v[120:123]
 v_mfma_f32_16x16x32_bf16 v[120:123], a[252:255], a[172:175], v[120:123]
 v_mfma_f32_16x16x32_bf16 v[76:79], a[192:195], a[176:179], 0
 v_mov_b32 v254, 0
 v_mov_b32 v215, 0
 v_mov_b32 v44, 0
 v_mfma_f32_16x16x32_bf16 v[76:79], a[196:199], a[180:183], v[76:79]
 v_mov_b32 v45, 0
 v_mov_b32 v46, 0
 v_mov_b32 v47, 0
 v_mfma_f32_16x16x32_bf16 v[76:79], a[200:203], a[184:187], v[76:79]
 v_max3_f32 v218, v68, v69, v70
 v_max3_f32 v218, v218, v71, v84
 v_max3_f32 v218, v218, v85, v86
 v_mfma_f32_16x16x32_bf16 v[76:79], a[204:207], a[188:191], v[76:79]
 v_max3_f32 v218, v218, v87, v100
 v_max3_f32 v218, v218, v101, v102
 v_max3_f32 v218, v218, v103, v116
 v_mfma_f32_16x16x32_bf16 v[92:95], a[208:211], a[176:179], 0
 v_max3_f32 v218, v218, v117, v118
 v_max_f32 v218, v218, v119
 v_mov_b32 v219, v218
 v_mfma_f32_16x16x32_bf16 v[92:95], a[212:215], a[180:183], v[92:95]
 s_nop 0
 v_permlane32_swap_b32 v219, v218
 v_max_f32 v218, v218, v219
 v_mov_b32 v219, v218
 v_mfma_f32_16x16x32_bf16 v[92:95], a[216:219], a[184:187], v[92:95]
 s_nop 0
 v_permlane16_swap_b32 v219, v218
 v_max_f32 v218, v218, v219
 v_ceil_f32 v218, v218
 v_mfma_f32_16x16x32_bf16 v[92:95], a[220:223], a[188:191], v[92:95]
 v_sub_f32 v196, 3268018176, v218
 v_sub_f32 v197, 3268018176, v218
 v_sub_f32 v198, 3268018176, v218
 v_mfma_f32_16x16x32_bf16 v[108:111], a[224:227], a[176:179], 0
 v_sub_f32 v199, 3268018176, v218
 v_add_f32 v68, v68, v196
 v_add_f32 v69, v69, v196
 v_mfma_f32_16x16x32_bf16 v[108:111], a[228:231], a[180:183], v[108:111]
 v_add_f32 v70, v70, v196
 v_add_f32 v71, v71, v196
 v_add_f32 v84, v84, v196
 v_mfma_f32_16x16x32_bf16 v[108:111], a[232:235], a[184:187], v[108:111]
 v_add_f32 v85, v85, v196
 v_add_f32 v86, v86, v196
 v_add_f32 v87, v87, v196
 v_mfma_f32_16x16x32_bf16 v[108:111], a[236:239], a[188:191], v[108:111]
 v_add_f32 v100, v100, v196
 v_add_f32 v101, v101, v196
 v_add_f32 v102, v102, v196
 v_mfma_f32_16x16x32_bf16 v[124:127], a[240:243], a[176:179], 0
 v_add_f32 v103, v103, v196
 v_add_f32 v116, v116, v196
 v_add_f32 v117, v117, v196
 v_mfma_f32_16x16x32_bf16 v[124:127], a[244:247], a[180:183], v[124:127]
 v_add_f32 v118, v118, v196
 v_add_f32 v119, v119, v196
 v_mfma_f32_16x16x32_bf16 v[124:127], a[248:251], a[184:187], v[124:127]
 v_mfma_f32_16x16x32_bf16 v[124:127], a[252:255], a[188:191], v[124:127]
 v_max3_f32 v216, v72, v73, v74
 v_max3_f32 v218, v76, v77, v78
 v_max3_f32 v216, v216, v75, v88
 v_max3_f32 v218, v218, v79, v92
 v_max3_f32 v216, v216, v89, v90
 v_max3_f32 v218, v218, v93, v94
 v_max3_f32 v216, v216, v91, v104
 v_max3_f32 v218, v218, v95, v108
 v_max3_f32 v216, v216, v105, v106
 v_max3_f32 v218, v218, v109, v110
 v_max3_f32 v216, v216, v107, v120
 v_max3_f32 v218, v218, v111, v124
 v_max3_f32 v216, v216, v121, v122
 v_max3_f32 v218, v218, v125, v126
 v_max_f32 v216, v216, v123
 v_max_f32 v218, v218, v127
 v_mov_b32 v217, v216
 v_mov_b32 v219, v218
 s_nop 0
 v_permlane32_swap_b32 v217, v216
 s_nop 0
 v_permlane32_swap_b32 v219, v218
 v_max_f32 v216, v216, v217
 v_max_f32 v218, v218, v219
 v_mov_b32 v217, v216
 v_mov_b32 v219, v218
 s_nop 0
 v_permlane16_swap_b32 v217, v216
 s_nop 0
 v_permlane16_swap_b32 v219, v218
 v_max_f32 v216, v216, v217
 v_max_f32 v218, v218, v219
 v_ceil_f32 v216, v216
 v_ceil_f32 v218, v218
 v_sub_f32 v200, 3268018176, v216
 v_sub_f32 v204, 3268018176, v218
 v_sub_f32 v201, 3268018176, v216
 v_sub_f32 v205, 3268018176, v218
 v_sub_f32 v202, 3268018176, v216
 v_sub_f32 v206, 3268018176, v218
 v_sub_f32 v203, 3268018176, v216
 v_sub_f32 v207, 3268018176, v218
 v_add_f32 v72, v72, v200
 v_add_f32 v76, v76, v204
 v_add_f32 v73, v73, v200
 v_add_f32 v77, v77, v204
 v_add_f32 v74, v74, v200
 v_add_f32 v78, v78, v204
 v_add_f32 v75, v75, v200
 v_add_f32 v79, v79, v204
 v_add_f32 v88, v88, v200
 v_add_f32 v92, v92, v204
 v_add_f32 v89, v89, v200
 v_add_f32 v93, v93, v204
 v_add_f32 v90, v90, v200
 v_add_f32 v94, v94, v204
 v_add_f32 v91, v91, v200
 v_add_f32 v95, v95, v204
 v_add_f32 v104, v104, v200
 v_add_f32 v108, v108, v204
 v_add_f32 v105, v105, v200
 v_add_f32 v109, v109, v204
 v_add_f32 v106, v106, v200
 v_add_f32 v110, v110, v204
 v_add_f32 v107, v107, v200
 v_add_f32 v111, v111, v204
 v_add_f32 v120, v120, v200
 v_add_f32 v124, v124, v204
 v_add_f32 v121, v121, v200
 v_add_f32 v125, v125, v204
 v_add_f32 v122, v122, v200
 v_add_f32 v126, v126, v204
 v_add_f32 v123, v123, v200
 v_add_f32 v127, v127, v204
 v_exp_f32 v16, v64
 v_exp_f32 v17, v65
 v_exp_f32 v18, v66
 v_exp_f32 v19, v67
 v_cvt_pk_bf16_f32 v128, v16, v17
 v_cvt_pk_bf16_f32 v129, v18, v19
 v_exp_f32 v32, v80
 v_exp_f32 v33, v81
 v_exp_f32 v34, v82
 v_exp_f32 v35, v83
 v_cvt_pk_bf16_f32 v130, v32, v33
 v_cvt_pk_bf16_f32 v131, v34, v35
 v_exp_f32 v208, v68
 v_add_f32 v253, v253, v255
 v_exp_f32 v209, v69
 s_nop 0
 v_cvt_pk_bf16_f32 v132, v208, v209
 v_exp_f32 v210, v70
 v_add_f32 v255, v16, v17
 v_add_f32 v255, v255, v18
 v_exp_f32 v211, v71
 s_nop 0
 v_cvt_pk_bf16_f32 v133, v210, v211
 v_exp_f32 v208, v84
 v_add_f32 v255, v255, v19
 v_exp_f32 v209, v85
 s_nop 0
 v_cvt_pk_bf16_f32 v134, v208, v209
 v_exp_f32 v210, v86
 v_add_f32 v255, v255, v32
 v_add_f32 v255, v255, v33
 v_exp_f32 v211, v87
 s_nop 0
 v_cvt_pk_bf16_f32 v135, v210, v211
 v_exp_f32 v24, v72
 v_add_f32 v255, v255, v34
 v_exp_f32 v25, v73
 s_nop 0
 v_mfma_f32_16x16x32_bf16 v[20:23], v[240:243], v[132:135], v[36:39]
 v_add_f32 v255, v255, v35
 v_add_f32 v254, v254, v215
 v_cvt_pk_bf16_f32 v136, v24, v25
 v_exp_f32 v26, v74
 v_add_f32 v215, v24, v25
 v_add_f32 v215, v215, v26
 v_exp_f32 v27, v75
 s_nop 0
 v_cvt_pk_bf16_f32 v137, v26, v27
 v_exp_f32 v40, v88
 v_add_f32 v215, v215, v27
 v_exp_f32 v41, v89
 s_nop 0
 v_cvt_pk_bf16_f32 v138, v40, v41
 v_exp_f32 v42, v90
 s_waitcnt vmcnt(16)
 s_barrier
 v_exp_f32 v43, v91
 ds_read_b128 a[192:195], v224 offset:16384
 v_cvt_pk_bf16_f32 v139, v42, v43
 v_exp_f32 v208, v76
 v_add_f32 v215, v215, v40
 v_exp_f32 v209, v77
 s_nop 0
 v_cvt_pk_bf16_f32 v140, v208, v209
 buffer_store_dwordx2 v[238:239], v214, s[24:27], 0 offen sc0 sc1
 s_nop 0
 s_add_u32 m0, s36, 49152
 s_nop 0
 v_exp_f32 v210, v78
 buffer_load_dwordx4 v236, s[8:11], s34 offen offset:0 lds
 v_add_f32 v215, v215, v41
 v_exp_f32 v211, v79
 ds_read_b128 a[196:199], v225 offset:16384
 v_cvt_pk_bf16_f32 v141, v210, v211
 v_exp_f32 v208, v92
 v_add_f32 v215, v215, v43
 v_exp_f32 v209, v93
 s_nop 0
 v_cvt_pk_bf16_f32 v142, v208, v209
 v_exp_f32 v210, v94
 buffer_load_dwordx4 v236, s[8:11], s34 offen offset:1024 lds
 v_add_f32 v215, v215, v42
 v_exp_f32 v211, v95
 ds_read_b128 a[200:203], v226 offset:16384
 v_cvt_pk_bf16_f32 v143, v210, v211
 v_exp_f32 v16, v96
 v_exp_f32 v17, v97
 s_nop 0
 v_mfma_f32_16x16x32_bf16 v[28:31], v[240:243], v[140:143], v[44:47]
 v_cvt_pk_bf16_f32 v144, v16, v17
 v_exp_f32 v18, v98
 buffer_load_dwordx4 v236, s[8:11], s34 offen offset:2048 lds
 v_exp_f32 v19, v99
 ds_read_b128 a[204:207], v227 offset:16384
 v_cvt_pk_bf16_f32 v145, v18, v19
 v_exp_f32 v32, v112
 v_exp_f32 v33, v113
 s_nop 0
 v_cvt_pk_bf16_f32 v146, v32, v33
 v_exp_f32 v34, v114
 buffer_load_dwordx4 v236, s[8:11], s34 offen offset:3072 lds
 s_add_u32 s34, s34, 16384
 s_waitcnt lgkmcnt(0)
 v_exp_f32 v35, v115
 v_mfma_f32_16x16x32_bf16 v[64:67], a[192:195], a[128:131], v[192:195]
 ds_read_b128 a[208:211], v224 offset:17408
 v_cvt_pk_bf16_f32 v147, v34, v35
 v_mfma_f32_16x16x32_bf16 v[64:67], a[196:199], a[132:135], v[64:67]
 v_exp_f32 v208, v100
 v_mfma_f32_16x16x32_bf16 v[64:67], a[200:203], a[136:139], v[64:67]
 v_add_f32 v253, v253, v255
 v_mfma_f32_16x16x32_bf16 v[64:67], a[204:207], a[140:143], v[64:67]
 v_exp_f32 v209, v101
 s_nop 0
 v_cvt_pk_bf16_f32 v148, v208, v209
 s_add_u32 m0, s36, 98304
 s_nop 0
 v_exp_f32 v210, v102
 buffer_load_dwordx4 v237, s[12:15], s35 offen offset:0 lds
 v_add_f32 v255, v16, v17
 v_add_f32 v255, v255, v18
 v_exp_f32 v211, v103
 v_mfma_f32_16x16x32_bf16 v[68:71], a[192:195], a[144:147], v[196:199]
 ds_read_b128 a[212:215], v225 offset:17408
 v_cvt_pk_bf16_f32 v149, v210, v211
 v_mfma_f32_16x16x32_bf16 v[68:71], a[196:199], a[148:151], v[68:71]
 v_exp_f32 v208, v116
 v_mfma_f32_16x16x32_bf16 v[68:71], a[200:203], a[152:155], v[68:71]
 v_add_f32 v255, v255, v19
 v_mfma_f32_16x16x32_bf16 v[68:71], a[204:207], a[156:159], v[68:71]
 v_exp_f32 v209, v117
 s_nop 0
 v_cvt_pk_bf16_f32 v150, v208, v209
 v_exp_f32 v210, v118
 buffer_load_dwordx4 v237, s[12:15], s35 offen offset:1024 lds
 v_add_f32 v255, v255, v32
 v_add_f32 v255, v255, v33
 v_exp_f32 v211, v119
 v_mfma_f32_16x16x32_bf16 v[72:75], a[192:195], a[160:163], v[200:203]
 ds_read_b128 a[216:219], v226 offset:17408
 v_cvt_pk_bf16_f32 v151, v210, v211
 v_mfma_f32_16x16x32_bf16 v[72:75], a[196:199], a[164:167], v[72:75]
 v_exp_f32 v24, v104
 v_mfma_f32_16x16x32_bf16 v[72:75], a[200:203], a[168:171], v[72:75]
 v_add_f32 v255, v255, v34
 v_mfma_f32_16x16x32_bf16 v[72:75], a[204:207], a[172:175], v[72:75]
 v_exp_f32 v25, v105
 v_mfma_f32_16x16x32_bf16 v[36:39], v[240:243], v[148:151], v[20:23]
 v_add_f32 v255, v255, v35
 v_add_f32 v254, v254, v215
 v_cvt_pk_bf16_f32 v152, v24, v25
 v_exp_f32 v26, v106
 buffer_load_dwordx4 v237, s[12:15], s35 offen offset:2048 lds
 v_add_f32 v215, v24, v25
 v_add_f32 v215, v215, v26
 v_exp_f32 v27, v107
 v_mfma_f32_16x16x32_bf16 v[76:79], a[192:195], a[176:179], v[204:207]
 ds_read_b128 a[220:223], v227 offset:17408
 v_cvt_pk_bf16_f32 v153, v26, v27
 v_mfma_f32_16x16x32_bf16 v[76:79], a[196:199], a[180:183], v[76:79]
 v_exp_f32 v40, v120
 v_mfma_f32_16x16x32_bf16 v[76:79], a[200:203], a[184:187], v[76:79]
 v_add_f32 v215, v215, v27
 v_mfma_f32_16x16x32_bf16 v[76:79], a[204:207], a[188:191], v[76:79]
 v_exp_f32 v41, v121
 s_nop 0
 v_cvt_pk_bf16_f32 v154, v40, v41
 s_waitcnt vmcnt(8)
 ds_read_b64_tr_b16 v[6:7], v48 offset:0
 ds_read_b64_tr_b16 v[8:9], v48 offset:1024
 ds_read_b64_tr_b16 v[10:11], v49 offset:0
 ds_read_b64_tr_b16 v[12:13], v49 offset:1024
 ds_read_b64_tr_b16 v[56:57], v50 offset:0
 ds_read_b64_tr_b16 v[58:59], v50 offset:1024
 s_nop 0
 v_exp_f32 v42, v122
 buffer_load_dwordx4 v237, s[12:15], s35 offen offset:3072 lds
 s_add_u32 s35, s35, 16384
 s_waitcnt lgkmcnt(6)
 v_exp_f32 v43, v123
 v_mfma_f32_16x16x32_bf16 v[80:83], a[208:211], a[128:131], v[192:195]
 ds_read_b128 a[192:195], v224 offset:18432
 v_cvt_pk_bf16_f32 v155, v42, v43
 v_mfma_f32_16x16x32_bf16 v[80:83], a[212:215], a[132:135], v[80:83]
 v_exp_f32 v208, v108
 v_mfma_f32_16x16x32_bf16 v[80:83], a[216:219], a[136:139], v[80:83]
 v_add_f32 v215, v215, v40
 v_mfma_f32_16x16x32_bf16 v[80:83], a[220:223], a[140:143], v[80:83]
 v_exp_f32 v209, v109
 s_nop 0
 v_cvt_pk_bf16_f32 v156, v208, v209
 ds_read_b64_tr_b16 v[60:61], v51 offset:0
 ds_read_b64_tr_b16 v[62:63], v51 offset:1024
 ds_read_b64_tr_b16 v[244:245], v52 offset:0
 ds_read_b64_tr_b16 v[246:247], v52 offset:1024
 ds_read_b64_tr_b16 v[248:249], v53 offset:0
 ds_read_b64_tr_b16 v[250:251], v53 offset:1024
 s_nop 0
 v_exp_f32 v210, v110
 v_add_f32 v215, v215, v41
 v_exp_f32 v211, v111
 v_mfma_f32_16x16x32_bf16 v[84:87], a[208:211], a[144:147], v[196:199]
 ds_read_b128 a[196:199], v225 offset:18432
 v_cvt_pk_bf16_f32 v157, v210, v211
 v_mfma_f32_16x16x32_bf16 v[84:87], a[212:215], a[148:151], v[84:87]
 v_exp_f32 v208, v124
 v_mfma_f32_16x16x32_bf16 v[84:87], a[216:219], a[152:155], v[84:87]
 v_add_f32 v215, v215, v43
 v_mfma_f32_16x16x32_bf16 v[84:87], a[220:223], a[156:159], v[84:87]
 v_exp_f32 v209, v125
 s_nop 0
 v_cvt_pk_bf16_f32 v158, v208, v209
 s_mov_b32 s42, s98
 s_mov_b32 s43, s42
 s_waitcnt lgkmcnt(12)
 buffer_store_dwordx4 v[6:9], v252, s[20:23], s43 offen offset:0 sc1
 s_nop 0
 v_exp_f32 v210, v126
 s_waitcnt lgkmcnt(10)
 buffer_store_dwordx4 v[10:13], v252, s[20:23], s43 offen offset:1024 sc1
 v_add_f32 v215, v215, v42
 v_exp_f32 v211, v127
 v_mfma_f32_16x16x32_bf16 v[88:91], a[208:211], a[160:163], v[200:203]
 ds_read_b128 a[200:203], v226 offset:18432
 v_cvt_pk_bf16_f32 v159, v210, v211
 v_mfma_f32_16x16x32_bf16 v[88:91], a[212:215], a[164:167], v[88:91]
 v_exp_f32 v16, v64
 v_mfma_f32_16x16x32_bf16 v[88:91], a[216:219], a[168:171], v[88:91]
 ds_read_b64_tr_b16 a[224:225], v228 offset:0
 v_mfma_f32_16x16x32_bf16 v[88:91], a[220:223], a[172:175], v[88:91]
 v_exp_f32 v17, v65
 v_mfma_f32_16x16x32_bf16 v[44:47], v[240:243], v[156:159], v[28:31]
 ds_read_b64_tr_b16 a[226:227], v228 offset:1024
 v_cvt_pk_bf16_f32 v160, v16, v17
 ds_read_b64_tr_b16 v[6:7], v54 offset:0
 ds_read_b64_tr_b16 v[8:9], v54 offset:1024
 ds_read_b64_tr_b16 v[10:11], v55 offset:0
 ds_read_b64_tr_b16 v[12:13], v55 offset:1024
 s_add_u32 s43, s42, s99
 s_waitcnt lgkmcnt(15)
 buffer_store_dwordx4 v[56:59], v252, s[20:23], s43 offen offset:0 sc1
 s_nop 0
 v_exp_f32 v18, v66
 s_waitcnt lgkmcnt(12)
 buffer_store_dwordx4 v[60:63], v252, s[20:23], s43 offen offset:1024 sc1
 v_exp_f32 v19, v67
 v_mfma_f32_16x16x32_bf16 v[92:95], a[208:211], a[176:179], v[204:207]
 ds_read_b128 a[204:207], v227 offset:18432
 v_cvt_pk_bf16_f32 v161, v18, v19
 v_mfma_f32_16x16x32_bf16 v[92:95], a[212:215], a[180:183], v[92:95]
 v_exp_f32 v32, v80
 v_mfma_f32_16x16x32_bf16 v[92:95], a[216:219], a[184:187], v[92:95]
 ds_read_b64_tr_b16 a[228:229], v228 offset:2048
 v_mfma_f32_16x16x32_bf16 v[92:95], a[220:223], a[188:191], v[92:95]
 v_exp_f32 v33, v81
 ds_read_b64_tr_b16 a[230:231], v228 offset:3072
 v_cvt_pk_bf16_f32 v162, v32, v33
 s_add_u32 s42, s98, s100
 s_mov_b32 s43, s42
 s_waitcnt lgkmcnt(13)
 buffer_store_dwordx4 v[244:247], v252, s[20:23], s43 offen offset:0 sc1
 s_nop 0
 v_exp_f32 v34, v82
 s_waitcnt lgkmcnt(11)
 buffer_store_dwordx4 v[248:251], v252, s[20:23], s43 offen offset:1024 sc1
 s_waitcnt lgkmcnt(2)
 v_exp_f32 v35, v83
 s_add_u32 s43, s42, s99
 s_waitcnt lgkmcnt(5)
 buffer_store_dwordx4 v[6:9], v252, s[20:23], s43 offen offset:0 sc1
 s_waitcnt lgkmcnt(3)
 buffer_store_dwordx4 v[10:13], v252, s[20:23], s43 offen offset:1024 sc1
 s_waitcnt lgkmcnt(0)
 s_nop 0
 v_lshlrev_b32 v6, 28, v1
 v_lshl_add_u32 v6, s33, 2, v6
 v_mov_b32 v7, s94
 v_cmp_eq_u32 vcc, 0, v1
 v_mov_b32 v8, 0x40000000
 s_mov_b32 s97, s96
 v_cndmask_b32 v6, v8, v6, vcc
 v_and_b32 v8, 31, v1
 v_lshlrev_b32 v8, 2, v8
 s_mov_b32 s38, 7
.p2align 6
L_loop:
 v_mfma_f32_16x16x32_bf16 v[96:99], a[192:195], a[128:131], v[192:195]
 ds_read_b128 a[208:211], v224 offset:19456
 v_cvt_pk_bf16_f32 v163, v34, v35
 v_mfma_f32_16x16x32_bf16 v[96:99], a[196:199], a[132:135], v[96:99]
 v_exp_f32 v208, v68
 v_mfma_f32_16x16x32_bf16 v[96:99], a[200:203], a[136:139], v[96:99]
 ds_read_b64_tr_b16 a[232:233], v229 offset:0
 v_add_f32 v253, v253, v255
 v_mfma_f32_16x16x32_bf16 v[96:99], a[204:207], a[140:143], v[96:99]
 s_waitcnt lgkmcnt(2)
 v_exp_f32 v209, v69
 v_mfma_f32_16x16x32_bf16 a[0:3], a[224:227], v[128:131], a[0:3]
 ds_read_b64_tr_b16 a[234:235], v229 offset:1024
 v_cvt_pk_bf16_f32 v164, v208, v209
 v_mfma_f32_16x16x32_bf16 a[0:3], a[228:231], v[144:147], a[0:3]
 v_exp_f32 v210, v70
 v_mfma_f32_16x16x32_bf16 a[4:7], a[224:227], v[132:135], a[4:7]
 v_add_f32 v255, v16, v17
 v_add_f32 v255, v255, v18
 v_mfma_f32_16x16x32_bf16 a[4:7], a[228:231], v[148:151], a[4:7]
 v_exp_f32 v211, v71
 v_mfma_f32_16x16x32_bf16 v[100:103], a[192:195], a[144:147], v[196:199]
 ds_read_b128 a[212:215], v225 offset:19456
 v_cvt_pk_bf16_f32 v165, v210, v211
 v_mfma_f32_16x16x32_bf16 v[100:103], a[196:199], a[148:151], v[100:103]
 v_exp_f32 v208, v84
 v_mfma_f32_16x16x32_bf16 v[100:103], a[200:203], a[152:155], v[100:103]
 ds_read_b64_tr_b16 a[236:237], v229 offset:2048
 v_add_f32 v255, v255, v19
 v_mfma_f32_16x16x32_bf16 v[100:103], a[204:207], a[156:159], v[100:103]
 v_exp_f32 v209, v85
 v_mfma_f32_16x16x32_bf16 a[8:11], a[224:227], v[136:139], a[8:11]
 ds_read_b64_tr_b16 a[238:239], v229 offset:3072
 v_cvt_pk_bf16_f32 v166, v208, v209
 v_mfma_f32_16x16x32_bf16 a[8:11], a[228:231], v[152:155], a[8:11]
 v_exp_f32 v210, v86
 v_mfma_f32_16x16x32_bf16 a[12:15], a[224:227], v[140:143], a[12:15]
 v_add_f32 v255, v255, v32
 v_add_f32 v255, v255, v33
 v_mfma_f32_16x16x32_bf16 a[12:15], a[228:231], v[156:159], a[12:15]
 v_exp_f32 v211, v87
 v_mfma_f32_16x16x32_bf16 v[104:107], a[192:195], a[160:163], v[200:203]
 ds_read_b128 a[216:219], v226 offset:19456
 v_cvt_pk_bf16_f32 v167, v210, v211
 v_mfma_f32_16x16x32_bf16 v[104:107], a[196:199], a[164:167], v[104:107]
 v_exp_f32 v24, v72
 v_mfma_f32_16x16x32_bf16 v[104:107], a[200:203], a[168:171], v[104:107]
 ds_read_b64_tr_b16 a[240:241], v230 offset:0
 v_add_f32 v255, v255, v34
 v_mfma_f32_16x16x32_bf16 v[104:107], a[204:207], a[172:175], v[104:107]
 s_waitcnt lgkmcnt(2)
 v_exp_f32 v25, v73
 v_mfma_f32_16x16x32_bf16 v[20:23], v[240:243], v[164:167], v[36:39]
 v_add_f32 v255, v255, v35
 v_add_f32 v254, v254, v215
 v_mfma_f32_16x16x32_bf16 a[16:19], a[232:235], v[128:131], a[16:19]
 ds_read_b64_tr_b16 a[242:243], v230 offset:1024
 v_cvt_pk_bf16_f32 v168, v24, v25
 v_mfma_f32_16x16x32_bf16 a[16:19], a[236:239], v[144:147], a[16:19]
 v_exp_f32 v26, v74
 v_mfma_f32_16x16x32_bf16 a[20:23], a[232:235], v[132:135], a[20:23]
 v_add_f32 v215, v24, v25
 v_add_f32 v215, v215, v26
 v_mfma_f32_16x16x32_bf16 a[20:23], a[236:239], v[148:151], a[20:23]
 v_exp_f32 v27, v75
 v_mfma_f32_16x16x32_bf16 v[108:111], a[192:195], a[176:179], v[204:207]
 ds_read_b128 a[220:223], v227 offset:19456
 v_cvt_pk_bf16_f32 v169, v26, v27
 v_mfma_f32_16x16x32_bf16 v[108:111], a[196:199], a[180:183], v[108:111]
 v_exp_f32 v40, v88
 v_mfma_f32_16x16x32_bf16 v[108:111], a[200:203], a[184:187], v[108:111]
 ds_read_b64_tr_b16 a[244:245], v230 offset:2048
 v_add_f32 v215, v215, v27
 v_mfma_f32_16x16x32_bf16 v[108:111], a[204:207], a[188:191], v[108:111]
 v_exp_f32 v41, v89
 v_mfma_f32_16x16x32_bf16 a[24:27], a[232:235], v[136:139], a[24:27]
 ds_read_b64_tr_b16 a[246:247], v230 offset:3072
 v_cvt_pk_bf16_f32 v170, v40, v41
 v_mfma_f32_16x16x32_bf16 a[24:27], a[236:239], v[152:155], a[24:27]
 v_exp_f32 v42, v90
 v_mfma_f32_16x16x32_bf16 a[28:31], a[232:235], v[140:143], a[28:31]
 s_waitcnt vmcnt(8) lgkmcnt(2)
 s_barrier
 v_mfma_f32_16x16x32_bf16 a[28:31], a[236:239], v[156:159], a[28:31]
 v_exp_f32 v43, v91
 v_mfma_f32_16x16x32_bf16 v[112:115], a[208:211], a[128:131], v[192:195]
 ds_read_b128 a[192:195], v224 offset:32768
 v_cvt_pk_bf16_f32 v171, v42, v43
 v_mfma_f32_16x16x32_bf16 v[112:115], a[212:215], a[132:135], v[112:115]
 v_exp_f32 v208, v76
 v_mfma_f32_16x16x32_bf16 v[112:115], a[216:219], a[136:139], v[112:115]
 ds_read_b64_tr_b16 a[248:249], v231 offset:0
 v_add_f32 v215, v215, v40
 v_mfma_f32_16x16x32_bf16 v[112:115], a[220:223], a[140:143], v[112:115]
 s_waitcnt lgkmcnt(2)
 v_exp_f32 v209, v77
 v_mfma_f32_16x16x32_bf16 a[32:35], a[240:243], v[128:131], a[32:35]
 ds_read_b64_tr_b16 a[250:251], v231 offset:1024
 v_cvt_pk_bf16_f32 v172, v208, v209
 v_mfma_f32_16x16x32_bf16 a[32:35], a[244:247], v[144:147], a[32:35]
 s_add_u32 m0, s36, 0
 v_exp_f32 v210, v78
 v_mfma_f32_16x16x32_bf16 a[36:39], a[240:243], v[132:135], a[36:39]
 buffer_load_dwordx4 v236, s[8:11], s34 offen offset:0 lds
 v_add_f32 v215, v215, v41
 v_mfma_f32_16x16x32_bf16 a[36:39], a[244:247], v[148:151], a[36:39]
 v_exp_f32 v211, v79
 v_mfma_f32_16x16x32_bf16 v[116:119], a[208:211], a[144:147], v[196:199]
 ds_read_b128 a[196:199], v225 offset:32768
 v_cvt_pk_bf16_f32 v173, v210, v211
 v_mfma_f32_16x16x32_bf16 v[116:119], a[212:215], a[148:151], v[116:119]
 v_exp_f32 v208, v92
 v_mfma_f32_16x16x32_bf16 v[116:119], a[216:219], a[152:155], v[116:119]
 ds_read_b64_tr_b16 a[252:253], v231 offset:2048
 v_add_f32 v215, v215, v43
 v_mfma_f32_16x16x32_bf16 v[116:119], a[220:223], a[156:159], v[116:119]
 v_exp_f32 v209, v93
 v_mfma_f32_16x16x32_bf16 a[40:43], a[240:243], v[136:139], a[40:43]
 ds_read_b64_tr_b16 a[254:255], v231 offset:3072
 v_cvt_pk_bf16_f32 v174, v208, v209
 v_mfma_f32_16x16x32_bf16 a[40:43], a[244:247], v[152:155], a[40:43]
 v_exp_f32 v210, v94
 v_mfma_f32_16x16x32_bf16 a[44:47], a[240:243], v[140:143], a[44:47]
 buffer_load_dwordx4 v236, s[8:11], s34 offen offset:1024 lds
 v_add_f32 v215, v215, v42
 v_mfma_f32_16x16x32_bf16 a[44:47], a[244:247], v[156:159], a[44:47]
 v_exp_f32 v211, v95
 v_mfma_f32_16x16x32_bf16 v[120:123], a[208:211], a[160:163], v[200:203]
 ds_read_b128 a[200:203], v226 offset:32768
 v_cvt_pk_bf16_f32 v175, v210, v211
 v_mfma_f32_16x16x32_bf16 v[120:123], a[212:215], a[164:167], v[120:123]
 v_exp_f32 v16, v96
 v_mfma_f32_16x16x32_bf16 v[120:123], a[216:219], a[168:171], v[120:123]
 ds_read_b64_tr_b16 a[224:225], v232 offset:0
 v_max3_f32 v212, v255, v20, v215
 v_mfma_f32_16x16x32_bf16 v[120:123], a[220:223], a[172:175], v[120:123]
 s_waitcnt lgkmcnt(2)
 v_exp_f32 v17, v97
 v_mfma_f32_16x16x32_bf16 v[28:31], v[240:243], v[172:175], v[44:47]
 buffer_load_dwordx4 v236, s[8:11], s34 offen offset:2048 lds
 v_cmp_ngt_f32 s[46:47], s37, v212
 v_mfma_f32_16x16x32_bf16 a[48:51], a[248:251], v[128:131], a[48:51]
 ds_read_b64_tr_b16 a[226:227], v232 offset:1024
 v_cvt_pk_bf16_f32 v176, v16, v17
 v_mfma_f32_16x16x32_bf16 a[48:51], a[252:255], v[144:147], a[48:51]
 v_exp_f32 v18, v98
 v_mfma_f32_16x16x32_bf16 a[52:55], a[248:251], v[132:135], a[52:55]
 buffer_load_dwordx4 v236, s[8:11], s34 offen offset:3072 lds
 s_add_u32 s34, s34, 16384
 v_mfma_f32_16x16x32_bf16 a[52:55], a[252:255], v[148:151], a[52:55]
 v_exp_f32 v19, v99
 v_mfma_f32_16x16x32_bf16 v[124:127], a[208:211], a[176:179], v[204:207]
 ds_read_b128 a[204:207], v227 offset:32768
 v_cvt_pk_bf16_f32 v177, v18, v19
 v_mfma_f32_16x16x32_bf16 v[124:127], a[212:215], a[180:183], v[124:127]
 v_exp_f32 v32, v112
 v_mfma_f32_16x16x32_bf16 v[124:127], a[216:219], a[184:187], v[124:127]
 ds_read_b64_tr_b16 a[228:229], v232 offset:2048
 v_cmp_ngt_f32 vcc, s37, v28
 v_mfma_f32_16x16x32_bf16 v[124:127], a[220:223], a[188:191], v[124:127]
 v_exp_f32 v33, v113
 v_mfma_f32_16x16x32_bf16 a[56:59], a[248:251], v[136:139], a[56:59]
 ds_read_b64_tr_b16 a[230:231], v232 offset:3072
 v_cvt_pk_bf16_f32 v178, v32, v33
 v_mfma_f32_16x16x32_bf16 a[56:59], a[252:255], v[152:155], a[56:59]
 s_or_b64 vcc, vcc, s[46:47]
 v_exp_f32 v34, v114
 v_mfma_f32_16x16x32_bf16 a[60:63], a[248:251], v[140:143], a[60:63]
 s_cbranch_vccnz L_tr_m2
L_back_m2:
 v_mfma_f32_16x16x32_bf16 a[60:63], a[252:255], v[156:159], a[60:63]
 s_waitcnt lgkmcnt(2)
 v_exp_f32 v35, v115
 v_mfma_f32_16x16x32_bf16 v[64:67], a[192:195], a[128:131], v[192:195]
 ds_read_b128 a[208:211], v224 offset:33792
 v_cvt_pk_bf16_f32 v179, v34, v35
 v_mfma_f32_16x16x32_bf16 v[64:67], a[196:199], a[132:135], v[64:67]
 v_exp_f32 v208, v100
 v_mfma_f32_16x16x32_bf16 v[64:67], a[200:203], a[136:139], v[64:67]
 ds_read_b64_tr_b16 a[232:233], v233 offset:0
 v_add_f32 v253, v253, v255
 v_mfma_f32_16x16x32_bf16 v[64:67], a[204:207], a[140:143], v[64:67]
 s_waitcnt lgkmcnt(2)
 v_exp_f32 v209, v101
 v_mfma_f32_16x16x32_bf16 a[64:67], a[224:227], v[128:131], a[64:67]
 ds_read_b64_tr_b16 a[234:235], v233 offset:1024
 v_cvt_pk_bf16_f32 v180, v208, v209
 v_mfma_f32_16x16x32_bf16 a[64:67], a[228:231], v[144:147], a[64:67]
 v_exp_f32 v210, v102
 v_mfma_f32_16x16x32_bf16 a[68:71], a[224:227], v[132:135], a[68:71]
 v_add_f32 v255, v16, v17
 v_add_f32 v255, v255, v18
 v_mfma_f32_16x16x32_bf16 a[68:71], a[228:231], v[148:151], a[68:71]
 v_exp_f32 v211, v103
 v_mfma_f32_16x16x32_bf16 v[68:71], a[192:195], a[144:147], v[196:199]
 ds_read_b128 a[212:215], v225 offset:33792
 v_cvt_pk_bf16_f32 v181, v210, v211
 v_mfma_f32_16x16x32_bf16 v[68:71], a[196:199], a[148:151], v[68:71]
 v_exp_f32 v208, v116
 v_mfma_f32_16x16x32_bf16 v[68:71], a[200:203], a[152:155], v[68:71]
 ds_read_b64_tr_b16 a[236:237], v233 offset:2048
 v_add_f32 v255, v255, v19
 v_mfma_f32_16x16x32_bf16 v[68:71], a[204:207], a[156:159], v[68:71]
 v_exp_f32 v209, v117
 v_mfma_f32_16x16x32_bf16 a[72:75], a[224:227], v[136:139], a[72:75]
 ds_read_b64_tr_b16 a[238:239], v233 offset:3072
 v_cvt_pk_bf16_f32 v182, v208, v209
 v_mfma_f32_16x16x32_bf16 a[72:75], a[228:231], v[152:155], a[72:75]
 v_exp_f32 v210, v118
 v_mfma_f32_16x16x32_bf16 a[76:79], a[224:227], v[140:143], a[76:79]
 v_add_f32 v255, v255, v32
 v_add_f32 v255, v255, v33
 v_mfma_f32_16x16x32_bf16 a[76:79], a[228:231], v[156:159], a[76:79]
 v_exp_f32 v211, v119
 v_mfma_f32_16x16x32_bf16 v[72:75], a[192:195], a[160:163], v[200:203]
 ds_read_b128 a[216:219], v226 offset:33792
 v_cvt_pk_bf16_f32 v183, v210, v211
 v_mfma_f32_16x16x32_bf16 v[72:75], a[196:199], a[164:167], v[72:75]
 v_exp_f32 v24, v104
 v_mfma_f32_16x16x32_bf16 v[72:75], a[200:203], a[168:171], v[72:75]
 ds_read_b64_tr_b16 a[240:241], v234 offset:0
 v_add_f32 v255, v255, v34
 v_mfma_f32_16x16x32_bf16 v[72:75], a[204:207], a[172:175], v[72:75]
 s_waitcnt lgkmcnt(2)
 v_exp_f32 v25, v105
 v_mfma_f32_16x16x32_bf16 v[36:39], v[240:243], v[180:183], v[20:23]
 v_add_f32 v255, v255, v35
 v_add_f32 v254, v254, v215
 v_mfma_f32_16x16x32_bf16 a[80:83], a[232:235], v[128:131], a[80:83]
 ds_read_b64_tr_b16 a[242:243], v234 offset:1024
 v_cvt_pk_bf16_f32 v184, v24, v25
 v_mfma_f32_16x16x32_bf16 a[80:83], a[236:239], v[144:147], a[80:83]
 v_exp_f32 v26, v106
 v_mfma_f32_16x16x32_bf16 a[84:87], a[232:235], v[132:135], a[84:87]
 v_add_f32 v215, v24, v25
 v_add_f32 v215, v215, v26
 v_mfma_f32_16x16x32_bf16 a[84:87], a[236:239], v[148:151], a[84:87]
 v_exp_f32 v27, v107
 v_mfma_f32_16x16x32_bf16 v[76:79], a[192:195], a[176:179], v[204:207]
 ds_read_b128 a[220:223], v227 offset:33792
 v_cvt_pk_bf16_f32 v185, v26, v27
 v_mfma_f32_16x16x32_bf16 v[76:79], a[196:199], a[180:183], v[76:79]
 v_exp_f32 v40, v120
 v_mfma_f32_16x16x32_bf16 v[76:79], a[200:203], a[184:187], v[76:79]
 ds_read_b64_tr_b16 a[244:245], v234 offset:2048
 v_add_f32 v215, v215, v27
 v_mfma_f32_16x16x32_bf16 v[76:79], a[204:207], a[188:191], v[76:79]
 v_exp_f32 v41, v121
 v_mfma_f32_16x16x32_bf16 a[88:91], a[232:235], v[136:139], a[88:91]
 ds_read_b64_tr_b16 a[246:247], v234 offset:3072
 v_cvt_pk_bf16_f32 v186, v40, v41
 v_mfma_f32_16x16x32_bf16 a[88:91], a[236:239], v[152:155], a[88:91]
 s_add_u32 m0, s36, 114688
 v_exp_f32 v42, v122
 v_mfma_f32_16x16x32_bf16 a[92:95], a[232:235], v[140:143], a[92:95]
 buffer_load_dwordx4 v237, s[12:15], s35 offen offset:0 lds
 v_mfma_f32_16x16x32_bf16 a[92:95], a[236:239], v[156:159], a[92:95]
 s_waitcnt lgkmcnt(2)
 v_exp_f32 v43, v123
 v_mfma_f32_16x16x32_bf16 v[80:83], a[208:211], a[128:131], v[192:195]
 ds_read_b128 a[192:195], v224 offset:34816
 v_cvt_pk_bf16_f32 v187, v42, v43
 v_mfma_f32_16x16x32_bf16 v[80:83], a[212:215], a[132:135], v[80:83]
 v_exp_f32 v208, v108
 v_mfma_f32_16x16x32_bf16 v[80:83], a[216:219], a[136:139], v[80:83]
 ds_read_b64_tr_b16 a[248:249], v235 offset:0
 v_add_f32 v215, v215, v40
 v_mfma_f32_16x16x32_bf16 v[80:83], a[220:223], a[140:143], v[80:83]
 s_waitcnt lgkmcnt(2)
 v_exp_f32 v209, v109
 v_mfma_f32_16x16x32_bf16 a[96:99], a[240:243], v[128:131], a[96:99]
 ds_read_b64_tr_b16 a[250:251], v235 offset:1024
 v_cvt_pk_bf16_f32 v188, v208, v209
 v_mfma_f32_16x16x32_bf16 a[96:99], a[244:247], v[144:147], a[96:99]
 v_exp_f32 v210, v110
 v_mfma_f32_16x16x32_bf16 a[100:103], a[240:243], v[132:135], a[100:103]
 buffer_load_dwordx4 v237, s[12:15], s35 offen offset:1024 lds
 v_add_f32 v215, v215, v41
 v_mfma_f32_16x16x32_bf16 a[100:103], a[244:247], v[148:151], a[100:103]
 v_exp_f32 v211, v111
 v_mfma_f32_16x16x32_bf16 v[84:87], a[208:211], a[144:147], v[196:199]
 ds_read_b128 a[196:199], v225 offset:34816
 v_cvt_pk_bf16_f32 v189, v210, v211
 v_mfma_f32_16x16x32_bf16 v[84:87], a[212:215], a[148:151], v[84:87]
 v_exp_f32 v208, v124
 v_mfma_f32_16x16x32_bf16 v[84:87], a[216:219], a[152:155], v[84:87]
 ds_read_b64_tr_b16 a[252:253], v235 offset:2048
 v_add_f32 v215, v215, v43
 v_mfma_f32_16x16x32_bf16 v[84:87], a[220:223], a[156:159], v[84:87]
 v_exp_f32 v209, v125
 v_mfma_f32_16x16x32_bf16 a[104:107], a[240:243], v[136:139], a[104:107]
 ds_read_b64_tr_b16 a[254:255], v235 offset:3072
 v_cvt_pk_bf16_f32 v190, v208, v209
 v_mfma_f32_16x16x32_bf16 a[104:107], a[244:247], v[152:155], a[104:107]
 v_exp_f32 v210, v126
 v_mfma_f32_16x16x32_bf16 a[108:111], a[240:243], v[140:143], a[108:111]
 buffer_load_dwordx4 v237, s[12:15], s35 offen offset:2048 lds
 v_add_f32 v215, v215, v42
 v_mfma_f32_16x16x32_bf16 a[108:111], a[244:247], v[156:159], a[108:111]
 v_exp_f32 v211, v127
 v_mfma_f32_16x16x32_bf16 v[88:91], a[208:211], a[160:163], v[200:203]
 ds_read_b128 a[200:203], v226 offset:34816
 v_cvt_pk_bf16_f32 v191, v210, v211
 v_mfma_f32_16x16x32_bf16 v[88:91], a[212:215], a[164:167], v[88:91]
 v_exp_f32 v16, v64
 v_mfma_f32_16x16x32_bf16 v[88:91], a[216:219], a[168:171], v[88:91]
 ds_read_b64_tr_b16 a[224:225], v228 offset:16384
 v_max3_f32 v212, v255, v36, v215
 v_mfma_f32_16x16x32_bf16 v[88:91], a[220:223], a[172:175], v[88:91]
 s_waitcnt lgkmcnt(2)
 v_exp_f32 v17, v65
 v_mfma_f32_16x16x32_bf16 v[44:47], v[240:243], v[188:191], v[28:31]
 v_cmp_ngt_f32 s[46:47], s37, v212
 v_mfma_f32_16x16x32_bf16 a[112:115], a[248:251], v[128:131], a[112:115]
 ds_read_b64_tr_b16 a[226:227], v228 offset:17408
 v_cvt_pk_bf16_f32 v128, v16, v17
 v_mfma_f32_16x16x32_bf16 a[112:115], a[252:255], v[144:147], a[112:115]
 v_exp_f32 v18, v66
 v_mfma_f32_16x16x32_bf16 a[116:119], a[248:251], v[132:135], a[116:119]
 buffer_load_dwordx4 v237, s[12:15], s35 offen offset:3072 lds
 s_add_u32 s35, s35, 16384
 v_mfma_f32_16x16x32_bf16 a[116:119], a[252:255], v[148:151], a[116:119]
 v_exp_f32 v19, v67
 v_mfma_f32_16x16x32_bf16 v[92:95], a[208:211], a[176:179], v[204:207]
 ds_read_b128 a[204:207], v227 offset:34816
 v_cvt_pk_bf16_f32 v129, v18, v19
 v_mfma_f32_16x16x32_bf16 v[92:95], a[212:215], a[180:183], v[92:95]
 v_exp_f32 v32, v80
 v_mfma_f32_16x16x32_bf16 v[92:95], a[216:219], a[184:187], v[92:95]
 ds_read_b64_tr_b16 a[228:229], v228 offset:18432
 v_cmp_ngt_f32 vcc, s37, v44
 v_mfma_f32_16x16x32_bf16 v[92:95], a[220:223], a[188:191], v[92:95]
 v_exp_f32 v33, v81
 v_mfma_f32_16x16x32_bf16 a[120:123], a[248:251], v[136:139], a[120:123]
 ds_read_b64_tr_b16 a[230:231], v228 offset:19456
 v_cvt_pk_bf16_f32 v130, v32, v33
 v_mfma_f32_16x16x32_bf16 a[120:123], a[252:255], v[152:155], a[120:123]
 s_or_b64 vcc, vcc, s[46:47]
 v_exp_f32 v34, v82
 v_mfma_f32_16x16x32_bf16 a[124:127], a[248:251], v[140:143], a[124:127]
 s_cbranch_vccnz L_tr_m3
L_back_m3:
 v_mfma_f32_16x16x32_bf16 a[124:127], a[252:255], v[156:159], a[124:127]
 s_waitcnt lgkmcnt(2)
 v_exp_f32 v35, v83
 v_mfma_f32_16x16x32_bf16 v[96:99], a[192:195], a[128:131], v[192:195]
 ds_read_b128 a[208:211], v224 offset:35840
 v_cvt_pk_bf16_f32 v131, v34, v35
 v_mfma_f32_16x16x32_bf16 v[96:99], a[196:199], a[132:135], v[96:99]
 v_exp_f32 v208, v68
 v_mfma_f32_16x16x32_bf16 v[96:99], a[200:203], a[136:139], v[96:99]
 ds_read_b64_tr_b16 a[232:233], v229 offset:16384
 v_add_f32 v253, v253, v255
 v_mfma_f32_16x16x32_bf16 v[96:99], a[204:207], a[140:143], v[96:99]
 s_waitcnt lgkmcnt(2)
 v_exp_f32 v209, v69
 v_mfma_f32_16x16x32_bf16 a[0:3], a[224:227], v[160:163], a[0:3]
 ds_read_b64_tr_b16 a[234:235], v229 offset:17408
 v_cvt_pk_bf16_f32 v132, v208, v209
 v_mfma_f32_16x16x32_bf16 a[0:3], a[228:231], v[176:179], a[0:3]
 v_exp_f32 v210, v70
 v_mfma_f32_16x16x32_bf16 a[4:7], a[224:227], v[164:167], a[4:7]
 v_add_f32 v255, v16, v17
 v_add_f32 v255, v255, v18
 v_mfma_f32_16x16x32_bf16 a[4:7], a[228:231], v[180:183], a[4:7]
 v_exp_f32 v211, v71
 v_mfma_f32_16x16x32_bf16 v[100:103], a[192:195], a[144:147], v[196:199]
 ds_read_b128 a[212:215], v225 offset:35840
 v_cvt_pk_bf16_f32 v133, v210, v211
 v_mfma_f32_16x16x32_bf16 v[100:103], a[196:199], a[148:151], v[100:103]
 v_exp_f32 v208, v84
 v_mfma_f32_16x16x32_bf16 v[100:103], a[200:203], a[152:155], v[100:103]
 ds_read_b64_tr_b16 a[236:237], v229 offset:18432
 v_add_f32 v255, v255, v19
 v_mfma_f32_16x16x32_bf16 v[100:103], a[204:207], a[156:159], v[100:103]
 v_exp_f32 v209, v85
 v_mfma_f32_16x16x32_bf16 a[8:11], a[224:227], v[168:171], a[8:11]
 ds_read_b64_tr_b16 a[238:239], v229 offset:19456
 v_cvt_pk_bf16_f32 v134, v208, v209
 v_mfma_f32_16x16x32_bf16 a[8:11], a[228:231], v[184:187], a[8:11]
 v_exp_f32 v210, v86
 v_mfma_f32_16x16x32_bf16 a[12:15], a[224:227], v[172:175], a[12:15]
 v_add_f32 v255, v255, v32
 v_add_f32 v255, v255, v33
 v_mfma_f32_16x16x32_bf16 a[12:15], a[228:231], v[188:191], a[12:15]
 v_exp_f32 v211, v87
 v_mfma_f32_16x16x32_bf16 v[104:107], a[192:195], a[160:163], v[200:203]
 ds_read_b128 a[216:219], v226 offset:35840
 v_cvt_pk_bf16_f32 v135, v210, v211
 v_mfma_f32_16x16x32_bf16 v[104:107], a[196:199], a[164:167], v[104:107]
 v_exp_f32 v24, v72
 v_mfma_f32_16x16x32_bf16 v[104:107], a[200:203], a[168:171], v[104:107]
 ds_read_b64_tr_b16 a[240:241], v230 offset:16384
 v_add_f32 v255, v255, v34
 v_mfma_f32_16x16x32_bf16 v[104:107], a[204:207], a[172:175], v[104:107]
 s_waitcnt lgkmcnt(2)
 v_exp_f32 v25, v73
 v_mfma_f32_16x16x32_bf16 v[20:23], v[240:243], v[132:135], v[36:39]
 v_add_f32 v255, v255, v35
 v_add_f32 v254, v254, v215
 v_mfma_f32_16x16x32_bf16 a[16:19], a[232:235], v[160:163], a[16:19]
 ds_read_b64_tr_b16 a[242:243], v230 offset:17408
 v_cvt_pk_bf16_f32 v136, v24, v25
 v_mfma_f32_16x16x32_bf16 a[16:19], a[236:239], v[176:179], a[16:19]
 v_exp_f32 v26, v74
 v_mfma_f32_16x16x32_bf16 a[20:23], a[232:235], v[164:167], a[20:23]
 v_add_f32 v215, v24, v25
 v_add_f32 v215, v215, v26
 v_mfma_f32_16x16x32_bf16 a[20:23], a[236:239], v[180:183], a[20:23]
 v_exp_f32 v27, v75
 v_mfma_f32_16x16x32_bf16 v[108:111], a[192:195], a[176:179], v[204:207]
 ds_read_b128 a[220:223], v227 offset:35840
 v_cvt_pk_bf16_f32 v137, v26, v27
 v_mfma_f32_16x16x32_bf16 v[108:111], a[196:199], a[180:183], v[108:111]
 v_exp_f32 v40, v88
 v_mfma_f32_16x16x32_bf16 v[108:111], a[200:203], a[184:187], v[108:111]
 ds_read_b64_tr_b16 a[244:245], v230 offset:18432
 v_add_f32 v215, v215, v27
 v_mfma_f32_16x16x32_bf16 v[108:111], a[204:207], a[188:191], v[108:111]
 v_exp_f32 v41, v89
 v_mfma_f32_16x16x32_bf16 a[24:27], a[232:235], v[168:171], a[24:27]
 ds_read_b64_tr_b16 a[246:247], v230 offset:19456
 v_cvt_pk_bf16_f32 v138, v40, v41
 v_mfma_f32_16x16x32_bf16 a[24:27], a[236:239], v[184:187], a[24:27]
 v_exp_f32 v42, v90
 v_mfma_f32_16x16x32_bf16 a[28:31], a[232:235], v[172:175], a[28:31]
 s_waitcnt vmcnt(8) lgkmcnt(2)
 s_barrier
 v_mfma_f32_16x16x32_bf16 a[28:31], a[236:239], v[188:191], a[28:31]
 v_exp_f32 v43, v91
 v_mfma_f32_16x16x32_bf16 v[112:115], a[208:211], a[128:131], v[192:195]
 ds_read_b128 a[192:195], v224 offset:49152
 v_cvt_pk_bf16_f32 v139, v42, v43
 v_mfma_f32_16x16x32_bf16 v[112:115], a[212:215], a[132:135], v[112:115]
 v_exp_f32 v208, v76
 v_mfma_f32_16x16x32_bf16 v[112:115], a[216:219], a[136:139], v[112:115]
 ds_read_b64_tr_b16 a[248:249], v231 offset:16384
 v_add_f32 v215, v215, v40
 v_mfma_f32_16x16x32_bf16 v[112:115], a[220:223], a[140:143], v[112:115]
 s_waitcnt lgkmcnt(2)
 v_exp_f32 v209, v77
 v_mfma_f32_16x16x32_bf16 a[32:35], a[240:243], v[160:163], a[32:35]
 ds_read_b64_tr_b16 a[250:251], v231 offset:17408
 v_cvt_pk_bf16_f32 v140, v208, v209
 v_mfma_f32_16x16x32_bf16 a[32:35], a[244:247], v[176:179], a[32:35]
 buffer_store_dword v7, v6, s[24:27], s97 offen sc1
 s_mov_b32 s97, 0x40000000
 s_add_u32 m0, s36, 16384
 v_exp_f32 v210, v78
 v_mfma_f32_16x16x32_bf16 a[36:39], a[240:243], v[164:167], a[36:39]
 buffer_load_dwordx4 v236, s[8:11], s34 offen offset:0 lds
 v_add_f32 v215, v215, v41
 v_mfma_f32_16x16x32_bf16 a[36:39], a[244:247], v[180:183], a[36:39]
 v_exp_f32 v211, v79
 v_mfma_f32_16x16x32_bf16 v[116:119], a[208:211], a[144:147], v[196:199]
 ds_read_b128 a[196:199], v225 offset:49152
 v_cvt_pk_bf16_f32 v141, v210, v211
 v_mfma_f32_16x16x32_bf16 v[116:119], a[212:215], a[148:151], v[116:119]
 v_exp_f32 v208, v92
 v_mfma_f32_16x16x32_bf16 v[116:119], a[216:219], a[152:155], v[116:119]
 ds_read_b64_tr_b16 a[252:253], v231 offset:18432
 v_add_f32 v215, v215, v43
 v_mfma_f32_16x16x32_bf16 v[116:119], a[220:223], a[156:159], v[116:119]
 v_exp_f32 v209, v93
 v_mfma_f32_16x16x32_bf16 a[40:43], a[240:243], v[168:171], a[40:43]
 ds_read_b64_tr_b16 a[254:255], v231 offset:19456
 v_cvt_pk_bf16_f32 v142, v208, v209
 v_mfma_f32_16x16x32_bf16 a[40:43], a[244:247], v[184:187], a[40:43]
 v_exp_f32 v210, v94
 v_mfma_f32_16x16x32_bf16 a[44:47], a[240:243], v[172:175], a[44:47]
 buffer_load_dwordx4 v236, s[8:11], s34 offen offset:1024 lds
 v_add_f32 v215, v215, v42
 v_mfma_f32_16x16x32_bf16 a[44:47], a[244:247], v[188:191], a[44:47]
 v_exp_f32 v211, v95
 v_mfma_f32_16x16x32_bf16 v[120:123], a[208:211], a[160:163], v[200:203]
 ds_read_b128 a[200:203], v226 offset:49152
 v_cvt_pk_bf16_f32 v143, v210, v211
 v_mfma_f32_16x16x32_bf16 v[120:123], a[212:215], a[164:167], v[120:123]
 v_exp_f32 v16, v96
 v_mfma_f32_16x16x32_bf16 v[120:123], a[216:219], a[168:171], v[120:123]
 ds_read_b64_tr_b16 a[224:225], v232 offset:16384
 v_max3_f32 v212, v255, v20, v215
 v_mfma_f32_16x16x32_bf16 v[120:123], a[220:223], a[172:175], v[120:123]
 s_waitcnt lgkmcnt(2)
 v_exp_f32 v17, v97
 v_mfma_f32_16x16x32_bf16 v[28:31], v[240:243], v[140:143], v[44:47]
 buffer_load_dwordx4 v236, s[8:11], s34 offen offset:2048 lds
 v_cmp_ngt_f32 s[46:47], s37, v212
 v_mfma_f32_16x16x32_bf16 a[48:51], a[248:251], v[160:163], a[48:51]
 ds_read_b64_tr_b16 a[226:227], v232 offset:17408
 v_cvt_pk_bf16_f32 v144, v16, v17
 v_mfma_f32_16x16x32_bf16 a[48:51], a[252:255], v[176:179], a[48:51]
 v_exp_f32 v18, v98
 v_mfma_f32_16x16x32_bf16 a[52:55], a[248:251], v[164:167], a[52:55]
 buffer_load_dwordx4 v236, s[8:11], s34 offen offset:3072 lds
 s_add_u32 s34, s34, 16384
 v_mfma_f32_16x16x32_bf16 a[52:55], a[252:255], v[180:183], a[52:55]
 v_exp_f32 v19, v99
 v_mfma_f32_16x16x32_bf16 v[124:127], a[208:211], a[176:179], v[204:207]
 ds_read_b128 a[204:207], v227 offset:49152
 v_cvt_pk_bf16_f32 v145, v18, v19
 v_mfma_f32_16x16x32_bf16 v[124:127], a[212:215], a[180:183], v[124:127]
 v_exp_f32 v32, v112
 v_mfma_f32_16x16x32_bf16 v[124:127], a[216:219], a[184:187], v[124:127]
 ds_read_b64_tr_b16 a[228:229], v232 offset:18432
 v_cmp_ngt_f32 vcc, s37, v28
 v_mfma_f32_16x16x32_bf16 v[124:127], a[220:223], a[188:191], v[124:127]
 v_exp_f32 v33, v113
 v_mfma_f32_16x16x32_bf16 a[56:59], a[248:251], v[168:171], a[56:59]
 ds_read_b64_tr_b16 a[230:231], v232 offset:19456
 v_cvt_pk_bf16_f32 v146, v32, v33
 v_mfma_f32_16x16x32_bf16 a[56:59], a[252:255], v[184:187], a[56:59]
 s_or_b64 vcc, vcc, s[46:47]
 v_exp_f32 v34, v114
 v_mfma_f32_16x16x32_bf16 a[60:63], a[248:251], v[172:175], a[60:63]
 s_cbranch_vccnz L_tr_m4
L_back_m4:
 v_mfma_f32_16x16x32_bf16 a[60:63], a[252:255], v[188:191], a[60:63]
 s_waitcnt lgkmcnt(2)
 v_exp_f32 v35, v115
 v_mfma_f32_16x16x32_bf16 v[64:67], a[192:195], a[128:131], v[192:195]
 ds_read_b128 a[208:211], v224 offset:50176
 v_cvt_pk_bf16_f32 v147, v34, v35
 v_mfma_f32_16x16x32_bf16 v[64:67], a[196:199], a[132:135], v[64:67]
 v_exp_f32 v208, v100
 v_mfma_f32_16x16x32_bf16 v[64:67], a[200:203], a[136:139], v[64:67]
 ds_read_b64_tr_b16 a[232:233], v233 offset:16384
 v_add_f32 v253, v253, v255
 v_mfma_f32_16x16x32_bf16 v[64:67], a[204:207], a[140:143], v[64:67]
 s_waitcnt lgkmcnt(2)
 v_exp_f32 v209, v101
 v_mfma_f32_16x16x32_bf16 a[64:67], a[224:227], v[160:163], a[64:67]
 ds_read_b64_tr_b16 a[234:235], v233 offset:17408
 v_cvt_pk_bf16_f32 v148, v208, v209
 v_mfma_f32_16x16x32_bf16 a[64:67], a[228:231], v[176:179], a[64:67]
 v_exp_f32 v210, v102
 v_mfma_f32_16x16x32_bf16 a[68:71], a[224:227], v[164:167], a[68:71]
 v_add_f32 v255, v16, v17
 v_add_f32 v255, v255, v18
 v_mfma_f32_16x16x32_bf16 a[68:71], a[228:231], v[180:183], a[68:71]
 v_exp_f32 v211, v103
 v_mfma_f32_16x16x32_bf16 v[68:71], a[192:195], a[144:147], v[196:199]
 ds_read_b128 a[212:215], v225 offset:50176
 v_cvt_pk_bf16_f32 v149, v210, v211
 v_mfma_f32_16x16x32_bf16 v[68:71], a[196:199], a[148:151], v[68:71]
 v_exp_f32 v208, v116
 v_mfma_f32_16x16x32_bf16 v[68:71], a[200:203], a[152:155], v[68:71]
 ds_read_b64_tr_b16 a[236:237], v233 offset:18432
 v_add_f32 v255, v255, v19
 v_mfma_f32_16x16x32_bf16 v[68:71], a[204:207], a[156:159], v[68:71]
 v_exp_f32 v209, v117
 v_mfma_f32_16x16x32_bf16 a[72:75], a[224:227], v[168:171], a[72:75]
 ds_read_b64_tr_b16 a[238:239], v233 offset:19456
 v_cvt_pk_bf16_f32 v150, v208, v209
 v_mfma_f32_16x16x32_bf16 a[72:75], a[228:231], v[184:187], a[72:75]
 v_exp_f32 v210, v118
 v_mfma_f32_16x16x32_bf16 a[76:79], a[224:227], v[172:175], a[76:79]
 v_add_f32 v255, v255, v32
 v_add_f32 v255, v255, v33
 v_mfma_f32_16x16x32_bf16 a[76:79], a[228:231], v[188:191], a[76:79]
 v_exp_f32 v211, v119
 v_mfma_f32_16x16x32_bf16 v[72:75], a[192:195], a[160:163], v[200:203]
 ds_read_b128 a[216:219], v226 offset:50176
 v_cvt_pk_bf16_f32 v151, v210, v211
 v_mfma_f32_16x16x32_bf16 v[72:75], a[196:199], a[164:167], v[72:75]
 v_exp_f32 v24, v104
 v_mfma_f32_16x16x32_bf16 v[72:75], a[200:203], a[168:171], v[72:75]
 ds_read_b64_tr_b16 a[240:241], v234 offset:16384
 v_add_f32 v255, v255, v34
 v_mfma_f32_16x16x32_bf16 v[72:75], a[204:207], a[172:175], v[72:75]
 s_waitcnt lgkmcnt(2)
 v_exp_f32 v25, v105
 v_mfma_f32_16x16x32_bf16 v[36:39], v[240:243], v[148:151], v[20:23]
 v_add_f32 v255, v255, v35
 v_add_f32 v254, v254, v215
 v_mfma_f32_16x16x32_bf16 a[80:83], a[232:235], v[160:163], a[80:83]
 ds_read_b64_tr_b16 a[242:243], v234 offset:17408
 v_cvt_pk_bf16_f32 v152, v24, v25
 v_mfma_f32_16x16x32_bf16 a[80:83], a[236:239], v[176:179], a[80:83]
 v_exp_f32 v26, v106
 v_mfma_f32_16x16x32_bf16 a[84:87], a[232:235], v[164:167], a[84:87]
 v_add_f32 v215, v24, v25
 v_add_f32 v215, v215, v26
 v_mfma_f32_16x16x32_bf16 a[84:87], a[236:239], v[180:183], a[84:87]
 v_exp_f32 v27, v107
 v_mfma_f32_16x16x32_bf16 v[76:79], a[192:195], a[176:179], v[204:207]
 ds_read_b128 a[220:223], v227 offset:50176
 v_cvt_pk_bf16_f32 v153, v26, v27
 v_mfma_f32_16x16x32_bf16 v[76:79], a[196:199], a[180:183], v[76:79]
 v_exp_f32 v40, v120
 v_mfma_f32_16x16x32_bf16 v[76:79], a[200:203], a[184:187], v[76:79]
 ds_read_b64_tr_b16 a[244:245], v234 offset:18432
 v_add_f32 v215, v215, v27
 v_mfma_f32_16x16x32_bf16 v[76:79], a[204:207], a[188:191], v[76:79]
 v_exp_f32 v41, v121
 v_mfma_f32_16x16x32_bf16 a[88:91], a[232:235], v[168:171], a[88:91]
 ds_read_b64_tr_b16 a[246:247], v234 offset:19456
 v_cvt_pk_bf16_f32 v154, v40, v41
 v_mfma_f32_16x16x32_bf16 a[88:91], a[236:239], v[184:187], a[88:91]
 s_add_u32 m0, s36, 65536
 v_exp_f32 v42, v122
 v_mfma_f32_16x16x32_bf16 a[92:95], a[232:235], v[172:175], a[92:95]
 buffer_load_dwordx4 v237, s[12:15], s35 offen offset:0 lds
 v_mfma_f32_16x16x32_bf16 a[92:95], a[236:239], v[188:191], a[92:95]
 s_waitcnt lgkmcnt(2)
 v_exp_f32 v43, v123
 v_mfma_f32_16x16x32_bf16 v[80:83], a[208:211], a[128:131], v[192:195]
 ds_read_b128 a[192:195], v224 offset:51200
 v_cvt_pk_bf16_f32 v155, v42, v43
 v_mfma_f32_16x16x32_bf16 v[80:83], a[212:215], a[132:135], v[80:83]
 v_exp_f32 v208, v108
 v_mfma_f32_16x16x32_bf16 v[80:83], a[216:219], a[136:139], v[80:83]
 ds_read_b64_tr_b16 a[248:249], v235 offset:16384
 v_add_f32 v215, v215, v40
 v_mfma_f32_16x16x32_bf16 v[80:83], a[220:223], a[140:143], v[80:83]
 s_waitcnt lgkmcnt(2)
 v_exp_f32 v209, v109
 v_mfma_f32_16x16x32_bf16 a[96:99], a[240:243], v[160:163], a[96:99]
 ds_read_b64_tr_b16 a[250:251], v235 offset:17408
 v_cvt_pk_bf16_f32 v156, v208, v209
 v_mfma_f32_16x16x32_bf16 a[96:99], a[244:247], v[176:179], a[96:99]
 v_exp_f32 v210, v110
 v_mfma_f32_16x16x32_bf16 a[100:103], a[240:243], v[164:167], a[100:103]
 buffer_load_dwordx4 v237, s[12:15], s35 offen offset:1024 lds
 v_add_f32 v215, v215, v41
 v_mfma_f32_16x16x32_bf16 a[100:103], a[244:247], v[180:183], a[100:103]
 v_exp_f32 v211, v111
 v_mfma_f32_16x16x32_bf16 v[84:87], a[208:211], a[144:147], v[196:199]
 ds_read_b128 a[196:199], v225 offset:51200
 v_cvt_pk_bf16_f32 v157, v210, v211
 v_mfma_f32_16x16x32_bf16 v[84:87], a[212:215], a[148:151], v[84:87]
 v_exp_f32 v208, v124
 v_mfma_f32_16x16x32_bf16 v[84:87], a[216:219], a[152:155], v[84:87]
 ds_read_b64_tr_b16 a[252:253], v235 offset:18432
 v_add_f32 v215, v215, v43
 v_mfma_f32_16x16x32_bf16 v[84:87], a[220:223], a[156:159], v[84:87]
 v_exp_f32 v209, v125
 v_mfma_f32_16x16x32_bf16 a[104:107], a[240:243], v[168:171], a[104:107]
 ds_read_b64_tr_b16 a[254:255], v235 offset:19456
 v_cvt_pk_bf16_f32 v158, v208, v209
 v_mfma_f32_16x16x32_bf16 a[104:107], a[244:247], v[184:187], a[104:107]
 v_exp_f32 v210, v126
 v_mfma_f32_16x16x32_bf16 a[108:111], a[240:243], v[172:175], a[108:111]
 buffer_load_dwordx4 v237, s[12:15], s35 offen offset:2048 lds
 v_add_f32 v215, v215, v42
 v_mfma_f32_16x16x32_bf16 a[108:111], a[244:247], v[188:191], a[108:111]
 v_exp_f32 v211, v127
 v_mfma_f32_16x16x32_bf16 v[88:91], a[208:211], a[160:163], v[200:203]
 ds_read_b128 a[200:203], v226 offset:51200
 v_cvt_pk_bf16_f32 v159, v210, v211
 v_mfma_f32_16x16x32_bf16 v[88:91], a[212:215], a[164:167], v[88:91]
 v_exp_f32 v16, v64
 v_mfma_f32_16x16x32_bf16 v[88:91], a[216:219], a[168:171], v[88:91]
 ds_read_b64_tr_b16 a[224:225], v228 offset:32768
 v_max3_f32 v212, v255, v36, v215
 v_mfma_f32_16x16x32_bf16 v[88:91], a[220:223], a[172:175], v[88:91]
 s_waitcnt lgkmcnt(2)
 v_exp_f32 v17, v65
 v_mfma_f32_16x16x32_bf16 v[44:47], v[240:243], v[156:159], v[28:31]
 v_cmp_ngt_f32 s[46:47], s37, v212
 v_mfma_f32_16x16x32_bf16 a[112:115], a[248:251], v[160:163], a[112:115]
 ds_read_b64_tr_b16 a[226:227], v228 offset:33792
 v_cvt_pk_bf16_f32 v160, v16, v17
 v_mfma_f32_16x16x32_bf16 a[112:115], a[252:255], v[176:179], a[112:115]
 v_exp_f32 v18, v66
 v_mfma_f32_16x16x32_bf16 a[116:119], a[248:251], v[164:167], a[116:119]
 buffer_load_dwordx4 v237, s[12:15], s35 offen offset:3072 lds
 s_add_u32 s35, s35, 16384
 v_mfma_f32_16x16x32_bf16 a[116:119], a[252:255], v[180:183], a[116:119]
 v_exp_f32 v19, v67
 v_mfma_f32_16x16x32_bf16 v[92:95], a[208:211], a[176:179], v[204:207]
 ds_read_b128 a[204:207], v227 offset:51200
 v_cvt_pk_bf16_f32 v161, v18, v19
 v_mfma_f32_16x16x32_bf16 v[92:95], a[212:215], a[180:183], v[92:95]
 v_exp_f32 v32, v80
 v_mfma_f32_16x16x32_bf16 v[92:95], a[216:219], a[184:187], v[92:95]
 ds_read_b64_tr_b16 a[228:229], v228 offset:34816
 v_cmp_ngt_f32 vcc, s37, v44
 v_mfma_f32_16x16x32_bf16 v[92:95], a[220:223], a[188:191], v[92:95]
 v_exp_f32 v33, v81
 v_mfma_f32_16x16x32_bf16 a[120:123], a[248:251], v[168:171], a[120:123]
 ds_read_b64_tr_b16 a[230:231], v228 offset:35840
 v_cvt_pk_bf16_f32 v162, v32, v33
 v_mfma_f32_16x16x32_bf16 a[120:123], a[252:255], v[184:187], a[120:123]
 s_or_b64 vcc, vcc, s[46:47]
 v_exp_f32 v34, v82
 v_mfma_f32_16x16x32_bf16 a[124:127], a[248:251], v[172:175], a[124:127]
 s_cbranch_vccnz L_tr_m5
L_back_m5:
 v_mfma_f32_16x16x32_bf16 a[124:127], a[252:255], v[188:191], a[124:127]
 s_waitcnt lgkmcnt(2)
 v_exp_f32 v35, v83
 v_mfma_f32_16x16x32_bf16 v[96:99], a[192:195], a[128:131], v[192:195]
 ds_read_b128 a[208:211], v224 offset:52224
 v_cvt_pk_bf16_f32 v163, v34, v35
 v_mfma_f32_16x16x32_bf16 v[96:99], a[196:199], a[132:135], v[96:99]
 v_exp_f32 v208, v68
 v_mfma_f32_16x16x32_bf16 v[96:99], a[200:203], a[136:139], v[96:99]
 ds_read_b64_tr_b16 a[232:233], v229 offset:32768
 v_add_f32 v253, v253, v255
 v_mfma_f32_16x16x32_bf16 v[96:99], a[204:207], a[140:143], v[96:99]
 s_waitcnt lgkmcnt(2)
 v_exp_f32 v209, v69
 v_mfma_f32_16x16x32_bf16 a[0:3], a[224:227], v[128:131], a[0:3]
 ds_read_b64_tr_b16 a[234:235], v229 offset:33792
 v_cvt_pk_bf16_f32 v164, v208, v209
 v_mfma_f32_16x16x32_bf16 a[0:3], a[228:231], v[144:147], a[0:3]
 v_exp_f32 v210, v70
 v_mfma_f32_16x16x32_bf16 a[4:7], a[224:227], v[132:135], a[4:7]
 v_add_f32 v255, v16, v17
 v_add_f32 v255, v255, v18
 v_mfma_f32_16x16x32_bf16 a[4:7], a[228:231], v[148:151], a[4:7]
 v_exp_f32 v211, v71
 v_mfma_f32_16x16x32_bf16 v[100:103], a[192:195], a[144:147], v[196:199]
 ds_read_b128 a[212:215], v225 offset:52224
 v_cvt_pk_bf16_f32 v165, v210, v211
 v_mfma_f32_16x16x32_bf16 v[100:103], a[196:199], a[148:151], v[100:103]
 v_exp_f32 v208, v84
 v_mfma_f32_16x16x32_bf16 v[100:103], a[200:203], a[152:155], v[100:103]
 ds_read_b64_tr_b16 a[236:237], v229 offset:34816
 v_add_f32 v255, v255, v19
 v_mfma_f32_16x16x32_bf16 v[100:103], a[204:207], a[156:159], v[100:103]
 v_exp_f32 v209, v85
 v_mfma_f32_16x16x32_bf16 a[8:11], a[224:227], v[136:139], a[8:11]
 ds_read_b64_tr_b16 a[238:239], v229 offset:35840
 v_cvt_pk_bf16_f32 v166, v208, v209
 v_mfma_f32_16x16x32_bf16 a[8:11], a[228:231], v[152:155], a[8:11]
 v_exp_f32 v210, v86
 v_mfma_f32_16x16x32_bf16 a[12:15], a[224:227], v[140:143], a[12:15]
 v_add_f32 v255, v255, v32
 v_add_f32 v255, v255, v33
 v_mfma_f32_16x16x32_bf16 a[12:15], a[228:231], v[156:159], a[12:15]
 v_exp_f32 v211, v87
 v_mfma_f32_16x16x32_bf16 v[104:107], a[192:195], a[160:163], v[200:203]
 ds_read_b128 a[216:219], v226 offset:52224
 v_cvt_pk_bf16_f32 v167, v210, v211
 v_mfma_f32_16x16x32_bf16 v[104:107], a[196:199], a[164:167], v[104:107]
 v_exp_f32 v24, v72
 v_mfma_f32_16x16x32_bf16 v[104:107], a[200:203], a[168:171], v[104:107]
 ds_read_b64_tr_b16 a[240:241], v230 offset:32768
 v_add_f32 v255, v255, v34
 v_mfma_f32_16x16x32_bf16 v[104:107], a[204:207], a[172:175], v[104:107]
 s_waitcnt lgkmcnt(2)
 v_exp_f32 v25, v73
 v_mfma_f32_16x16x32_bf16 v[20:23], v[240:243], v[164:167], v[36:39]
 v_add_f32 v255, v255, v35
 v_add_f32 v254, v254, v215
 v_mfma_f32_16x16x32_bf16 a[16:19], a[232:235], v[128:131], a[16:19]
 ds_read_b64_tr_b16 a[242:243], v230 offset:33792
 v_cvt_pk_bf16_f32 v168, v24, v25
 v_mfma_f32_16x16x32_bf16 a[16:19], a[236:239], v[144:147], a[16:19]
 v_exp_f32 v26, v74
 v_mfma_f32_16x16x32_bf16 a[20:23], a[232:235], v[132:135], a[20:23]
 v_add_f32 v215, v24, v25
 v_add_f32 v215, v215, v26
 v_mfma_f32_16x16x32_bf16 a[20:23], a[236:239], v[148:151], a[20:23]
 v_exp_f32 v27, v75
 v_mfma_f32_16x16x32_bf16 v[108:111], a[192:195], a[176:179], v[204:207]
 ds_read_b128 a[220:223], v227 offset:52224
 v_cvt_pk_bf16_f32 v169, v26, v27
 v_mfma_f32_16x16x32_bf16 v[108:111], a[196:199], a[180:183], v[108:111]
 v_exp_f32 v40, v88
 v_mfma_f32_16x16x32_bf16 v[108:111], a[200:203], a[184:187], v[108:111]
 ds_read_b64_tr_b16 a[244:245], v230 offset:34816
 v_add_f32 v215, v215, v27
 v_mfma_f32_16x16x32_bf16 v[108:111], a[204:207], a[188:191], v[108:111]
 v_exp_f32 v41, v89
 v_mfma_f32_16x16x32_bf16 a[24:27], a[232:235], v[136:139], a[24:27]
 ds_read_b64_tr_b16 a[246:247], v230 offset:35840
 v_cvt_pk_bf16_f32 v170, v40, v41
 v_mfma_f32_16x16x32_bf16 a[24:27], a[236:239], v[152:155], a[24:27]
 v_exp_f32 v42, v90
 v_mfma_f32_16x16x32_bf16 a[28:31], a[232:235], v[140:143], a[28:31]
 s_waitcnt vmcnt(8) lgkmcnt(2)
 s_barrier
 v_mfma_f32_16x16x32_bf16 a[28:31], a[236:239], v[156:159], a[28:31]
 v_exp_f32 v43, v91
 v_mfma_f32_16x16x32_bf16 v[112:115], a[208:211], a[128:131], v[192:195]
 ds_read_b128 a[192:195], v224 offset:0
 v_cvt_pk_bf16_f32 v171, v42, v43
 v_mfma_f32_16x16x32_bf16 v[112:115], a[212:215], a[132:135], v[112:115]
 v_exp_f32 v208, v76
 v_mfma_f32_16x16x32_bf16 v[112:115], a[216:219], a[136:139], v[112:115]
 ds_read_b64_tr_b16 a[248:249], v231 offset:32768
 v_add_f32 v215, v215, v40
 v_mfma_f32_16x16x32_bf16 v[112:115], a[220:223], a[140:143], v[112:115]
 s_waitcnt lgkmcnt(2)
 v_exp_f32 v209, v77
 v_mfma_f32_16x16x32_bf16 a[32:35], a[240:243], v[128:131], a[32:35]
 ds_read_b64_tr_b16 a[250:251], v231 offset:33792
 v_cvt_pk_bf16_f32 v172, v208, v209
 v_mfma_f32_16x16x32_bf16 a[32:35], a[244:247], v[144:147], a[32:35]
 s_add_u32 m0, s36, 32768
 v_exp_f32 v210, v78
 v_mfma_f32_16x16x32_bf16 a[36:39], a[240:243], v[132:135], a[36:39]
 buffer_load_dwordx4 v236, s[8:11], s34 offen offset:0 lds
 v_add_f32 v215, v215, v41
 v_mfma_f32_16x16x32_bf16 a[36:39], a[244:247], v[148:151], a[36:39]
 v_exp_f32 v211, v79
 v_mfma_f32_16x16x32_bf16 v[116:119], a[208:211], a[144:147], v[196:199]
 ds_read_b128 a[196:199], v225 offset:0
 v_cvt_pk_bf16_f32 v173, v210, v211
 v_mfma_f32_16x16x32_bf16 v[116:119], a[212:215], a[148:151], v[116:119]
 v_exp_f32 v208, v92
 v_mfma_f32_16x16x32_bf16 v[116:119], a[216:219], a[152:155], v[116:119]
 ds_read_b64_tr_b16 a[252:253], v231 offset:34816
 v_add_f32 v215, v215, v43
 v_mfma_f32_16x16x32_bf16 v[116:119], a[220:223], a[156:159], v[116:119]
 v_exp_f32 v209, v93
 v_mfma_f32_16x16x32_bf16 a[40:43], a[240:243], v[136:139], a[40:43]
 ds_read_b64_tr_b16 a[254:255], v231 offset:35840
 v_cvt_pk_bf16_f32 v174, v208, v209
 v_mfma_f32_16x16x32_bf16 a[40:43], a[244:247], v[152:155], a[40:43]
 v_exp_f32 v210, v94
 v_mfma_f32_16x16x32_bf16 a[44:47], a[240:243], v[140:143], a[44:47]
 buffer_load_dwordx4 v236, s[8:11], s34 offen offset:1024 lds
 v_add_f32 v215, v215, v42
 v_mfma_f32_16x16x32_bf16 a[44:47], a[244:247], v[156:159], a[44:47]
 v_exp_f32 v211, v95
 v_mfma_f32_16x16x32_bf16 v[120:123], a[208:211], a[160:163], v[200:203]
 ds_read_b128 a[200:203], v226 offset:0
 v_cvt_pk_bf16_f32 v175, v210, v211
 v_mfma_f32_16x16x32_bf16 v[120:123], a[212:215], a[164:167], v[120:123]
 v_exp_f32 v16, v96
 v_mfma_f32_16x16x32_bf16 v[120:123], a[216:219], a[168:171], v[120:123]
 ds_read_b64_tr_b16 a[224:225], v232 offset:32768
 v_max3_f32 v212, v255, v20, v215
 v_mfma_f32_16x16x32_bf16 v[120:123], a[220:223], a[172:175], v[120:123]
 s_waitcnt lgkmcnt(2)
 v_exp_f32 v17, v97
 v_mfma_f32_16x16x32_bf16 v[28:31], v[240:243], v[172:175], v[44:47]
 buffer_load_dwordx4 v236, s[8:11], s34 offen offset:2048 lds
 v_cmp_ngt_f32 s[46:47], s37, v212
 v_mfma_f32_16x16x32_bf16 a[48:51], a[248:251], v[128:131], a[48:51]
 ds_read_b64_tr_b16 a[226:227], v232 offset:33792
 v_cvt_pk_bf16_f32 v176, v16, v17
 v_mfma_f32_16x16x32_bf16 a[48:51], a[252:255], v[144:147], a[48:51]
 v_exp_f32 v18, v98
 v_mfma_f32_16x16x32_bf16 a[52:55], a[248:251], v[132:135], a[52:55]
 buffer_load_dwordx4 v236, s[8:11], s34 offen offset:3072 lds
 s_add_u32 s34, s34, 16384
 v_mfma_f32_16x16x32_bf16 a[52:55], a[252:255], v[148:151], a[52:55]
 v_exp_f32 v19, v99
 v_mfma_f32_16x16x32_bf16 v[124:127], a[208:211], a[176:179], v[204:207]
 ds_read_b128 a[204:207], v227 offset:0
 v_cvt_pk_bf16_f32 v177, v18, v19
 v_mfma_f32_16x16x32_bf16 v[124:127], a[212:215], a[180:183], v[124:127]
 v_exp_f32 v32, v112
 v_mfma_f32_16x16x32_bf16 v[124:127], a[216:219], a[184:187], v[124:127]
 ds_read_b64_tr_b16 a[228:229], v232 offset:34816
 v_cmp_ngt_f32 vcc, s37, v28
 v_mfma_f32_16x16x32_bf16 v[124:127], a[220:223], a[188:191], v[124:127]
 v_exp_f32 v33, v113
 v_mfma_f32_16x16x32_bf16 a[56:59], a[248:251], v[136:139], a[56:59]
 ds_read_b64_tr_b16 a[230:231], v232 offset:35840
 v_cvt_pk_bf16_f32 v178, v32, v33
 v_mfma_f32_16x16x32_bf16 a[56:59], a[252:255], v[152:155], a[56:59]
 s_or_b64 vcc, vcc, s[46:47]
 v_exp_f32 v34, v114
 v_mfma_f32_16x16x32_bf16 a[60:63], a[248:251], v[140:143], a[60:63]
 s_cbranch_vccnz L_tr_m6
L_back_m6:
 v_mfma_f32_16x16x32_bf16 a[60:63], a[252:255], v[156:159], a[60:63]
 s_waitcnt lgkmcnt(2)
 v_exp_f32 v35, v115
 v_mfma_f32_16x16x32_bf16 v[64:67], a[192:195], a[128:131], v[192:195]
 ds_read_b128 a[208:211], v224 offset:1024
 v_cvt_pk_bf16_f32 v179, v34, v35
 v_mfma_f32_16x16x32_bf16 v[64:67], a[196:199], a[132:135], v[64:67]
 v_exp_f32 v208, v100
 v_mfma_f32_16x16x32_bf16 v[64:67], a[200:203], a[136:139], v[64:67]
 ds_read_b64_tr_b16 a[232:233], v233 offset:32768
 v_add_f32 v253, v253, v255
 v_mfma_f32_16x16x32_bf16 v[64:67], a[204:207], a[140:143], v[64:67]
 s_waitcnt lgkmcnt(2)
 v_exp_f32 v209, v101
 v_mfma_f32_16x16x32_bf16 a[64:67], a[224:227], v[128:131], a[64:67]
 ds_read_b64_tr_b16 a[234:235], v233 offset:33792
 v_cvt_pk_bf16_f32 v180, v208, v209
 v_mfma_f32_16x16x32_bf16 a[64:67], a[228:231], v[144:147], a[64:67]
 v_exp_f32 v210, v102
 v_mfma_f32_16x16x32_bf16 a[68:71], a[224:227], v[132:135], a[68:71]
 v_add_f32 v255, v16, v17
 v_add_f32 v255, v255, v18
 v_mfma_f32_16x16x32_bf16 a[68:71], a[228:231], v[148:151], a[68:71]
 v_exp_f32 v211, v103
 v_mfma_f32_16x16x32_bf16 v[68:71], a[192:195], a[144:147], v[196:199]
 ds_read_b128 a[212:215], v225 offset:1024
 v_cvt_pk_bf16_f32 v181, v210, v211
 v_mfma_f32_16x16x32_bf16 v[68:71], a[196:199], a[148:151], v[68:71]
 v_exp_f32 v208, v116
 v_mfma_f32_16x16x32_bf16 v[68:71], a[200:203], a[152:155], v[68:71]
 ds_read_b64_tr_b16 a[236:237], v233 offset:34816
 v_add_f32 v255, v255, v19
 v_mfma_f32_16x16x32_bf16 v[68:71], a[204:207], a[156:159], v[68:71]
 v_exp_f32 v209, v117
 v_mfma_f32_16x16x32_bf16 a[72:75], a[224:227], v[136:139], a[72:75]
 ds_read_b64_tr_b16 a[238:239], v233 offset:35840
 v_cvt_pk_bf16_f32 v182, v208, v209
 v_mfma_f32_16x16x32_bf16 a[72:75], a[228:231], v[152:155], a[72:75]
 v_exp_f32 v210, v118
 v_mfma_f32_16x16x32_bf16 a[76:79], a[224:227], v[140:143], a[76:79]
 v_add_f32 v255, v255, v32
 v_add_f32 v255, v255, v33
 v_mfma_f32_16x16x32_bf16 a[76:79], a[228:231], v[156:159], a[76:79]
 v_exp_f32 v211, v119
 v_mfma_f32_16x16x32_bf16 v[72:75], a[192:195], a[160:163], v[200:203]
 ds_read_b128 a[216:219], v226 offset:1024
 v_cvt_pk_bf16_f32 v183, v210, v211
 v_mfma_f32_16x16x32_bf16 v[72:75], a[196:199], a[164:167], v[72:75]
 v_exp_f32 v24, v104
 v_mfma_f32_16x16x32_bf16 v[72:75], a[200:203], a[168:171], v[72:75]
 ds_read_b64_tr_b16 a[240:241], v234 offset:32768
 v_add_f32 v255, v255, v34
 v_mfma_f32_16x16x32_bf16 v[72:75], a[204:207], a[172:175], v[72:75]
 s_waitcnt lgkmcnt(2)
 v_exp_f32 v25, v105
 v_mfma_f32_16x16x32_bf16 v[36:39], v[240:243], v[180:183], v[20:23]
 v_add_f32 v255, v255, v35
 v_add_f32 v254, v254, v215
 v_mfma_f32_16x16x32_bf16 a[80:83], a[232:235], v[128:131], a[80:83]
 ds_read_b64_tr_b16 a[242:243], v234 offset:33792
 v_cvt_pk_bf16_f32 v184, v24, v25
 v_mfma_f32_16x16x32_bf16 a[80:83], a[236:239], v[144:147], a[80:83]
 v_exp_f32 v26, v106
 v_mfma_f32_16x16x32_bf16 a[84:87], a[232:235], v[132:135], a[84:87]
 v_add_f32 v215, v24, v25
 v_add_f32 v215, v215, v26
 v_mfma_f32_16x16x32_bf16 a[84:87], a[236:239], v[148:151], a[84:87]
 v_exp_f32 v27, v107
 v_mfma_f32_16x16x32_bf16 v[76:79], a[192:195], a[176:179], v[204:207]
 ds_read_b128 a[220:223], v227 offset:1024
 v_cvt_pk_bf16_f32 v185, v26, v27
 v_mfma_f32_16x16x32_bf16 v[76:79], a[196:199], a[180:183], v[76:79]
 v_exp_f32 v40, v120
 v_mfma_f32_16x16x32_bf16 v[76:79], a[200:203], a[184:187], v[76:79]
 ds_read_b64_tr_b16 a[244:245], v234 offset:34816
 v_add_f32 v215, v215, v27
 v_mfma_f32_16x16x32_bf16 v[76:79], a[204:207], a[188:191], v[76:79]
 v_exp_f32 v41, v121
 v_mfma_f32_16x16x32_bf16 a[88:91], a[232:235], v[136:139], a[88:91]
 ds_read_b64_tr_b16 a[246:247], v234 offset:35840
 v_cvt_pk_bf16_f32 v186, v40, v41
 v_mfma_f32_16x16x32_bf16 a[88:91], a[236:239], v[152:155], a[88:91]
 s_add_u32 m0, s36, 81920
 v_exp_f32 v42, v122
 v_mfma_f32_16x16x32_bf16 a[92:95], a[232:235], v[140:143], a[92:95]
 buffer_load_dwordx4 v237, s[12:15], s35 offen offset:0 lds
 v_mfma_f32_16x16x32_bf16 a[92:95], a[236:239], v[156:159], a[92:95]
 s_waitcnt lgkmcnt(2)
 v_exp_f32 v43, v123
 v_mfma_f32_16x16x32_bf16 v[80:83], a[208:211], a[128:131], v[192:195]
 ds_read_b128 a[192:195], v224 offset:2048
 v_cvt_pk_bf16_f32 v187, v42, v43
 v_mfma_f32_16x16x32_bf16 v[80:83], a[212:215], a[132:135], v[80:83]
 v_exp_f32 v208, v108
 v_mfma_f32_16x16x32_bf16 v[80:83], a[216:219], a[136:139], v[80:83]
 ds_read_b64_tr_b16 a[248:249], v235 offset:32768
 v_add_f32 v215, v215, v40
 v_mfma_f32_16x16x32_bf16 v[80:83], a[220:223], a[140:143], v[80:83]
 s_waitcnt lgkmcnt(2)
 v_exp_f32 v209, v109
 v_mfma_f32_16x16x32_bf16 a[96:99], a[240:243], v[128:131], a[96:99]
 ds_read_b64_tr_b16 a[250:251], v235 offset:33792
 v_cvt_pk_bf16_f32 v188, v208, v209
 v_mfma_f32_16x16x32_bf16 a[96:99], a[244:247], v[144:147], a[96:99]
 v_exp_f32 v210, v110
 v_mfma_f32_16x16x32_bf16 a[100:103], a[240:243], v[132:135], a[100:103]
 buffer_load_dwordx4 v237, s[12:15], s35 offen offset:1024 lds
 v_add_f32 v215, v215, v41
 v_mfma_f32_16x16x32_bf16 a[100:103], a[244:247], v[148:151], a[100:103]
 v_exp_f32 v211, v111
 v_mfma_f32_16x16x32_bf16 v[84:87], a[208:211], a[144:147], v[196:199]
 ds_read_b128 a[196:199], v225 offset:2048
 v_cvt_pk_bf16_f32 v189, v210, v211
 v_mfma_f32_16x16x32_bf16 v[84:87], a[212:215], a[148:151], v[84:87]
 v_exp_f32 v208, v124
 v_mfma_f32_16x16x32_bf16 v[84:87], a[216:219], a[152:155], v[84:87]
 ds_read_b64_tr_b16 a[252:253], v235 offset:34816
 v_add_f32 v215, v215, v43
 v_mfma_f32_16x16x32_bf16 v[84:87], a[220:223], a[156:159], v[84:87]
 v_exp_f32 v209, v125
 v_mfma_f32_16x16x32_bf16 a[104:107], a[240:243], v[136:139], a[104:107]
 ds_read_b64_tr_b16 a[254:255], v235 offset:35840
 v_cvt_pk_bf16_f32 v190, v208, v209
 v_mfma_f32_16x16x32_bf16 a[104:107], a[244:247], v[152:155], a[104:107]
 v_exp_f32 v210, v126
 v_mfma_f32_16x16x32_bf16 a[108:111], a[240:243], v[140:143], a[108:111]
 buffer_load_dwordx4 v237, s[12:15], s35 offen offset:2048 lds
 v_add_f32 v215, v215, v42
 v_mfma_f32_16x16x32_bf16 a[108:111], a[244:247], v[156:159], a[108:111]
 v_exp_f32 v211, v127
 v_mfma_f32_16x16x32_bf16 v[88:91], a[208:211], a[160:163], v[200:203]
 ds_read_b128 a[200:203], v226 offset:2048
 v_cvt_pk_bf16_f32 v191, v210, v211
 v_mfma_f32_16x16x32_bf16 v[88:91], a[212:215], a[164:167], v[88:91]
 v_exp_f32 v16, v64
 v_mfma_f32_16x16x32_bf16 v[88:91], a[216:219], a[168:171], v[88:91]
 ds_read_b64_tr_b16 a[224:225], v228 offset:49152
 v_max3_f32 v212, v255, v36, v215
 v_mfma_f32_16x16x32_bf16 v[88:91], a[220:223], a[172:175], v[88:91]
 s_waitcnt lgkmcnt(2)
 v_exp_f32 v17, v65
 v_mfma_f32_16x16x32_bf16 v[44:47], v[240:243], v[188:191], v[28:31]
 v_cmp_ngt_f32 s[46:47], s37, v212
 v_mfma_f32_16x16x32_bf16 a[112:115], a[248:251], v[128:131], a[112:115]
 ds_read_b64_tr_b16 a[226:227], v228 offset:50176
 v_cvt_pk_bf16_f32 v128, v16, v17
 v_mfma_f32_16x16x32_bf16 a[112:115], a[252:255], v[144:147], a[112:115]
 v_exp_f32 v18, v66
 v_mfma_f32_16x16x32_bf16 a[116:119], a[248:251], v[132:135], a[116:119]
 buffer_load_dwordx4 v237, s[12:15], s35 offen offset:3072 lds
 s_add_u32 s35, s35, 16384
 v_mfma_f32_16x16x32_bf16 a[116:119], a[252:255], v[148:151], a[116:119]
 v_exp_f32 v19, v67
 v_mfma_f32_16x16x32_bf16 v[92:95], a[208:211], a[176:179], v[204:207]
 ds_read_b128 a[204:207], v227 offset:2048
 v_cvt_pk_bf16_f32 v129, v18, v19
 v_mfma_f32_16x16x32_bf16 v[92:95], a[212:215], a[180:183], v[92:95]
 v_exp_f32 v32, v80
 v_mfma_f32_16x16x32_bf16 v[92:95], a[216:219], a[184:187], v[92:95]
 ds_read_b64_tr_b16 a[228:229], v228 offset:51200
 v_cmp_ngt_f32 vcc, s37, v44
 v_mfma_f32_16x16x32_bf16 v[92:95], a[220:223], a[188:191], v[92:95]
 v_exp_f32 v33, v81
 v_mfma_f32_16x16x32_bf16 a[120:123], a[248:251], v[136:139], a[120:123]
 ds_read_b64_tr_b16 a[230:231], v228 offset:52224
 v_cvt_pk_bf16_f32 v130, v32, v33
 v_mfma_f32_16x16x32_bf16 a[120:123], a[252:255], v[152:155], a[120:123]
 s_or_b64 vcc, vcc, s[46:47]
 v_exp_f32 v34, v82
 v_mfma_f32_16x16x32_bf16 a[124:127], a[248:251], v[140:143], a[124:127]
 s_cbranch_vccnz L_tr_m7
L_back_m7:
 v_mfma_f32_16x16x32_bf16 a[124:127], a[252:255], v[156:159], a[124:127]
 s_waitcnt lgkmcnt(2)
 v_exp_f32 v35, v83
 v_mfma_f32_16x16x32_bf16 v[96:99], a[192:195], a[128:131], v[192:195]
 ds_read_b128 a[208:211], v224 offset:3072
 v_cvt_pk_bf16_f32 v131, v34, v35
 v_mfma_f32_16x16x32_bf16 v[96:99], a[196:199], a[132:135], v[96:99]
 v_exp_f32 v208, v68
 v_mfma_f32_16x16x32_bf16 v[96:99], a[200:203], a[136:139], v[96:99]
 ds_read_b64_tr_b16 a[232:233], v229 offset:49152
 v_add_f32 v253, v253, v255
 v_mfma_f32_16x16x32_bf16 v[96:99], a[204:207], a[140:143], v[96:99]
 s_waitcnt lgkmcnt(2)
 v_exp_f32 v209, v69
 v_mfma_f32_16x16x32_bf16 a[0:3], a[224:227], v[160:163], a[0:3]
 ds_read_b64_tr_b16 a[234:235], v229 offset:50176
 v_cvt_pk_bf16_f32 v132, v208, v209
 v_mfma_f32_16x16x32_bf16 a[0:3], a[228:231], v[176:179], a[0:3]
 v_exp_f32 v210, v70
 v_mfma_f32_16x16x32_bf16 a[4:7], a[224:227], v[164:167], a[4:7]
 v_add_f32 v255, v16, v17
 v_add_f32 v255, v255, v18
 v_mfma_f32_16x16x32_bf16 a[4:7], a[228:231], v[180:183], a[4:7]
 v_exp_f32 v211, v71
 v_mfma_f32_16x16x32_bf16 v[100:103], a[192:195], a[144:147], v[196:199]
 ds_read_b128 a[212:215], v225 offset:3072
 v_cvt_pk_bf16_f32 v133, v210, v211
 v_mfma_f32_16x16x32_bf16 v[100:103], a[196:199], a[148:151], v[100:103]
 v_exp_f32 v208, v84
 v_mfma_f32_16x16x32_bf16 v[100:103], a[200:203], a[152:155], v[100:103]
 ds_read_b64_tr_b16 a[236:237], v229 offset:51200
 v_add_f32 v255, v255, v19
 v_mfma_f32_16x16x32_bf16 v[100:103], a[204:207], a[156:159], v[100:103]
 v_exp_f32 v209, v85
 v_mfma_f32_16x16x32_bf16 a[8:11], a[224:227], v[168:171], a[8:11]
 ds_read_b64_tr_b16 a[238:239], v229 offset:52224
 v_cvt_pk_bf16_f32 v134, v208, v209
 v_mfma_f32_16x16x32_bf16 a[8:11], a[228:231], v[184:187], a[8:11]
 v_exp_f32 v210, v86
 v_mfma_f32_16x16x32_bf16 a[12:15], a[224:227], v[172:175], a[12:15]
 v_add_f32 v255, v255, v32
 v_add_f32 v255, v255, v33
 v_mfma_f32_16x16x32_bf16 a[12:15], a[228:231], v[188:191], a[12:15]
 v_exp_f32 v211, v87
 v_mfma_f32_16x16x32_bf16 v[104:107], a[192:195], a[160:163], v[200:203]
 ds_read_b128 a[216:219], v226 offset:3072
 v_cvt_pk_bf16_f32 v135, v210, v211
 v_mfma_f32_16x16x32_bf16 v[104:107], a[196:199], a[164:167], v[104:107]
 v_exp_f32 v24, v72
 v_mfma_f32_16x16x32_bf16 v[104:107], a[200:203], a[168:171], v[104:107]
 ds_read_b64_tr_b16 a[240:241], v230 offset:49152
 v_add_f32 v255, v255, v34
 v_mfma_f32_16x16x32_bf16 v[104:107], a[204:207], a[172:175], v[104:107]
 s_waitcnt lgkmcnt(2)
 v_exp_f32 v25, v73
 v_mfma_f32_16x16x32_bf16 v[20:23], v[240:243], v[132:135], v[36:39]
 v_add_f32 v255, v255, v35
 v_add_f32 v254, v254, v215
 v_mfma_f32_16x16x32_bf16 a[16:19], a[232:235], v[160:163], a[16:19]
 ds_read_b64_tr_b16 a[242:243], v230 offset:50176
 v_cvt_pk_bf16_f32 v136, v24, v25
 v_mfma_f32_16x16x32_bf16 a[16:19], a[236:239], v[176:179], a[16:19]
 v_exp_f32 v26, v74
 v_mfma_f32_16x16x32_bf16 a[20:23], a[232:235], v[164:167], a[20:23]
 v_add_f32 v215, v24, v25
 v_add_f32 v215, v215, v26
 v_mfma_f32_16x16x32_bf16 a[20:23], a[236:239], v[180:183], a[20:23]
 v_exp_f32 v27, v75
 v_mfma_f32_16x16x32_bf16 v[108:111], a[192:195], a[176:179], v[204:207]
 ds_read_b128 a[220:223], v227 offset:3072
 v_cvt_pk_bf16_f32 v137, v26, v27
 v_mfma_f32_16x16x32_bf16 v[108:111], a[196:199], a[180:183], v[108:111]
 v_exp_f32 v40, v88
 v_mfma_f32_16x16x32_bf16 v[108:111], a[200:203], a[184:187], v[108:111]
 ds_read_b64_tr_b16 a[244:245], v230 offset:51200
 v_add_f32 v215, v215, v27
 v_mfma_f32_16x16x32_bf16 v[108:111], a[204:207], a[188:191], v[108:111]
 v_exp_f32 v41, v89
 v_mfma_f32_16x16x32_bf16 a[24:27], a[232:235], v[168:171], a[24:27]
 ds_read_b64_tr_b16 a[246:247], v230 offset:52224
 v_cvt_pk_bf16_f32 v138, v40, v41
 v_mfma_f32_16x16x32_bf16 a[24:27], a[236:239], v[184:187], a[24:27]
 v_exp_f32 v42, v90
 v_mfma_f32_16x16x32_bf16 a[28:31], a[232:235], v[172:175], a[28:31]
 s_waitcnt vmcnt(8) lgkmcnt(2)
 s_barrier
 v_mfma_f32_16x16x32_bf16 a[28:31], a[236:239], v[188:191], a[28:31]
 v_exp_f32 v43, v91
 v_mfma_f32_16x16x32_bf16 v[112:115], a[208:211], a[128:131], v[192:195]
 ds_read_b128 a[192:195], v224 offset:16384
 v_cvt_pk_bf16_f32 v139, v42, v43
 v_mfma_f32_16x16x32_bf16 v[112:115], a[212:215], a[132:135], v[112:115]
 v_exp_f32 v208, v76
 v_mfma_f32_16x16x32_bf16 v[112:115], a[216:219], a[136:139], v[112:115]
 ds_read_b64_tr_b16 a[248:249], v231 offset:49152
 v_add_f32 v215, v215, v40
 v_mfma_f32_16x16x32_bf16 v[112:115], a[220:223], a[140:143], v[112:115]
 s_waitcnt lgkmcnt(2)
 v_exp_f32 v209, v77
 v_mfma_f32_16x16x32_bf16 a[32:35], a[240:243], v[160:163], a[32:35]
 ds_read_b64_tr_b16 a[250:251], v231 offset:50176
 v_cvt_pk_bf16_f32 v140, v208, v209
 v_mfma_f32_16x16x32_bf16 a[32:35], a[244:247], v[176:179], a[32:35]
 buffer_load_dword v9, v8, s[24:27], s96 offen sc1
 s_add_u32 m0, s36, 49152
 v_exp_f32 v210, v78
 v_mfma_f32_16x16x32_bf16 a[36:39], a[240:243], v[164:167], a[36:39]
 buffer_load_dwordx4 v236, s[8:11], s34 offen offset:0 lds
 v_add_f32 v215, v215, v41
 v_mfma_f32_16x16x32_bf16 a[36:39], a[244:247], v[180:183], a[36:39]
 v_exp_f32 v211, v79
 v_mfma_f32_16x16x32_bf16 v[116:119], a[208:211], a[144:147], v[196:199]
 ds_read_b128 a[196:199], v225 offset:16384
 v_cvt_pk_bf16_f32 v141, v210, v211
 v_mfma_f32_16x16x32_bf16 v[116:119], a[212:215], a[148:151], v[116:119]
 v_exp_f32 v208, v92
 v_mfma_f32_16x16x32_bf16 v[116:119], a[216:219], a[152:155], v[116:119]
 ds_read_b64_tr_b16 a[252:253], v231 offset:51200
 v_add_f32 v215, v215, v43
 v_mfma_f32_16x16x32_bf16 v[116:119], a[220:223], a[156:159], v[116:119]
 v_exp_f32 v209, v93
 v_mfma_f32_16x16x32_bf16 a[40:43], a[240:243], v[168:171], a[40:43]
 ds_read_b64_tr_b16 a[254:255], v231 offset:52224
 v_cvt_pk_bf16_f32 v142, v208, v209
 v_mfma_f32_16x16x32_bf16 a[40:43], a[244:247], v[184:187], a[40:43]
 v_exp_f32 v210, v94
 v_mfma_f32_16x16x32_bf16 a[44:47], a[240:243], v[172:175], a[44:47]
 buffer_load_dwordx4 v236, s[8:11], s34 offen offset:1024 lds
 v_add_f32 v215, v215, v42
 v_mfma_f32_16x16x32_bf16 a[44:47], a[244:247], v[188:191], a[44:47]
 v_exp_f32 v211, v95
 v_mfma_f32_16x16x32_bf16 v[120:123], a[208:211], a[160:163], v[200:203]
 ds_read_b128 a[200:203], v226 offset:16384
 v_cvt_pk_bf16_f32 v143, v210, v211
 v_mfma_f32_16x16x32_bf16 v[120:123], a[212:215], a[164:167], v[120:123]
 v_exp_f32 v16, v96
 v_mfma_f32_16x16x32_bf16 v[120:123], a[216:219], a[168:171], v[120:123]
 ds_read_b64_tr_b16 a[224:225], v232 offset:49152
 v_max3_f32 v212, v255, v20, v215
 v_mfma_f32_16x16x32_bf16 v[120:123], a[220:223], a[172:175], v[120:123]
 s_waitcnt lgkmcnt(2)
 v_exp_f32 v17, v97
 v_mfma_f32_16x16x32_bf16 v[28:31], v[240:243], v[140:143], v[44:47]
 buffer_load_dwordx4 v236, s[8:11], s34 offen offset:2048 lds
 v_cmp_ngt_f32 s[46:47], s37, v212
 v_mfma_f32_16x16x32_bf16 a[48:51], a[248:251], v[160:163], a[48:51]
 ds_read_b64_tr_b16 a[226:227], v232 offset:50176
 v_cvt_pk_bf16_f32 v144, v16, v17
 v_mfma_f32_16x16x32_bf16 a[48:51], a[252:255], v[176:179], a[48:51]
 v_exp_f32 v18, v98
 v_mfma_f32_16x16x32_bf16 a[52:55], a[248:251], v[164:167], a[52:55]
 buffer_load_dwordx4 v236, s[8:11], s34 offen offset:3072 lds
 s_add_u32 s34, s34, 16384
 v_mfma_f32_16x16x32_bf16 a[52:55], a[252:255], v[180:183], a[52:55]
 v_exp_f32 v19, v99
 v_mfma_f32_16x16x32_bf16 v[124:127], a[208:211], a[176:179], v[204:207]
 ds_read_b128 a[204:207], v227 offset:16384
 v_cvt_pk_bf16_f32 v145, v18, v19
 v_mfma_f32_16x16x32_bf16 v[124:127], a[212:215], a[180:183], v[124:127]
 v_exp_f32 v32, v112
 v_mfma_f32_16x16x32_bf16 v[124:127], a[216:219], a[184:187], v[124:127]
 ds_read_b64_tr_b16 a[228:229], v232 offset:51200
 v_cmp_ngt_f32 vcc, s37, v28
 v_mfma_f32_16x16x32_bf16 v[124:127], a[220:223], a[188:191], v[124:127]
 v_exp_f32 v33, v113
 v_mfma_f32_16x16x32_bf16 a[56:59], a[248:251], v[168:171], a[56:59]
 ds_read_b64_tr_b16 a[230:231], v232 offset:52224
 v_cvt_pk_bf16_f32 v146, v32, v33
 v_mfma_f32_16x16x32_bf16 a[56:59], a[252:255], v[184:187], a[56:59]
 s_or_b64 vcc, vcc, s[46:47]
 v_exp_f32 v34, v114
 v_mfma_f32_16x16x32_bf16 a[60:63], a[248:251], v[172:175], a[60:63]
 s_cbranch_vccnz L_tr_m8
L_back_m8:
 v_mfma_f32_16x16x32_bf16 a[60:63], a[252:255], v[188:191], a[60:63]
 s_waitcnt lgkmcnt(2)
 v_exp_f32 v35, v115
 v_mfma_f32_16x16x32_bf16 v[64:67], a[192:195], a[128:131], v[192:195]
 ds_read_b128 a[208:211], v224 offset:17408
 v_cvt_pk_bf16_f32 v147, v34, v35
 v_mfma_f32_16x16x32_bf16 v[64:67], a[196:199], a[132:135], v[64:67]
 v_exp_f32 v208, v100
 v_mfma_f32_16x16x32_bf16 v[64:67], a[200:203], a[136:139], v[64:67]
 ds_read_b64_tr_b16 a[232:233], v233 offset:49152
 v_add_f32 v253, v253, v255
 v_mfma_f32_16x16x32_bf16 v[64:67], a[204:207], a[140:143], v[64:67]
 s_waitcnt lgkmcnt(2)
 v_exp_f32 v209, v101
 v_mfma_f32_16x16x32_bf16 a[64:67], a[224:227], v[160:163], a[64:67]
 ds_read_b64_tr_b16 a[234:235], v233 offset:50176
 v_cvt_pk_bf16_f32 v148, v208, v209
 v_mfma_f32_16x16x32_bf16 a[64:67], a[228:231], v[176:179], a[64:67]
 v_exp_f32 v210, v102
 v_mfma_f32_16x16x32_bf16 a[68:71], a[224:227], v[164:167], a[68:71]
 v_add_f32 v255, v16, v17
 v_add_f32 v255, v255, v18
 v_mfma_f32_16x16x32_bf16 a[68:71], a[228:231], v[180:183], a[68:71]
 v_exp_f32 v211, v103
 v_mfma_f32_16x16x32_bf16 v[68:71], a[192:195], a[144:147], v[196:199]
 ds_read_b128 a[212:215], v225 offset:17408
 v_cvt_pk_bf16_f32 v149, v210, v211
 v_mfma_f32_16x16x32_bf16 v[68:71], a[196:199], a[148:151], v[68:71]
 v_exp_f32 v208, v116
 v_mfma_f32_16x16x32_bf16 v[68:71], a[200:203], a[152:155], v[68:71]
 ds_read_b64_tr_b16 a[236:237], v233 offset:51200
 v_add_f32 v255, v255, v19
 v_mfma_f32_16x16x32_bf16 v[68:71], a[204:207], a[156:159], v[68:71]
 v_exp_f32 v209, v117
 v_mfma_f32_16x16x32_bf16 a[72:75], a[224:227], v[168:171], a[72:75]
 ds_read_b64_tr_b16 a[238:239], v233 offset:52224
 v_cvt_pk_bf16_f32 v150, v208, v209
 v_mfma_f32_16x16x32_bf16 a[72:75], a[228:231], v[184:187], a[72:75]
 v_exp_f32 v210, v118
 v_mfma_f32_16x16x32_bf16 a[76:79], a[224:227], v[172:175], a[76:79]
 v_add_f32 v255, v255, v32
 v_add_f32 v255, v255, v33
 v_mfma_f32_16x16x32_bf16 a[76:79], a[228:231], v[188:191], a[76:79]
 v_exp_f32 v211, v119
 v_mfma_f32_16x16x32_bf16 v[72:75], a[192:195], a[160:163], v[200:203]
 ds_read_b128 a[216:219], v226 offset:17408
 v_cvt_pk_bf16_f32 v151, v210, v211
 v_mfma_f32_16x16x32_bf16 v[72:75], a[196:199], a[164:167], v[72:75]
 v_exp_f32 v24, v104
 v_mfma_f32_16x16x32_bf16 v[72:75], a[200:203], a[168:171], v[72:75]
 ds_read_b64_tr_b16 a[240:241], v234 offset:49152
 v_add_f32 v255, v255, v34
 v_mfma_f32_16x16x32_bf16 v[72:75], a[204:207], a[172:175], v[72:75]
 s_waitcnt lgkmcnt(2)
 v_exp_f32 v25, v105
 v_mfma_f32_16x16x32_bf16 v[36:39], v[240:243], v[148:151], v[20:23]
 v_add_f32 v255, v255, v35
 v_add_f32 v254, v254, v215
 v_mfma_f32_16x16x32_bf16 a[80:83], a[232:235], v[160:163], a[80:83]
 ds_read_b64_tr_b16 a[242:243], v234 offset:50176
 v_cvt_pk_bf16_f32 v152, v24, v25
 v_mfma_f32_16x16x32_bf16 a[80:83], a[236:239], v[176:179], a[80:83]
 v_exp_f32 v26, v106
 v_mfma_f32_16x16x32_bf16 a[84:87], a[232:235], v[164:167], a[84:87]
 v_add_f32 v215, v24, v25
 v_add_f32 v215, v215, v26
 v_mfma_f32_16x16x32_bf16 a[84:87], a[236:239], v[180:183], a[84:87]
 v_exp_f32 v27, v107
 v_mfma_f32_16x16x32_bf16 v[76:79], a[192:195], a[176:179], v[204:207]
 ds_read_b128 a[220:223], v227 offset:17408
 v_cvt_pk_bf16_f32 v153, v26, v27
 v_mfma_f32_16x16x32_bf16 v[76:79], a[196:199], a[180:183], v[76:79]
 v_exp_f32 v40, v120
 v_mfma_f32_16x16x32_bf16 v[76:79], a[200:203], a[184:187], v[76:79]
 ds_read_b64_tr_b16 a[244:245], v234 offset:51200
 v_add_f32 v215, v215, v27
 v_mfma_f32_16x16x32_bf16 v[76:79], a[204:207], a[188:191], v[76:79]
 v_exp_f32 v41, v121
 v_mfma_f32_16x16x32_bf16 a[88:91], a[232:235], v[168:171], a[88:91]
 ds_read_b64_tr_b16 a[246:247], v234 offset:52224
 v_cvt_pk_bf16_f32 v154, v40, v41
 v_mfma_f32_16x16x32_bf16 a[88:91], a[236:239], v[184:187], a[88:91]
 s_add_u32 m0, s36, 98304
 v_exp_f32 v42, v122
 v_mfma_f32_16x16x32_bf16 a[92:95], a[232:235], v[172:175], a[92:95]
 buffer_load_dwordx4 v237, s[12:15], s35 offen offset:0 lds
 v_mfma_f32_16x16x32_bf16 a[92:95], a[236:239], v[188:191], a[92:95]
 s_waitcnt lgkmcnt(2)
 v_exp_f32 v43, v123
 v_mfma_f32_16x16x32_bf16 v[80:83], a[208:211], a[128:131], v[192:195]
 ds_read_b128 a[192:195], v224 offset:18432
 v_cvt_pk_bf16_f32 v155, v42, v43
 v_mfma_f32_16x16x32_bf16 v[80:83], a[212:215], a[132:135], v[80:83]
 v_exp_f32 v208, v108
 v_mfma_f32_16x16x32_bf16 v[80:83], a[216:219], a[136:139], v[80:83]
 ds_read_b64_tr_b16 a[248:249], v235 offset:49152
 v_add_f32 v215, v215, v40
 v_mfma_f32_16x16x32_bf16 v[80:83], a[220:223], a[140:143], v[80:83]
 s_waitcnt lgkmcnt(2)
 v_exp_f32 v209, v109
 v_mfma_f32_16x16x32_bf16 a[96:99], a[240:243], v[160:163], a[96:99]
 ds_read_b64_tr_b16 a[250:251], v235 offset:50176
 v_cvt_pk_bf16_f32 v156, v208, v209
 v_mfma_f32_16x16x32_bf16 a[96:99], a[244:247], v[176:179], a[96:99]
 v_exp_f32 v210, v110
 v_mfma_f32_16x16x32_bf16 a[100:103], a[240:243], v[164:167], a[100:103]
 buffer_load_dwordx4 v237, s[12:15], s35 offen offset:1024 lds
 v_add_f32 v215, v215, v41
 v_mfma_f32_16x16x32_bf16 a[100:103], a[244:247], v[180:183], a[100:103]
 v_exp_f32 v211, v111
 v_mfma_f32_16x16x32_bf16 v[84:87], a[208:211], a[144:147], v[196:199]
 ds_read_b128 a[196:199], v225 offset:18432
 v_cvt_pk_bf16_f32 v157, v210, v211
 v_mfma_f32_16x16x32_bf16 v[84:87], a[212:215], a[148:151], v[84:87]
 v_exp_f32 v208, v124
 v_mfma_f32_16x16x32_bf16 v[84:87], a[216:219], a[152:155], v[84:87]
 ds_read_b64_tr_b16 a[252:253], v235 offset:51200
 v_add_f32 v215, v215, v43
 v_mfma_f32_16x16x32_bf16 v[84:87], a[220:223], a[156:159], v[84:87]
 v_exp_f32 v209, v125
 v_mfma_f32_16x16x32_bf16 a[104:107], a[240:243], v[168:171], a[104:107]
 ds_read_b64_tr_b16 a[254:255], v235 offset:52224
 v_cvt_pk_bf16_f32 v158, v208, v209
 v_mfma_f32_16x16x32_bf16 a[104:107], a[244:247], v[184:187], a[104:107]
 v_exp_f32 v210, v126
 v_mfma_f32_16x16x32_bf16 a[108:111], a[240:243], v[172:175], a[108:111]
 buffer_load_dwordx4 v237, s[12:15], s35 offen offset:2048 lds
 v_add_f32 v215, v215, v42
 v_mfma_f32_16x16x32_bf16 a[108:111], a[244:247], v[188:191], a[108:111]
 v_exp_f32 v211, v127
 v_mfma_f32_16x16x32_bf16 v[88:91], a[208:211], a[160:163], v[200:203]
 ds_read_b128 a[200:203], v226 offset:18432
 v_cvt_pk_bf16_f32 v159, v210, v211
 v_mfma_f32_16x16x32_bf16 v[88:91], a[212:215], a[164:167], v[88:91]
 v_exp_f32 v16, v64
 v_mfma_f32_16x16x32_bf16 v[88:91], a[216:219], a[168:171], v[88:91]
 ds_read_b64_tr_b16 a[224:225], v228 offset:0
 v_max3_f32 v212, v255, v36, v215
 v_mfma_f32_16x16x32_bf16 v[88:91], a[220:223], a[172:175], v[88:91]
 s_waitcnt lgkmcnt(2)
 v_exp_f32 v17, v65
 v_mfma_f32_16x16x32_bf16 v[44:47], v[240:243], v[156:159], v[28:31]
 v_cmp_ngt_f32 s[46:47], s37, v212
 v_mfma_f32_16x16x32_bf16 a[112:115], a[248:251], v[160:163], a[112:115]
 ds_read_b64_tr_b16 a[226:227], v228 offset:1024
 v_cvt_pk_bf16_f32 v160, v16, v17
 v_mfma_f32_16x16x32_bf16 a[112:115], a[252:255], v[176:179], a[112:115]
 v_exp_f32 v18, v66
 v_mfma_f32_16x16x32_bf16 a[116:119], a[248:251], v[164:167], a[116:119]
 buffer_load_dwordx4 v237, s[12:15], s35 offen offset:3072 lds
 s_add_u32 s35, s35, 16384
 v_mfma_f32_16x16x32_bf16 a[116:119], a[252:255], v[180:183], a[116:119]
 v_exp_f32 v19, v67
 v_mfma_f32_16x16x32_bf16 v[92:95], a[208:211], a[176:179], v[204:207]
 ds_read_b128 a[204:207], v227 offset:18432
 v_cvt_pk_bf16_f32 v161, v18, v19
 v_mfma_f32_16x16x32_bf16 v[92:95], a[212:215], a[180:183], v[92:95]
 v_exp_f32 v32, v80
 v_mfma_f32_16x16x32_bf16 v[92:95], a[216:219], a[184:187], v[92:95]
 ds_read_b64_tr_b16 a[228:229], v228 offset:2048
 v_cmp_ngt_f32 vcc, s37, v44
 v_mfma_f32_16x16x32_bf16 v[92:95], a[220:223], a[188:191], v[92:95]
 v_exp_f32 v33, v81
 v_mfma_f32_16x16x32_bf16 a[120:123], a[248:251], v[168:171], a[120:123]
 ds_read_b64_tr_b16 a[230:231], v228 offset:3072
 v_cvt_pk_bf16_f32 v162, v32, v33
 v_mfma_f32_16x16x32_bf16 a[120:123], a[252:255], v[184:187], a[120:123]
 s_or_b64 vcc, vcc, s[46:47]
 v_exp_f32 v34, v82
 v_mfma_f32_16x16x32_bf16 a[124:127], a[248:251], v[172:175], a[124:127]
 s_cbranch_vccnz L_tr_m9
L_back_m9:
 v_mfma_f32_16x16x32_bf16 a[124:127], a[252:255], v[188:191], a[124:127]
 s_waitcnt lgkmcnt(2)
 v_exp_f32 v35, v83
 s_sub_u32 s38, s38, 1
 s_cmp_lg_u32 s38, 0
 s_cbranch_scc1 L_loop
 v_mfma_f32_16x16x32_bf16 v[96:99], a[192:195], a[128:131], v[192:195]
 ds_read_b128 a[208:211], v224 offset:19456
 v_cvt_pk_bf16_f32 v163, v34, v35
 v_mfma_f32_16x16x32_bf16 v[96:99], a[196:199], a[132:135], v[96:99]
 v_exp_f32 v208, v68
 v_mfma_f32_16x16x32_bf16 v[96:99], a[200:203], a[136:139], v[96:99]
 ds_read_b64_tr_b16 a[232:233], v229 offset:0
 v_add_f32 v253, v253, v255
 v_mfma_f32_16x16x32_bf16 v[96:99], a[204:207], a[140:143], v[96:99]
 s_waitcnt lgkmcnt(2)
 v_exp_f32 v209, v69
 v_mfma_f32_16x16x32_bf16 a[0:3], a[224:227], v[128:131], a[0:3]
 ds_read_b64_tr_b16 a[234:235], v229 offset:1024
 v_cvt_pk_bf16_f32 v164, v208, v209
 v_mfma_f32_16x16x32_bf16 a[0:3], a[228:231], v[144:147], a[0:3]
 v_exp_f32 v210, v70
 v_mfma_f32_16x16x32_bf16 a[4:7], a[224:227], v[132:135], a[4:7]
 s_waitcnt vmcnt(8)
 s_mov_b32 s45, 0x100000
L_pkc:
 v_cmp_ne_u32 vcc, s94, v9
 s_cbranch_vccz L_pkcx
 s_sub_u32 s45, s45, 1
 s_cbranch_scc1 L_pkcx
  buffer_load_dword v9, v8, s[24:27], s96 offen sc1
  s_waitcnt vmcnt(0)
 s_branch L_pkc
L_pkcx:
 v_lshlrev_b32 v222, 7, v1
 v_add_f32 v255, v16, v17
 v_add_f32 v255, v255, v18
 v_mfma_f32_16x16x32_bf16 a[4:7], a[228:231], v[148:151], a[4:7]
 s_mul_i32 s41, s101, 16384
 v_exp_f32 v211, v71
 v_mfma_f32_16x16x32_bf16 v[100:103], a[192:195], a[144:147], v[196:199]
 ds_read_b128 a[212:215], v225 offset:19456
 v_cvt_pk_bf16_f32 v165, v210, v211
 v_mfma_f32_16x16x32_bf16 v[100:103], a[196:199], a[148:151], v[100:103]
 v_exp_f32 v208, v84
 v_mfma_f32_16x16x32_bf16 v[100:103], a[200:203], a[152:155], v[100:103]
 ds_read_b64_tr_b16 a[236:237], v229 offset:2048
 v_add_f32 v255, v255, v19
 v_mfma_f32_16x16x32_bf16 v[100:103], a[204:207], a[156:159], v[100:103]
 v_exp_f32 v209, v85
 v_mfma_f32_16x16x32_bf16 a[8:11], a[224:227], v[136:139], a[8:11]
 ds_read_b64_tr_b16 a[238:239], v229 offset:3072
 v_cvt_pk_bf16_f32 v166, v208, v209
 v_mfma_f32_16x16x32_bf16 a[8:11], a[228:231], v[152:155], a[8:11]
 v_exp_f32 v210, v86
 v_mfma_f32_16x16x32_bf16 a[12:15], a[224:227], v[140:143], a[12:15]
 buffer_load_dword v14, v222, s[20:23], s41 offen sc1
 v_add_f32 v255, v255, v32
 v_add_f32 v255, v255, v33
 v_mfma_f32_16x16x32_bf16 a[12:15], a[228:231], v[156:159], a[12:15]
 s_add_u32 s41, s41, 8192
 v_exp_f32 v211, v87
 v_mfma_f32_16x16x32_bf16 v[104:107], a[192:195], a[160:163], v[200:203]
 ds_read_b128 a[216:219], v226 offset:19456
 v_cvt_pk_bf16_f32 v167, v210, v211
 v_mfma_f32_16x16x32_bf16 v[104:107], a[196:199], a[164:167], v[104:107]
 v_exp_f32 v24, v72
 v_mfma_f32_16x16x32_bf16 v[104:107], a[200:203], a[168:171], v[104:107]
 ds_read_b64_tr_b16 a[240:241], v230 offset:0
 v_add_f32 v255, v255, v34
 v_mfma_f32_16x16x32_bf16 v[104:107], a[204:207], a[172:175], v[104:107]
 s_waitcnt lgkmcnt(2)
 v_exp_f32 v25, v73
 v_mfma_f32_16x16x32_bf16 v[20:23], v[240:243], v[164:167], v[36:39]
 v_add_f32 v255, v255, v35
 v_add_f32 v254, v254, v215
 v_mfma_f32_16x16x32_bf16 a[16:19], a[232:235], v[128:131], a[16:19]
 ds_read_b64_tr_b16 a[242:243], v230 offset:1024
 v_cvt_pk_bf16_f32 v168, v24, v25
 v_mfma_f32_16x16x32_bf16 a[16:19], a[236:239], v[144:147], a[16:19]
 v_exp_f32 v26, v74
 v_mfma_f32_16x16x32_bf16 a[20:23], a[232:235], v[132:135], a[20:23]
 buffer_load_dword v14, v222, s[20:23], s41 offen sc1
 v_add_f32 v215, v24, v25
 v_add_f32 v215, v215, v26
 v_mfma_f32_16x16x32_bf16 a[20:23], a[236:239], v[148:151], a[20:23]
 s_add_u32 s41, s41, 8192
 v_exp_f32 v27, v75
 v_mfma_f32_16x16x32_bf16 v[108:111], a[192:195], a[176:179], v[204:207]
 ds_read_b128 a[220:223], v227 offset:19456
 v_cvt_pk_bf16_f32 v169, v26, v27
 v_mfma_f32_16x16x32_bf16 v[108:111], a[196:199], a[180:183], v[108:111]
 s_lshr_b32 s41, s2, 3
 v_exp_f32 v40, v88
 v_mfma_f32_16x16x32_bf16 v[108:111], a[200:203], a[184:187], v[108:111]
 ds_read_b64_tr_b16 a[244:245], v230 offset:2048
 v_add_f32 v215, v215, v27
 v_mfma_f32_16x16x32_bf16 v[108:111], a[204:207], a[188:191], v[108:111]
 s_lshl_b32 s41, s41, 2
 v_exp_f32 v41, v89
 v_mfma_f32_16x16x32_bf16 a[24:27], a[232:235], v[136:139], a[24:27]
 ds_read_b64_tr_b16 a[246:247], v230 offset:3072
 v_cvt_pk_bf16_f32 v170, v40, v41
 v_mfma_f32_16x16x32_bf16 a[24:27], a[236:239], v[152:155], a[24:27]
 s_add_u32 s41, s41, s3
 v_exp_f32 v42, v90
 v_mfma_f32_16x16x32_bf16 a[28:31], a[232:235], v[140:143], a[28:31]
 s_waitcnt vmcnt(10) lgkmcnt(2)
 s_barrier
 v_and_b32 v222, 1, v1
 v_lshl_add_u32 v222, s41, 1, v222
 v_mfma_f32_16x16x32_bf16 a[28:31], a[236:239], v[156:159], a[28:31]
 v_exp_f32 v43, v91
 v_mfma_f32_16x16x32_bf16 v[112:115], a[208:211], a[128:131], v[192:195]
 ds_read_b128 a[192:195], v224 offset:32768
 v_cvt_pk_bf16_f32 v171, v42, v43
 v_mfma_f32_16x16x32_bf16 v[112:115], a[212:215], a[132:135], v[112:115]
 v_exp_f32 v208, v76
 v_mfma_f32_16x16x32_bf16 v[112:115], a[216:219], a[136:139], v[112:115]
 ds_read_b64_tr_b16 a[248:249], v231 offset:0
 v_add_f32 v215, v215, v40
 v_mfma_f32_16x16x32_bf16 v[112:115], a[220:223], a[140:143], v[112:115]
 s_waitcnt lgkmcnt(2)
 v_exp_f32 v209, v77
 v_mfma_f32_16x16x32_bf16 a[32:35], a[240:243], v[128:131], a[32:35]
 ds_read_b64_tr_b16 a[250:251], v231 offset:1024
 v_cvt_pk_bf16_f32 v172, v208, v209
 v_mfma_f32_16x16x32_bf16 a[32:35], a[244:247], v[144:147], a[32:35]
 v_exp_f32 v210, v78
 v_mfma_f32_16x16x32_bf16 a[36:39], a[240:243], v[132:135], a[36:39]
 v_lshlrev_b32 v222, 7, v222
 s_getpc_b64 s[90:91]
 global_load_dword v14, v222, s[90:91]
 v_add_f32 v215, v215, v41
 v_mfma_f32_16x16x32_bf16 a[36:39], a[244:247], v[148:151], a[36:39]
 v_exp_f32 v211, v79
 v_mfma_f32_16x16x32_bf16 v[116:119], a[208:211], a[144:147], v[196:199]
 ds_read_b128 a[196:199], v225 offset:32768
 v_cvt_pk_bf16_f32 v173, v210, v211
 v_mfma_f32_16x16x32_bf16 v[116:119], a[212:215], a[148:151], v[116:119]
 v_exp_f32 v208, v92
 v_mfma_f32_16x16x32_bf16 v[116:119], a[216:219], a[152:155], v[116:119]
 ds_read_b64_tr_b16 a[252:253], v231 offset:2048
 v_add_f32 v215, v215, v43
 v_mfma_f32_16x16x32_bf16 v[116:119], a[220:223], a[156:159], v[116:119]
 v_exp_f32 v209, v93
 v_mfma_f32_16x16x32_bf16 a[40:43], a[240:243], v[136:139], a[40:43]
 ds_read_b64_tr_b16 a[254:255], v231 offset:3072
 v_cvt_pk_bf16_f32 v174, v208, v209
 v_mfma_f32_16x16x32_bf16 a[40:43], a[244:247], v[152:155], a[40:43]
 v_exp_f32 v210, v94
 v_mfma_f32_16x16x32_bf16 a[44:47], a[240:243], v[140:143], a[44:47]
 v_add_f32 v215, v215, v42
 v_mfma_f32_16x16x32_bf16 a[44:47], a[244:247], v[156:159], a[44:47]
 v_exp_f32 v211, v95
 v_mfma_f32_16x16x32_bf16 v[120:123], a[208:211], a[160:163], v[200:203]
 ds_read_b128 a[200:203], v226 offset:32768
 v_cvt_pk_bf16_f32 v175, v210, v211
 v_mfma_f32_16x16x32_bf16 v[120:123], a[212:215], a[164:167], v[120:123]
 v_exp_f32 v16, v96
 v_mfma_f32_16x16x32_bf16 v[120:123], a[216:219], a[168:171], v[120:123]
 ds_read_b64_tr_b16 a[224:225], v232 offset:0
 v_max3_f32 v212, v255, v20, v215
 v_mfma_f32_16x16x32_bf16 v[120:123], a[220:223], a[172:175], v[120:123]
 s_waitcnt lgkmcnt(2)
 v_exp_f32 v17, v97
 v_mfma_f32_16x16x32_bf16 v[28:31], v[240:243], v[172:175], v[44:47]
 v_cmp_ngt_f32 s[46:47], s37, v212
 v_mfma_f32_16x16x32_bf16 a[48:51], a[248:251], v[128:131], a[48:51]
 ds_read_b64_tr_b16 a[226:227], v232 offset:1024
 v_cvt_pk_bf16_f32 v176, v16, v17
 v_mfma_f32_16x16x32_bf16 a[48:51], a[252:255], v[144:147], a[48:51]
 v_exp_f32 v18, v98
 v_mfma_f32_16x16x32_bf16 a[52:55], a[248:251], v[132:135], a[52:55]
 v_mfma_f32_16x16x32_bf16 a[52:55], a[252:255], v[148:151], a[52:55]
 v_exp_f32 v19, v99
 v_mfma_f32_16x16x32_bf16 v[124:127], a[208:211], a[176:179], v[204:207]
 ds_read_b128 a[204:207], v227 offset:32768
 v_cvt_pk_bf16_f32 v177, v18, v19
 v_mfma_f32_16x16x32_bf16 v[124:127], a[212:215], a[180:183], v[124:127]
 v_exp_f32 v32, v112
 v_mfma_f32_16x16x32_bf16 v[124:127], a[216:219], a[184:187], v[124:127]
 ds_read_b64_tr_b16 a[228:229], v232 offset:2048
 v_cmp_ngt_f32 vcc, s37, v28
 v_mfma_f32_16x16x32_bf16 v[124:127], a[220:223], a[188:191], v[124:127]
 v_exp_f32 v33, v113
 v_mfma_f32_16x16x32_bf16 a[56:59], a[248:251], v[136:139], a[56:59]
 ds_read_b64_tr_b16 a[230:231], v232 offset:3072
 v_cvt_pk_bf16_f32 v178, v32, v33
 v_mfma_f32_16x16x32_bf16 a[56:59], a[252:255], v[152:155], a[56:59]
 s_or_b64 vcc, vcc, s[46:47]
 v_exp_f32 v34, v114
 v_mfma_f32_16x16x32_bf16 a[60:63], a[248:251], v[140:143], a[60:63]
 s_cbranch_vccnz L_tr_e58
L_back_e58:
 v_mfma_f32_16x16x32_bf16 a[60:63], a[252:255], v[156:159], a[60:63]
 s_waitcnt lgkmcnt(2)
 v_exp_f32 v35, v115
 v_mfma_f32_16x16x32_bf16 v[64:67], a[192:195], a[128:131], v[192:195]
 ds_read_b128 a[208:211], v224 offset:33792
 v_cvt_pk_bf16_f32 v179, v34, v35
 v_mfma_f32_16x16x32_bf16 v[64:67], a[196:199], a[132:135], v[64:67]
 v_exp_f32 v208, v100
 v_mfma_f32_16x16x32_bf16 v[64:67], a[200:203], a[136:139], v[64:67]
 ds_read_b64_tr_b16 a[232:233], v233 offset:0
 v_add_f32 v253, v253, v255
 v_mfma_f32_16x16x32_bf16 v[64:67], a[204:207], a[140:143], v[64:67]
 s_waitcnt lgkmcnt(2)
 v_exp_f32 v209, v101
 v_mfma_f32_16x16x32_bf16 a[64:67], a[224:227], v[128:131], a[64:67]
 ds_read_b64_tr_b16 a[234:235], v233 offset:1024
 v_cvt_pk_bf16_f32 v180, v208, v209
 v_mfma_f32_16x16x32_bf16 a[64:67], a[228:231], v[144:147], a[64:67]
 v_exp_f32 v210, v102
 v_mfma_f32_16x16x32_bf16 a[68:71], a[224:227], v[132:135], a[68:71]
 v_add_f32 v255, v16, v17
 v_add_f32 v255, v255, v18
 v_mfma_f32_16x16x32_bf16 a[68:71], a[228:231], v[148:151], a[68:71]
 v_exp_f32 v211, v103
 v_mfma_f32_16x16x32_bf16 v[68:71], a[192:195], a[144:147], v[196:199]
 ds_read_b128 a[212:215], v225 offset:33792
 v_cvt_pk_bf16_f32 v181, v210, v211
 v_mfma_f32_16x16x32_bf16 v[68:71], a[196:199], a[148:151], v[68:71]
 v_exp_f32 v208, v116
 v_mfma_f32_16x16x32_bf16 v[68:71], a[200:203], a[152:155], v[68:71]
 ds_read_b64_tr_b16 a[236:237], v233 offset:2048
 v_add_f32 v255, v255, v19
 v_mfma_f32_16x16x32_bf16 v[68:71], a[204:207], a[156:159], v[68:71]
 v_exp_f32 v209, v117
 v_mfma_f32_16x16x32_bf16 a[72:75], a[224:227], v[136:139], a[72:75]
 ds_read_b64_tr_b16 a[238:239], v233 offset:3072
 v_cvt_pk_bf16_f32 v182, v208, v209
 v_mfma_f32_16x16x32_bf16 a[72:75], a[228:231], v[152:155], a[72:75]
 v_exp_f32 v210, v118
 v_mfma_f32_16x16x32_bf16 a[76:79], a[224:227], v[140:143], a[76:79]
 v_add_f32 v255, v255, v32
 v_add_f32 v255, v255, v33
 v_mfma_f32_16x16x32_bf16 a[76:79], a[228:231], v[156:159], a[76:79]
 v_exp_f32 v211, v119
 v_mfma_f32_16x16x32_bf16 v[72:75], a[192:195], a[160:163], v[200:203]
 ds_read_b128 a[216:219], v226 offset:33792
 v_cvt_pk_bf16_f32 v183, v210, v211
 v_mfma_f32_16x16x32_bf16 v[72:75], a[196:199], a[164:167], v[72:75]
 v_exp_f32 v24, v104
 v_mfma_f32_16x16x32_bf16 v[72:75], a[200:203], a[168:171], v[72:75]
 ds_read_b64_tr_b16 a[240:241], v234 offset:0
 v_add_f32 v255, v255, v34
 v_mfma_f32_16x16x32_bf16 v[72:75], a[204:207], a[172:175], v[72:75]
 s_waitcnt lgkmcnt(2)
 v_exp_f32 v25, v105
 v_mfma_f32_16x16x32_bf16 v[36:39], v[240:243], v[180:183], v[20:23]
 v_add_f32 v255, v255, v35
 v_add_f32 v254, v254, v215
 v_mfma_f32_16x16x32_bf16 a[80:83], a[232:235], v[128:131], a[80:83]
 ds_read_b64_tr_b16 a[242:243], v234 offset:1024
 v_cvt_pk_bf16_f32 v184, v24, v25
 v_mfma_f32_16x16x32_bf16 a[80:83], a[236:239], v[144:147], a[80:83]
 v_exp_f32 v26, v106
 v_mfma_f32_16x16x32_bf16 a[84:87], a[232:235], v[132:135], a[84:87]
 v_add_f32 v215, v24, v25
 v_add_f32 v215, v215, v26
 v_mfma_f32_16x16x32_bf16 a[84:87], a[236:239], v[148:151], a[84:87]
 v_exp_f32 v27, v107
 v_mfma_f32_16x16x32_bf16 v[76:79], a[192:195], a[176:179], v[204:207]
 ds_read_b128 a[220:223], v227 offset:33792
 v_cvt_pk_bf16_f32 v185, v26, v27
 v_mfma_f32_16x16x32_bf16 v[76:79], a[196:199], a[180:183], v[76:79]
 v_exp_f32 v40, v120
 v_mfma_f32_16x16x32_bf16 v[76:79], a[200:203], a[184:187], v[76:79]
 ds_read_b64_tr_b16 a[244:245], v234 offset:2048
 v_add_f32 v215, v215, v27
 v_mfma_f32_16x16x32_bf16 v[76:79], a[204:207], a[188:191], v[76:79]
 v_exp_f32 v41, v121
 v_mfma_f32_16x16x32_bf16 a[88:91], a[232:235], v[136:139], a[88:91]
 ds_read_b64_tr_b16 a[246:247], v234 offset:3072
 v_cvt_pk_bf16_f32 v186, v40, v41
 v_mfma_f32_16x16x32_bf16 a[88:91], a[236:239], v[152:155], a[88:91]
 s_add_u32 m0, s36, 114688
 v_exp_f32 v42, v122
 v_mfma_f32_16x16x32_bf16 a[92:95], a[232:235], v[140:143], a[92:95]
 buffer_load_dwordx4 v237, s[12:15], s35 offen offset:0 lds
 v_mfma_f32_16x16x32_bf16 a[92:95], a[236:239], v[156:159], a[92:95]
 s_waitcnt lgkmcnt(2)
 v_exp_f32 v43, v123
 v_mfma_f32_16x16x32_bf16 v[80:83], a[208:211], a[128:131], v[192:195]
 ds_read_b128 a[192:195], v224 offset:34816
 v_cvt_pk_bf16_f32 v187, v42, v43
 v_mfma_f32_16x16x32_bf16 v[80:83], a[212:215], a[132:135], v[80:83]
 v_exp_f32 v208, v108
 v_mfma_f32_16x16x32_bf16 v[80:83], a[216:219], a[136:139], v[80:83]
 ds_read_b64_tr_b16 a[248:249], v235 offset:0
 v_add_f32 v215, v215, v40
 v_mfma_f32_16x16x32_bf16 v[80:83], a[220:223], a[140:143], v[80:83]
 s_waitcnt lgkmcnt(2)
 v_exp_f32 v209, v109
 v_mfma_f32_16x16x32_bf16 a[96:99], a[240:243], v[128:131], a[96:99]
 ds_read_b64_tr_b16 a[250:251], v235 offset:1024
 v_cvt_pk_bf16_f32 v188, v208, v209
 v_mfma_f32_16x16x32_bf16 a[96:99], a[244:247], v[144:147], a[96:99]
 v_exp_f32 v210, v110
 v_mfma_f32_16x16x32_bf16 a[100:103], a[240:243], v[132:135], a[100:103]
 buffer_load_dwordx4 v237, s[12:15], s35 offen offset:1024 lds
 v_add_f32 v215, v215, v41
 v_mfma_f32_16x16x32_bf16 a[100:103], a[244:247], v[148:151], a[100:103]
 v_exp_f32 v211, v111
 v_mfma_f32_16x16x32_bf16 v[84:87], a[208:211], a[144:147], v[196:199]
 ds_read_b128 a[196:199], v225 offset:34816
 v_cvt_pk_bf16_f32 v189, v210, v211
 v_mfma_f32_16x16x32_bf16 v[84:87], a[212:215], a[148:151], v[84:87]
 v_exp_f32 v208, v124
 v_mfma_f32_16x16x32_bf16 v[84:87], a[216:219], a[152:155], v[84:87]
 ds_read_b64_tr_b16 a[252:253], v235 offset:2048
 v_add_f32 v215, v215, v43
 v_mfma_f32_16x16x32_bf16 v[84:87], a[220:223], a[156:159], v[84:87]
 v_exp_f32 v209, v125
 v_mfma_f32_16x16x32_bf16 a[104:107], a[240:243], v[136:139], a[104:107]
 ds_read_b64_tr_b16 a[254:255], v235 offset:3072
 v_cvt_pk_bf16_f32 v190, v208, v209
 v_mfma_f32_16x16x32_bf16 a[104:107], a[244:247], v[152:155], a[104:107]
 v_exp_f32 v210, v126
 v_mfma_f32_16x16x32_bf16 a[108:111], a[240:243], v[140:143], a[108:111]
 buffer_load_dwordx4 v237, s[12:15], s35 offen offset:2048 lds
 v_add_f32 v215, v215, v42
 v_mfma_f32_16x16x32_bf16 a[108:111], a[244:247], v[156:159], a[108:111]
 v_exp_f32 v211, v127
 v_mfma_f32_16x16x32_bf16 v[88:91], a[208:211], a[160:163], v[200:203]
 ds_read_b128 a[200:203], v226 offset:34816
 v_cvt_pk_bf16_f32 v191, v210, v211
 v_mfma_f32_16x16x32_bf16 v[88:91], a[212:215], a[164:167], v[88:91]
 v_exp_f32 v16, v64
 v_mfma_f32_16x16x32_bf16 v[88:91], a[216:219], a[168:171], v[88:91]
 ds_read_b64_tr_b16 a[224:225], v228 offset:16384
 v_max3_f32 v212, v255, v36, v215
 v_mfma_f32_16x16x32_bf16 v[88:91], a[220:223], a[172:175], v[88:91]
 s_waitcnt lgkmcnt(2)
 v_exp_f32 v17, v65
 v_mfma_f32_16x16x32_bf16 v[44:47], v[240:243], v[188:191], v[28:31]
 v_cmp_ngt_f32 s[46:47], s37, v212
 v_mfma_f32_16x16x32_bf16 a[112:115], a[248:251], v[128:131], a[112:115]
 ds_read_b64_tr_b16 a[226:227], v228 offset:17408
 v_cvt_pk_bf16_f32 v128, v16, v17
 v_mfma_f32_16x16x32_bf16 a[112:115], a[252:255], v[144:147], a[112:115]
 v_exp_f32 v18, v66
 v_mfma_f32_16x16x32_bf16 a[116:119], a[248:251], v[132:135], a[116:119]
 buffer_load_dwordx4 v237, s[12:15], s35 offen offset:3072 lds
 s_add_u32 s35, s35, 16384
 v_mfma_f32_16x16x32_bf16 a[116:119], a[252:255], v[148:151], a[116:119]
 v_exp_f32 v19, v67
 v_mfma_f32_16x16x32_bf16 v[92:95], a[208:211], a[176:179], v[204:207]
 ds_read_b128 a[204:207], v227 offset:34816
 v_cvt_pk_bf16_f32 v129, v18, v19
 v_mfma_f32_16x16x32_bf16 v[92:95], a[212:215], a[180:183], v[92:95]
 v_exp_f32 v32, v80
 v_mfma_f32_16x16x32_bf16 v[92:95], a[216:219], a[184:187], v[92:95]
 ds_read_b64_tr_b16 a[228:229], v228 offset:18432
 v_cmp_ngt_f32 vcc, s37, v44
 v_mfma_f32_16x16x32_bf16 v[92:95], a[220:223], a[188:191], v[92:95]
 v_exp_f32 v33, v81
 v_mfma_f32_16x16x32_bf16 a[120:123], a[248:251], v[136:139], a[120:123]
 ds_read_b64_tr_b16 a[230:231], v228 offset:19456
 v_cvt_pk_bf16_f32 v130, v32, v33
 v_mfma_f32_16x16x32_bf16 a[120:123], a[252:255], v[152:155], a[120:123]
 s_or_b64 vcc, vcc, s[46:47]
 v_exp_f32 v34, v82
 v_mfma_f32_16x16x32_bf16 a[124:127], a[248:251], v[140:143], a[124:127]
 s_cbranch_vccnz L_tr_e59
L_back_e59:
 v_mfma_f32_16x16x32_bf16 a[124:127], a[252:255], v[156:159], a[124:127]
 s_waitcnt lgkmcnt(2)
 v_exp_f32 v35, v83
 v_mfma_f32_16x16x32_bf16 v[96:99], a[192:195], a[128:131], v[192:195]
 ds_read_b128 a[208:211], v224 offset:35840
 v_cvt_pk_bf16_f32 v131, v34, v35
 v_mfma_f32_16x16x32_bf16 v[96:99], a[196:199], a[132:135], v[96:99]
 s_lshr_b32 s41, s32, 1
 v_exp_f32 v208, v68
 v_mfma_f32_16x16x32_bf16 v[96:99], a[200:203], a[136:139], v[96:99]
 ds_read_b64_tr_b16 a[232:233], v229 offset:16384
 v_add_f32 v253, v253, v255
 v_mfma_f32_16x16x32_bf16 v[96:99], a[204:207], a[140:143], v[96:99]
 s_waitcnt lgkmcnt(2)
 s_add_u32 s41, s41, 0
 v_exp_f32 v209, v69
 v_mfma_f32_16x16x32_bf16 a[0:3], a[224:227], v[160:163], a[0:3]
 ds_read_b64_tr_b16 a[234:235], v229 offset:17408
 v_cvt_pk_bf16_f32 v132, v208, v209
 v_mfma_f32_16x16x32_bf16 a[0:3], a[228:231], v[176:179], a[0:3]
 s_and_b32 s41, s41, 3
 v_exp_f32 v210, v70
 v_mfma_f32_16x16x32_bf16 a[4:7], a[224:227], v[164:167], a[4:7]
 s_add_u32 m0, s39, 0
 s_mov_b32 s52, 114688
 buffer_load_dwordx4 v252, s[20:23], s52 offen offset:0 sc1 lds
 s_lshl_b32 s41, s41, 14
 v_add_u32 v48, s41, v213
 v_add_f32 v255, v16, v17
 v_add_f32 v255, v255, v18
 v_mfma_f32_16x16x32_bf16 a[4:7], a[228:231], v[180:183], a[4:7]
 s_lshr_b32 s41, s32, 1
 v_exp_f32 v211, v71
 v_mfma_f32_16x16x32_bf16 v[100:103], a[192:195], a[144:147], v[196:199]
 ds_read_b128 a[212:215], v225 offset:35840
 v_cvt_pk_bf16_f32 v133, v210, v211
 v_mfma_f32_16x16x32_bf16 v[100:103], a[196:199], a[148:151], v[100:103]
 s_add_u32 s41, s41, 1
 v_exp_f32 v208, v84
 v_mfma_f32_16x16x32_bf16 v[100:103], a[200:203], a[152:155], v[100:103]
 ds_read_b64_tr_b16 a[236:237], v229 offset:18432
 v_add_f32 v255, v255, v19
 v_mfma_f32_16x16x32_bf16 v[100:103], a[204:207], a[156:159], v[100:103]
 s_and_b32 s41, s41, 3
 v_exp_f32 v209, v85
 v_mfma_f32_16x16x32_bf16 a[8:11], a[224:227], v[168:171], a[8:11]
 ds_read_b64_tr_b16 a[238:239], v229 offset:19456
 v_cvt_pk_bf16_f32 v134, v208, v209
 v_mfma_f32_16x16x32_bf16 a[8:11], a[228:231], v[184:187], a[8:11]
 s_lshl_b32 s41, s41, 14
 v_exp_f32 v210, v86
 v_mfma_f32_16x16x32_bf16 a[12:15], a[224:227], v[172:175], a[12:15]
 buffer_load_dwordx4 v252, s[20:23], s52 offen offset:1024 sc1 lds
 v_add_u32 v49, s41, v213
 v_add_f32 v255, v255, v32
 v_add_f32 v255, v255, v33
 v_mfma_f32_16x16x32_bf16 a[12:15], a[228:231], v[188:191], a[12:15]
 s_lshr_b32 s41, s32, 1
 v_exp_f32 v211, v87
 v_mfma_f32_16x16x32_bf16 v[104:107], a[192:195], a[160:163], v[200:203]
 ds_read_b128 a[216:219], v226 offset:35840
 v_cvt_pk_bf16_f32 v135, v210, v211
 v_mfma_f32_16x16x32_bf16 v[104:107], a[196:199], a[164:167], v[104:107]
 s_add_u32 s41, s41, 2
 v_exp_f32 v24, v72
 v_mfma_f32_16x16x32_bf16 v[104:107], a[200:203], a[168:171], v[104:107]
 ds_read_b64_tr_b16 a[240:241], v230 offset:16384
 v_add_f32 v255, v255, v34
 v_mfma_f32_16x16x32_bf16 v[104:107], a[204:207], a[172:175], v[104:107]
 s_waitcnt lgkmcnt(2)
 s_and_b32 s41, s41, 3
 v_exp_f32 v25, v73
 v_mfma_f32_16x16x32_bf16 v[20:23], v[240:243], v[132:135], v[36:39]
 v_add_f32 v255, v255, v35
 v_add_f32 v254, v254, v215
 v_mfma_f32_16x16x32_bf16 a[16:19], a[232:235], v[160:163], a[16:19]
 ds_read_b64_tr_b16 a[242:243], v230 offset:17408
 v_cvt_pk_bf16_f32 v136, v24, v25
 v_mfma_f32_16x16x32_bf16 a[16:19], a[236:239], v[176:179], a[16:19]
 s_lshl_b32 s41, s41, 14
 v_exp_f32 v26, v74
 v_mfma_f32_16x16x32_bf16 a[20:23], a[232:235], v[164:167], a[20:23]
 buffer_load_dwordx4 v252, s[20:23], s52 offen offset:2048 sc1 lds
 v_add_u32 v50, s41, v213
 v_add_f32 v215, v24, v25
 v_add_f32 v215, v215, v26
 v_mfma_f32_16x16x32_bf16 a[20:23], a[236:239], v[180:183], a[20:23]
 s_lshr_b32 s41, s32, 1
 v_exp_f32 v27, v75
 v_mfma_f32_16x16x32_bf16 v[108:111], a[192:195], a[176:179], v[204:207]
 ds_read_b128 a[220:223], v227 offset:35840
 v_cvt_pk_bf16_f32 v137, v26, v27
 v_mfma_f32_16x16x32_bf16 v[108:111], a[196:199], a[180:183], v[108:111]
 s_add_u32 s41, s41, 3
 v_exp_f32 v40, v88
 v_mfma_f32_16x16x32_bf16 v[108:111], a[200:203], a[184:187], v[108:111]
 ds_read_b64_tr_b16 a[244:245], v230 offset:18432
 v_add_f32 v215, v215, v27
 v_mfma_f32_16x16x32_bf16 v[108:111], a[204:207], a[188:191], v[108:111]
 s_and_b32 s41, s41, 3
 v_exp_f32 v41, v89
 v_mfma_f32_16x16x32_bf16 a[24:27], a[232:235], v[168:171], a[24:27]
 ds_read_b64_tr_b16 a[246:247], v230 offset:19456
 v_cvt_pk_bf16_f32 v138, v40, v41
 v_mfma_f32_16x16x32_bf16 a[24:27], a[236:239], v[184:187], a[24:27]
 s_lshl_b32 s41, s41, 14
 v_exp_f32 v42, v90
 v_mfma_f32_16x16x32_bf16 a[28:31], a[232:235], v[172:175], a[28:31]
 s_waitcnt vmcnt(10) lgkmcnt(2)
 s_barrier
 buffer_load_dwordx4 v252, s[20:23], s52 offen offset:3072 sc1 lds
 v_add_u32 v51, s41, v213
 v_mfma_f32_16x16x32_bf16 a[28:31], a[236:239], v[188:191], a[28:31]
 v_exp_f32 v43, v91
 v_mfma_f32_16x16x32_bf16 v[112:115], a[208:211], a[128:131], v[192:195]
 ds_read_b128 a[192:195], v224 offset:49152
 v_cvt_pk_bf16_f32 v139, v42, v43
 v_mfma_f32_16x16x32_bf16 v[112:115], a[212:215], a[132:135], v[112:115]
 v_exp_f32 v208, v76
 v_mfma_f32_16x16x32_bf16 v[112:115], a[216:219], a[136:139], v[112:115]
 ds_read_b64_tr_b16 a[248:249], v231 offset:16384
 v_add_f32 v215, v215, v40
 v_mfma_f32_16x16x32_bf16 v[112:115], a[220:223], a[140:143], v[112:115]
 s_waitcnt lgkmcnt(2)
 v_exp_f32 v209, v77
 v_mfma_f32_16x16x32_bf16 a[32:35], a[240:243], v[160:163], a[32:35]
 ds_read_b64_tr_b16 a[250:251], v231 offset:17408
 v_cvt_pk_bf16_f32 v140, v208, v209
 v_mfma_f32_16x16x32_bf16 a[32:35], a[244:247], v[176:179], a[32:35]
 v_exp_f32 v210, v78
 v_mfma_f32_16x16x32_bf16 a[36:39], a[240:243], v[164:167], a[36:39]
 s_add_u32 m0, s39, 4096
 s_mov_b32 s52, 118784
 buffer_load_dwordx4 v252, s[20:23], s52 offen offset:0 sc1 lds
 v_add_f32 v215, v215, v41
 v_mfma_f32_16x16x32_bf16 a[36:39], a[244:247], v[180:183], a[36:39]
 v_exp_f32 v211, v79
 v_mfma_f32_16x16x32_bf16 v[116:119], a[208:211], a[144:147], v[196:199]
 ds_read_b128 a[196:199], v225 offset:49152
 v_cvt_pk_bf16_f32 v141, v210, v211
 v_mfma_f32_16x16x32_bf16 v[116:119], a[212:215], a[148:151], v[116:119]
 v_exp_f32 v208, v92
 v_mfma_f32_16x16x32_bf16 v[116:119], a[216:219], a[152:155], v[116:119]
 ds_read_b64_tr_b16 a[252:253], v231 offset:18432
 v_add_f32 v215, v215, v43
 v_mfma_f32_16x16x32_bf16 v[116:119], a[220:223], a[156:159], v[116:119]
 v_exp_f32 v209, v93
 v_mfma_f32_16x16x32_bf16 a[40:43], a[240:243], v[168:171], a[40:43]
 ds_read_b64_tr_b16 a[254:255], v231 offset:19456
 v_cvt_pk_bf16_f32 v142, v208, v209
 v_mfma_f32_16x16x32_bf16 a[40:43], a[244:247], v[184:187], a[40:43]
 v_exp_f32 v210, v94
 v_mfma_f32_16x16x32_bf16 a[44:47], a[240:243], v[172:175], a[44:47]
 buffer_load_dwordx4 v252, s[20:23], s52 offen offset:1024 sc1 lds
 v_add_f32 v215, v215, v42
 v_mfma_f32_16x16x32_bf16 a[44:47], a[244:247], v[188:191], a[44:47]
 v_exp_f32 v211, v95
 v_mfma_f32_16x16x32_bf16 v[120:123], a[208:211], a[160:163], v[200:203]
 ds_read_b128 a[200:203], v226 offset:49152
 v_cvt_pk_bf16_f32 v143, v210, v211
 v_mfma_f32_16x16x32_bf16 v[120:123], a[212:215], a[164:167], v[120:123]
 v_exp_f32 v16, v96
 v_mfma_f32_16x16x32_bf16 v[120:123], a[216:219], a[168:171], v[120:123]
 ds_read_b64_tr_b16 a[224:225], v232 offset:16384
 v_max3_f32 v212, v255, v20, v215
 v_mfma_f32_16x16x32_bf16 v[120:123], a[220:223], a[172:175], v[120:123]
 s_waitcnt lgkmcnt(2)
 v_exp_f32 v17, v97
 v_mfma_f32_16x16x32_bf16 v[28:31], v[240:243], v[140:143], v[44:47]
 v_cmp_ngt_f32 s[46:47], s37, v212
 v_mfma_f32_16x16x32_bf16 a[48:51], a[248:251], v[160:163], a[48:51]
 ds_read_b64_tr_b16 a[226:227], v232 offset:17408
 v_cvt_pk_bf16_f32 v144, v16, v17
 v_mfma_f32_16x16x32_bf16 a[48:51], a[252:255], v[176:179], a[48:51]
 v_exp_f32 v18, v98
 v_mfma_f32_16x16x32_bf16 a[52:55], a[248:251], v[164:167], a[52:55]
 buffer_load_dwordx4 v252, s[20:23], s52 offen offset:2048 sc1 lds
 v_mfma_f32_16x16x32_bf16 a[52:55], a[252:255], v[180:183], a[52:55]
 v_exp_f32 v19, v99
 v_mfma_f32_16x16x32_bf16 v[124:127], a[208:211], a[176:179], v[204:207]
 ds_read_b128 a[204:207], v227 offset:49152
 v_cvt_pk_bf16_f32 v145, v18, v19
 v_mfma_f32_16x16x32_bf16 v[124:127], a[212:215], a[180:183], v[124:127]
 v_exp_f32 v32, v112
 v_mfma_f32_16x16x32_bf16 v[124:127], a[216:219], a[184:187], v[124:127]
 ds_read_b64_tr_b16 a[228:229], v232 offset:18432
 v_cmp_ngt_f32 vcc, s37, v28
 v_mfma_f32_16x16x32_bf16 v[124:127], a[220:223], a[188:191], v[124:127]
 v_exp_f32 v33, v113
 v_mfma_f32_16x16x32_bf16 a[56:59], a[248:251], v[168:171], a[56:59]
 ds_read_b64_tr_b16 a[230:231], v232 offset:19456
 v_cvt_pk_bf16_f32 v146, v32, v33
 v_mfma_f32_16x16x32_bf16 a[56:59], a[252:255], v[184:187], a[56:59]
 s_or_b64 vcc, vcc, s[46:47]
 v_exp_f32 v34, v114
 v_mfma_f32_16x16x32_bf16 a[60:63], a[248:251], v[172:175], a[60:63]
 s_cbranch_vccnz L_tr_e60
L_back_e60:
 buffer_load_dwordx4 v252, s[20:23], s52 offen offset:3072 sc1 lds
 v_mfma_f32_16x16x32_bf16 a[60:63], a[252:255], v[188:191], a[60:63]
 s_waitcnt lgkmcnt(2)
 v_exp_f32 v35, v115
 v_mfma_f32_16x16x32_bf16 v[64:67], a[192:195], a[128:131], v[192:195]
 ds_read_b128 a[208:211], v224 offset:50176
 v_cvt_pk_bf16_f32 v147, v34, v35
 v_mfma_f32_16x16x32_bf16 v[64:67], a[196:199], a[132:135], v[64:67]
 v_exp_f32 v208, v100
 v_mfma_f32_16x16x32_bf16 v[64:67], a[200:203], a[136:139], v[64:67]
 ds_read_b64_tr_b16 a[232:233], v233 offset:16384
 v_add_f32 v253, v253, v255
 v_mfma_f32_16x16x32_bf16 v[64:67], a[204:207], a[140:143], v[64:67]
 s_waitcnt lgkmcnt(2)
 v_exp_f32 v209, v101
 v_mfma_f32_16x16x32_bf16 a[64:67], a[224:227], v[160:163], a[64:67]
 ds_read_b64_tr_b16 a[234:235], v233 offset:17408
 v_cvt_pk_bf16_f32 v148, v208, v209
 v_mfma_f32_16x16x32_bf16 a[64:67], a[228:231], v[176:179], a[64:67]
 v_exp_f32 v210, v102
 v_mfma_f32_16x16x32_bf16 a[68:71], a[224:227], v[164:167], a[68:71]
 s_add_u32 m0, s40, 0
 s_mov_b32 s52, 122880
 buffer_load_dwordx4 v252, s[20:23], s52 offen offset:0 sc1 lds
 v_add_u32 v59, s39, v252
 v_add_u32 v60, s40, v252
 v_add_f32 v255, v16, v17
 v_add_f32 v255, v255, v18
 v_mfma_f32_16x16x32_bf16 a[68:71], a[228:231], v[180:183], a[68:71]
 v_exp_f32 v211, v103
 v_mfma_f32_16x16x32_bf16 v[68:71], a[192:195], a[144:147], v[196:199]
 ds_read_b128 a[212:215], v225 offset:50176
 v_cvt_pk_bf16_f32 v149, v210, v211
 v_mfma_f32_16x16x32_bf16 v[68:71], a[196:199], a[148:151], v[68:71]
 v_exp_f32 v208, v116
 v_mfma_f32_16x16x32_bf16 v[68:71], a[200:203], a[152:155], v[68:71]
 ds_read_b64_tr_b16 a[236:237], v233 offset:18432
 v_add_f32 v255, v255, v19
 v_mfma_f32_16x16x32_bf16 v[68:71], a[204:207], a[156:159], v[68:71]
 v_exp_f32 v209, v117
 v_mfma_f32_16x16x32_bf16 a[72:75], a[224:227], v[168:171], a[72:75]
 ds_read_b64_tr_b16 a[238:239], v233 offset:19456
 v_cvt_pk_bf16_f32 v150, v208, v209
 v_mfma_f32_16x16x32_bf16 a[72:75], a[228:231], v[184:187], a[72:75]
 v_exp_f32 v210, v118
 v_mfma_f32_16x16x32_bf16 a[76:79], a[224:227], v[172:175], a[76:79]
 buffer_load_dwordx4 v252, s[20:23], s52 offen offset:1024 sc1 lds
 v_add_f32 v255, v255, v32
 v_add_f32 v255, v255, v33
 v_mfma_f32_16x16x32_bf16 a[76:79], a[228:231], v[188:191], a[76:79]
 v_exp_f32 v211, v119
 v_mfma_f32_16x16x32_bf16 v[72:75], a[192:195], a[160:163], v[200:203]
 ds_read_b128 a[216:219], v226 offset:50176
 v_cvt_pk_bf16_f32 v151, v210, v211
 v_mfma_f32_16x16x32_bf16 v[72:75], a[196:199], a[164:167], v[72:75]
 v_exp_f32 v24, v104
 v_mfma_f32_16x16x32_bf16 v[72:75], a[200:203], a[168:171], v[72:75]
 ds_read_b64_tr_b16 a[240:241], v234 offset:16384
 v_add_f32 v255, v255, v34
 v_mfma_f32_16x16x32_bf16 v[72:75], a[204:207], a[172:175], v[72:75]
 s_waitcnt lgkmcnt(2)
 v_exp_f32 v25, v105
 v_mfma_f32_16x16x32_bf16 v[36:39], v[240:243], v[148:151], v[20:23]
 v_add_f32 v255, v255, v35
 v_add_f32 v254, v254, v215
 v_mfma_f32_16x16x32_bf16 a[80:83], a[232:235], v[160:163], a[80:83]
 ds_read_b64_tr_b16 a[242:243], v234 offset:17408
 v_cvt_pk_bf16_f32 v152, v24, v25
 v_mfma_f32_16x16x32_bf16 a[80:83], a[236:239], v[176:179], a[80:83]
 v_exp_f32 v26, v106
 v_mfma_f32_16x16x32_bf16 a[84:87], a[232:235], v[164:167], a[84:87]
 buffer_load_dwordx4 v252, s[20:23], s52 offen offset:2048 sc1 lds
 v_add_f32 v215, v24, v25
 v_add_f32 v215, v215, v26
 v_mfma_f32_16x16x32_bf16 a[84:87], a[236:239], v[180:183], a[84:87]
 v_exp_f32 v27, v107
 v_mfma_f32_16x16x32_bf16 v[76:79], a[192:195], a[176:179], v[204:207]
 ds_read_b128 a[220:223], v227 offset:50176
 v_cvt_pk_bf16_f32 v153, v26, v27
 v_mfma_f32_16x16x32_bf16 v[76:79], a[196:199], a[180:183], v[76:79]
 v_exp_f32 v40, v120
 v_mfma_f32_16x16x32_bf16 v[76:79], a[200:203], a[184:187], v[76:79]
 ds_read_b64_tr_b16 a[244:245], v234 offset:18432
 v_add_f32 v215, v215, v27
 v_mfma_f32_16x16x32_bf16 v[76:79], a[204:207], a[188:191], v[76:79]
 v_exp_f32 v41, v121
 v_mfma_f32_16x16x32_bf16 a[88:91], a[232:235], v[168:171], a[88:91]
 ds_read_b64_tr_b16 a[246:247], v234 offset:19456
 v_cvt_pk_bf16_f32 v154, v40, v41
 v_mfma_f32_16x16x32_bf16 a[88:91], a[236:239], v[184:187], a[88:91]
 v_exp_f32 v42, v122
 v_mfma_f32_16x16x32_bf16 a[92:95], a[232:235], v[172:175], a[92:95]
 buffer_load_dwordx4 v252, s[20:23], s52 offen offset:3072 sc1 lds
 v_mfma_f32_16x16x32_bf16 a[92:95], a[236:239], v[188:191], a[92:95]
 s_waitcnt lgkmcnt(2)
 v_exp_f32 v43, v123
 v_mfma_f32_16x16x32_bf16 v[80:83], a[208:211], a[128:131], v[192:195]
 ds_read_b128 a[192:195], v224 offset:51200
 v_cvt_pk_bf16_f32 v155, v42, v43
 v_mfma_f32_16x16x32_bf16 v[80:83], a[212:215], a[132:135], v[80:83]
 v_exp_f32 v208, v108
 v_mfma_f32_16x16x32_bf16 v[80:83], a[216:219], a[136:139], v[80:83]
 ds_read_b64_tr_b16 a[248:249], v235 offset:16384
 v_add_f32 v215, v215, v40
 v_mfma_f32_16x16x32_bf16 v[80:83], a[220:223], a[140:143], v[80:83]
 s_waitcnt lgkmcnt(2)
 v_exp_f32 v209, v109
 v_mfma_f32_16x16x32_bf16 a[96:99], a[240:243], v[160:163], a[96:99]
 ds_read_b64_tr_b16 a[250:251], v235 offset:17408
 v_cvt_pk_bf16_f32 v156, v208, v209
 v_mfma_f32_16x16x32_bf16 a[96:99], a[244:247], v[176:179], a[96:99]
 v_exp_f32 v210, v110
 v_mfma_f32_16x16x32_bf16 a[100:103], a[240:243], v[164:167], a[100:103]
 s_add_u32 m0, s40, 4096
 s_mov_b32 s52, 126976
 buffer_load_dwordx4 v252, s[20:23], s52 offen offset:0 sc1 lds
 v_add_f32 v215, v215, v41
 v_mfma_f32_16x16x32_bf16 a[100:103], a[244:247], v[180:183], a[100:103]
 v_exp_f32 v211, v111
 v_mfma_f32_16x16x32_bf16 v[84:87], a[208:211], a[144:147], v[196:199]
 ds_read_b128 a[196:199], v225 offset:51200
 v_cvt_pk_bf16_f32 v157, v210, v211
 v_mfma_f32_16x16x32_bf16 v[84:87], a[212:215], a[148:151], v[84:87]
 v_exp_f32 v208, v124
 v_mfma_f32_16x16x32_bf16 v[84:87], a[216:219], a[152:155], v[84:87]
 ds_read_b64_tr_b16 a[252:253], v235 offset:18432
 v_add_f32 v215, v215, v43
 v_mfma_f32_16x16x32_bf16 v[84:87], a[220:223], a[156:159], v[84:87]
 v_exp_f32 v209, v125
 v_mfma_f32_16x16x32_bf16 a[104:107], a[240:243], v[168:171], a[104:107]
 ds_read_b64_tr_b16 a[254:255], v235 offset:19456
 v_cvt_pk_bf16_f32 v158, v208, v209
 v_mfma_f32_16x16x32_bf16 a[104:107], a[244:247], v[184:187], a[104:107]
 v_exp_f32 v210, v126
 v_mfma_f32_16x16x32_bf16 a[108:111], a[240:243], v[172:175], a[108:111]
 buffer_load_dwordx4 v252, s[20:23], s52 offen offset:1024 sc1 lds
 v_add_f32 v215, v215, v42
 v_mfma_f32_16x16x32_bf16 a[108:111], a[244:247], v[188:191], a[108:111]
 v_exp_f32 v211, v127
 v_mfma_f32_16x16x32_bf16 v[88:91], a[208:211], a[160:163], v[200:203]
 ds_read_b128 a[200:203], v226 offset:51200
 v_cvt_pk_bf16_f32 v159, v210, v211
 v_mfma_f32_16x16x32_bf16 v[88:91], a[212:215], a[164:167], v[88:91]
 v_exp_f32 v16, v64
 v_mfma_f32_16x16x32_bf16 v[88:91], a[216:219], a[168:171], v[88:91]
 ds_read_b64_tr_b16 a[224:225], v228 offset:32768
 v_max3_f32 v212, v255, v36, v215
 v_mfma_f32_16x16x32_bf16 v[88:91], a[220:223], a[172:175], v[88:91]
 s_waitcnt lgkmcnt(2)
 v_exp_f32 v17, v65
 v_mfma_f32_16x16x32_bf16 v[44:47], v[240:243], v[156:159], v[28:31]
 v_cmp_ngt_f32 s[46:47], s37, v212
 v_mfma_f32_16x16x32_bf16 a[112:115], a[248:251], v[160:163], a[112:115]
 ds_read_b64_tr_b16 a[226:227], v228 offset:33792
 v_cvt_pk_bf16_f32 v160, v16, v17
 v_mfma_f32_16x16x32_bf16 a[112:115], a[252:255], v[176:179], a[112:115]
 v_exp_f32 v18, v66
 v_mfma_f32_16x16x32_bf16 a[116:119], a[248:251], v[164:167], a[116:119]
 buffer_load_dwordx4 v252, s[20:23], s52 offen offset:2048 sc1 lds
 v_mfma_f32_16x16x32_bf16 a[116:119], a[252:255], v[180:183], a[116:119]
 v_exp_f32 v19, v67
 v_mfma_f32_16x16x32_bf16 v[92:95], a[208:211], a[176:179], v[204:207]
 ds_read_b128 a[204:207], v227 offset:51200
 v_cvt_pk_bf16_f32 v161, v18, v19
 v_mfma_f32_16x16x32_bf16 v[92:95], a[212:215], a[180:183], v[92:95]
 v_exp_f32 v32, v80
 v_mfma_f32_16x16x32_bf16 v[92:95], a[216:219], a[184:187], v[92:95]
 ds_read_b64_tr_b16 a[228:229], v228 offset:34816
 v_cmp_ngt_f32 vcc, s37, v44
 v_mfma_f32_16x16x32_bf16 v[92:95], a[220:223], a[188:191], v[92:95]
 v_exp_f32 v33, v81
 v_mfma_f32_16x16x32_bf16 a[120:123], a[248:251], v[168:171], a[120:123]
 ds_read_b64_tr_b16 a[230:231], v228 offset:35840
 v_cvt_pk_bf16_f32 v162, v32, v33
 v_mfma_f32_16x16x32_bf16 a[120:123], a[252:255], v[184:187], a[120:123]
 s_or_b64 vcc, vcc, s[46:47]
 v_exp_f32 v34, v82
 v_mfma_f32_16x16x32_bf16 a[124:127], a[248:251], v[172:175], a[124:127]
 s_cbranch_vccnz L_tr_e61
L_back_e61:
 buffer_load_dwordx4 v252, s[20:23], s52 offen offset:3072 sc1 lds
 v_mfma_f32_16x16x32_bf16 a[124:127], a[252:255], v[188:191], a[124:127]
 s_waitcnt lgkmcnt(2)
 v_exp_f32 v35, v83
 v_mfma_f32_16x16x32_bf16 v[96:99], a[192:195], a[128:131], v[192:195]
 ds_read_b128 a[208:211], v224 offset:52224
 v_cvt_pk_bf16_f32 v163, v34, v35
 v_mfma_f32_16x16x32_bf16 v[96:99], a[196:199], a[132:135], v[96:99]
 v_exp_f32 v208, v68
 v_mfma_f32_16x16x32_bf16 v[96:99], a[200:203], a[136:139], v[96:99]
 ds_read_b64_tr_b16 a[232:233], v229 offset:32768
 v_add_f32 v253, v253, v255
 v_mfma_f32_16x16x32_bf16 v[96:99], a[204:207], a[140:143], v[96:99]
 s_waitcnt lgkmcnt(2)
 v_exp_f32 v209, v69
 v_mfma_f32_16x16x32_bf16 a[0:3], a[224:227], v[128:131], a[0:3]
 ds_read_b64_tr_b16 a[234:235], v229 offset:33792
 v_cvt_pk_bf16_f32 v164, v208, v209
 v_mfma_f32_16x16x32_bf16 a[0:3], a[228:231], v[144:147], a[0:3]
 v_exp_f32 v210, v70
 v_mfma_f32_16x16x32_bf16 a[4:7], a[224:227], v[132:135], a[4:7]
 v_add_f32 v255, v16, v17
 v_add_f32 v255, v255, v18
 v_mfma_f32_16x16x32_bf16 a[4:7], a[228:231], v[148:151], a[4:7]
 v_exp_f32 v211, v71
 v_mfma_f32_16x16x32_bf16 v[100:103], a[192:195], a[144:147], v[196:199]
 ds_read_b128 a[212:215], v225 offset:52224
 v_cvt_pk_bf16_f32 v165, v210, v211
 v_mfma_f32_16x16x32_bf16 v[100:103], a[196:199], a[148:151], v[100:103]
 v_exp_f32 v208, v84
 v_mfma_f32_16x16x32_bf16 v[100:103], a[200:203], a[152:155], v[100:103]
 ds_read_b64_tr_b16 a[236:237], v229 offset:34816
 v_add_f32 v255, v255, v19
 v_mfma_f32_16x16x32_bf16 v[100:103], a[204:207], a[156:159], v[100:103]
 v_exp_f32 v209, v85
 v_mfma_f32_16x16x32_bf16 a[8:11], a[224:227], v[136:139], a[8:11]
 ds_read_b64_tr_b16 a[238:239], v229 offset:35840
 v_cvt_pk_bf16_f32 v166, v208, v209
 v_mfma_f32_16x16x32_bf16 a[8:11], a[228:231], v[152:155], a[8:11]
 v_exp_f32 v210, v86
 v_mfma_f32_16x16x32_bf16 a[12:15], a[224:227], v[140:143], a[12:15]
 v_add_f32 v255, v255, v32
 v_add_f32 v255, v255, v33
 v_mfma_f32_16x16x32_bf16 a[12:15], a[228:231], v[156:159], a[12:15]
 v_exp_f32 v211, v87
 v_mfma_f32_16x16x32_bf16 v[104:107], a[192:195], a[160:163], v[200:203]
 ds_read_b128 a[216:219], v226 offset:52224
 v_cvt_pk_bf16_f32 v167, v210, v211
 v_mfma_f32_16x16x32_bf16 v[104:107], a[196:199], a[164:167], v[104:107]
 v_exp_f32 v24, v72
 v_mfma_f32_16x16x32_bf16 v[104:107], a[200:203], a[168:171], v[104:107]
 ds_read_b64_tr_b16 a[240:241], v230 offset:32768
 v_add_f32 v255, v255, v34
 v_mfma_f32_16x16x32_bf16 v[104:107], a[204:207], a[172:175], v[104:107]
 s_waitcnt lgkmcnt(2)
 v_exp_f32 v25, v73
 v_mfma_f32_16x16x32_bf16 v[20:23], v[240:243], v[164:167], v[36:39]
 v_add_f32 v255, v255, v35
 v_add_f32 v254, v254, v215
 v_mfma_f32_16x16x32_bf16 a[16:19], a[232:235], v[128:131], a[16:19]
 ds_read_b64_tr_b16 a[242:243], v230 offset:33792
 v_cvt_pk_bf16_f32 v168, v24, v25
 v_mfma_f32_16x16x32_bf16 a[16:19], a[236:239], v[144:147], a[16:19]
 v_exp_f32 v26, v74
 v_mfma_f32_16x16x32_bf16 a[20:23], a[232:235], v[132:135], a[20:23]
 v_add_f32 v215, v24, v25
 v_add_f32 v215, v215, v26
 v_mfma_f32_16x16x32_bf16 a[20:23], a[236:239], v[148:151], a[20:23]
 v_exp_f32 v27, v75
 v_mfma_f32_16x16x32_bf16 v[108:111], a[192:195], a[176:179], v[204:207]
 ds_read_b128 a[220:223], v227 offset:52224
 v_cvt_pk_bf16_f32 v169, v26, v27
 v_mfma_f32_16x16x32_bf16 v[108:111], a[196:199], a[180:183], v[108:111]
 v_exp_f32 v40, v88
 v_mfma_f32_16x16x32_bf16 v[108:111], a[200:203], a[184:187], v[108:111]
 ds_read_b64_tr_b16 a[244:245], v230 offset:34816
 v_add_f32 v215, v215, v27
 v_mfma_f32_16x16x32_bf16 v[108:111], a[204:207], a[188:191], v[108:111]
 v_exp_f32 v41, v89
 v_mfma_f32_16x16x32_bf16 a[24:27], a[232:235], v[136:139], a[24:27]
 ds_read_b64_tr_b16 a[246:247], v230 offset:35840
 v_cvt_pk_bf16_f32 v170, v40, v41
 v_mfma_f32_16x16x32_bf16 a[24:27], a[236:239], v[152:155], a[24:27]
 v_exp_f32 v42, v90
 v_mfma_f32_16x16x32_bf16 a[28:31], a[232:235], v[140:143], a[28:31]
 s_waitcnt vmcnt(16) lgkmcnt(2)
 s_barrier
 v_mfma_f32_16x16x32_bf16 a[28:31], a[236:239], v[156:159], a[28:31]
 v_exp_f32 v43, v91
 v_mfma_f32_16x16x32_bf16 v[112:115], a[208:211], a[128:131], v[192:195]
 v_cvt_pk_bf16_f32 v171, v42, v43
 v_mfma_f32_16x16x32_bf16 v[112:115], a[212:215], a[132:135], v[112:115]
 v_exp_f32 v208, v76
 v_mfma_f32_16x16x32_bf16 v[112:115], a[216:219], a[136:139], v[112:115]
 ds_read_b64_tr_b16 a[248:249], v231 offset:32768
 v_add_f32 v215, v215, v40
 v_mfma_f32_16x16x32_bf16 v[112:115], a[220:223], a[140:143], v[112:115]
 s_waitcnt lgkmcnt(1)
 v_exp_f32 v209, v77
 v_mfma_f32_16x16x32_bf16 a[32:35], a[240:243], v[128:131], a[32:35]
 ds_read_b64_tr_b16 a[250:251], v231 offset:33792
 v_cvt_pk_bf16_f32 v172, v208, v209
 v_mfma_f32_16x16x32_bf16 a[32:35], a[244:247], v[144:147], a[32:35]
 v_exp_f32 v210, v78
 v_mfma_f32_16x16x32_bf16 a[36:39], a[240:243], v[132:135], a[36:39]
 s_mov_b32 s55, 16384
 buffer_load_dwordx4 a[192:195], v252, s[20:23], s55 offen offset:0 sc1
 v_add_f32 v215, v215, v41
 v_mfma_f32_16x16x32_bf16 a[36:39], a[244:247], v[148:151], a[36:39]
 v_exp_f32 v211, v79
 v_mfma_f32_16x16x32_bf16 v[116:119], a[208:211], a[144:147], v[196:199]
 v_cvt_pk_bf16_f32 v173, v210, v211
 v_mfma_f32_16x16x32_bf16 v[116:119], a[212:215], a[148:151], v[116:119]
 v_exp_f32 v208, v92
 v_mfma_f32_16x16x32_bf16 v[116:119], a[216:219], a[152:155], v[116:119]
 ds_read_b64_tr_b16 a[252:253], v231 offset:34816
 v_add_f32 v215, v215, v43
 v_mfma_f32_16x16x32_bf16 v[116:119], a[220:223], a[156:159], v[116:119]
 v_exp_f32 v209, v93
 v_mfma_f32_16x16x32_bf16 a[40:43], a[240:243], v[136:139], a[40:43]
 ds_read_b64_tr_b16 a[254:255], v231 offset:35840
 v_cvt_pk_bf16_f32 v174, v208, v209
 v_mfma_f32_16x16x32_bf16 a[40:43], a[244:247], v[152:155], a[40:43]
 v_exp_f32 v210, v94
 v_mfma_f32_16x16x32_bf16 a[44:47], a[240:243], v[140:143], a[44:47]
 buffer_load_dwordx4 a[196:199], v252, s[20:23], s55 offen offset:1024 sc1
 v_add_f32 v215, v215, v42
 v_mfma_f32_16x16x32_bf16 a[44:47], a[244:247], v[156:159], a[44:47]
 v_exp_f32 v211, v95
 v_mfma_f32_16x16x32_bf16 v[120:123], a[208:211], a[160:163], v[200:203]
 v_cvt_pk_bf16_f32 v175, v210, v211
 v_mfma_f32_16x16x32_bf16 v[120:123], a[212:215], a[164:167], v[120:123]
 v_exp_f32 v16, v96
 v_mfma_f32_16x16x32_bf16 v[120:123], a[216:219], a[168:171], v[120:123]
 ds_read_b64_tr_b16 a[224:225], v232 offset:32768
 v_max3_f32 v212, v255, v20, v215
 v_mfma_f32_16x16x32_bf16 v[120:123], a[220:223], a[172:175], v[120:123]
 s_waitcnt lgkmcnt(1)
 v_exp_f32 v17, v97
 v_mfma_f32_16x16x32_bf16 v[28:31], v[240:243], v[172:175], v[44:47]
 v_cmp_ngt_f32 s[46:47], s37, v212
 v_mfma_f32_16x16x32_bf16 a[48:51], a[248:251], v[128:131], a[48:51]
 ds_read_b64_tr_b16 a[226:227], v232 offset:33792
 v_cvt_pk_bf16_f32 v176, v16, v17
 v_mfma_f32_16x16x32_bf16 a[48:51], a[252:255], v[144:147], a[48:51]
 v_exp_f32 v18, v98
 v_mfma_f32_16x16x32_bf16 a[52:55], a[248:251], v[132:135], a[52:55]
 buffer_load_dwordx4 a[200:203], v252, s[20:23], s55 offen offset:2048 sc1
 v_mfma_f32_16x16x32_bf16 a[52:55], a[252:255], v[148:151], a[52:55]
 v_exp_f32 v19, v99
 v_mfma_f32_16x16x32_bf16 v[124:127], a[208:211], a[176:179], v[204:207]
 v_cvt_pk_bf16_f32 v177, v18, v19
 v_mfma_f32_16x16x32_bf16 v[124:127], a[212:215], a[180:183], v[124:127]
 v_exp_f32 v32, v112
 v_mfma_f32_16x16x32_bf16 v[124:127], a[216:219], a[184:187], v[124:127]
 ds_read_b64_tr_b16 a[228:229], v232 offset:34816
 v_cmp_ngt_f32 vcc, s37, v28
 v_mfma_f32_16x16x32_bf16 v[124:127], a[220:223], a[188:191], v[124:127]
 v_exp_f32 v33, v113
 v_mfma_f32_16x16x32_bf16 a[56:59], a[248:251], v[136:139], a[56:59]
 ds_read_b64_tr_b16 a[230:231], v232 offset:35840
 v_cvt_pk_bf16_f32 v178, v32, v33
 v_mfma_f32_16x16x32_bf16 a[56:59], a[252:255], v[152:155], a[56:59]
 s_or_b64 vcc, vcc, s[46:47]
 v_exp_f32 v34, v114
 v_mfma_f32_16x16x32_bf16 a[60:63], a[248:251], v[140:143], a[60:63]
 s_cbranch_vccnz L_tr_e62
L_back_e62:
 buffer_load_dwordx4 a[204:207], v252, s[20:23], s55 offen offset:3072 sc1
 v_mfma_f32_16x16x32_bf16 a[60:63], a[252:255], v[156:159], a[60:63]
 v_exp_f32 v35, v115
 s_nop 0
 v_cvt_pk_bf16_f32 v179, v34, v35
 v_exp_f32 v208, v100
 ds_read_b64_tr_b16 a[232:233], v233 offset:32768
 v_add_f32 v253, v253, v255
 s_waitcnt lgkmcnt(1)
 v_exp_f32 v209, v101
 s_nop 0
 v_mfma_f32_16x16x32_bf16 a[64:67], a[224:227], v[128:131], a[64:67]
 ds_read_b64_tr_b16 a[234:235], v233 offset:33792
 v_cvt_pk_bf16_f32 v180, v208, v209
 v_mfma_f32_16x16x32_bf16 a[64:67], a[228:231], v[144:147], a[64:67]
 s_mov_b32 s54, 0
 buffer_load_dwordx4 a[128:131], v252, s[20:23], s54 offen offset:0 sc1
 v_exp_f32 v210, v102
 v_mfma_f32_16x16x32_bf16 a[68:71], a[224:227], v[132:135], a[68:71]
 buffer_load_dwordx4 a[132:135], v252, s[20:23], s54 offen offset:1024 sc1
 v_add_f32 v255, v16, v17
 v_add_f32 v255, v255, v18
 v_mfma_f32_16x16x32_bf16 a[68:71], a[228:231], v[148:151], a[68:71]
 v_exp_f32 v211, v103
 s_nop 0
 v_cvt_pk_bf16_f32 v181, v210, v211
 v_exp_f32 v208, v116
 ds_read_b64_tr_b16 a[236:237], v233 offset:34816
 v_add_f32 v255, v255, v19
 v_exp_f32 v209, v117
 v_mfma_f32_16x16x32_bf16 a[72:75], a[224:227], v[136:139], a[72:75]
 ds_read_b64_tr_b16 a[238:239], v233 offset:35840
 v_cvt_pk_bf16_f32 v182, v208, v209
 v_mfma_f32_16x16x32_bf16 a[72:75], a[228:231], v[152:155], a[72:75]
 v_exp_f32 v210, v118
 v_mfma_f32_16x16x32_bf16 a[76:79], a[224:227], v[140:143], a[76:79]
 buffer_load_dwordx4 a[136:139], v252, s[20:23], s54 offen offset:2048 sc1
 v_add_f32 v255, v255, v32
 v_add_f32 v255, v255, v33
 v_mfma_f32_16x16x32_bf16 a[76:79], a[228:231], v[156:159], a[76:79]
 v_exp_f32 v211, v119
 s_nop 0
 v_cvt_pk_bf16_f32 v183, v210, v211
 v_exp_f32 v24, v104
 ds_read_b64_tr_b16 a[240:241], v234 offset:32768
 v_add_f32 v255, v255, v34
 s_waitcnt lgkmcnt(1)
 v_exp_f32 v25, v105
 s_nop 0
 v_mfma_f32_16x16x32_bf16 v[36:39], v[240:243], v[180:183], v[20:23]
 v_add_f32 v255, v255, v35
 v_add_f32 v254, v254, v215
 v_mfma_f32_16x16x32_bf16 a[80:83], a[232:235], v[128:131], a[80:83]
 ds_read_b64_tr_b16 a[242:243], v234 offset:33792
 v_cvt_pk_bf16_f32 v184, v24, v25
 v_mfma_f32_16x16x32_bf16 a[80:83], a[236:239], v[144:147], a[80:83]
 buffer_load_dwordx4 a[140:143], v252, s[20:23], s54 offen offset:3072 sc1
 v_exp_f32 v26, v106
 v_mfma_f32_16x16x32_bf16 a[84:87], a[232:235], v[132:135], a[84:87]
 s_mov_b32 s55, 4096
 buffer_load_dwordx4 a[144:147], v252, s[20:23], s55 offen offset:0 sc1
 v_add_f32 v215, v24, v25
 v_add_f32 v215, v215, v26
 v_mfma_f32_16x16x32_bf16 a[84:87], a[236:239], v[148:151], a[84:87]
 v_exp_f32 v27, v107
 s_nop 0
 v_cvt_pk_bf16_f32 v185, v26, v27
 v_exp_f32 v40, v120
 ds_read_b64_tr_b16 a[244:245], v234 offset:34816
 v_add_f32 v215, v215, v27
 v_exp_f32 v41, v121
 v_mfma_f32_16x16x32_bf16 a[88:91], a[232:235], v[136:139], a[88:91]
 ds_read_b64_tr_b16 a[246:247], v234 offset:35840
 v_cvt_pk_bf16_f32 v186, v40, v41
 v_mfma_f32_16x16x32_bf16 a[88:91], a[236:239], v[152:155], a[88:91]
 v_exp_f32 v42, v122
 v_mfma_f32_16x16x32_bf16 a[92:95], a[232:235], v[140:143], a[92:95]
 buffer_load_dwordx4 a[148:151], v252, s[20:23], s55 offen offset:1024 sc1
 v_mfma_f32_16x16x32_bf16 a[92:95], a[236:239], v[156:159], a[92:95]
 v_exp_f32 v43, v123
 s_nop 0
 v_cvt_pk_bf16_f32 v187, v42, v43
 v_exp_f32 v208, v108
 ds_read_b64_tr_b16 a[248:249], v235 offset:32768
 v_add_f32 v215, v215, v40
 s_waitcnt lgkmcnt(1)
 v_exp_f32 v209, v109
 s_nop 0
 v_mfma_f32_16x16x32_bf16 a[96:99], a[240:243], v[128:131], a[96:99]
 ds_read_b64_tr_b16 a[250:251], v235 offset:33792
 v_cvt_pk_bf16_f32 v188, v208, v209
 v_mfma_f32_16x16x32_bf16 a[96:99], a[244:247], v[144:147], a[96:99]
 buffer_load_dwordx4 a[152:155], v252, s[20:23], s55 offen offset:2048 sc1
 v_exp_f32 v210, v110
 v_mfma_f32_16x16x32_bf16 a[100:103], a[240:243], v[132:135], a[100:103]
 buffer_load_dwordx4 a[156:159], v252, s[20:23], s55 offen offset:3072 sc1
 v_add_f32 v215, v215, v41
 v_mfma_f32_16x16x32_bf16 a[100:103], a[244:247], v[148:151], a[100:103]
 v_exp_f32 v211, v111
 s_nop 0
 v_cvt_pk_bf16_f32 v189, v210, v211
 v_exp_f32 v208, v124
 ds_read_b64_tr_b16 a[252:253], v235 offset:34816
 v_add_f32 v215, v215, v43
 v_exp_f32 v209, v125
 v_mfma_f32_16x16x32_bf16 a[104:107], a[240:243], v[136:139], a[104:107]
 ds_read_b64_tr_b16 a[254:255], v235 offset:35840
 v_cvt_pk_bf16_f32 v190, v208, v209
 v_mfma_f32_16x16x32_bf16 a[104:107], a[244:247], v[152:155], a[104:107]
 v_exp_f32 v210, v126
 v_mfma_f32_16x16x32_bf16 a[108:111], a[240:243], v[140:143], a[108:111]
 s_mov_b32 s54, 8192
 buffer_load_dwordx4 a[160:163], v252, s[20:23], s54 offen offset:0 sc1
 v_add_f32 v215, v215, v42
 v_mfma_f32_16x16x32_bf16 a[108:111], a[244:247], v[156:159], a[108:111]
 v_exp_f32 v211, v127
 s_nop 0
 v_cvt_pk_bf16_f32 v191, v210, v211
 ds_read_b64_tr_b16 a[224:225], v228 offset:49152
 v_max3_f32 v212, v255, v36, v215
 s_waitcnt lgkmcnt(1)
 s_nop 0
 v_mfma_f32_16x16x32_bf16 v[44:47], v[240:243], v[188:191], v[28:31]
 v_cmp_ngt_f32 s[46:47], s37, v212
 v_mfma_f32_16x16x32_bf16 a[112:115], a[248:251], v[128:131], a[112:115]
 ds_read_b64_tr_b16 a[226:227], v228 offset:50176
 v_mfma_f32_16x16x32_bf16 a[112:115], a[252:255], v[144:147], a[112:115]
 ds_read_b64_tr_b16 a[232:233], v229 offset:49152
 buffer_load_dwordx4 a[164:167], v252, s[20:23], s54 offen offset:1024 sc1
 v_mfma_f32_16x16x32_bf16 a[116:119], a[248:251], v[132:135], a[116:119]
 buffer_load_dwordx4 a[168:171], v252, s[20:23], s54 offen offset:2048 sc1
 v_mfma_f32_16x16x32_bf16 a[116:119], a[252:255], v[148:151], a[116:119]
 ds_read_b64_tr_b16 a[234:235], v229 offset:50176
 ds_read_b64_tr_b16 a[228:229], v228 offset:51200
 v_mfma_f32_16x16x32_bf16 a[120:123], a[248:251], v[136:139], a[120:123]
 ds_read_b64_tr_b16 a[230:231], v228 offset:52224
 v_mfma_f32_16x16x32_bf16 a[120:123], a[252:255], v[152:155], a[120:123]
 ds_read_b64_tr_b16 a[236:237], v229 offset:51200
 v_cmp_ngt_f32 vcc, s37, v44
 v_mfma_f32_16x16x32_bf16 a[124:127], a[248:251], v[140:143], a[124:127]
 s_or_b64 vcc, vcc, s[46:47]
 buffer_load_dwordx4 a[172:175], v252, s[20:23], s54 offen offset:3072 sc1
 v_mfma_f32_16x16x32_bf16 a[124:127], a[252:255], v[156:159], a[124:127]
 ds_read_b64_tr_b16 a[238:239], v229 offset:52224
 s_cbranch_vccnz L_tr_e63
L_back_e63:
 s_waitcnt lgkmcnt(2)
 v_mfma_f32_16x16x32_bf16 a[0:3], a[224:227], v[160:163], a[0:3]
 ds_read_b64_tr_b16 a[240:241], v230 offset:49152
 s_setreg_imm32_b32 hwreg(HW_REG_MODE, 4, 2), 3
 v_mfma_f32_16x16x32_bf16 a[0:3], a[228:231], v[176:179], a[0:3]
 ds_read_b64_tr_b16 a[242:243], v230 offset:50176
 s_mov_b32 s55, 12288
 buffer_load_dwordx4 a[176:179], v252, s[20:23], s55 offen offset:0 sc1
 s_lshl_b32 s41, s3, 11
 v_mfma_f32_16x16x32_bf16 a[4:7], a[224:227], v[164:167], a[4:7]
 ds_read_b64_tr_b16 a[244:245], v230 offset:51200
 v_add_u32 v208, s41, v213
 v_mfma_f32_16x16x32_bf16 a[4:7], a[228:231], v[180:183], a[4:7]
 ds_read_b64_tr_b16 a[246:247], v230 offset:52224
 v_mfma_f32_16x16x32_bf16 a[8:11], a[224:227], v[168:171], a[8:11]
 v_mfma_f32_16x16x32_bf16 a[8:11], a[228:231], v[184:187], a[8:11]
 buffer_load_dwordx4 a[180:183], v252, s[20:23], s55 offen offset:1024 sc1
 v_mfma_f32_16x16x32_bf16 a[12:15], a[224:227], v[172:175], a[12:15]
 v_mfma_f32_16x16x32_bf16 a[12:15], a[228:231], v[188:191], a[12:15]
 s_waitcnt lgkmcnt(4)
 v_mfma_f32_16x16x32_bf16 a[16:19], a[232:235], v[160:163], a[16:19]
 ds_read_b64_tr_b16 a[248:249], v231 offset:49152
 v_add_f32 v253, v253, v255
 v_add_f32 v254, v254, v215
 v_mov_b32 v255, v253
 v_mfma_f32_16x16x32_bf16 a[16:19], a[236:239], v[176:179], a[16:19]
 ds_read_b64_tr_b16 a[250:251], v231 offset:50176
 buffer_load_dwordx4 a[184:187], v252, s[20:23], s55 offen offset:2048 sc1
 v_mov_b32 v215, v254
 s_nop 0
 v_permlane32_swap_b32 v255, v253
 v_mfma_f32_16x16x32_bf16 a[20:23], a[232:235], v[164:167], a[20:23]
 ds_read_b64_tr_b16 a[252:253], v231 offset:51200
 v_permlane32_swap_b32 v215, v254
 v_add_f32 v253, v253, v255
 v_add_f32 v254, v254, v215
 v_mfma_f32_16x16x32_bf16 a[20:23], a[236:239], v[180:183], a[20:23]
 ds_read_b64_tr_b16 a[254:255], v231 offset:52224
 v_mov_b32 v255, v253
 v_mov_b32 v215, v254
 s_nop 0
 v_mfma_f32_16x16x32_bf16 a[24:27], a[232:235], v[168:171], a[24:27]
 v_permlane16_swap_b32 v255, v253
 v_permlane16_swap_b32 v215, v254
 v_add_f32 v253, v253, v255
 v_mfma_f32_16x16x32_bf16 a[24:27], a[236:239], v[184:187], a[24:27]
 buffer_load_dwordx4 a[188:191], v252, s[20:23], s55 offen offset:3072 sc1
 v_add_f32 v254, v254, v215
 v_rcp_f32 v216, v253
 v_rcp_f32 v217, v36
 v_mfma_f32_16x16x32_bf16 a[28:31], a[232:235], v[172:175], a[28:31]
 v_rcp_f32 v218, v254
 v_rcp_f32 v219, v44
 v_mfma_f32_16x16x32_bf16 a[28:31], a[236:239], v[188:191], a[28:31]
 s_waitcnt lgkmcnt(4)
 v_mfma_f32_16x16x32_bf16 a[32:35], a[240:243], v[160:163], a[32:35]
 ds_read_b64_tr_b16 a[224:225], v232 offset:49152
 v_accvgpr_read_b32 v64, a0
 v_accvgpr_read_b32 v65, a1
 v_mfma_f32_16x16x32_bf16 a[32:35], a[244:247], v[176:179], a[32:35]
 ds_read_b64_tr_b16 a[226:227], v232 offset:50176
 s_mov_b32 s54, 20480
 buffer_load_dwordx4 a[208:211], v252, s[20:23], s54 offen offset:0 sc1
 v_accvgpr_read_b32 v66, a2
 v_accvgpr_read_b32 v67, a3
 v_mfma_f32_16x16x32_bf16 a[36:39], a[240:243], v[164:167], a[36:39]
 ds_read_b64_tr_b16 a[228:229], v232 offset:51200
 v_accvgpr_read_b32 v68, a16
 v_accvgpr_read_b32 v69, a17
 v_mfma_f32_16x16x32_bf16 a[36:39], a[244:247], v[180:183], a[36:39]
 ds_read_b64_tr_b16 a[230:231], v232 offset:52224
 v_accvgpr_read_b32 v70, a18
 v_accvgpr_read_b32 v71, a19
 v_mfma_f32_16x16x32_bf16 a[40:43], a[240:243], v[168:171], a[40:43]
 v_accvgpr_read_b32 v72, a4
 v_accvgpr_read_b32 v73, a5
 v_mfma_f32_16x16x32_bf16 a[40:43], a[244:247], v[184:187], a[40:43]
 buffer_load_dwordx4 a[212:215], v252, s[20:23], s54 offen offset:1024 sc1
 v_accvgpr_read_b32 v74, a6
 v_accvgpr_read_b32 v75, a7
 v_mfma_f32_16x16x32_bf16 a[44:47], a[240:243], v[172:175], a[44:47]
 v_accvgpr_read_b32 v76, a20
 v_accvgpr_read_b32 v77, a21
 v_mfma_f32_16x16x32_bf16 a[44:47], a[244:247], v[188:191], a[44:47]
 v_accvgpr_read_b32 v78, a22
 v_accvgpr_read_b32 v79, a23
 s_waitcnt lgkmcnt(4)
 v_mfma_f32_16x16x32_bf16 a[48:51], a[248:251], v[160:163], a[48:51]
 ds_read_b64_tr_b16 a[232:233], v233 offset:49152
 v_accvgpr_read_b32 v80, a8
 v_accvgpr_read_b32 v81, a9
 v_mfma_f32_16x16x32_bf16 a[48:51], a[252:255], v[176:179], a[48:51]
 ds_read_b64_tr_b16 a[234:235], v233 offset:50176
 buffer_load_dwordx4 a[216:219], v252, s[20:23], s54 offen offset:2048 sc1
 v_accvgpr_read_b32 v82, a10
 v_accvgpr_read_b32 v83, a11
 v_mfma_f32_16x16x32_bf16 a[52:55], a[248:251], v[164:167], a[52:55]
 ds_read_b64_tr_b16 a[236:237], v233 offset:51200
 v_accvgpr_read_b32 v84, a24
 v_accvgpr_read_b32 v85, a25
 v_mfma_f32_16x16x32_bf16 a[52:55], a[252:255], v[180:183], a[52:55]
 ds_read_b64_tr_b16 a[238:239], v233 offset:52224
 v_accvgpr_read_b32 v86, a26
 v_accvgpr_read_b32 v87, a27
 v_mfma_f32_16x16x32_bf16 a[56:59], a[248:251], v[168:171], a[56:59]
 v_accvgpr_read_b32 v88, a12
 v_accvgpr_read_b32 v89, a13
 v_mfma_f32_16x16x32_bf16 a[56:59], a[252:255], v[184:187], a[56:59]
 buffer_load_dwordx4 a[220:223], v252, s[20:23], s54 offen offset:3072 sc1
 v_accvgpr_read_b32 v90, a14
 v_accvgpr_read_b32 v91, a15
 v_mfma_f32_16x16x32_bf16 a[60:63], a[248:251], v[172:175], a[60:63]
 v_accvgpr_read_b32 v92, a28
 v_accvgpr_read_b32 v93, a29
 v_mfma_f32_16x16x32_bf16 a[60:63], a[252:255], v[188:191], a[60:63]
 v_accvgpr_read_b32 v94, a30
 v_accvgpr_read_b32 v95, a31
 s_waitcnt lgkmcnt(4)
 v_mfma_f32_16x16x32_bf16 a[64:67], a[224:227], v[160:163], a[64:67]
 ds_read_b64_tr_b16 a[240:241], v234 offset:49152
 s_mov_b32 s55, 32768
 buffer_load_dwordx4 a[0:3], v252, s[20:23], s55 offen offset:0 sc1
 v_accvgpr_read_b32 v96, a32
 v_accvgpr_read_b32 v97, a33
 v_mfma_f32_16x16x32_bf16 a[64:67], a[228:231], v[176:179], a[64:67]
 ds_read_b64_tr_b16 a[242:243], v234 offset:50176
 v_accvgpr_read_b32 v98, a34
 v_accvgpr_read_b32 v99, a35
 v_mfma_f32_16x16x32_bf16 a[68:71], a[224:227], v[164:167], a[68:71]
 ds_read_b64_tr_b16 a[244:245], v234 offset:51200
 buffer_load_dwordx4 a[4:7], v252, s[20:23], s55 offen offset:1024 sc1
 v_accvgpr_read_b32 v100, a48
 v_accvgpr_read_b32 v101, a49
 v_mfma_f32_16x16x32_bf16 a[68:71], a[228:231], v[180:183], a[68:71]
 ds_read_b64_tr_b16 a[246:247], v234 offset:52224
 v_accvgpr_read_b32 v102, a50
 v_accvgpr_read_b32 v103, a51
 v_mfma_f32_16x16x32_bf16 a[72:75], a[224:227], v[168:171], a[72:75]
 buffer_load_dwordx4 a[8:11], v252, s[20:23], s55 offen offset:2048 sc1
 v_accvgpr_read_b32 v104, a36
 v_accvgpr_read_b32 v105, a37
 v_mfma_f32_16x16x32_bf16 a[72:75], a[228:231], v[184:187], a[72:75]
 v_accvgpr_read_b32 v106, a38
 v_accvgpr_read_b32 v107, a39
 v_mfma_f32_16x16x32_bf16 a[76:79], a[224:227], v[172:175], a[76:79]
 buffer_load_dwordx4 a[12:15], v252, s[20:23], s55 offen offset:3072 sc1
 v_accvgpr_read_b32 v108, a52
 v_accvgpr_read_b32 v109, a53
 v_mfma_f32_16x16x32_bf16 a[76:79], a[228:231], v[188:191], a[76:79]
 v_accvgpr_read_b32 v110, a54
 v_accvgpr_read_b32 v111, a55
 s_waitcnt lgkmcnt(4)
 v_mfma_f32_16x16x32_bf16 a[80:83], a[232:235], v[160:163], a[80:83]
 ds_read_b64_tr_b16 a[248:249], v235 offset:49152
 s_mov_b32 s54, 36864
 buffer_load_dwordx4 a[16:19], v252, s[20:23], s54 offen offset:0 sc1
 v_accvgpr_read_b32 v112, a40
 v_accvgpr_read_b32 v113, a41
 v_mfma_f32_16x16x32_bf16 a[80:83], a[236:239], v[176:179], a[80:83]
 ds_read_b64_tr_b16 a[250:251], v235 offset:50176
 v_accvgpr_read_b32 v114, a42
 v_accvgpr_read_b32 v115, a43
 v_mfma_f32_16x16x32_bf16 a[84:87], a[232:235], v[164:167], a[84:87]
 ds_read_b64_tr_b16 a[252:253], v235 offset:51200
 buffer_load_dwordx4 a[20:23], v252, s[20:23], s54 offen offset:1024 sc1
 v_accvgpr_read_b32 v116, a56
 v_accvgpr_read_b32 v117, a57
 v_mfma_f32_16x16x32_bf16 a[84:87], a[236:239], v[180:183], a[84:87]
 ds_read_b64_tr_b16 a[254:255], v235 offset:52224
 v_accvgpr_read_b32 v118, a58
 v_accvgpr_read_b32 v119, a59
 v_mfma_f32_16x16x32_bf16 a[88:91], a[232:235], v[168:171], a[88:91]
 buffer_load_dwordx4 a[24:27], v252, s[20:23], s54 offen offset:2048 sc1
 v_accvgpr_read_b32 v120, a44
 v_accvgpr_read_b32 v121, a45
 v_mfma_f32_16x16x32_bf16 a[88:91], a[236:239], v[184:187], a[88:91]
 v_accvgpr_read_b32 v122, a46
 v_accvgpr_read_b32 v123, a47
 v_mfma_f32_16x16x32_bf16 a[92:95], a[232:235], v[172:175], a[92:95]
 buffer_load_dwordx4 a[28:31], v252, s[20:23], s54 offen offset:3072 sc1
 v_accvgpr_read_b32 v124, a60
 v_accvgpr_read_b32 v125, a61
 v_mfma_f32_16x16x32_bf16 a[92:95], a[236:239], v[188:191], a[92:95]
 v_accvgpr_read_b32 v126, a62
 v_accvgpr_read_b32 v127, a63
 s_waitcnt lgkmcnt(4)
 s_waitcnt lgkmcnt(0)
 s_barrier
 v_mfma_f32_16x16x32_bf16 a[96:99], a[240:243], v[160:163], a[96:99]
 s_mov_b32 s55, 40960
 buffer_load_dwordx4 a[32:35], v252, s[20:23], s55 offen offset:0 sc1
 v_accvgpr_read_b32 v128, a64
 v_accvgpr_read_b32 v129, a65
 v_mfma_f32_16x16x32_bf16 a[96:99], a[244:247], v[176:179], a[96:99]
 v_accvgpr_read_b32 v130, a66
 v_accvgpr_read_b32 v131, a67
 v_mfma_f32_16x16x32_bf16 a[100:103], a[240:243], v[164:167], a[100:103]
 buffer_load_dwordx4 a[36:39], v252, s[20:23], s55 offen offset:1024 sc1
 v_accvgpr_read_b32 v132, a80
 v_accvgpr_read_b32 v133, a81
 v_mfma_f32_16x16x32_bf16 a[100:103], a[244:247], v[180:183], a[100:103]
 v_accvgpr_read_b32 v134, a82
 v_accvgpr_read_b32 v135, a83
 v_mfma_f32_16x16x32_bf16 a[104:107], a[240:243], v[168:171], a[104:107]
 buffer_load_dwordx4 a[40:43], v252, s[20:23], s55 offen offset:2048 sc1
 v_accvgpr_read_b32 v136, a68
 v_accvgpr_read_b32 v137, a69
 v_mfma_f32_16x16x32_bf16 a[104:107], a[244:247], v[184:187], a[104:107]
 v_accvgpr_read_b32 v138, a70
 v_accvgpr_read_b32 v139, a71
 v_mfma_f32_16x16x32_bf16 a[108:111], a[240:243], v[172:175], a[108:111]
 buffer_load_dwordx4 a[44:47], v252, s[20:23], s55 offen offset:3072 sc1
 v_accvgpr_read_b32 v140, a84
 v_accvgpr_read_b32 v141, a85
 v_mfma_f32_16x16x32_bf16 a[108:111], a[244:247], v[188:191], a[108:111]
 v_accvgpr_read_b32 v142, a86
 v_accvgpr_read_b32 v143, a87
 s_waitcnt lgkmcnt(0)
 v_mfma_f32_16x16x32_bf16 a[112:115], a[248:251], v[160:163], a[112:115]
 s_mov_b32 s54, 45056
 buffer_load_dwordx4 a[48:51], v252, s[20:23], s54 offen offset:0 sc1
 v_accvgpr_read_b32 v144, a72
 v_accvgpr_read_b32 v145, a73
 v_mfma_f32_16x16x32_bf16 a[112:115], a[252:255], v[176:179], a[112:115]
 v_accvgpr_read_b32 v146, a74
 v_accvgpr_read_b32 v147, a75
 v_mfma_f32_16x16x32_bf16 a[116:119], a[248:251], v[164:167], a[116:119]
 buffer_load_dwordx4 a[52:55], v252, s[20:23], s54 offen offset:1024 sc1
 v_accvgpr_read_b32 v148, a88
 v_accvgpr_read_b32 v149, a89
 v_mfma_f32_16x16x32_bf16 a[116:119], a[252:255], v[180:183], a[116:119]
 v_accvgpr_read_b32 v150, a90
 v_accvgpr_read_b32 v151, a91
 v_mfma_f32_16x16x32_bf16 a[120:123], a[248:251], v[168:171], a[120:123]
 buffer_load_dwordx4 a[56:59], v252, s[20:23], s54 offen offset:2048 sc1
 v_accvgpr_read_b32 v152, a76
 v_accvgpr_read_b32 v153, a77
 v_mfma_f32_16x16x32_bf16 a[120:123], a[252:255], v[184:187], a[120:123]
 v_accvgpr_read_b32 v154, a78
 v_accvgpr_read_b32 v155, a79
 v_mfma_f32_16x16x32_bf16 a[124:127], a[248:251], v[172:175], a[124:127]
 buffer_load_dwordx4 a[60:63], v252, s[20:23], s54 offen offset:3072 sc1
 v_accvgpr_read_b32 v156, a92
 v_accvgpr_read_b32 v157, a93
 v_mfma_f32_16x16x32_bf16 a[124:127], a[252:255], v[188:191], a[124:127]
 v_accvgpr_read_b32 v158, a94
 v_accvgpr_read_b32 v159, a95
 v_pk_mul_f32 v[64:65], v[64:65], v[216:217] op_sel:[0,0] op_sel_hi:[1,0]
 v_pk_mul_f32 v[66:67], v[66:67], v[216:217] op_sel:[0,0] op_sel_hi:[1,0]
 v_pk_mul_f32 v[68:69], v[68:69], v[216:217] op_sel:[0,0] op_sel_hi:[1,0]
 v_pk_mul_f32 v[70:71], v[70:71], v[216:217] op_sel:[0,0] op_sel_hi:[1,0]
 v_cvt_pk_bf16_f32 v64, v64, v65
 v_cvt_pk_bf16_f32 v65, v66, v67
 v_cvt_pk_bf16_f32 v66, v68, v69
 v_cvt_pk_bf16_f32 v67, v70, v71
 ds_write_b128 v208, v[64:67] offset:0
 s_mov_b32 s55, 24576
 buffer_load_dwordx4 a[224:227], v252, s[20:23], s55 offen offset:0 sc1
 v_pk_mul_f32 v[72:73], v[72:73], v[216:217] op_sel:[0,1] op_sel_hi:[1,1]
 v_pk_mul_f32 v[74:75], v[74:75], v[216:217] op_sel:[0,1] op_sel_hi:[1,1]
 v_pk_mul_f32 v[76:77], v[76:77], v[216:217] op_sel:[0,1] op_sel_hi:[1,1]
 v_pk_mul_f32 v[78:79], v[78:79], v[216:217] op_sel:[0,1] op_sel_hi:[1,1]
 v_cvt_pk_bf16_f32 v72, v72, v73
 v_cvt_pk_bf16_f32 v73, v74, v75
 v_cvt_pk_bf16_f32 v74, v76, v77
 v_cvt_pk_bf16_f32 v75, v78, v79
 ds_write_b128 v208, v[72:75] offset:16384
 v_pk_mul_f32 v[80:81], v[80:81], v[218:219] op_sel:[0,0] op_sel_hi:[1,0]
 v_pk_mul_f32 v[82:83], v[82:83], v[218:219] op_sel:[0,0] op_sel_hi:[1,0]
 v_pk_mul_f32 v[84:85], v[84:85], v[218:219] op_sel:[0,0] op_sel_hi:[1,0]
 v_pk_mul_f32 v[86:87], v[86:87], v[218:219] op_sel:[0,0] op_sel_hi:[1,0]
 v_cvt_pk_bf16_f32 v80, v80, v81
 v_cvt_pk_bf16_f32 v81, v82, v83
 v_cvt_pk_bf16_f32 v82, v84, v85
 v_cvt_pk_bf16_f32 v83, v86, v87
 ds_write_b128 v208, v[80:83] offset:32768
 buffer_load_dwordx4 a[228:231], v252, s[20:23], s55 offen offset:1024 sc1
 v_pk_mul_f32 v[88:89], v[88:89], v[218:219] op_sel:[0,1] op_sel_hi:[1,1]
 v_pk_mul_f32 v[90:91], v[90:91], v[218:219] op_sel:[0,1] op_sel_hi:[1,1]
 v_pk_mul_f32 v[92:93], v[92:93], v[218:219] op_sel:[0,1] op_sel_hi:[1,1]
 v_pk_mul_f32 v[94:95], v[94:95], v[218:219] op_sel:[0,1] op_sel_hi:[1,1]
 v_cvt_pk_bf16_f32 v88, v88, v89
 v_cvt_pk_bf16_f32 v89, v90, v91
 v_cvt_pk_bf16_f32 v90, v92, v93
 v_cvt_pk_bf16_f32 v91, v94, v95
 ds_write_b128 v208, v[88:91] offset:49152
 v_pk_mul_f32 v[96:97], v[96:97], v[216:217] op_sel:[0,0] op_sel_hi:[1,0]
 v_pk_mul_f32 v[98:99], v[98:99], v[216:217] op_sel:[0,0] op_sel_hi:[1,0]
 v_pk_mul_f32 v[100:101], v[100:101], v[216:217] op_sel:[0,0] op_sel_hi:[1,0]
 v_pk_mul_f32 v[102:103], v[102:103], v[216:217] op_sel:[0,0] op_sel_hi:[1,0]
 v_cvt_pk_bf16_f32 v96, v96, v97
 v_cvt_pk_bf16_f32 v97, v98, v99
 v_cvt_pk_bf16_f32 v98, v100, v101
 v_cvt_pk_bf16_f32 v99, v102, v103
 ds_write_b128 v208, v[96:99] offset:512
 buffer_load_dwordx4 a[232:235], v252, s[20:23], s55 offen offset:2048 sc1
 v_pk_mul_f32 v[104:105], v[104:105], v[216:217] op_sel:[0,1] op_sel_hi:[1,1]
 v_pk_mul_f32 v[106:107], v[106:107], v[216:217] op_sel:[0,1] op_sel_hi:[1,1]
 v_pk_mul_f32 v[108:109], v[108:109], v[216:217] op_sel:[0,1] op_sel_hi:[1,1]
 v_pk_mul_f32 v[110:111], v[110:111], v[216:217] op_sel:[0,1] op_sel_hi:[1,1]
 v_cvt_pk_bf16_f32 v104, v104, v105
 v_cvt_pk_bf16_f32 v105, v106, v107
 v_cvt_pk_bf16_f32 v106, v108, v109
 v_cvt_pk_bf16_f32 v107, v110, v111
 ds_write_b128 v208, v[104:107] offset:16896
 v_pk_mul_f32 v[112:113], v[112:113], v[218:219] op_sel:[0,0] op_sel_hi:[1,0]
 v_pk_mul_f32 v[114:115], v[114:115], v[218:219] op_sel:[0,0] op_sel_hi:[1,0]
 v_pk_mul_f32 v[116:117], v[116:117], v[218:219] op_sel:[0,0] op_sel_hi:[1,0]
 v_pk_mul_f32 v[118:119], v[118:119], v[218:219] op_sel:[0,0] op_sel_hi:[1,0]
 v_cvt_pk_bf16_f32 v112, v112, v113
 v_cvt_pk_bf16_f32 v113, v114, v115
 v_cvt_pk_bf16_f32 v114, v116, v117
 v_cvt_pk_bf16_f32 v115, v118, v119
 ds_write_b128 v208, v[112:115] offset:33280
 buffer_load_dwordx4 a[236:239], v252, s[20:23], s55 offen offset:3072 sc1
 v_pk_mul_f32 v[120:121], v[120:121], v[218:219] op_sel:[0,1] op_sel_hi:[1,1]
 v_pk_mul_f32 v[122:123], v[122:123], v[218:219] op_sel:[0,1] op_sel_hi:[1,1]
 v_pk_mul_f32 v[124:125], v[124:125], v[218:219] op_sel:[0,1] op_sel_hi:[1,1]
 v_pk_mul_f32 v[126:127], v[126:127], v[218:219] op_sel:[0,1] op_sel_hi:[1,1]
 v_cvt_pk_bf16_f32 v120, v120, v121
 v_cvt_pk_bf16_f32 v121, v122, v123
 v_cvt_pk_bf16_f32 v122, v124, v125
 v_cvt_pk_bf16_f32 v123, v126, v127
 ds_write_b128 v208, v[120:123] offset:49664
 v_pk_mul_f32 v[128:129], v[128:129], v[216:217] op_sel:[0,0] op_sel_hi:[1,0]
 v_pk_mul_f32 v[130:131], v[130:131], v[216:217] op_sel:[0,0] op_sel_hi:[1,0]
 v_pk_mul_f32 v[132:133], v[132:133], v[216:217] op_sel:[0,0] op_sel_hi:[1,0]
 v_pk_mul_f32 v[134:135], v[134:135], v[216:217] op_sel:[0,0] op_sel_hi:[1,0]
 v_cvt_pk_bf16_f32 v128, v128, v129
 v_cvt_pk_bf16_f32 v129, v130, v131
 v_cvt_pk_bf16_f32 v130, v132, v133
 v_cvt_pk_bf16_f32 v131, v134, v135
 ds_write_b128 v208, v[128:131] offset:1024
 s_mov_b32 s54, 28672
 buffer_load_dwordx4 a[240:243], v252, s[20:23], s54 offen offset:0 sc1
 v_pk_mul_f32 v[136:137], v[136:137], v[216:217] op_sel:[0,1] op_sel_hi:[1,1]
 v_pk_mul_f32 v[138:139], v[138:139], v[216:217] op_sel:[0,1] op_sel_hi:[1,1]
 v_pk_mul_f32 v[140:141], v[140:141], v[216:217] op_sel:[0,1] op_sel_hi:[1,1]
 v_pk_mul_f32 v[142:143], v[142:143], v[216:217] op_sel:[0,1] op_sel_hi:[1,1]
 v_cvt_pk_bf16_f32 v136, v136, v137
 v_cvt_pk_bf16_f32 v137, v138, v139
 v_cvt_pk_bf16_f32 v138, v140, v141
 v_cvt_pk_bf16_f32 v139, v142, v143
 ds_write_b128 v208, v[136:139] offset:17408
 v_pk_mul_f32 v[144:145], v[144:145], v[218:219] op_sel:[0,0] op_sel_hi:[1,0]
 v_pk_mul_f32 v[146:147], v[146:147], v[218:219] op_sel:[0,0] op_sel_hi:[1,0]
 v_pk_mul_f32 v[148:149], v[148:149], v[218:219] op_sel:[0,0] op_sel_hi:[1,0]
 v_pk_mul_f32 v[150:151], v[150:151], v[218:219] op_sel:[0,0] op_sel_hi:[1,0]
 v_cvt_pk_bf16_f32 v144, v144, v145
 v_cvt_pk_bf16_f32 v145, v146, v147
 v_cvt_pk_bf16_f32 v146, v148, v149
 v_cvt_pk_bf16_f32 v147, v150, v151
 ds_write_b128 v208, v[144:147] offset:33792
 buffer_load_dwordx4 a[244:247], v252, s[20:23], s54 offen offset:1024 sc1
 v_pk_mul_f32 v[152:153], v[152:153], v[218:219] op_sel:[0,1] op_sel_hi:[1,1]
 v_pk_mul_f32 v[154:155], v[154:155], v[218:219] op_sel:[0,1] op_sel_hi:[1,1]
 v_pk_mul_f32 v[156:157], v[156:157], v[218:219] op_sel:[0,1] op_sel_hi:[1,1]
 v_pk_mul_f32 v[158:159], v[158:159], v[218:219] op_sel:[0,1] op_sel_hi:[1,1]
 v_cvt_pk_bf16_f32 v152, v152, v153
 v_cvt_pk_bf16_f32 v153, v154, v155
 v_cvt_pk_bf16_f32 v154, v156, v157
 v_cvt_pk_bf16_f32 v155, v158, v159
 ds_write_b128 v208, v[152:155] offset:50176
 v_accvgpr_read_b32 v160, a96
 v_accvgpr_read_b32 v161, a97
 v_accvgpr_read_b32 v162, a98
 v_accvgpr_read_b32 v163, a99
 v_accvgpr_read_b32 v164, a112
 v_accvgpr_read_b32 v165, a113
 v_accvgpr_read_b32 v166, a114
 v_accvgpr_read_b32 v167, a115
 v_pk_mul_f32 v[160:161], v[160:161], v[216:217] op_sel:[0,0] op_sel_hi:[1,0]
 v_pk_mul_f32 v[162:163], v[162:163], v[216:217] op_sel:[0,0] op_sel_hi:[1,0]
 v_pk_mul_f32 v[164:165], v[164:165], v[216:217] op_sel:[0,0] op_sel_hi:[1,0]
 v_pk_mul_f32 v[166:167], v[166:167], v[216:217] op_sel:[0,0] op_sel_hi:[1,0]
 v_cvt_pk_bf16_f32 v160, v160, v161
 v_cvt_pk_bf16_f32 v161, v162, v163
 v_cvt_pk_bf16_f32 v162, v164, v165
 v_cvt_pk_bf16_f32 v163, v166, v167
 ds_write_b128 v208, v[160:163] offset:1536
 buffer_load_dwordx4 a[248:251], v252, s[20:23], s54 offen offset:2048 sc1
 v_accvgpr_read_b32 v168, a100
 v_accvgpr_read_b32 v169, a101
 v_accvgpr_read_b32 v170, a102
 v_accvgpr_read_b32 v171, a103
 v_accvgpr_read_b32 v172, a116
 v_accvgpr_read_b32 v173, a117
 v_accvgpr_read_b32 v174, a118
 v_accvgpr_read_b32 v175, a119
 v_pk_mul_f32 v[168:169], v[168:169], v[216:217] op_sel:[0,1] op_sel_hi:[1,1]
 v_pk_mul_f32 v[170:171], v[170:171], v[216:217] op_sel:[0,1] op_sel_hi:[1,1]
 v_pk_mul_f32 v[172:173], v[172:173], v[216:217] op_sel:[0,1] op_sel_hi:[1,1]
 v_pk_mul_f32 v[174:175], v[174:175], v[216:217] op_sel:[0,1] op_sel_hi:[1,1]
 v_cvt_pk_bf16_f32 v168, v168, v169
 v_cvt_pk_bf16_f32 v169, v170, v171
 v_cvt_pk_bf16_f32 v170, v172, v173
 v_cvt_pk_bf16_f32 v171, v174, v175
 ds_write_b128 v208, v[168:171] offset:17920
 v_accvgpr_read_b32 v176, a104
 v_accvgpr_read_b32 v177, a105
 v_accvgpr_read_b32 v178, a106
 v_accvgpr_read_b32 v179, a107
 v_accvgpr_read_b32 v180, a120
 v_accvgpr_read_b32 v181, a121
 v_accvgpr_read_b32 v182, a122
 v_accvgpr_read_b32 v183, a123
 v_pk_mul_f32 v[176:177], v[176:177], v[218:219] op_sel:[0,0] op_sel_hi:[1,0]
 v_pk_mul_f32 v[178:179], v[178:179], v[218:219] op_sel:[0,0] op_sel_hi:[1,0]
 v_pk_mul_f32 v[180:181], v[180:181], v[218:219] op_sel:[0,0] op_sel_hi:[1,0]
 v_pk_mul_f32 v[182:183], v[182:183], v[218:219] op_sel:[0,0] op_sel_hi:[1,0]
 v_cvt_pk_bf16_f32 v176, v176, v177
 v_cvt_pk_bf16_f32 v177, v178, v179
 v_cvt_pk_bf16_f32 v178, v180, v181
 v_cvt_pk_bf16_f32 v179, v182, v183
 ds_write_b128 v208, v[176:179] offset:34304
 buffer_load_dwordx4 a[252:255], v252, s[20:23], s54 offen offset:3072 sc1
 v_accvgpr_read_b32 v184, a108
 v_accvgpr_read_b32 v185, a109
 v_accvgpr_read_b32 v186, a110
 v_accvgpr_read_b32 v187, a111
 v_accvgpr_read_b32 v188, a124
 v_accvgpr_read_b32 v189, a125
 v_accvgpr_read_b32 v190, a126
 v_accvgpr_read_b32 v191, a127
 v_pk_mul_f32 v[184:185], v[184:185], v[218:219] op_sel:[0,1] op_sel_hi:[1,1]
 v_pk_mul_f32 v[186:187], v[186:187], v[218:219] op_sel:[0,1] op_sel_hi:[1,1]
 v_pk_mul_f32 v[188:189], v[188:189], v[218:219] op_sel:[0,1] op_sel_hi:[1,1]
 v_pk_mul_f32 v[190:191], v[190:191], v[218:219] op_sel:[0,1] op_sel_hi:[1,1]
 v_cvt_pk_bf16_f32 v184, v184, v185
 v_cvt_pk_bf16_f32 v185, v186, v187
 v_cvt_pk_bf16_f32 v186, v188, v189
 v_cvt_pk_bf16_f32 v187, v190, v191
 ds_write_b128 v208, v[184:187] offset:50688
 s_setreg_imm32_b32 hwreg(HW_REG_MODE, 4, 2), 0
 s_waitcnt lgkmcnt(0)
 s_barrier
 ds_read_b128 v[128:131], v48 offset:0
 ds_read_b128 v[132:135], v48 offset:512
 ds_read_b128 v[136:139], v48 offset:1024
 ds_read_b128 v[140:143], v48 offset:1536
 ds_read_b128 v[144:147], v48 offset:2048
 ds_read_b128 v[148:151], v48 offset:2560
 ds_read_b128 v[152:155], v48 offset:3072
 ds_read_b128 v[156:159], v48 offset:3584
 s_waitcnt vmcnt(28) lgkmcnt(0)
 v_mfma_f32_16x16x32_bf16 v[64:67], a[128:131], v[128:131], 0
 ds_read_b128 v[160:163], v49 offset:0
 s_mov_b32 s55, 49152
 buffer_load_dwordx4 a[64:67], v252, s[20:23], s55 offen offset:0 sc1
 v_bfe_u32 v216, v1, 3, 1
 v_mfma_f32_16x16x32_bf16 v[64:67], a[136:139], v[132:135], v[64:67]
 ds_read_b128 v[164:167], v49 offset:512
 v_lshlrev_b32 v216, 12, v216
 v_mfma_f32_16x16x32_bf16 v[64:67], a[144:147], v[136:139], v[64:67]
 ds_read_b128 v[168:171], v49 offset:1024
 v_and_b32 v217, 7, v1
 v_mfma_f32_16x16x32_bf16 v[64:67], a[152:155], v[140:143], v[64:67]
 v_mfma_f32_16x16x32_bf16 v[64:67], a[160:163], v[144:147], v[64:67]
 ds_read_b128 v[172:175], v49 offset:1536
 buffer_load_dwordx4 a[68:71], v252, s[20:23], s55 offen offset:1024 sc1
 v_lshl_add_u32 v216, v217, 4, v216
 v_mfma_f32_16x16x32_bf16 v[64:67], a[168:171], v[148:151], v[64:67]
 ds_read_b128 v[176:179], v49 offset:2048
 v_lshrrev_b32 v217, 4, v1
 v_mfma_f32_16x16x32_bf16 v[64:67], a[176:179], v[152:155], v[64:67]
 ds_read_b128 v[180:183], v49 offset:2560
 v_lshl_add_u32 v216, v217, 7, v216
 v_mfma_f32_16x16x32_bf16 v[64:67], a[184:187], v[156:159], v[64:67]
 v_mfma_f32_16x16x32_bf16 v[68:71], a[132:135], v[128:131], 0
 ds_read_b128 v[184:187], v49 offset:3072
 buffer_load_dwordx4 a[72:75], v252, s[20:23], s55 offen offset:2048 sc1
 v_add_u32 v204, 0, v216
 v_mfma_f32_16x16x32_bf16 v[68:71], a[140:143], v[132:135], v[68:71]
 ds_read_b128 v[188:191], v49 offset:3584
 s_lshl_b32 s41, s3, 10
 v_mfma_f32_16x16x32_bf16 v[68:71], a[148:151], v[136:139], v[68:71]
 v_add_u32 v205, s41, v204
 s_mul_i32 s41, s33, 3072
 v_mfma_f32_16x16x32_bf16 v[68:71], a[156:159], v[140:143], v[68:71]
 v_mfma_f32_16x16x32_bf16 v[68:71], a[164:167], v[144:147], v[68:71]
 buffer_load_dwordx4 a[76:79], v252, s[20:23], s55 offen offset:3072 sc1
 s_add_u32 s41, s41, 131072
 s_lshl_b32 s42, s32, 2
 v_mfma_f32_16x16x32_bf16 v[68:71], a[172:175], v[148:151], v[68:71]
 s_add_u32 s42, s42, s41
 v_lshlrev_b32 v216, 7, v1
 v_mfma_f32_16x16x32_bf16 v[68:71], a[180:183], v[152:155], v[68:71]
 v_add_u32 v216, s42, v216
 v_cmp_gt_u32 vcc, 8, v1
 v_mfma_f32_16x16x32_bf16 v[68:71], a[188:191], v[156:159], v[68:71]
 s_waitcnt lgkmcnt(0)
 v_mfma_f32_16x16x32_bf16 v[72:75], a[128:131], v[160:163], 0
 ds_read_b128 v[128:131], v50 offset:0
 s_mov_b32 s54, 53248
 buffer_load_dwordx4 a[80:83], v252, s[20:23], s54 offen offset:0 sc1
 v_mov_b32 v217, 0x40000000
 v_mfma_f32_16x16x32_bf16 v[72:75], a[136:139], v[164:167], v[72:75]
 ds_read_b128 v[132:135], v50 offset:512
 s_lshl_b32 s42, s32, 7
 v_mfma_f32_16x16x32_bf16 v[72:75], a[144:147], v[168:171], v[72:75]
 ds_read_b128 v[136:139], v50 offset:1024
 v_cndmask_b32 v210, v217, v216, vcc
 v_mfma_f32_16x16x32_bf16 v[72:75], a[152:155], v[172:175], v[72:75]
 v_mfma_f32_16x16x32_bf16 v[72:75], a[160:163], v[176:179], v[72:75]
 ds_read_b128 v[140:143], v50 offset:1536
 buffer_load_dwordx4 a[84:87], v252, s[20:23], s54 offen offset:1024 sc1
 s_add_u32 s42, s42, s41
 v_mfma_f32_16x16x32_bf16 v[72:75], a[168:171], v[180:183], v[72:75]
 ds_read_b128 v[144:147], v50 offset:2048
 v_and_b32 v216, 7, v1
 v_mfma_f32_16x16x32_bf16 v[72:75], a[176:179], v[184:187], v[72:75]
 ds_read_b128 v[148:151], v50 offset:2560
 v_lshl_add_u32 v211, v216, 2, s42
 v_mfma_f32_16x16x32_bf16 v[72:75], a[184:187], v[188:191], v[72:75]
 v_mfma_f32_16x16x32_bf16 v[76:79], a[132:135], v[160:163], 0
 ds_read_b128 v[152:155], v50 offset:3072
 buffer_load_dwordx4 a[88:91], v252, s[20:23], s54 offen offset:2048 sc1
 v_cndmask_b32 v211, v217, v211, vcc
 v_mfma_f32_16x16x32_bf16 v[76:79], a[140:143], v[164:167], v[76:79]
 ds_read_b128 v[156:159], v50 offset:3584
 v_mov_b32 v212, s94
 v_mfma_f32_16x16x32_bf16 v[76:79], a[148:151], v[168:171], v[76:79]
 v_bfe_u32 v216, v1, 3, 1
 v_mul_u32_u24 v216, 65536, v216
 v_mfma_f32_16x16x32_bf16 v[76:79], a[156:159], v[172:175], v[76:79]
 v_mfma_f32_16x16x32_bf16 v[76:79], a[164:167], v[176:179], v[76:79]
 buffer_load_dwordx4 a[92:95], v252, s[20:23], s54 offen offset:3072 sc1
 v_and_b32 v217, 7, v1
 v_lshl_add_u32 v216, v217, 4, v216
 v_mfma_f32_16x16x32_bf16 v[76:79], a[172:175], v[180:183], v[76:79]
 v_lshrrev_b32 v217, 4, v1
 v_lshl_add_u32 v216, v217, 7, v216
 v_mfma_f32_16x16x32_bf16 v[76:79], a[180:183], v[184:187], v[76:79]
 v_add_u32 v214, 0, v216
 s_lshl_b32 s41, s3, 11
 v_mfma_f32_16x16x32_bf16 v[76:79], a[188:191], v[188:191], v[76:79]
 s_waitcnt lgkmcnt(0)
 v_mfma_f32_16x16x32_bf16 v[80:83], a[128:131], v[128:131], 0
 ds_read_b128 v[160:163], v51 offset:0
 s_mov_b32 s55, 57344
 buffer_load_dwordx4 a[96:99], v252, s[20:23], s55 offen offset:0 sc1
 v_add_u32 v214, s41, v214
 v_mfma_f32_16x16x32_bf16 v[80:83], a[136:139], v[132:135], v[80:83]
 ds_read_b128 v[164:167], v51 offset:512
 v_lshl_add_u32 v215, v1, 4, s41
 v_mfma_f32_16x16x32_bf16 v[80:83], a[144:147], v[136:139], v[80:83]
 ds_read_b128 v[168:171], v51 offset:1024
 v_subrev_u32 v216, v213, v48
 v_mfma_f32_16x16x32_bf16 v[80:83], a[152:155], v[140:143], v[80:83]
 v_mfma_f32_16x16x32_bf16 v[80:83], a[160:163], v[144:147], v[80:83]
 ds_read_b128 v[172:175], v51 offset:1536
 buffer_load_dwordx4 a[100:103], v252, s[20:23], s55 offen offset:1024 sc1
 v_lshrrev_b32 v216, 1, v216
 v_mfma_f32_16x16x32_bf16 v[80:83], a[168:171], v[148:151], v[80:83]
 ds_read_b128 v[176:179], v51 offset:2048
 v_add_u32 v52, v216, v204
 v_mfma_f32_16x16x32_bf16 v[80:83], a[176:179], v[152:155], v[80:83]
 ds_read_b128 v[180:183], v51 offset:2560
 v_subrev_u32 v216, v213, v49
 v_mfma_f32_16x16x32_bf16 v[80:83], a[184:187], v[156:159], v[80:83]
 v_mfma_f32_16x16x32_bf16 v[84:87], a[132:135], v[128:131], 0
 ds_read_b128 v[184:187], v51 offset:3072
 buffer_load_dwordx4 a[104:107], v252, s[20:23], s55 offen offset:2048 sc1
 v_lshrrev_b32 v216, 1, v216
 v_mfma_f32_16x16x32_bf16 v[84:87], a[140:143], v[132:135], v[84:87]
 ds_read_b128 v[188:191], v51 offset:3584
 v_add_u32 v53, v216, v204
 v_mfma_f32_16x16x32_bf16 v[84:87], a[148:151], v[136:139], v[84:87]
 v_subrev_u32 v216, v213, v50
 v_lshrrev_b32 v216, 1, v216
 v_mfma_f32_16x16x32_bf16 v[84:87], a[156:159], v[140:143], v[84:87]
 v_mfma_f32_16x16x32_bf16 v[84:87], a[164:167], v[144:147], v[84:87]
 buffer_load_dwordx4 a[108:111], v252, s[20:23], s55 offen offset:3072 sc1
 v_add_u32 v54, v216, v204
 v_subrev_u32 v216, v213, v51
 v_mfma_f32_16x16x32_bf16 v[84:87], a[172:175], v[148:151], v[84:87]
 v_lshrrev_b32 v216, 1, v216
 v_add_u32 v55, v216, v204
 v_mfma_f32_16x16x32_bf16 v[84:87], a[180:183], v[152:155], v[84:87]
 v_bfe_u32 v216, v1, 3, 1
 s_and_b32 s41, s32, 1
 v_mfma_f32_16x16x32_bf16 v[84:87], a[188:191], v[156:159], v[84:87]
 s_waitcnt lgkmcnt(0)
 v_mfma_f32_16x16x32_bf16 v[88:91], a[128:131], v[160:163], 0
 ds_read_b128 v[128:131], v48 offset:4096
 s_mov_b32 s54, 61440
 buffer_load_dwordx4 a[112:115], v252, s[20:23], s54 offen offset:0 sc1
 v_cmp_eq_u32 vcc, s41, v216
 v_mfma_f32_16x16x32_bf16 v[88:91], a[136:139], v[164:167], v[88:91]
 ds_read_b128 v[132:135], v48 offset:4608
 v_mov_b32 v217, 0x40000000
 v_mfma_f32_16x16x32_bf16 v[88:91], a[144:147], v[168:171], v[88:91]
 ds_read_b128 v[136:139], v48 offset:5120
 v_xor_b32 v216, s41, v216
 v_mfma_f32_16x16x32_bf16 v[88:91], a[152:155], v[172:175], v[88:91]
 v_mfma_f32_16x16x32_bf16 v[88:91], a[160:163], v[176:179], v[88:91]
 ds_read_b128 v[140:143], v48 offset:5632
 buffer_load_dwordx4 a[116:119], v252, s[20:23], s54 offen offset:1024 sc1
 v_cndmask_b32 v56, v214, v217, vcc
 v_mfma_f32_16x16x32_bf16 v[88:91], a[168:171], v[180:183], v[88:91]
 ds_read_b128 v[144:147], v48 offset:6144
 v_and_b32 v217, 0xffff, v214
 v_mfma_f32_16x16x32_bf16 v[88:91], a[176:179], v[184:187], v[88:91]
 ds_read_b128 v[148:151], v48 offset:6656
 v_lshl_add_u32 v57, v216, 13, v217
 v_mfma_f32_16x16x32_bf16 v[88:91], a[184:187], v[188:191], v[88:91]
 v_mfma_f32_16x16x32_bf16 v[92:95], a[132:135], v[160:163], 0
 ds_read_b128 v[152:155], v48 offset:7168
 buffer_load_dwordx4 a[120:123], v252, s[20:23], s54 offen offset:2048 sc1
 v_add_u32 v57, 32768, v57
 v_mfma_f32_16x16x32_bf16 v[92:95], a[140:143], v[164:167], v[92:95]
 ds_read_b128 v[156:159], v48 offset:7680
 v_add_u32 v58, 32768, v215
 v_mfma_f32_16x16x32_bf16 v[92:95], a[148:151], v[168:171], v[92:95]
 v_lshrrev_b32 v240, 5, v1
 v_bfe_u32 v241, v1, 3, 2
 v_mfma_f32_16x16x32_bf16 v[92:95], a[156:159], v[172:175], v[92:95]
 v_mfma_f32_16x16x32_bf16 v[92:95], a[164:167], v[176:179], v[92:95]
 buffer_load_dwordx4 a[124:127], v252, s[20:23], s54 offen offset:3072 sc1
 v_lshl_add_u32 v240, v240, 3, v241
 v_lshlrev_b32 v240, 4, v240
 v_mfma_f32_16x16x32_bf16 v[92:95], a[172:175], v[180:183], v[92:95]
 v_lshl_add_u32 v240, s3, 9, v240
 v_lshrrev_b32 v241, 1, v240
 v_mfma_f32_16x16x32_bf16 v[92:95], a[180:183], v[184:187], v[92:95]
 v_and_b32 v242, 7, v1
 s_lshl_b32 s46, s33, 3
 v_mfma_f32_16x16x32_bf16 v[92:95], a[188:191], v[188:191], v[92:95]
 s_waitcnt vmcnt(16)
 s_waitcnt lgkmcnt(0)
 v_mfma_f32_16x16x32_bf16 v[64:67], a[192:195], v[128:131], v[64:67]
 ds_read_b128 v[160:163], v49 offset:4096
 s_mov_b32 s55, 65536
 buffer_load_dwordx4 a[128:131], v252, s[20:23], s55 offen offset:0 sc1
 s_add_u32 s46, s46, s32
 v_mfma_f32_16x16x32_bf16 v[64:67], a[200:203], v[132:135], v[64:67]
 ds_read_b128 v[164:167], v49 offset:4608
 s_lshl_b32 s46, s46, 13
 v_mfma_f32_16x16x32_bf16 v[64:67], a[208:211], v[136:139], v[64:67]
 ds_read_b128 v[168:171], v49 offset:5120
 v_lshl_add_u32 v14, v242, 10, v241
 v_mfma_f32_16x16x32_bf16 v[64:67], a[216:219], v[140:143], v[64:67]
 v_mfma_f32_16x16x32_bf16 v[64:67], a[224:227], v[144:147], v[64:67]
 ds_read_b128 v[172:175], v49 offset:5632
 buffer_load_dwordx4 a[132:135], v252, s[20:23], s55 offen offset:1024 sc1
 v_mul_u32_u24 v206, 1056, v242
 v_mfma_f32_16x16x32_bf16 v[64:67], a[232:235], v[148:151], v[64:67]
 ds_read_b128 v[176:179], v49 offset:6144
 v_add_u32 v206, v206, v241
 v_mfma_f32_16x16x32_bf16 v[64:67], a[240:243], v[152:155], v[64:67]
 ds_read_b128 v[180:183], v49 offset:6656
 v_add_u32 v206, 49152, v206
 v_mfma_f32_16x16x32_bf16 v[64:67], a[248:251], v[156:159], v[64:67]
 v_mfma_f32_16x16x32_bf16 v[68:71], a[196:199], v[128:131], v[68:71]
 ds_read_b128 v[184:187], v49 offset:7168
 buffer_load_dwordx4 a[136:139], v252, s[20:23], s55 offen offset:2048 sc1
 v_lshlrev_b32 v207, 5, v242
 v_mfma_f32_16x16x32_bf16 v[68:71], a[204:207], v[132:135], v[68:71]
 ds_read_b128 v[188:191], v49 offset:7680
 v_add_u32 v207, 65536, v207
 v_mfma_f32_16x16x32_bf16 v[68:71], a[212:215], v[136:139], v[68:71]
 v_lshlrev_b32 v241, 5, v1
 v_lshl_add_u32 v241, s3, 11, v241
 v_mfma_f32_16x16x32_bf16 v[68:71], a[220:223], v[140:143], v[68:71]
 v_mfma_f32_16x16x32_bf16 v[68:71], a[228:231], v[144:147], v[68:71]
 buffer_load_dwordx4 a[140:143], v252, s[20:23], s55 offen offset:3072 sc1
 s_mov_b32 s47, 16384
 s_mul_i32 s41, s33, 524288
 v_mfma_f32_16x16x32_bf16 v[68:71], a[236:239], v[148:151], v[68:71]
 s_lshl_b32 s42, s32, 13
 s_add_u32 s41, s41, s42
 v_mfma_f32_16x16x32_bf16 v[68:71], a[244:247], v[152:155], v[68:71]
 s_lshr_b32 s42, s32, 1
 s_add_u32 s42, s42, 0
 v_mfma_f32_16x16x32_bf16 v[68:71], a[252:255], v[156:159], v[68:71]
 s_waitcnt lgkmcnt(0)
 v_mfma_f32_16x16x32_bf16 v[72:75], a[192:195], v[160:163], v[72:75]
 ds_read_b128 v[128:131], v50 offset:4096
 s_mov_b32 s54, 69632
 buffer_load_dwordx4 a[144:147], v252, s[20:23], s54 offen offset:0 sc1
 v_mfma_f32_16x16x32_bf16 v[72:75], a[200:203], v[164:167], v[72:75]
 ds_read_b128 v[132:135], v50 offset:4608
 v_mfma_f32_16x16x32_bf16 v[72:75], a[208:211], v[168:171], v[72:75]
 ds_read_b128 v[136:139], v50 offset:5120
 v_mfma_f32_16x16x32_bf16 v[72:75], a[216:219], v[172:175], v[72:75]
 v_mfma_f32_16x16x32_bf16 v[72:75], a[224:227], v[176:179], v[72:75]
 ds_read_b128 v[140:143], v50 offset:5632
 buffer_load_dwordx4 a[148:151], v252, s[20:23], s54 offen offset:1024 sc1
 v_mfma_f32_16x16x32_bf16 v[72:75], a[232:235], v[180:183], v[72:75]
 ds_read_b128 v[144:147], v50 offset:6144
 v_mfma_f32_16x16x32_bf16 v[72:75], a[240:243], v[184:187], v[72:75]
 ds_read_b128 v[148:151], v50 offset:6656
 v_mfma_f32_16x16x32_bf16 v[72:75], a[248:251], v[188:191], v[72:75]
 v_mfma_f32_16x16x32_bf16 v[76:79], a[196:199], v[160:163], v[76:79]
 ds_read_b128 v[152:155], v50 offset:7168
 buffer_load_dwordx4 a[152:155], v252, s[20:23], s54 offen offset:2048 sc1
 v_cvt_pk_bf16_f32 v16, v64, v65
 v_mfma_f32_16x16x32_bf16 v[76:79], a[204:207], v[164:167], v[76:79]
 ds_read_b128 v[156:159], v50 offset:7680
 v_cvt_pk_bf16_f32 v17, v66, v67
 v_mfma_f32_16x16x32_bf16 v[76:79], a[212:215], v[168:171], v[76:79]
 v_cvt_pk_bf16_f32 v18, v68, v69
 v_mfma_f32_16x16x32_bf16 v[76:79], a[220:223], v[172:175], v[76:79]
 v_mfma_f32_16x16x32_bf16 v[76:79], a[228:231], v[176:179], v[76:79]
 buffer_load_dwordx4 a[156:159], v252, s[20:23], s54 offen offset:3072 sc1
 v_cvt_pk_bf16_f32 v19, v70, v71
 v_mfma_f32_16x16x32_bf16 v[76:79], a[236:239], v[180:183], v[76:79]
 v_mfma_f32_16x16x32_bf16 v[76:79], a[244:247], v[184:187], v[76:79]
 v_mfma_f32_16x16x32_bf16 v[76:79], a[252:255], v[188:191], v[76:79]
 s_waitcnt lgkmcnt(0)
 v_mfma_f32_16x16x32_bf16 v[80:83], a[192:195], v[128:131], v[80:83]
 ds_read_b128 v[160:163], v51 offset:4096
 s_mov_b32 s55, 73728
 buffer_load_dwordx4 a[160:163], v252, s[20:23], s55 offen offset:0 sc1
 v_mfma_f32_16x16x32_bf16 v[80:83], a[200:203], v[132:135], v[80:83]
 ds_read_b128 v[164:167], v51 offset:4608
 v_mfma_f32_16x16x32_bf16 v[80:83], a[208:211], v[136:139], v[80:83]
 ds_read_b128 v[168:171], v51 offset:5120
 v_mfma_f32_16x16x32_bf16 v[80:83], a[216:219], v[140:143], v[80:83]
 v_mfma_f32_16x16x32_bf16 v[80:83], a[224:227], v[144:147], v[80:83]
 ds_read_b128 v[172:175], v51 offset:5632
 buffer_load_dwordx4 a[164:167], v252, s[20:23], s55 offen offset:1024 sc1
 v_mfma_f32_16x16x32_bf16 v[80:83], a[232:235], v[148:151], v[80:83]
 ds_read_b128 v[176:179], v51 offset:6144
 v_mfma_f32_16x16x32_bf16 v[80:83], a[240:243], v[152:155], v[80:83]
 ds_read_b128 v[180:183], v51 offset:6656
 v_mfma_f32_16x16x32_bf16 v[80:83], a[248:251], v[156:159], v[80:83]
 v_mfma_f32_16x16x32_bf16 v[84:87], a[196:199], v[128:131], v[84:87]
 ds_read_b128 v[184:187], v51 offset:7168
 buffer_load_dwordx4 a[168:171], v252, s[20:23], s55 offen offset:2048 sc1
 v_cvt_pk_bf16_f32 v20, v72, v73
 v_mfma_f32_16x16x32_bf16 v[84:87], a[204:207], v[132:135], v[84:87]
 ds_read_b128 v[188:191], v51 offset:7680
 v_cvt_pk_bf16_f32 v21, v74, v75
 v_mfma_f32_16x16x32_bf16 v[84:87], a[212:215], v[136:139], v[84:87]
 v_cvt_pk_bf16_f32 v22, v76, v77
 v_mfma_f32_16x16x32_bf16 v[84:87], a[220:223], v[140:143], v[84:87]
 v_mfma_f32_16x16x32_bf16 v[84:87], a[228:231], v[144:147], v[84:87]
 buffer_load_dwordx4 a[172:175], v252, s[20:23], s55 offen offset:3072 sc1
 v_cvt_pk_bf16_f32 v23, v78, v79
 v_mfma_f32_16x16x32_bf16 v[84:87], a[236:239], v[148:151], v[84:87]
 v_mfma_f32_16x16x32_bf16 v[84:87], a[244:247], v[152:155], v[84:87]
 v_mfma_f32_16x16x32_bf16 v[84:87], a[252:255], v[156:159], v[84:87]
 s_waitcnt lgkmcnt(0)
 v_mfma_f32_16x16x32_bf16 v[88:91], a[192:195], v[160:163], v[88:91]
 ds_read_b128 v[128:131], v48 offset:0
 s_mov_b32 s54, 77824
 buffer_load_dwordx4 a[176:179], v252, s[20:23], s54 offen offset:0 sc1
 v_mfma_f32_16x16x32_bf16 v[88:91], a[200:203], v[164:167], v[88:91]
 ds_read_b128 v[132:135], v48 offset:512
 v_mfma_f32_16x16x32_bf16 v[88:91], a[208:211], v[168:171], v[88:91]
 ds_read_b128 v[136:139], v48 offset:1024
 v_mfma_f32_16x16x32_bf16 v[88:91], a[216:219], v[172:175], v[88:91]
 v_mfma_f32_16x16x32_bf16 v[88:91], a[224:227], v[176:179], v[88:91]
 ds_read_b128 v[140:143], v48 offset:1536
 buffer_load_dwordx4 a[180:183], v252, s[20:23], s54 offen offset:1024 sc1
 v_mfma_f32_16x16x32_bf16 v[88:91], a[232:235], v[180:183], v[88:91]
 ds_read_b128 v[144:147], v48 offset:2048
 v_mfma_f32_16x16x32_bf16 v[88:91], a[240:243], v[184:187], v[88:91]
 ds_read_b128 v[148:151], v48 offset:2560
 v_mfma_f32_16x16x32_bf16 v[88:91], a[248:251], v[188:191], v[88:91]
 v_mfma_f32_16x16x32_bf16 v[92:95], a[196:199], v[160:163], v[92:95]
 ds_read_b128 v[152:155], v48 offset:3072
 buffer_load_dwordx4 a[184:187], v252, s[20:23], s54 offen offset:2048 sc1
 v_cvt_pk_bf16_f32 v24, v80, v81
 v_mfma_f32_16x16x32_bf16 v[92:95], a[204:207], v[164:167], v[92:95]
 ds_read_b128 v[156:159], v48 offset:3584
 v_cvt_pk_bf16_f32 v25, v82, v83
 v_mfma_f32_16x16x32_bf16 v[92:95], a[212:215], v[168:171], v[92:95]
 v_cvt_pk_bf16_f32 v26, v84, v85
 v_mfma_f32_16x16x32_bf16 v[92:95], a[220:223], v[172:175], v[92:95]
 v_mfma_f32_16x16x32_bf16 v[92:95], a[228:231], v[176:179], v[92:95]
 buffer_load_dwordx4 a[188:191], v252, s[20:23], s54 offen offset:3072 sc1
 v_cvt_pk_bf16_f32 v27, v86, v87
 v_mfma_f32_16x16x32_bf16 v[92:95], a[236:239], v[180:183], v[92:95]
 v_mfma_f32_16x16x32_bf16 v[92:95], a[244:247], v[184:187], v[92:95]
 v_mfma_f32_16x16x32_bf16 v[92:95], a[252:255], v[188:191], v[92:95]
 s_waitcnt vmcnt(40)
 s_waitcnt lgkmcnt(0)
 v_mfma_f32_16x16x32_bf16 v[96:99], a[0:3], v[128:131], 0
 ds_read_b128 v[160:163], v49 offset:0
 s_mov_b32 s55, 81920
 buffer_load_dwordx4 a[192:195], v252, s[20:23], s55 offen offset:0 sc1
 v_mfma_f32_16x16x32_bf16 v[96:99], a[8:11], v[132:135], v[96:99]
 ds_read_b128 v[164:167], v49 offset:512
 v_mfma_f32_16x16x32_bf16 v[96:99], a[16:19], v[136:139], v[96:99]
 ds_read_b128 v[168:171], v49 offset:1024
 v_mfma_f32_16x16x32_bf16 v[96:99], a[24:27], v[140:143], v[96:99]
 v_mfma_f32_16x16x32_bf16 v[96:99], a[32:35], v[144:147], v[96:99]
 ds_read_b128 v[172:175], v49 offset:1536
 buffer_load_dwordx4 a[196:199], v252, s[20:23], s55 offen offset:1024 sc1
 v_mfma_f32_16x16x32_bf16 v[96:99], a[40:43], v[148:151], v[96:99]
 ds_read_b128 v[176:179], v49 offset:2048
 v_mfma_f32_16x16x32_bf16 v[96:99], a[48:51], v[152:155], v[96:99]
 ds_read_b128 v[180:183], v49 offset:2560
 v_mfma_f32_16x16x32_bf16 v[96:99], a[56:59], v[156:159], v[96:99]
 v_mfma_f32_16x16x32_bf16 v[100:103], a[4:7], v[128:131], 0
 ds_read_b128 v[184:187], v49 offset:3072
 buffer_load_dwordx4 a[200:203], v252, s[20:23], s55 offen offset:2048 sc1
 v_cvt_pk_bf16_f32 v28, v88, v89
 v_mfma_f32_16x16x32_bf16 v[100:103], a[12:15], v[132:135], v[100:103]
 ds_read_b128 v[188:191], v49 offset:3584
 v_cvt_pk_bf16_f32 v29, v90, v91
 v_mfma_f32_16x16x32_bf16 v[100:103], a[20:23], v[136:139], v[100:103]
 v_cvt_pk_bf16_f32 v30, v92, v93
 v_mfma_f32_16x16x32_bf16 v[100:103], a[28:31], v[140:143], v[100:103]
 v_mfma_f32_16x16x32_bf16 v[100:103], a[36:39], v[144:147], v[100:103]
 buffer_load_dwordx4 a[204:207], v252, s[20:23], s55 offen offset:3072 sc1
 v_cvt_pk_bf16_f32 v31, v94, v95
 v_mfma_f32_16x16x32_bf16 v[100:103], a[44:47], v[148:151], v[100:103]
 v_mfma_f32_16x16x32_bf16 v[100:103], a[52:55], v[152:155], v[100:103]
 v_mfma_f32_16x16x32_bf16 v[100:103], a[60:63], v[156:159], v[100:103]
 s_waitcnt lgkmcnt(0)
 v_mfma_f32_16x16x32_bf16 v[104:107], a[0:3], v[160:163], 0
 ds_read_b128 v[128:131], v50 offset:0
 s_mov_b32 s54, 86016
 buffer_load_dwordx4 a[208:211], v252, s[20:23], s54 offen offset:0 sc1
 s_and_b32 s42, s42, 3
 v_mfma_f32_16x16x32_bf16 v[104:107], a[8:11], v[164:167], v[104:107]
 ds_read_b128 v[132:135], v50 offset:512
 s_lshl_b32 s42, s42, 17
 v_mfma_f32_16x16x32_bf16 v[104:107], a[16:19], v[168:171], v[104:107]
 ds_read_b128 v[136:139], v50 offset:1024
 s_add_u32 s42, s42, s41
 v_mfma_f32_16x16x32_bf16 v[104:107], a[24:27], v[172:175], v[104:107]
 v_mfma_f32_16x16x32_bf16 v[104:107], a[32:35], v[176:179], v[104:107]
 ds_read_b128 v[140:143], v50 offset:1536
 buffer_load_dwordx4 a[212:215], v252, s[20:23], s54 offen offset:1024 sc1
 s_add_u32 s42, s42, 1048576
 v_mfma_f32_16x16x32_bf16 v[104:107], a[40:43], v[180:183], v[104:107]
 ds_read_b128 v[144:147], v50 offset:2048
 s_lshr_b32 s43, s32, 1
 v_mfma_f32_16x16x32_bf16 v[104:107], a[48:51], v[184:187], v[104:107]
 ds_read_b128 v[148:151], v50 offset:2560
 s_add_u32 s43, s43, 1
 v_mfma_f32_16x16x32_bf16 v[104:107], a[56:59], v[188:191], v[104:107]
 v_mfma_f32_16x16x32_bf16 v[108:111], a[4:7], v[160:163], 0
 ds_read_b128 v[152:155], v50 offset:3072
 buffer_load_dwordx4 a[216:219], v252, s[20:23], s54 offen offset:2048 sc1
 s_and_b32 s43, s43, 3
 v_mfma_f32_16x16x32_bf16 v[108:111], a[12:15], v[164:167], v[108:111]
 ds_read_b128 v[156:159], v50 offset:3584
 s_lshl_b32 s43, s43, 17
 v_mfma_f32_16x16x32_bf16 v[108:111], a[20:23], v[168:171], v[108:111]
 s_add_u32 s43, s43, s41
 s_add_u32 s43, s43, 1048576
 v_mfma_f32_16x16x32_bf16 v[108:111], a[28:31], v[172:175], v[108:111]
 v_mfma_f32_16x16x32_bf16 v[108:111], a[36:39], v[176:179], v[108:111]
 buffer_load_dwordx4 a[220:223], v252, s[20:23], s54 offen offset:3072 sc1
 s_lshr_b32 s44, s32, 1
 s_add_u32 s44, s44, 2
 v_mfma_f32_16x16x32_bf16 v[108:111], a[44:47], v[180:183], v[108:111]
 s_and_b32 s44, s44, 3
 s_lshl_b32 s44, s44, 17
 v_mfma_f32_16x16x32_bf16 v[108:111], a[52:55], v[184:187], v[108:111]
 s_add_u32 s44, s44, s41
 s_add_u32 s44, s44, 1048576
 v_mfma_f32_16x16x32_bf16 v[108:111], a[60:63], v[188:191], v[108:111]
 s_waitcnt lgkmcnt(0)
 v_mfma_f32_16x16x32_bf16 v[112:115], a[0:3], v[128:131], 0
 ds_read_b128 v[160:163], v51 offset:0
 s_mov_b32 s55, 90112
 buffer_load_dwordx4 a[224:227], v252, s[20:23], s55 offen offset:0 sc1
 s_lshr_b32 s45, s32, 1
 v_mfma_f32_16x16x32_bf16 v[112:115], a[8:11], v[132:135], v[112:115]
 ds_read_b128 v[164:167], v51 offset:512
 s_add_u32 s45, s45, 3
 v_mfma_f32_16x16x32_bf16 v[112:115], a[16:19], v[136:139], v[112:115]
 ds_read_b128 v[168:171], v51 offset:1024
 s_and_b32 s45, s45, 3
 v_mfma_f32_16x16x32_bf16 v[112:115], a[24:27], v[140:143], v[112:115]
 v_mfma_f32_16x16x32_bf16 v[112:115], a[32:35], v[144:147], v[112:115]
 ds_read_b128 v[172:175], v51 offset:1536
 buffer_load_dwordx4 a[228:231], v252, s[20:23], s55 offen offset:1024 sc1
 s_lshl_b32 s45, s45, 17
 v_mfma_f32_16x16x32_bf16 v[112:115], a[40:43], v[148:151], v[112:115]
 ds_read_b128 v[176:179], v51 offset:2048
 s_add_u32 s45, s45, s41
 v_mfma_f32_16x16x32_bf16 v[112:115], a[48:51], v[152:155], v[112:115]
 ds_read_b128 v[180:183], v51 offset:2560
 s_add_u32 s45, s45, 1048576
 v_mfma_f32_16x16x32_bf16 v[112:115], a[56:59], v[156:159], v[112:115]
 v_mfma_f32_16x16x32_bf16 v[116:119], a[4:7], v[128:131], 0
 ds_read_b128 v[184:187], v51 offset:3072
 buffer_load_dwordx4 a[232:235], v252, s[20:23], s55 offen offset:2048 sc1
 v_mfma_f32_16x16x32_bf16 v[116:119], a[12:15], v[132:135], v[116:119]
 ds_read_b128 v[188:191], v51 offset:3584
 v_mfma_f32_16x16x32_bf16 v[116:119], a[20:23], v[136:139], v[116:119]
 v_mfma_f32_16x16x32_bf16 v[116:119], a[28:31], v[140:143], v[116:119]
 v_mfma_f32_16x16x32_bf16 v[116:119], a[36:39], v[144:147], v[116:119]
 buffer_load_dwordx4 a[236:239], v252, s[20:23], s55 offen offset:3072 sc1
 v_mfma_f32_16x16x32_bf16 v[116:119], a[44:47], v[148:151], v[116:119]
 v_mfma_f32_16x16x32_bf16 v[116:119], a[52:55], v[152:155], v[116:119]
 v_mfma_f32_16x16x32_bf16 v[116:119], a[60:63], v[156:159], v[116:119]
 s_waitcnt lgkmcnt(0)
 v_mfma_f32_16x16x32_bf16 v[120:123], a[0:3], v[160:163], 0
 ds_read_b128 v[128:131], v48 offset:4096
 s_mov_b32 s54, 94208
 buffer_load_dwordx4 a[240:243], v252, s[20:23], s54 offen offset:0 sc1
 v_mfma_f32_16x16x32_bf16 v[120:123], a[8:11], v[164:167], v[120:123]
 ds_read_b128 v[132:135], v48 offset:4608
 v_mfma_f32_16x16x32_bf16 v[120:123], a[16:19], v[168:171], v[120:123]
 ds_read_b128 v[136:139], v48 offset:5120
 v_mfma_f32_16x16x32_bf16 v[120:123], a[24:27], v[172:175], v[120:123]
 v_mfma_f32_16x16x32_bf16 v[120:123], a[32:35], v[176:179], v[120:123]
 ds_read_b128 v[140:143], v48 offset:5632
 buffer_load_dwordx4 a[244:247], v252, s[20:23], s54 offen offset:1024 sc1
 v_mfma_f32_16x16x32_bf16 v[120:123], a[40:43], v[180:183], v[120:123]
 ds_read_b128 v[144:147], v48 offset:6144
 v_mfma_f32_16x16x32_bf16 v[120:123], a[48:51], v[184:187], v[120:123]
 ds_read_b128 v[148:151], v48 offset:6656
 v_mfma_f32_16x16x32_bf16 v[120:123], a[56:59], v[188:191], v[120:123]
 v_mfma_f32_16x16x32_bf16 v[124:127], a[4:7], v[160:163], 0
 ds_read_b128 v[152:155], v48 offset:7168
 buffer_load_dwordx4 a[248:251], v252, s[20:23], s54 offen offset:2048 sc1
 v_mfma_f32_16x16x32_bf16 v[124:127], a[12:15], v[164:167], v[124:127]
 ds_read_b128 v[156:159], v48 offset:7680
 v_mfma_f32_16x16x32_bf16 v[124:127], a[20:23], v[168:171], v[124:127]
 v_mfma_f32_16x16x32_bf16 v[124:127], a[28:31], v[172:175], v[124:127]
 v_mfma_f32_16x16x32_bf16 v[124:127], a[36:39], v[176:179], v[124:127]
 buffer_load_dwordx4 a[252:255], v252, s[20:23], s54 offen offset:3072 sc1
 v_mfma_f32_16x16x32_bf16 v[124:127], a[44:47], v[180:183], v[124:127]
 v_mfma_f32_16x16x32_bf16 v[124:127], a[52:55], v[184:187], v[124:127]
 v_mfma_f32_16x16x32_bf16 v[124:127], a[60:63], v[188:191], v[124:127]
 s_waitcnt vmcnt(32)
 s_waitcnt lgkmcnt(0)
 v_mfma_f32_16x16x32_bf16 v[96:99], a[64:67], v[128:131], v[96:99]
 ds_read_b128 v[160:163], v49 offset:4096
 s_mov_b32 s55, 98304
 buffer_load_dwordx4 a[0:3], v252, s[20:23], s55 offen offset:0 sc1
 v_mfma_f32_16x16x32_bf16 v[96:99], a[72:75], v[132:135], v[96:99]
 ds_read_b128 v[164:167], v49 offset:4608
 v_mfma_f32_16x16x32_bf16 v[96:99], a[80:83], v[136:139], v[96:99]
 ds_read_b128 v[168:171], v49 offset:5120
 v_mfma_f32_16x16x32_bf16 v[96:99], a[88:91], v[140:143], v[96:99]
 v_mfma_f32_16x16x32_bf16 v[96:99], a[96:99], v[144:147], v[96:99]
 ds_read_b128 v[172:175], v49 offset:5632
 buffer_load_dwordx4 a[4:7], v252, s[20:23], s55 offen offset:1024 sc1
 v_mfma_f32_16x16x32_bf16 v[96:99], a[104:107], v[148:151], v[96:99]
 ds_read_b128 v[176:179], v49 offset:6144
 v_mfma_f32_16x16x32_bf16 v[96:99], a[112:115], v[152:155], v[96:99]
 ds_read_b128 v[180:183], v49 offset:6656
 v_mfma_f32_16x16x32_bf16 v[96:99], a[120:123], v[156:159], v[96:99]
 v_mfma_f32_16x16x32_bf16 v[100:103], a[68:71], v[128:131], v[100:103]
 ds_read_b128 v[184:187], v49 offset:7168
 buffer_load_dwordx4 a[8:11], v252, s[20:23], s55 offen offset:2048 sc1
 v_mfma_f32_16x16x32_bf16 v[100:103], a[76:79], v[132:135], v[100:103]
 ds_read_b128 v[188:191], v49 offset:7680
 v_mfma_f32_16x16x32_bf16 v[100:103], a[84:87], v[136:139], v[100:103]
 v_mfma_f32_16x16x32_bf16 v[100:103], a[92:95], v[140:143], v[100:103]
 v_mfma_f32_16x16x32_bf16 v[100:103], a[100:103], v[144:147], v[100:103]
 buffer_load_dwordx4 a[12:15], v252, s[20:23], s55 offen offset:3072 sc1
 v_mfma_f32_16x16x32_bf16 v[100:103], a[108:111], v[148:151], v[100:103]
 v_mfma_f32_16x16x32_bf16 v[100:103], a[116:119], v[152:155], v[100:103]
 v_mfma_f32_16x16x32_bf16 v[100:103], a[124:127], v[156:159], v[100:103]
 s_waitcnt lgkmcnt(0)
 v_mfma_f32_16x16x32_bf16 v[104:107], a[64:67], v[160:163], v[104:107]
 ds_read_b128 v[128:131], v50 offset:4096
 s_mov_b32 s54, 102400
 buffer_load_dwordx4 a[16:19], v252, s[20:23], s54 offen offset:0 sc1
 v_mfma_f32_16x16x32_bf16 v[104:107], a[72:75], v[164:167], v[104:107]
 ds_read_b128 v[132:135], v50 offset:4608
 v_mfma_f32_16x16x32_bf16 v[104:107], a[80:83], v[168:171], v[104:107]
 ds_read_b128 v[136:139], v50 offset:5120
 v_mfma_f32_16x16x32_bf16 v[104:107], a[88:91], v[172:175], v[104:107]
 v_mfma_f32_16x16x32_bf16 v[104:107], a[96:99], v[176:179], v[104:107]
 ds_read_b128 v[140:143], v50 offset:5632
 buffer_load_dwordx4 a[20:23], v252, s[20:23], s54 offen offset:1024 sc1
 v_mfma_f32_16x16x32_bf16 v[104:107], a[104:107], v[180:183], v[104:107]
 ds_read_b128 v[144:147], v50 offset:6144
 v_mfma_f32_16x16x32_bf16 v[104:107], a[112:115], v[184:187], v[104:107]
 ds_read_b128 v[148:151], v50 offset:6656
 v_mfma_f32_16x16x32_bf16 v[104:107], a[120:123], v[188:191], v[104:107]
 v_mfma_f32_16x16x32_bf16 v[108:111], a[68:71], v[160:163], v[108:111]
 ds_read_b128 v[152:155], v50 offset:7168
 buffer_load_dwordx4 a[24:27], v252, s[20:23], s54 offen offset:2048 sc1
 v_cvt_pk_bf16_f32 v32, v96, v97
 v_mfma_f32_16x16x32_bf16 v[108:111], a[76:79], v[164:167], v[108:111]
 ds_read_b128 v[156:159], v50 offset:7680
 v_cvt_pk_bf16_f32 v33, v98, v99
 v_mfma_f32_16x16x32_bf16 v[108:111], a[84:87], v[168:171], v[108:111]
 v_cvt_pk_bf16_f32 v34, v100, v101
 v_mfma_f32_16x16x32_bf16 v[108:111], a[92:95], v[172:175], v[108:111]
 v_mfma_f32_16x16x32_bf16 v[108:111], a[100:103], v[176:179], v[108:111]
 buffer_load_dwordx4 a[28:31], v252, s[20:23], s54 offen offset:3072 sc1
 v_cvt_pk_bf16_f32 v35, v102, v103
 v_mfma_f32_16x16x32_bf16 v[108:111], a[108:111], v[180:183], v[108:111]
 v_mfma_f32_16x16x32_bf16 v[108:111], a[116:119], v[184:187], v[108:111]
 v_mfma_f32_16x16x32_bf16 v[108:111], a[124:127], v[188:191], v[108:111]
 s_waitcnt lgkmcnt(0)
 v_mfma_f32_16x16x32_bf16 v[112:115], a[64:67], v[128:131], v[112:115]
 ds_read_b128 v[160:163], v51 offset:4096
 s_mov_b32 s55, 106496
 buffer_load_dwordx4 a[32:35], v252, s[20:23], s55 offen offset:0 sc1
 v_mfma_f32_16x16x32_bf16 v[112:115], a[72:75], v[132:135], v[112:115]
 ds_read_b128 v[164:167], v51 offset:4608
 v_mfma_f32_16x16x32_bf16 v[112:115], a[80:83], v[136:139], v[112:115]
 ds_read_b128 v[168:171], v51 offset:5120
 v_mfma_f32_16x16x32_bf16 v[112:115], a[88:91], v[140:143], v[112:115]
 v_mfma_f32_16x16x32_bf16 v[112:115], a[96:99], v[144:147], v[112:115]
 ds_read_b128 v[172:175], v51 offset:5632
 buffer_load_dwordx4 a[36:39], v252, s[20:23], s55 offen offset:1024 sc1
 v_mfma_f32_16x16x32_bf16 v[112:115], a[104:107], v[148:151], v[112:115]
 ds_read_b128 v[176:179], v51 offset:6144
 v_mfma_f32_16x16x32_bf16 v[112:115], a[112:115], v[152:155], v[112:115]
 ds_read_b128 v[180:183], v51 offset:6656
 v_mfma_f32_16x16x32_bf16 v[112:115], a[120:123], v[156:159], v[112:115]
 v_mfma_f32_16x16x32_bf16 v[116:119], a[68:71], v[128:131], v[116:119]
 ds_read_b128 v[184:187], v51 offset:7168
 buffer_load_dwordx4 a[40:43], v252, s[20:23], s55 offen offset:2048 sc1
 v_cvt_pk_bf16_f32 v36, v104, v105
 v_mfma_f32_16x16x32_bf16 v[116:119], a[76:79], v[132:135], v[116:119]
 ds_read_b128 v[188:191], v51 offset:7680
 v_cvt_pk_bf16_f32 v37, v106, v107
 v_mfma_f32_16x16x32_bf16 v[116:119], a[84:87], v[136:139], v[116:119]
 v_cvt_pk_bf16_f32 v38, v108, v109
 v_mfma_f32_16x16x32_bf16 v[116:119], a[92:95], v[140:143], v[116:119]
 v_mfma_f32_16x16x32_bf16 v[116:119], a[100:103], v[144:147], v[116:119]
 buffer_load_dwordx4 a[44:47], v252, s[20:23], s55 offen offset:3072 sc1
 v_cvt_pk_bf16_f32 v39, v110, v111
 v_mfma_f32_16x16x32_bf16 v[116:119], a[108:111], v[148:151], v[116:119]
 v_mfma_f32_16x16x32_bf16 v[116:119], a[116:119], v[152:155], v[116:119]
 v_mfma_f32_16x16x32_bf16 v[116:119], a[124:127], v[156:159], v[116:119]
 s_waitcnt lgkmcnt(0)
 v_mfma_f32_16x16x32_bf16 v[120:123], a[64:67], v[160:163], v[120:123]
 ds_read_b128 v[128:131], v48 offset:0
 s_mov_b32 s54, 110592
 buffer_load_dwordx4 a[48:51], v252, s[20:23], s54 offen offset:0 sc1
 v_mfma_f32_16x16x32_bf16 v[120:123], a[72:75], v[164:167], v[120:123]
 ds_read_b128 v[132:135], v48 offset:512
 v_mfma_f32_16x16x32_bf16 v[120:123], a[80:83], v[168:171], v[120:123]
 ds_read_b128 v[136:139], v48 offset:1024
 v_mfma_f32_16x16x32_bf16 v[120:123], a[88:91], v[172:175], v[120:123]
 v_mfma_f32_16x16x32_bf16 v[120:123], a[96:99], v[176:179], v[120:123]
 ds_read_b128 v[140:143], v48 offset:1536
 buffer_load_dwordx4 a[52:55], v252, s[20:23], s54 offen offset:1024 sc1
 v_mfma_f32_16x16x32_bf16 v[120:123], a[104:107], v[180:183], v[120:123]
 ds_read_b128 v[144:147], v48 offset:2048
 v_mfma_f32_16x16x32_bf16 v[120:123], a[112:115], v[184:187], v[120:123]
 ds_read_b128 v[148:151], v48 offset:2560
 v_mfma_f32_16x16x32_bf16 v[120:123], a[120:123], v[188:191], v[120:123]
 v_mfma_f32_16x16x32_bf16 v[124:127], a[68:71], v[160:163], v[124:127]
 ds_read_b128 v[152:155], v48 offset:3072
 buffer_load_dwordx4 a[56:59], v252, s[20:23], s54 offen offset:2048 sc1
 v_cvt_pk_bf16_f32 v40, v112, v113
 v_mfma_f32_16x16x32_bf16 v[124:127], a[76:79], v[164:167], v[124:127]
 ds_read_b128 v[156:159], v48 offset:3584
 v_cvt_pk_bf16_f32 v41, v114, v115
 v_mfma_f32_16x16x32_bf16 v[124:127], a[84:87], v[168:171], v[124:127]
 v_cvt_pk_bf16_f32 v42, v116, v117
 v_mfma_f32_16x16x32_bf16 v[124:127], a[92:95], v[172:175], v[124:127]
 v_mfma_f32_16x16x32_bf16 v[124:127], a[100:103], v[176:179], v[124:127]
 buffer_load_dwordx4 a[60:63], v252, s[20:23], s54 offen offset:3072 sc1
 v_cvt_pk_bf16_f32 v43, v118, v119
 v_mfma_f32_16x16x32_bf16 v[124:127], a[108:111], v[180:183], v[124:127]
 v_mfma_f32_16x16x32_bf16 v[124:127], a[116:119], v[184:187], v[124:127]
 v_mfma_f32_16x16x32_bf16 v[124:127], a[124:127], v[188:191], v[124:127]
 s_waitcnt vmcnt(32)
 s_waitcnt lgkmcnt(0)
 v_mfma_f32_16x16x32_bf16 v[64:67], a[128:131], v[128:131], 0
 ds_read_b128 v[160:163], v49 offset:0
 buffer_store_dwordx4 v[16:19], v56, s[24:27], s42 offen offset:0 sc1
 ds_write_b128 v57, v[16:19] offset:0
 v_mfma_f32_16x16x32_bf16 v[64:67], a[136:139], v[132:135], v[64:67]
 ds_read_b128 v[164:167], v49 offset:512
 v_mfma_f32_16x16x32_bf16 v[64:67], a[144:147], v[136:139], v[64:67]
 ds_read_b128 v[168:171], v49 offset:1024
 v_mfma_f32_16x16x32_bf16 v[64:67], a[152:155], v[140:143], v[64:67]
 v_mfma_f32_16x16x32_bf16 v[64:67], a[160:163], v[144:147], v[64:67]
 ds_read_b128 v[172:175], v49 offset:1536
 v_mfma_f32_16x16x32_bf16 v[64:67], a[168:171], v[148:151], v[64:67]
 ds_read_b128 v[176:179], v49 offset:2048
 v_mfma_f32_16x16x32_bf16 v[64:67], a[176:179], v[152:155], v[64:67]
 ds_read_b128 v[180:183], v49 offset:2560
 v_mfma_f32_16x16x32_bf16 v[64:67], a[184:187], v[156:159], v[64:67]
 v_mfma_f32_16x16x32_bf16 v[68:71], a[132:135], v[128:131], 0
 ds_read_b128 v[184:187], v49 offset:3072
 v_cvt_pk_bf16_f32 v44, v120, v121
 v_mfma_f32_16x16x32_bf16 v[68:71], a[140:143], v[132:135], v[68:71]
 ds_read_b128 v[188:191], v49 offset:3584
 v_cvt_pk_bf16_f32 v45, v122, v123
 v_mfma_f32_16x16x32_bf16 v[68:71], a[148:151], v[136:139], v[68:71]
 ds_read_b128 a[64:67], v59 offset:0
 v_cvt_pk_bf16_f32 v46, v124, v125
 v_mfma_f32_16x16x32_bf16 v[68:71], a[156:159], v[140:143], v[68:71]
 v_mfma_f32_16x16x32_bf16 v[68:71], a[164:167], v[144:147], v[68:71]
 ds_read_b128 a[68:71], v59 offset:1024
 buffer_store_dwordx4 v[20:23], v214, s[24:27], s43 offen offset:0 sc1
 v_cvt_pk_bf16_f32 v47, v126, v127
 v_mfma_f32_16x16x32_bf16 v[68:71], a[172:175], v[148:151], v[68:71]
 v_mfma_f32_16x16x32_bf16 v[68:71], a[180:183], v[152:155], v[68:71]
 v_mfma_f32_16x16x32_bf16 v[68:71], a[188:191], v[156:159], v[68:71]
 s_waitcnt lgkmcnt(2)
 v_mfma_f32_16x16x32_bf16 v[72:75], a[128:131], v[160:163], 0
 ds_read_b128 v[128:131], v50 offset:0
 v_mfma_f32_16x16x32_bf16 v[72:75], a[136:139], v[164:167], v[72:75]
 ds_read_b128 v[132:135], v50 offset:512
 v_mfma_f32_16x16x32_bf16 v[72:75], a[144:147], v[168:171], v[72:75]
 ds_read_b128 v[136:139], v50 offset:1024
 v_mfma_f32_16x16x32_bf16 v[72:75], a[152:155], v[172:175], v[72:75]
 v_mfma_f32_16x16x32_bf16 v[72:75], a[160:163], v[176:179], v[72:75]
 ds_read_b128 v[140:143], v50 offset:1536
 v_mfma_f32_16x16x32_bf16 v[72:75], a[168:171], v[180:183], v[72:75]
 ds_read_b128 v[144:147], v50 offset:2048
 v_mfma_f32_16x16x32_bf16 v[72:75], a[176:179], v[184:187], v[72:75]
 ds_read_b128 v[148:151], v50 offset:2560
 v_mfma_f32_16x16x32_bf16 v[72:75], a[184:187], v[188:191], v[72:75]
 v_mfma_f32_16x16x32_bf16 v[76:79], a[132:135], v[160:163], 0
 ds_read_b128 v[152:155], v50 offset:3072
 buffer_store_dwordx4 v[24:27], v214, s[24:27], s44 offen offset:0 sc1
 v_mfma_f32_16x16x32_bf16 v[76:79], a[140:143], v[164:167], v[76:79]
 ds_read_b128 v[156:159], v50 offset:3584
 v_mfma_f32_16x16x32_bf16 v[76:79], a[148:151], v[168:171], v[76:79]
 ds_read_b128 a[72:75], v59 offset:2048
 v_mfma_f32_16x16x32_bf16 v[76:79], a[156:159], v[172:175], v[76:79]
 v_mfma_f32_16x16x32_bf16 v[76:79], a[164:167], v[176:179], v[76:79]
 ds_read_b128 a[76:79], v59 offset:3072
 v_mfma_f32_16x16x32_bf16 v[76:79], a[172:175], v[180:183], v[76:79]
 v_mfma_f32_16x16x32_bf16 v[76:79], a[180:183], v[184:187], v[76:79]
 v_mfma_f32_16x16x32_bf16 v[76:79], a[188:191], v[188:191], v[76:79]
 s_waitcnt lgkmcnt(2)
 v_mfma_f32_16x16x32_bf16 v[80:83], a[128:131], v[128:131], 0
 ds_read_b128 v[160:163], v51 offset:0
 v_mfma_f32_16x16x32_bf16 v[80:83], a[136:139], v[132:135], v[80:83]
 ds_read_b128 v[164:167], v51 offset:512
 v_mfma_f32_16x16x32_bf16 v[80:83], a[144:147], v[136:139], v[80:83]
 ds_read_b128 v[168:171], v51 offset:1024
 v_mfma_f32_16x16x32_bf16 v[80:83], a[152:155], v[140:143], v[80:83]
 v_mfma_f32_16x16x32_bf16 v[80:83], a[160:163], v[144:147], v[80:83]
 ds_read_b128 v[172:175], v51 offset:1536
 buffer_store_dwordx4 v[28:31], v214, s[24:27], s45 offen offset:0 sc1
 v_mfma_f32_16x16x32_bf16 v[80:83], a[168:171], v[148:151], v[80:83]
 ds_read_b128 v[176:179], v51 offset:2048
 v_mfma_f32_16x16x32_bf16 v[80:83], a[176:179], v[152:155], v[80:83]
 ds_read_b128 v[180:183], v51 offset:2560
 v_mfma_f32_16x16x32_bf16 v[80:83], a[184:187], v[156:159], v[80:83]
 v_mfma_f32_16x16x32_bf16 v[84:87], a[132:135], v[128:131], 0
 ds_read_b128 v[184:187], v51 offset:3072
 v_mfma_f32_16x16x32_bf16 v[84:87], a[140:143], v[132:135], v[84:87]
 ds_read_b128 v[188:191], v51 offset:3584
 v_mfma_f32_16x16x32_bf16 v[84:87], a[148:151], v[136:139], v[84:87]
 ds_read_b128 a[80:83], v59 offset:4096
 v_mfma_f32_16x16x32_bf16 v[84:87], a[156:159], v[140:143], v[84:87]
 v_mfma_f32_16x16x32_bf16 v[84:87], a[164:167], v[144:147], v[84:87]
 ds_read_b128 a[84:87], v59 offset:5120
 v_mfma_f32_16x16x32_bf16 v[84:87], a[172:175], v[148:151], v[84:87]
 v_mfma_f32_16x16x32_bf16 v[84:87], a[180:183], v[152:155], v[84:87]
 v_mfma_f32_16x16x32_bf16 v[84:87], a[188:191], v[156:159], v[84:87]
 s_waitcnt lgkmcnt(2)
 v_mfma_f32_16x16x32_bf16 v[88:91], a[128:131], v[160:163], 0
 ds_read_b128 v[128:131], v48 offset:4096
 buffer_store_dwordx4 v[32:35], v56, s[24:27], s42 offen offset:512 sc1
 ds_write_b128 v57, v[32:35] offset:512
 v_mfma_f32_16x16x32_bf16 v[88:91], a[136:139], v[164:167], v[88:91]
 ds_read_b128 v[132:135], v48 offset:4608
 v_mfma_f32_16x16x32_bf16 v[88:91], a[144:147], v[168:171], v[88:91]
 ds_read_b128 v[136:139], v48 offset:5120
 v_mfma_f32_16x16x32_bf16 v[88:91], a[152:155], v[172:175], v[88:91]
 v_mfma_f32_16x16x32_bf16 v[88:91], a[160:163], v[176:179], v[88:91]
 ds_read_b128 v[140:143], v48 offset:5632
 v_mfma_f32_16x16x32_bf16 v[88:91], a[168:171], v[180:183], v[88:91]
 ds_read_b128 v[144:147], v48 offset:6144
 v_mfma_f32_16x16x32_bf16 v[88:91], a[176:179], v[184:187], v[88:91]
 ds_read_b128 v[148:151], v48 offset:6656
 v_mfma_f32_16x16x32_bf16 v[88:91], a[184:187], v[188:191], v[88:91]
 v_mfma_f32_16x16x32_bf16 v[92:95], a[132:135], v[160:163], 0
 ds_read_b128 v[152:155], v48 offset:7168
 v_mfma_f32_16x16x32_bf16 v[92:95], a[140:143], v[164:167], v[92:95]
 ds_read_b128 v[156:159], v48 offset:7680
 v_mfma_f32_16x16x32_bf16 v[92:95], a[148:151], v[168:171], v[92:95]
 ds_read_b128 a[88:91], v59 offset:6144
 v_mfma_f32_16x16x32_bf16 v[92:95], a[156:159], v[172:175], v[92:95]
 v_mfma_f32_16x16x32_bf16 v[92:95], a[164:167], v[176:179], v[92:95]
 ds_read_b128 a[92:95], v59 offset:7168
 buffer_store_dwordx4 v[36:39], v214, s[24:27], s43 offen offset:512 sc1
 v_mfma_f32_16x16x32_bf16 v[92:95], a[172:175], v[180:183], v[92:95]
 v_mfma_f32_16x16x32_bf16 v[92:95], a[180:183], v[184:187], v[92:95]
 v_mfma_f32_16x16x32_bf16 v[92:95], a[188:191], v[188:191], v[92:95]
 s_waitcnt vmcnt(22)
 s_waitcnt lgkmcnt(2)
 v_mfma_f32_16x16x32_bf16 v[64:67], a[192:195], v[128:131], v[64:67]
 ds_read_b128 v[160:163], v49 offset:4096
 v_mfma_f32_16x16x32_bf16 v[64:67], a[200:203], v[132:135], v[64:67]
 ds_read_b128 v[164:167], v49 offset:4608
 v_mfma_f32_16x16x32_bf16 v[64:67], a[208:211], v[136:139], v[64:67]
 ds_read_b128 v[168:171], v49 offset:5120
 v_mfma_f32_16x16x32_bf16 v[64:67], a[216:219], v[140:143], v[64:67]
 v_mfma_f32_16x16x32_bf16 v[64:67], a[224:227], v[144:147], v[64:67]
 ds_read_b128 v[172:175], v49 offset:5632
 v_mfma_f32_16x16x32_bf16 v[64:67], a[232:235], v[148:151], v[64:67]
 ds_read_b128 v[176:179], v49 offset:6144
 v_mfma_f32_16x16x32_bf16 v[64:67], a[240:243], v[152:155], v[64:67]
 ds_read_b128 v[180:183], v49 offset:6656
 v_mfma_f32_16x16x32_bf16 v[64:67], a[248:251], v[156:159], v[64:67]
 v_mfma_f32_16x16x32_bf16 v[68:71], a[196:199], v[128:131], v[68:71]
 ds_read_b128 v[184:187], v49 offset:7168
 buffer_store_dwordx4 v[40:43], v214, s[24:27], s44 offen offset:512 sc1
 v_mfma_f32_16x16x32_bf16 v[68:71], a[204:207], v[132:135], v[68:71]
 ds_read_b128 v[188:191], v49 offset:7680
 v_mfma_f32_16x16x32_bf16 v[68:71], a[212:215], v[136:139], v[68:71]
 ds_read_b128 a[96:99], v60 offset:0
 v_mfma_f32_16x16x32_bf16 v[68:71], a[220:223], v[140:143], v[68:71]
 v_mfma_f32_16x16x32_bf16 v[68:71], a[228:231], v[144:147], v[68:71]
 ds_read_b128 a[100:103], v60 offset:1024
 v_mfma_f32_16x16x32_bf16 v[68:71], a[236:239], v[148:151], v[68:71]
 v_mfma_f32_16x16x32_bf16 v[68:71], a[244:247], v[152:155], v[68:71]
 v_mfma_f32_16x16x32_bf16 v[68:71], a[252:255], v[156:159], v[68:71]
 s_waitcnt lgkmcnt(2)
 v_mfma_f32_16x16x32_bf16 v[72:75], a[192:195], v[160:163], v[72:75]
 ds_read_b128 v[128:131], v50 offset:4096
 v_mfma_f32_16x16x32_bf16 v[72:75], a[200:203], v[164:167], v[72:75]
 ds_read_b128 v[132:135], v50 offset:4608
 v_mfma_f32_16x16x32_bf16 v[72:75], a[208:211], v[168:171], v[72:75]
 ds_read_b128 v[136:139], v50 offset:5120
 v_mfma_f32_16x16x32_bf16 v[72:75], a[216:219], v[172:175], v[72:75]
 v_mfma_f32_16x16x32_bf16 v[72:75], a[224:227], v[176:179], v[72:75]
 ds_read_b128 v[140:143], v50 offset:5632
 buffer_store_dwordx4 v[44:47], v214, s[24:27], s45 offen offset:512 sc1
 v_mfma_f32_16x16x32_bf16 v[72:75], a[232:235], v[180:183], v[72:75]
 ds_read_b128 v[144:147], v50 offset:6144
 v_mfma_f32_16x16x32_bf16 v[72:75], a[240:243], v[184:187], v[72:75]
 ds_read_b128 v[148:151], v50 offset:6656
 v_mfma_f32_16x16x32_bf16 v[72:75], a[248:251], v[188:191], v[72:75]
 v_mfma_f32_16x16x32_bf16 v[76:79], a[196:199], v[160:163], v[76:79]
 ds_read_b128 v[152:155], v50 offset:7168
 v_cvt_pk_bf16_f32 v224, v64, v65
 v_mfma_f32_16x16x32_bf16 v[76:79], a[204:207], v[164:167], v[76:79]
 ds_read_b128 v[156:159], v50 offset:7680
 v_cvt_pk_bf16_f32 v225, v66, v67
 v_mfma_f32_16x16x32_bf16 v[76:79], a[212:215], v[168:171], v[76:79]
 ds_read_b128 a[104:107], v60 offset:2048
 v_cvt_pk_bf16_f32 v226, v68, v69
 v_mfma_f32_16x16x32_bf16 v[76:79], a[220:223], v[172:175], v[76:79]
 v_mfma_f32_16x16x32_bf16 v[76:79], a[228:231], v[176:179], v[76:79]
 ds_read_b128 a[108:111], v60 offset:3072
 v_cvt_pk_bf16_f32 v227, v70, v71
 v_mfma_f32_16x16x32_bf16 v[76:79], a[236:239], v[180:183], v[76:79]
 buffer_store_dwordx4 v[224:227], v56, s[24:27], s42 offen offset:1024 sc1
 ds_write_b128 v57, v[224:227] offset:1024
 v_mfma_f32_16x16x32_bf16 v[76:79], a[244:247], v[184:187], v[76:79]
 v_mfma_f32_16x16x32_bf16 v[76:79], a[252:255], v[188:191], v[76:79]
 s_waitcnt lgkmcnt(3)
 v_mfma_f32_16x16x32_bf16 v[80:83], a[192:195], v[128:131], v[80:83]
 ds_read_b128 v[160:163], v51 offset:4096
 v_mfma_f32_16x16x32_bf16 v[80:83], a[200:203], v[132:135], v[80:83]
 ds_read_b128 v[164:167], v51 offset:4608
 v_mfma_f32_16x16x32_bf16 v[80:83], a[208:211], v[136:139], v[80:83]
 ds_read_b128 v[168:171], v51 offset:5120
 v_mfma_f32_16x16x32_bf16 v[80:83], a[216:219], v[140:143], v[80:83]
 v_mfma_f32_16x16x32_bf16 v[80:83], a[224:227], v[144:147], v[80:83]
 ds_read_b128 v[172:175], v51 offset:5632
 v_mfma_f32_16x16x32_bf16 v[80:83], a[232:235], v[148:151], v[80:83]
 ds_read_b128 v[176:179], v51 offset:6144
 v_mfma_f32_16x16x32_bf16 v[80:83], a[240:243], v[152:155], v[80:83]
 ds_read_b128 v[180:183], v51 offset:6656
 v_mfma_f32_16x16x32_bf16 v[80:83], a[248:251], v[156:159], v[80:83]
 v_mfma_f32_16x16x32_bf16 v[84:87], a[196:199], v[128:131], v[84:87]
 ds_read_b128 v[184:187], v51 offset:7168
 v_cvt_pk_bf16_f32 v228, v72, v73
 v_mfma_f32_16x16x32_bf16 v[84:87], a[204:207], v[132:135], v[84:87]
 ds_read_b128 v[188:191], v51 offset:7680
 v_cvt_pk_bf16_f32 v229, v74, v75
 v_mfma_f32_16x16x32_bf16 v[84:87], a[212:215], v[136:139], v[84:87]
 ds_read_b128 a[112:115], v60 offset:4096
 v_cvt_pk_bf16_f32 v230, v76, v77
 v_mfma_f32_16x16x32_bf16 v[84:87], a[220:223], v[140:143], v[84:87]
 v_mfma_f32_16x16x32_bf16 v[84:87], a[228:231], v[144:147], v[84:87]
 ds_read_b128 a[116:119], v60 offset:5120
 v_cvt_pk_bf16_f32 v231, v78, v79
 v_mfma_f32_16x16x32_bf16 v[84:87], a[236:239], v[148:151], v[84:87]
 buffer_store_dwordx4 v[228:231], v214, s[24:27], s43 offen offset:1024 sc1
 v_mfma_f32_16x16x32_bf16 v[84:87], a[244:247], v[152:155], v[84:87]
 v_mfma_f32_16x16x32_bf16 v[84:87], a[252:255], v[156:159], v[84:87]
 s_waitcnt lgkmcnt(2)
 v_mfma_f32_16x16x32_bf16 v[88:91], a[192:195], v[160:163], v[88:91]
 ds_read_b128 v[128:131], v48 offset:0
 v_mfma_f32_16x16x32_bf16 v[88:91], a[200:203], v[164:167], v[88:91]
 ds_read_b128 v[132:135], v48 offset:512
 v_mfma_f32_16x16x32_bf16 v[88:91], a[208:211], v[168:171], v[88:91]
 ds_read_b128 v[136:139], v48 offset:1024
 v_mfma_f32_16x16x32_bf16 v[88:91], a[216:219], v[172:175], v[88:91]
 v_mfma_f32_16x16x32_bf16 v[88:91], a[224:227], v[176:179], v[88:91]
 ds_read_b128 v[140:143], v48 offset:1536
 v_mfma_f32_16x16x32_bf16 v[88:91], a[232:235], v[180:183], v[88:91]
 ds_read_b128 v[144:147], v48 offset:2048
 v_mfma_f32_16x16x32_bf16 v[88:91], a[240:243], v[184:187], v[88:91]
 ds_read_b128 v[148:151], v48 offset:2560
 v_mfma_f32_16x16x32_bf16 v[88:91], a[248:251], v[188:191], v[88:91]
 v_mfma_f32_16x16x32_bf16 v[92:95], a[196:199], v[160:163], v[92:95]
 ds_read_b128 v[152:155], v48 offset:3072
 v_cvt_pk_bf16_f32 v224, v80, v81
 v_mfma_f32_16x16x32_bf16 v[92:95], a[204:207], v[164:167], v[92:95]
 ds_read_b128 v[156:159], v48 offset:3584
 v_cvt_pk_bf16_f32 v225, v82, v83
 v_mfma_f32_16x16x32_bf16 v[92:95], a[212:215], v[168:171], v[92:95]
 ds_read_b128 a[120:123], v60 offset:6144
 v_cvt_pk_bf16_f32 v226, v84, v85
 v_mfma_f32_16x16x32_bf16 v[92:95], a[220:223], v[172:175], v[92:95]
 v_mfma_f32_16x16x32_bf16 v[92:95], a[228:231], v[176:179], v[92:95]
 ds_read_b128 a[124:127], v60 offset:7168
 v_cvt_pk_bf16_f32 v227, v86, v87
 v_mfma_f32_16x16x32_bf16 v[92:95], a[236:239], v[180:183], v[92:95]
 buffer_store_dwordx4 v[224:227], v214, s[24:27], s44 offen offset:1024 sc1
 v_mfma_f32_16x16x32_bf16 v[92:95], a[244:247], v[184:187], v[92:95]
 v_mfma_f32_16x16x32_bf16 v[92:95], a[252:255], v[188:191], v[92:95]
 s_waitcnt vmcnt(11)
 s_waitcnt lgkmcnt(2)
 v_mfma_f32_16x16x32_bf16 v[96:99], a[0:3], v[128:131], 0
 ds_read_b128 v[160:163], v49 offset:0
 v_mfma_f32_16x16x32_bf16 v[96:99], a[8:11], v[132:135], v[96:99]
 ds_read_b128 v[164:167], v49 offset:512
 v_mfma_f32_16x16x32_bf16 v[96:99], a[16:19], v[136:139], v[96:99]
 ds_read_b128 v[168:171], v49 offset:1024
 v_mfma_f32_16x16x32_bf16 v[96:99], a[24:27], v[140:143], v[96:99]
 v_mfma_f32_16x16x32_bf16 v[96:99], a[32:35], v[144:147], v[96:99]
 ds_read_b128 v[172:175], v49 offset:1536
 v_mfma_f32_16x16x32_bf16 v[96:99], a[40:43], v[148:151], v[96:99]
 ds_read_b128 v[176:179], v49 offset:2048
 v_mfma_f32_16x16x32_bf16 v[96:99], a[48:51], v[152:155], v[96:99]
 ds_read_b128 v[180:183], v49 offset:2560
 v_mfma_f32_16x16x32_bf16 v[96:99], a[56:59], v[156:159], v[96:99]
 v_mfma_f32_16x16x32_bf16 v[100:103], a[4:7], v[128:131], 0
 ds_read_b128 v[184:187], v49 offset:3072
 v_cvt_pk_bf16_f32 v228, v88, v89
 v_mfma_f32_16x16x32_bf16 v[100:103], a[12:15], v[132:135], v[100:103]
 ds_read_b128 v[188:191], v49 offset:3584
 v_cvt_pk_bf16_f32 v229, v90, v91
 v_mfma_f32_16x16x32_bf16 v[100:103], a[20:23], v[136:139], v[100:103]
 v_cvt_pk_bf16_f32 v230, v92, v93
 v_mfma_f32_16x16x32_bf16 v[100:103], a[28:31], v[140:143], v[100:103]
 v_mfma_f32_16x16x32_bf16 v[100:103], a[36:39], v[144:147], v[100:103]
 v_cvt_pk_bf16_f32 v231, v94, v95
 v_mfma_f32_16x16x32_bf16 v[100:103], a[44:47], v[148:151], v[100:103]
 buffer_store_dwordx4 v[228:231], v214, s[24:27], s45 offen offset:1024 sc1
 v_mfma_f32_16x16x32_bf16 v[100:103], a[52:55], v[152:155], v[100:103]
 v_mfma_f32_16x16x32_bf16 v[100:103], a[60:63], v[156:159], v[100:103]
 s_waitcnt lgkmcnt(0)
 v_mfma_f32_16x16x32_bf16 v[104:107], a[0:3], v[160:163], 0
 ds_read_b128 v[128:131], v50 offset:0
 buffer_load_dwordx4 v[192:195], v241, s[24:27], s47 offen offset:0 sc0 sc1
 v_mfma_f32_16x16x32_bf16 v[104:107], a[8:11], v[164:167], v[104:107]
 ds_read_b128 v[132:135], v50 offset:512
 buffer_load_dwordx4 v[196:199], v241, s[24:27], s47 offen offset:16 sc0 sc1
 v_mfma_f32_16x16x32_bf16 v[104:107], a[16:19], v[168:171], v[104:107]
 ds_read_b128 v[136:139], v50 offset:1024
 buffer_load_dwordx2 v[224:225], v14, s[4:7], s46 offen offset:0
 v_mfma_f32_16x16x32_bf16 v[104:107], a[24:27], v[172:175], v[104:107]
 v_mfma_f32_16x16x32_bf16 v[104:107], a[32:35], v[176:179], v[104:107]
 ds_read_b128 v[140:143], v50 offset:1536
 buffer_load_dwordx2 v[226:227], v14, s[4:7], s46 offen offset:32
 v_mfma_f32_16x16x32_bf16 v[104:107], a[40:43], v[180:183], v[104:107]
 ds_read_b128 v[144:147], v50 offset:2048
 buffer_load_dwordx2 v[228:229], v14, s[4:7], s46 offen offset:128
 v_mfma_f32_16x16x32_bf16 v[104:107], a[48:51], v[184:187], v[104:107]
 ds_read_b128 v[148:151], v50 offset:2560
 buffer_load_dwordx2 v[230:231], v14, s[4:7], s46 offen offset:160
 v_mfma_f32_16x16x32_bf16 v[104:107], a[56:59], v[188:191], v[104:107]
 v_mfma_f32_16x16x32_bf16 v[108:111], a[4:7], v[160:163], 0
 ds_read_b128 v[152:155], v50 offset:3072
 v_mfma_f32_16x16x32_bf16 v[108:111], a[12:15], v[164:167], v[108:111]
 ds_read_b128 v[156:159], v50 offset:3584
 v_mfma_f32_16x16x32_bf16 v[108:111], a[20:23], v[168:171], v[108:111]
 v_mfma_f32_16x16x32_bf16 v[108:111], a[28:31], v[172:175], v[108:111]
 v_mfma_f32_16x16x32_bf16 v[108:111], a[36:39], v[176:179], v[108:111]
 v_mfma_f32_16x16x32_bf16 v[108:111], a[44:47], v[180:183], v[108:111]
 v_mfma_f32_16x16x32_bf16 v[108:111], a[52:55], v[184:187], v[108:111]
 v_mfma_f32_16x16x32_bf16 v[108:111], a[60:63], v[188:191], v[108:111]
 s_waitcnt lgkmcnt(0)
 v_mfma_f32_16x16x32_bf16 v[112:115], a[0:3], v[128:131], 0
 ds_read_b128 v[160:163], v51 offset:0
 v_mfma_f32_16x16x32_bf16 v[112:115], a[8:11], v[132:135], v[112:115]
 ds_read_b128 v[164:167], v51 offset:512
 v_mfma_f32_16x16x32_bf16 v[112:115], a[16:19], v[136:139], v[112:115]
 ds_read_b128 v[168:171], v51 offset:1024
 v_mfma_f32_16x16x32_bf16 v[112:115], a[24:27], v[140:143], v[112:115]
 v_mfma_f32_16x16x32_bf16 v[112:115], a[32:35], v[144:147], v[112:115]
 ds_read_b128 v[172:175], v51 offset:1536
 v_mfma_f32_16x16x32_bf16 v[112:115], a[40:43], v[148:151], v[112:115]
 ds_read_b128 v[176:179], v51 offset:2048
 v_mfma_f32_16x16x32_bf16 v[112:115], a[48:51], v[152:155], v[112:115]
 ds_read_b128 v[180:183], v51 offset:2560
 v_mfma_f32_16x16x32_bf16 v[112:115], a[56:59], v[156:159], v[112:115]
 v_mfma_f32_16x16x32_bf16 v[116:119], a[4:7], v[128:131], 0
 ds_read_b128 v[184:187], v51 offset:3072
 v_mfma_f32_16x16x32_bf16 v[116:119], a[12:15], v[132:135], v[116:119]
 ds_read_b128 v[188:191], v51 offset:3584
 v_mfma_f32_16x16x32_bf16 v[116:119], a[20:23], v[136:139], v[116:119]
 v_mfma_f32_16x16x32_bf16 v[116:119], a[28:31], v[140:143], v[116:119]
 v_mfma_f32_16x16x32_bf16 v[116:119], a[36:39], v[144:147], v[116:119]
 v_mfma_f32_16x16x32_bf16 v[116:119], a[44:47], v[148:151], v[116:119]
 v_mfma_f32_16x16x32_bf16 v[116:119], a[52:55], v[152:155], v[116:119]
 v_mfma_f32_16x16x32_bf16 v[116:119], a[60:63], v[156:159], v[116:119]
 s_waitcnt lgkmcnt(0)
 v_mfma_f32_16x16x32_bf16 v[120:123], a[0:3], v[160:163], 0
 ds_read_b128 v[128:131], v48 offset:4096
 v_mfma_f32_16x16x32_bf16 v[120:123], a[8:11], v[164:167], v[120:123]
 ds_read_b128 v[132:135], v48 offset:4608
 v_mfma_f32_16x16x32_bf16 v[120:123], a[16:19], v[168:171], v[120:123]
 ds_read_b128 v[136:139], v48 offset:5120
 v_mfma_f32_16x16x32_bf16 v[120:123], a[24:27], v[172:175], v[120:123]
 v_mfma_f32_16x16x32_bf16 v[120:123], a[32:35], v[176:179], v[120:123]
 ds_read_b128 v[140:143], v48 offset:5632
 v_mfma_f32_16x16x32_bf16 v[120:123], a[40:43], v[180:183], v[120:123]
 ds_read_b128 v[144:147], v48 offset:6144
 v_mfma_f32_16x16x32_bf16 v[120:123], a[48:51], v[184:187], v[120:123]
 ds_read_b128 v[148:151], v48 offset:6656
 v_mfma_f32_16x16x32_bf16 v[120:123], a[56:59], v[188:191], v[120:123]
 v_mfma_f32_16x16x32_bf16 v[124:127], a[4:7], v[160:163], 0
 ds_read_b128 v[152:155], v48 offset:7168
 v_mfma_f32_16x16x32_bf16 v[124:127], a[12:15], v[164:167], v[124:127]
 ds_read_b128 v[156:159], v48 offset:7680
 v_mfma_f32_16x16x32_bf16 v[124:127], a[20:23], v[168:171], v[124:127]
 v_mfma_f32_16x16x32_bf16 v[124:127], a[28:31], v[172:175], v[124:127]
 v_mfma_f32_16x16x32_bf16 v[124:127], a[36:39], v[176:179], v[124:127]
 v_mfma_f32_16x16x32_bf16 v[124:127], a[44:47], v[180:183], v[124:127]
 v_mfma_f32_16x16x32_bf16 v[124:127], a[52:55], v[184:187], v[124:127]
 v_mfma_f32_16x16x32_bf16 v[124:127], a[60:63], v[188:191], v[124:127]
 s_waitcnt lgkmcnt(0)
 v_mfma_f32_16x16x32_bf16 v[96:99], a[64:67], v[128:131], v[96:99]
 ds_read_b128 v[160:163], v49 offset:4096
 v_mfma_f32_16x16x32_bf16 v[96:99], a[72:75], v[132:135], v[96:99]
 ds_read_b128 v[164:167], v49 offset:4608
 v_mfma_f32_16x16x32_bf16 v[96:99], a[80:83], v[136:139], v[96:99]
 ds_read_b128 v[168:171], v49 offset:5120
 v_mfma_f32_16x16x32_bf16 v[96:99], a[88:91], v[140:143], v[96:99]
 v_mfma_f32_16x16x32_bf16 v[96:99], a[96:99], v[144:147], v[96:99]
 ds_read_b128 v[172:175], v49 offset:5632
 v_mfma_f32_16x16x32_bf16 v[96:99], a[104:107], v[148:151], v[96:99]
 ds_read_b128 v[176:179], v49 offset:6144
 v_mfma_f32_16x16x32_bf16 v[96:99], a[112:115], v[152:155], v[96:99]
 ds_read_b128 v[180:183], v49 offset:6656
 v_mfma_f32_16x16x32_bf16 v[96:99], a[120:123], v[156:159], v[96:99]
 v_mfma_f32_16x16x32_bf16 v[100:103], a[68:71], v[128:131], v[100:103]
 ds_read_b128 v[184:187], v49 offset:7168
 v_mfma_f32_16x16x32_bf16 v[100:103], a[76:79], v[132:135], v[100:103]
 ds_read_b128 v[188:191], v49 offset:7680
 v_mfma_f32_16x16x32_bf16 v[100:103], a[84:87], v[136:139], v[100:103]
 v_mfma_f32_16x16x32_bf16 v[100:103], a[92:95], v[140:143], v[100:103]
 v_mfma_f32_16x16x32_bf16 v[100:103], a[100:103], v[144:147], v[100:103]
 v_mfma_f32_16x16x32_bf16 v[100:103], a[108:111], v[148:151], v[100:103]
 v_mfma_f32_16x16x32_bf16 v[100:103], a[116:119], v[152:155], v[100:103]
 v_mfma_f32_16x16x32_bf16 v[100:103], a[124:127], v[156:159], v[100:103]
 s_waitcnt lgkmcnt(0)
 v_mfma_f32_16x16x32_bf16 v[104:107], a[64:67], v[160:163], v[104:107]
 ds_read_b128 v[128:131], v50 offset:4096
 v_mfma_f32_16x16x32_bf16 v[104:107], a[72:75], v[164:167], v[104:107]
 ds_read_b128 v[132:135], v50 offset:4608
 v_mfma_f32_16x16x32_bf16 v[104:107], a[80:83], v[168:171], v[104:107]
 ds_read_b128 v[136:139], v50 offset:5120
 v_mfma_f32_16x16x32_bf16 v[104:107], a[88:91], v[172:175], v[104:107]
 v_mfma_f32_16x16x32_bf16 v[104:107], a[96:99], v[176:179], v[104:107]
 ds_read_b128 v[140:143], v50 offset:5632
 v_mfma_f32_16x16x32_bf16 v[104:107], a[104:107], v[180:183], v[104:107]
 ds_read_b128 v[144:147], v50 offset:6144
 v_mfma_f32_16x16x32_bf16 v[104:107], a[112:115], v[184:187], v[104:107]
 ds_read_b128 v[148:151], v50 offset:6656
 v_mfma_f32_16x16x32_bf16 v[104:107], a[120:123], v[188:191], v[104:107]
 v_mfma_f32_16x16x32_bf16 v[108:111], a[68:71], v[160:163], v[108:111]
 ds_read_b128 v[152:155], v50 offset:7168
 v_cvt_pk_bf16_f32 v232, v96, v97
 v_mfma_f32_16x16x32_bf16 v[108:111], a[76:79], v[164:167], v[108:111]
 ds_read_b128 v[156:159], v50 offset:7680
 v_cvt_pk_bf16_f32 v233, v98, v99
 v_mfma_f32_16x16x32_bf16 v[108:111], a[84:87], v[168:171], v[108:111]
 v_cvt_pk_bf16_f32 v234, v100, v101
 v_mfma_f32_16x16x32_bf16 v[108:111], a[92:95], v[172:175], v[108:111]
 v_mfma_f32_16x16x32_bf16 v[108:111], a[100:103], v[176:179], v[108:111]
 v_cvt_pk_bf16_f32 v235, v102, v103
 v_mfma_f32_16x16x32_bf16 v[108:111], a[108:111], v[180:183], v[108:111]
 buffer_store_dwordx4 v[232:235], v56, s[24:27], s42 offen offset:1536 sc1
 ds_write_b128 v57, v[232:235] offset:1536
 v_mfma_f32_16x16x32_bf16 v[108:111], a[116:119], v[184:187], v[108:111]
 v_mfma_f32_16x16x32_bf16 v[108:111], a[124:127], v[188:191], v[108:111]
 s_waitcnt lgkmcnt(1)
 v_mfma_f32_16x16x32_bf16 v[112:115], a[64:67], v[128:131], v[112:115]
 ds_read_b128 v[160:163], v51 offset:4096
 v_mfma_f32_16x16x32_bf16 v[112:115], a[72:75], v[132:135], v[112:115]
 ds_read_b128 v[164:167], v51 offset:4608
 v_mfma_f32_16x16x32_bf16 v[112:115], a[80:83], v[136:139], v[112:115]
 ds_read_b128 v[168:171], v51 offset:5120
 v_mfma_f32_16x16x32_bf16 v[112:115], a[88:91], v[140:143], v[112:115]
 v_mfma_f32_16x16x32_bf16 v[112:115], a[96:99], v[144:147], v[112:115]
 ds_read_b128 v[172:175], v51 offset:5632
 v_mfma_f32_16x16x32_bf16 v[112:115], a[104:107], v[148:151], v[112:115]
 ds_read_b128 v[176:179], v51 offset:6144
 v_mfma_f32_16x16x32_bf16 v[112:115], a[112:115], v[152:155], v[112:115]
 ds_read_b128 v[180:183], v51 offset:6656
 v_mfma_f32_16x16x32_bf16 v[112:115], a[120:123], v[156:159], v[112:115]
 v_mfma_f32_16x16x32_bf16 v[116:119], a[68:71], v[128:131], v[116:119]
 ds_read_b128 v[184:187], v51 offset:7168
 v_cvt_pk_bf16_f32 v236, v104, v105
 v_mfma_f32_16x16x32_bf16 v[116:119], a[76:79], v[132:135], v[116:119]
 ds_read_b128 v[188:191], v51 offset:7680
 v_cvt_pk_bf16_f32 v237, v106, v107
 v_mfma_f32_16x16x32_bf16 v[116:119], a[84:87], v[136:139], v[116:119]
 v_cvt_pk_bf16_f32 v238, v108, v109
 v_mfma_f32_16x16x32_bf16 v[116:119], a[92:95], v[140:143], v[116:119]
 v_mfma_f32_16x16x32_bf16 v[116:119], a[100:103], v[144:147], v[116:119]
 v_cvt_pk_bf16_f32 v239, v110, v111
 v_mfma_f32_16x16x32_bf16 v[116:119], a[108:111], v[148:151], v[116:119]
 buffer_store_dwordx4 v[236:239], v214, s[24:27], s43 offen offset:1536 sc1
 v_mfma_f32_16x16x32_bf16 v[116:119], a[116:119], v[152:155], v[116:119]
 v_mfma_f32_16x16x32_bf16 v[116:119], a[124:127], v[156:159], v[116:119]
 s_waitcnt lgkmcnt(0)
 v_mfma_f32_16x16x32_bf16 v[120:123], a[64:67], v[160:163], v[120:123]
 v_mfma_f32_16x16x32_bf16 v[120:123], a[72:75], v[164:167], v[120:123]
 v_mfma_f32_16x16x32_bf16 v[120:123], a[80:83], v[168:171], v[120:123]
 v_mfma_f32_16x16x32_bf16 v[120:123], a[88:91], v[172:175], v[120:123]
 v_mfma_f32_16x16x32_bf16 v[120:123], a[96:99], v[176:179], v[120:123]
 v_mfma_f32_16x16x32_bf16 v[120:123], a[104:107], v[180:183], v[120:123]
 v_mfma_f32_16x16x32_bf16 v[120:123], a[112:115], v[184:187], v[120:123]
 v_mfma_f32_16x16x32_bf16 v[120:123], a[120:123], v[188:191], v[120:123]
 v_mfma_f32_16x16x32_bf16 v[124:127], a[68:71], v[160:163], v[124:127]
 v_cvt_pk_bf16_f32 v232, v112, v113
 v_mfma_f32_16x16x32_bf16 v[124:127], a[76:79], v[164:167], v[124:127]
 v_cvt_pk_bf16_f32 v233, v114, v115
 v_mfma_f32_16x16x32_bf16 v[124:127], a[84:87], v[168:171], v[124:127]
 v_cvt_pk_bf16_f32 v234, v116, v117
 v_mfma_f32_16x16x32_bf16 v[124:127], a[92:95], v[172:175], v[124:127]
 v_mfma_f32_16x16x32_bf16 v[124:127], a[100:103], v[176:179], v[124:127]
 v_cvt_pk_bf16_f32 v235, v118, v119
 v_mfma_f32_16x16x32_bf16 v[124:127], a[108:111], v[180:183], v[124:127]
 buffer_store_dwordx4 v[232:235], v214, s[24:27], s44 offen offset:1536 sc1
 v_mfma_f32_16x16x32_bf16 v[124:127], a[116:119], v[184:187], v[124:127]
 v_mfma_f32_16x16x32_bf16 v[124:127], a[124:127], v[188:191], v[124:127]
 s_nop 5
 v_cvt_pk_bf16_f32 v236, v120, v121
 v_cvt_pk_bf16_f32 v237, v122, v123
 v_cvt_pk_bf16_f32 v238, v124, v125
 v_cvt_pk_bf16_f32 v239, v126, v127
 buffer_store_dwordx4 v[236:239], v214, s[24:27], s45 offen offset:1536 sc1
 s_waitcnt vmcnt(4)
 v_lshlrev_b32 v16, 16, v224
 v_and_b32 v17, 0xffff0000, v224
 v_lshlrev_b32 v18, 16, v225
 v_and_b32 v19, 0xffff0000, v225
 v_lshlrev_b32 v20, 16, v226
 v_and_b32 v21, 0xffff0000, v226
 v_lshlrev_b32 v22, 16, v227
 v_and_b32 v23, 0xffff0000, v227
 v_lshlrev_b32 v24, 16, v228
 v_and_b32 v25, 0xffff0000, v228
 v_lshlrev_b32 v26, 16, v229
 v_and_b32 v27, 0xffff0000, v229
 v_lshlrev_b32 v28, 16, v230
 v_and_b32 v29, 0xffff0000, v230
 v_lshlrev_b32 v30, 16, v231
 v_and_b32 v31, 0xffff0000, v231
 s_mov_b32 s38, 0x100000
L_lm:
 v_xor_b32 v217, s94, v193
 v_xor_b32 v218, s94, v195
 v_or_b32 v216, v217, v218
 v_xor_b32 v217, s94, v197
 v_xor_b32 v218, s94, v199
 v_or3_b32 v216, v216, v217, v218
 v_cmp_ne_u32 vcc, 0, v216
 s_cbranch_vccz L_lmx
 s_sub_u32 s38, s38, 1
 s_cbranch_scc1 L_lmx
  s_mov_b32 s43, 16384
  buffer_load_dwordx4 v[192:195], v241, s[24:27], s43 offen offset:0 sc0 sc1
  buffer_load_dwordx4 v[196:199], v241, s[24:27], s43 offen offset:16 sc0 sc1
  s_waitcnt vmcnt(0)
 s_branch L_lm
L_lmx:
 v_lshlrev_b32 v216, 16, v192
 v_and_b32 v217, 0xffff0000, v192
 v_lshlrev_b32 v218, 16, v194
 v_and_b32 v219, 0xffff0000, v194
 v_lshlrev_b32 v220, 16, v196
 v_and_b32 v221, 0xffff0000, v196
 v_lshlrev_b32 v222, 16, v198
 v_and_b32 v223, 0xffff0000, v198
 v_add_u32 v241, 69632, v241
 v_add_u32 v240, 69632, v240
 s_cmp_lg_u32 s3, 3
 s_cbranch_scc1 L_w3c
  s_mov_b32 s55, 212992
  buffer_load_dwordx4 a[128:131], v252, s[20:23], s55 offen offset:0 sc1
  buffer_load_dwordx4 a[132:135], v252, s[20:23], s55 offen offset:1024 sc1
  buffer_load_dwordx4 a[144:147], v252, s[20:23], s55 offen offset:2048 sc1
  buffer_load_dwordx4 a[148:151], v252, s[20:23], s55 offen offset:3072 sc1
  s_mov_b32 s54, 217088
  buffer_load_dwordx4 a[160:163], v252, s[20:23], s54 offen offset:0 sc1
  buffer_load_dwordx4 a[164:167], v252, s[20:23], s54 offen offset:1024 sc1
  buffer_load_dwordx4 a[176:179], v252, s[20:23], s54 offen offset:2048 sc1
  buffer_load_dwordx4 a[180:183], v252, s[20:23], s54 offen offset:3072 sc1
  s_mov_b32 s55, 221184
  buffer_load_dwordx4 a[192:195], v252, s[20:23], s55 offen offset:0 sc1
  buffer_load_dwordx4 a[196:199], v252, s[20:23], s55 offen offset:1024 sc1
  buffer_load_dwordx4 a[208:211], v252, s[20:23], s55 offen offset:2048 sc1
  buffer_load_dwordx4 a[212:215], v252, s[20:23], s55 offen offset:3072 sc1
  s_mov_b32 s54, 225280
  buffer_load_dwordx4 a[224:227], v252, s[20:23], s54 offen offset:0 sc1
  buffer_load_dwordx4 a[228:231], v252, s[20:23], s54 offen offset:1024 sc1
  buffer_load_dwordx4 a[240:243], v252, s[20:23], s54 offen offset:2048 sc1
  buffer_load_dwordx4 a[244:247], v252, s[20:23], s54 offen offset:3072 sc1
  s_mov_b32 s55, 196608
  buffer_load_dwordx4 a[0:3], v252, s[20:23], s55 offen offset:0 sc1
  buffer_load_dwordx4 a[4:7], v252, s[20:23], s55 offen offset:1024 sc1
  buffer_load_dwordx4 a[16:19], v252, s[20:23], s55 offen offset:2048 sc1
  buffer_load_dwordx4 a[20:23], v252, s[20:23], s55 offen offset:3072 sc1
  s_mov_b32 s54, 200704
  buffer_load_dwordx4 a[32:35], v252, s[20:23], s54 offen offset:0 sc1
  buffer_load_dwordx4 a[36:39], v252, s[20:23], s54 offen offset:1024 sc1
  buffer_load_dwordx4 a[48:51], v252, s[20:23], s54 offen offset:2048 sc1
  buffer_load_dwordx4 a[52:55], v252, s[20:23], s54 offen offset:3072 sc1
  s_mov_b32 s55, 204800
  buffer_load_dwordx4 a[64:67], v252, s[20:23], s55 offen offset:0 sc1
  buffer_load_dwordx4 a[68:71], v252, s[20:23], s55 offen offset:1024 sc1
  buffer_load_dwordx4 a[80:83], v252, s[20:23], s55 offen offset:2048 sc1
  buffer_load_dwordx4 a[84:87], v252, s[20:23], s55 offen offset:3072 sc1
  s_mov_b32 s54, 208896
  buffer_load_dwordx4 a[96:99], v252, s[20:23], s54 offen offset:0 sc1
  buffer_load_dwordx4 a[100:103], v252, s[20:23], s54 offen offset:1024 sc1
  buffer_load_dwordx4 a[112:115], v252, s[20:23], s54 offen offset:2048 sc1
  buffer_load_dwordx4 a[116:119], v252, s[20:23], s54 offen offset:3072 sc1
  s_waitcnt vmcnt(32) lgkmcnt(0)
  s_branch L_w3d
L_w3c:
 s_waitcnt vmcnt(0)
L_w3d:
 s_barrier
 s_cmp_lg_u32 s3, 0
 s_cbranch_scc1 L_nosig0
  buffer_store_dword v212, v210, s[24:27], 0 offen offset:0 sc1
L_nosig0:
 ds_write_b128 v241, v[216:219]
 ds_write_b128 v241, v[220:223] offset:16
 s_waitcnt lgkmcnt(0)
 s_cmp_eq_u32 s3, 3
 s_cbranch_scc1 L_pollw0
  s_mov_b32 s55, 212992
  buffer_load_dwordx4 a[128:131], v252, s[20:23], s55 offen offset:0 sc1
  buffer_load_dwordx4 a[132:135], v252, s[20:23], s55 offen offset:1024 sc1
  buffer_load_dwordx4 a[144:147], v252, s[20:23], s55 offen offset:2048 sc1
  buffer_load_dwordx4 a[148:151], v252, s[20:23], s55 offen offset:3072 sc1
  s_mov_b32 s54, 217088
  buffer_load_dwordx4 a[160:163], v252, s[20:23], s54 offen offset:0 sc1
  buffer_load_dwordx4 a[164:167], v252, s[20:23], s54 offen offset:1024 sc1
  buffer_load_dwordx4 a[176:179], v252, s[20:23], s54 offen offset:2048 sc1
  buffer_load_dwordx4 a[180:183], v252, s[20:23], s54 offen offset:3072 sc1
  s_mov_b32 s55, 221184
  buffer_load_dwordx4 a[192:195], v252, s[20:23], s55 offen offset:0 sc1
  buffer_load_dwordx4 a[196:199], v252, s[20:23], s55 offen offset:1024 sc1
  buffer_load_dwordx4 a[208:211], v252, s[20:23], s55 offen offset:2048 sc1
  buffer_load_dwordx4 a[212:215], v252, s[20:23], s55 offen offset:3072 sc1
  s_mov_b32 s54, 225280
  buffer_load_dwordx4 a[224:227], v252, s[20:23], s54 offen offset:0 sc1
  buffer_load_dwordx4 a[228:231], v252, s[20:23], s54 offen offset:1024 sc1
  buffer_load_dwordx4 a[240:243], v252, s[20:23], s54 offen offset:2048 sc1
  buffer_load_dwordx4 a[244:247], v252, s[20:23], s54 offen offset:3072 sc1
  s_mov_b32 s55, 245760
  buffer_load_dwordx4 a[136:139], v252, s[20:23], s55 offen offset:0 sc1
  buffer_load_dwordx4 a[140:143], v252, s[20:23], s55 offen offset:1024 sc1
  buffer_load_dwordx4 a[152:155], v252, s[20:23], s55 offen offset:2048 sc1
  buffer_load_dwordx4 a[156:159], v252, s[20:23], s55 offen offset:3072 sc1
  s_mov_b32 s54, 249856
  buffer_load_dwordx4 a[168:171], v252, s[20:23], s54 offen offset:0 sc1
  buffer_load_dwordx4 a[172:175], v252, s[20:23], s54 offen offset:1024 sc1
  buffer_load_dwordx4 a[184:187], v252, s[20:23], s54 offen offset:2048 sc1
  buffer_load_dwordx4 a[188:191], v252, s[20:23], s54 offen offset:3072 sc1
  s_mov_b32 s55, 253952
  buffer_load_dwordx4 a[200:203], v252, s[20:23], s55 offen offset:0 sc1
  buffer_load_dwordx4 a[204:207], v252, s[20:23], s55 offen offset:1024 sc1
  buffer_load_dwordx4 a[216:219], v252, s[20:23], s55 offen offset:2048 sc1
  buffer_load_dwordx4 a[220:223], v252, s[20:23], s55 offen offset:3072 sc1
  s_mov_b32 s54, 258048
  buffer_load_dwordx4 a[232:235], v252, s[20:23], s54 offen offset:0 sc1
  buffer_load_dwordx4 a[236:239], v252, s[20:23], s54 offen offset:1024 sc1
  buffer_load_dwordx4 a[248:251], v252, s[20:23], s54 offen offset:2048 sc1
  buffer_load_dwordx4 a[252:255], v252, s[20:23], s54 offen offset:3072 sc1
 s_branch L_pollx0
L_pollw0:
 s_mov_b32 s38, 0x100000
L_poll0:
  v_mov_b32 v238, 0
  buffer_atomic_or v238, v211, s[24:27], 0 offen offset:0 sc0 sc1
 s_sub_u32 s38, s38, 1
 s_cbranch_scc1 L_pollx0
  s_waitcnt vmcnt(0)
 v_cmp_ne_u32 vcc, s94, v238
 s_and_b32 vcc_lo, vcc_lo, 0xff
 s_cbranch_scc1 L_poll0
L_pollx0:
 s_barrier
 s_lshl_b32 s41, s33, 3
 s_add_u32 s41, s41, s32
 s_mul_i32 s41, s41, 65536
 s_add_u32 s41, s41, 1048576
 ds_read_b128 v[64:67], v58 offset:0
 ds_read_b128 v[68:71], v58 offset:1024
 s_add_u32 s42, s32, 1
 s_and_b32 s42, s42, 7
 s_lshl_b32 s42, s42, 13
 s_add_u32 s42, s42, s41
 buffer_load_dwordx4 v[72:75], v215, s[24:27], s42 offen offset:0 sc1
 buffer_load_dwordx4 v[76:79], v215, s[24:27], s42 offen offset:1024 sc1
 s_add_u32 s42, s32, 2
 s_and_b32 s42, s42, 7
 s_lshl_b32 s42, s42, 13
 s_add_u32 s42, s42, s41
 buffer_load_dwordx4 v[80:83], v215, s[24:27], s42 offen offset:0 sc1
 buffer_load_dwordx4 v[84:87], v215, s[24:27], s42 offen offset:1024 sc1
 s_add_u32 s42, s32, 3
 s_and_b32 s42, s42, 7
 s_lshl_b32 s42, s42, 13
 s_add_u32 s42, s42, s41
 buffer_load_dwordx4 v[88:91], v215, s[24:27], s42 offen offset:0 sc1
 buffer_load_dwordx4 v[92:95], v215, s[24:27], s42 offen offset:1024 sc1
 s_add_u32 s42, s32, 4
 s_and_b32 s42, s42, 7
 s_lshl_b32 s42, s42, 13
 s_add_u32 s42, s42, s41
 buffer_load_dwordx4 v[96:99], v215, s[24:27], s42 offen offset:0 sc1
 buffer_load_dwordx4 v[100:103], v215, s[24:27], s42 offen offset:1024 sc1
 s_add_u32 s42, s32, 5
 s_and_b32 s42, s42, 7
 s_lshl_b32 s42, s42, 13
 s_add_u32 s42, s42, s41
 buffer_load_dwordx4 v[104:107], v215, s[24:27], s42 offen offset:0 sc1
 buffer_load_dwordx4 v[108:111], v215, s[24:27], s42 offen offset:1024 sc1
 s_add_u32 s42, s32, 6
 s_and_b32 s42, s42, 7
 s_lshl_b32 s42, s42, 13
 s_add_u32 s42, s42, s41
 buffer_load_dwordx4 v[112:115], v215, s[24:27], s42 offen offset:0 sc1
 buffer_load_dwordx4 v[116:119], v215, s[24:27], s42 offen offset:1024 sc1
 s_add_u32 s42, s32, 7
 s_and_b32 s42, s42, 7
 s_lshl_b32 s42, s42, 13
 s_add_u32 s42, s42, s41
 buffer_load_dwordx4 v[120:123], v215, s[24:27], s42 offen offset:0 sc1
 buffer_load_dwordx4 v[124:127], v215, s[24:27], s42 offen offset:1024 sc1
 ds_read_b128 v[128:131], v240 offset:0
 ds_read_b128 v[132:135], v240 offset:64
 ds_read_b128 v[136:139], v240 offset:256
 ds_read_b128 v[140:143], v240 offset:320
 ds_read_b128 v[144:147], v240 offset:4096
 ds_read_b128 v[148:151], v240 offset:4160
 ds_read_b128 v[152:155], v240 offset:4352
 ds_read_b128 v[156:159], v240 offset:4416
 ds_read_b128 v[160:163], v240 offset:2048
 ds_read_b128 v[164:167], v240 offset:2112
 ds_read_b128 v[168:171], v240 offset:2304
 ds_read_b128 v[172:175], v240 offset:2368
 ds_read_b128 v[32:35], v240 offset:6144
 ds_read_b128 v[36:39], v240 offset:6208
 ds_read_b128 v[40:43], v240 offset:6400
 ds_read_b128 v[44:47], v240 offset:6464
 s_cmp_lg_u32 s3, 3
 s_cbranch_scc1 L_w3a
L_w3a:
 s_waitcnt lgkmcnt(15)
 v_lshlrev_b32 v184, 16, v64
 v_and_b32 v185, 0xffff0000, v64
 v_lshlrev_b32 v186, 16, v65
 v_and_b32 v187, 0xffff0000, v65
 v_lshlrev_b32 v188, 16, v66
 v_and_b32 v189, 0xffff0000, v66
 v_lshlrev_b32 v190, 16, v67
 v_and_b32 v191, 0xffff0000, v67
 v_lshlrev_b32 v192, 16, v68
 v_and_b32 v193, 0xffff0000, v68
 v_lshlrev_b32 v194, 16, v69
 v_and_b32 v195, 0xffff0000, v69
 v_lshlrev_b32 v196, 16, v70
 v_and_b32 v197, 0xffff0000, v70
 v_lshlrev_b32 v198, 16, v71
 v_and_b32 v199, 0xffff0000, v71
 s_waitcnt vmcnt(12)
 v_lshlrev_b32 v216, 16, v72
 v_and_b32 v217, 0xffff0000, v72
 v_pk_add_f32 v[184:185], v[184:185], v[216:217]
 v_lshlrev_b32 v218, 16, v73
 v_and_b32 v219, 0xffff0000, v73
 v_pk_add_f32 v[186:187], v[186:187], v[218:219]
 v_lshlrev_b32 v220, 16, v74
 v_and_b32 v221, 0xffff0000, v74
 v_pk_add_f32 v[188:189], v[188:189], v[220:221]
 v_lshlrev_b32 v222, 16, v75
 v_and_b32 v223, 0xffff0000, v75
 v_pk_add_f32 v[190:191], v[190:191], v[222:223]
 v_lshlrev_b32 v216, 16, v76
 v_and_b32 v217, 0xffff0000, v76
 v_pk_add_f32 v[192:193], v[192:193], v[216:217]
 v_lshlrev_b32 v218, 16, v77
 v_and_b32 v219, 0xffff0000, v77
 v_pk_add_f32 v[194:195], v[194:195], v[218:219]
 v_lshlrev_b32 v220, 16, v78
 v_and_b32 v221, 0xffff0000, v78
 v_pk_add_f32 v[196:197], v[196:197], v[220:221]
 v_lshlrev_b32 v222, 16, v79
 v_and_b32 v223, 0xffff0000, v79
 v_pk_add_f32 v[198:199], v[198:199], v[222:223]
 s_waitcnt vmcnt(10)
 v_lshlrev_b32 v216, 16, v80
 v_and_b32 v217, 0xffff0000, v80
 v_pk_add_f32 v[184:185], v[184:185], v[216:217]
 v_lshlrev_b32 v218, 16, v81
 v_and_b32 v219, 0xffff0000, v81
 v_pk_add_f32 v[186:187], v[186:187], v[218:219]
 v_lshlrev_b32 v220, 16, v82
 v_and_b32 v221, 0xffff0000, v82
 v_pk_add_f32 v[188:189], v[188:189], v[220:221]
 v_lshlrev_b32 v222, 16, v83
 v_and_b32 v223, 0xffff0000, v83
 v_pk_add_f32 v[190:191], v[190:191], v[222:223]
 v_lshlrev_b32 v216, 16, v84
 v_and_b32 v217, 0xffff0000, v84
 v_pk_add_f32 v[192:193], v[192:193], v[216:217]
 v_lshlrev_b32 v218, 16, v85
 v_and_b32 v219, 0xffff0000, v85
 v_pk_add_f32 v[194:195], v[194:195], v[218:219]
 v_lshlrev_b32 v220, 16, v86
 v_and_b32 v221, 0xffff0000, v86
 v_pk_add_f32 v[196:197], v[196:197], v[220:221]
 v_lshlrev_b32 v222, 16, v87
 v_and_b32 v223, 0xffff0000, v87
 v_pk_add_f32 v[198:199], v[198:199], v[222:223]
 s_waitcnt vmcnt(8)
 v_lshlrev_b32 v216, 16, v88
 v_and_b32 v217, 0xffff0000, v88
 v_pk_add_f32 v[184:185], v[184:185], v[216:217]
 v_lshlrev_b32 v218, 16, v89
 v_and_b32 v219, 0xffff0000, v89
 v_pk_add_f32 v[186:187], v[186:187], v[218:219]
 v_lshlrev_b32 v220, 16, v90
 v_and_b32 v221, 0xffff0000, v90
 v_pk_add_f32 v[188:189], v[188:189], v[220:221]
 v_lshlrev_b32 v222, 16, v91
 v_and_b32 v223, 0xffff0000, v91
 v_pk_add_f32 v[190:191], v[190:191], v[222:223]
 v_lshlrev_b32 v216, 16, v92
 v_and_b32 v217, 0xffff0000, v92
 v_pk_add_f32 v[192:193], v[192:193], v[216:217]
 v_lshlrev_b32 v218, 16, v93
 v_and_b32 v219, 0xffff0000, v93
 v_pk_add_f32 v[194:195], v[194:195], v[218:219]
 v_lshlrev_b32 v220, 16, v94
 v_and_b32 v221, 0xffff0000, v94
 v_pk_add_f32 v[196:197], v[196:197], v[220:221]
 v_lshlrev_b32 v222, 16, v95
 v_and_b32 v223, 0xffff0000, v95
 v_pk_add_f32 v[198:199], v[198:199], v[222:223]
 s_waitcnt vmcnt(6)
 v_lshlrev_b32 v216, 16, v96
 v_and_b32 v217, 0xffff0000, v96
 v_pk_add_f32 v[184:185], v[184:185], v[216:217]
 v_lshlrev_b32 v218, 16, v97
 v_and_b32 v219, 0xffff0000, v97
 v_pk_add_f32 v[186:187], v[186:187], v[218:219]
 v_lshlrev_b32 v220, 16, v98
 v_and_b32 v221, 0xffff0000, v98
 v_pk_add_f32 v[188:189], v[188:189], v[220:221]
 v_lshlrev_b32 v222, 16, v99
 v_and_b32 v223, 0xffff0000, v99
 v_pk_add_f32 v[190:191], v[190:191], v[222:223]
 v_lshlrev_b32 v216, 16, v100
 v_and_b32 v217, 0xffff0000, v100
 v_pk_add_f32 v[192:193], v[192:193], v[216:217]
 v_lshlrev_b32 v218, 16, v101
 v_and_b32 v219, 0xffff0000, v101
 v_pk_add_f32 v[194:195], v[194:195], v[218:219]
 v_lshlrev_b32 v220, 16, v102
 v_and_b32 v221, 0xffff0000, v102
 v_pk_add_f32 v[196:197], v[196:197], v[220:221]
 v_lshlrev_b32 v222, 16, v103
 v_and_b32 v223, 0xffff0000, v103
 v_pk_add_f32 v[198:199], v[198:199], v[222:223]
 s_waitcnt vmcnt(4)
 v_lshlrev_b32 v216, 16, v104
 v_and_b32 v217, 0xffff0000, v104
 v_pk_add_f32 v[184:185], v[184:185], v[216:217]
 v_lshlrev_b32 v218, 16, v105
 v_and_b32 v219, 0xffff0000, v105
 v_pk_add_f32 v[186:187], v[186:187], v[218:219]
 v_lshlrev_b32 v220, 16, v106
 v_and_b32 v221, 0xffff0000, v106
 v_pk_add_f32 v[188:189], v[188:189], v[220:221]
 v_lshlrev_b32 v222, 16, v107
 v_and_b32 v223, 0xffff0000, v107
 v_pk_add_f32 v[190:191], v[190:191], v[222:223]
 v_lshlrev_b32 v216, 16, v108
 v_and_b32 v217, 0xffff0000, v108
 v_pk_add_f32 v[192:193], v[192:193], v[216:217]
 v_lshlrev_b32 v218, 16, v109
 v_and_b32 v219, 0xffff0000, v109
 v_pk_add_f32 v[194:195], v[194:195], v[218:219]
 v_lshlrev_b32 v220, 16, v110
 v_and_b32 v221, 0xffff0000, v110
 v_pk_add_f32 v[196:197], v[196:197], v[220:221]
 v_lshlrev_b32 v222, 16, v111
 v_and_b32 v223, 0xffff0000, v111
 v_pk_add_f32 v[198:199], v[198:199], v[222:223]
 s_waitcnt vmcnt(2)
 v_lshlrev_b32 v216, 16, v112
 v_and_b32 v217, 0xffff0000, v112
 v_pk_add_f32 v[184:185], v[184:185], v[216:217]
 v_lshlrev_b32 v218, 16, v113
 v_and_b32 v219, 0xffff0000, v113
 v_pk_add_f32 v[186:187], v[186:187], v[218:219]
 v_lshlrev_b32 v220, 16, v114
 v_and_b32 v221, 0xffff0000, v114
 v_pk_add_f32 v[188:189], v[188:189], v[220:221]
 v_lshlrev_b32 v222, 16, v115
 v_and_b32 v223, 0xffff0000, v115
 v_pk_add_f32 v[190:191], v[190:191], v[222:223]
 v_lshlrev_b32 v216, 16, v116
 v_and_b32 v217, 0xffff0000, v116
 v_pk_add_f32 v[192:193], v[192:193], v[216:217]
 v_lshlrev_b32 v218, 16, v117
 v_and_b32 v219, 0xffff0000, v117
 v_pk_add_f32 v[194:195], v[194:195], v[218:219]
 v_lshlrev_b32 v220, 16, v118
 v_and_b32 v221, 0xffff0000, v118
 v_pk_add_f32 v[196:197], v[196:197], v[220:221]
 v_lshlrev_b32 v222, 16, v119
 v_and_b32 v223, 0xffff0000, v119
 v_pk_add_f32 v[198:199], v[198:199], v[222:223]
 s_waitcnt vmcnt(0)
 v_lshlrev_b32 v216, 16, v120
 v_and_b32 v217, 0xffff0000, v120
 v_pk_add_f32 v[184:185], v[184:185], v[216:217]
 v_lshlrev_b32 v218, 16, v121
 v_and_b32 v219, 0xffff0000, v121
 v_pk_add_f32 v[186:187], v[186:187], v[218:219]
 v_lshlrev_b32 v220, 16, v122
 v_and_b32 v221, 0xffff0000, v122
 v_pk_add_f32 v[188:189], v[188:189], v[220:221]
 v_lshlrev_b32 v222, 16, v123
 v_and_b32 v223, 0xffff0000, v123
 v_pk_add_f32 v[190:191], v[190:191], v[222:223]
 v_lshlrev_b32 v216, 16, v124
 v_and_b32 v217, 0xffff0000, v124
 v_pk_add_f32 v[192:193], v[192:193], v[216:217]
 v_lshlrev_b32 v218, 16, v125
 v_and_b32 v219, 0xffff0000, v125
 v_pk_add_f32 v[194:195], v[194:195], v[218:219]
 v_lshlrev_b32 v220, 16, v126
 v_and_b32 v221, 0xffff0000, v126
 v_pk_add_f32 v[196:197], v[196:197], v[220:221]
 v_lshlrev_b32 v222, 16, v127
 v_and_b32 v223, 0xffff0000, v127
 v_pk_add_f32 v[198:199], v[198:199], v[222:223]
 s_waitcnt lgkmcnt(0)
 v_pk_fma_f32 v[16:17], v[184:185], v[128:129], v[16:17]
 v_pk_fma_f32 v[18:19], v[186:187], v[130:131], v[18:19]
 v_pk_fma_f32 v[20:21], v[188:189], v[132:133], v[20:21]
 v_pk_fma_f32 v[22:23], v[190:191], v[134:135], v[22:23]
 v_pk_fma_f32 v[24:25], v[192:193], v[136:137], v[24:25]
 v_pk_fma_f32 v[26:27], v[194:195], v[138:139], v[26:27]
 v_pk_fma_f32 v[28:29], v[196:197], v[140:141], v[28:29]
 v_pk_fma_f32 v[30:31], v[198:199], v[142:143], v[30:31]
 v_pk_add_f32 v[216:217], v[16:17], v[18:19]
 v_pk_add_f32 v[216:217], v[216:217], v[20:21]
 v_pk_add_f32 v[216:217], v[216:217], v[22:23]
 v_pk_add_f32 v[216:217], v[216:217], v[24:25]
 v_pk_add_f32 v[216:217], v[216:217], v[26:27]
 v_pk_add_f32 v[216:217], v[216:217], v[28:29]
 v_pk_add_f32 v[216:217], v[216:217], v[30:31]
 v_add_f32 v216, v216, v217
 s_nop 0
 s_nop 0
 v_add_f32_dpp v216, v216, v216 row_ror:8 row_mask:0xf bank_mask:0xf
 v_mov_b32 v217, v216
 s_nop 1
 v_permlane16_swap_b32 v217, v216
 v_add_f32 v216, v216, v217
 v_mov_b32 v217, v216
 s_nop 1
 v_permlane32_swap_b32 v217, v216
 v_add_f32 v216, v216, v217
 v_mul_f32 v216, 1006632960, v216
 v_pk_add_f32 v[64:65], v[16:17], v[216:217] op_sel_hi:[1,0] neg_lo:[0,1] neg_hi:[0,1]
 v_pk_add_f32 v[66:67], v[18:19], v[216:217] op_sel_hi:[1,0] neg_lo:[0,1] neg_hi:[0,1]
 v_pk_add_f32 v[68:69], v[20:21], v[216:217] op_sel_hi:[1,0] neg_lo:[0,1] neg_hi:[0,1]
 v_pk_add_f32 v[70:71], v[22:23], v[216:217] op_sel_hi:[1,0] neg_lo:[0,1] neg_hi:[0,1]
 v_pk_add_f32 v[72:73], v[24:25], v[216:217] op_sel_hi:[1,0] neg_lo:[0,1] neg_hi:[0,1]
 v_pk_add_f32 v[74:75], v[26:27], v[216:217] op_sel_hi:[1,0] neg_lo:[0,1] neg_hi:[0,1]
 v_pk_add_f32 v[76:77], v[28:29], v[216:217] op_sel_hi:[1,0] neg_lo:[0,1] neg_hi:[0,1]
 v_pk_add_f32 v[78:79], v[30:31], v[216:217] op_sel_hi:[1,0] neg_lo:[0,1] neg_hi:[0,1]
 v_pk_mul_f32 v[218:219], v[64:65], v[64:65]
 v_pk_fma_f32 v[218:219], v[66:67], v[66:67], v[218:219]
 v_pk_fma_f32 v[218:219], v[68:69], v[68:69], v[218:219]
 v_pk_fma_f32 v[218:219], v[70:71], v[70:71], v[218:219]
 v_pk_fma_f32 v[218:219], v[72:73], v[72:73], v[218:219]
 v_pk_fma_f32 v[218:219], v[74:75], v[74:75], v[218:219]
 v_pk_fma_f32 v[218:219], v[76:77], v[76:77], v[218:219]
 v_pk_fma_f32 v[218:219], v[78:79], v[78:79], v[218:219]
 v_add_f32 v217, v218, v219
 s_nop 0
 s_nop 0
 v_add_f32_dpp v217, v217, v217 row_ror:8 row_mask:0xf bank_mask:0xf
 v_mov_b32 v218, v217
 s_nop 1
 v_permlane16_swap_b32 v218, v217
 v_add_f32 v217, v217, v218
 v_mov_b32 v218, v217
 s_nop 1
 v_permlane32_swap_b32 v218, v217
 v_add_f32 v217, v217, v218
 v_lshl_add_u32 v218, s3, 3, v207
 ds_write_b64 v218, v[216:217]
 s_waitcnt lgkmcnt(0)
 s_barrier
 ds_read_b128 v[220:223], v207
 ds_read_b128 v[224:227], v207 offset:16
 s_waitcnt lgkmcnt(0)
 v_pk_add_f32 v[218:219], v[220:221], v[222:223]
 v_pk_add_f32 v[228:229], v[224:225], v[226:227]
 v_pk_add_f32 v[218:219], v[218:219], v[228:229]
 v_mul_f32 v218, 0x3e800000, v218
 v_sub_f32 v220, v220, v218
 v_sub_f32 v222, v222, v218
 v_sub_f32 v224, v224, v218
 v_sub_f32 v226, v226, v218
 v_mul_f32 v228, v220, v220
 v_fmac_f32 v228, v222, v222
 v_fmac_f32 v228, v224, v224
 v_fmac_f32 v228, v226, v226
 v_fmac_f32 v219, 1124073472, v228
 v_mov_b32 v217, 925353388
 v_fmac_f32 v217, 989855744, v219
 v_rsq_f32 v217, v217
 v_sub_f32 v216, v216, v218
 v_pk_add_f32 v[64:65], v[64:65], v[216:217] op_sel_hi:[1,0]
 v_pk_mul_f32 v[64:65], v[64:65], v[216:217] op_sel:[0,1] op_sel_hi:[1,1]
 v_pk_fma_f32 v[64:65], v[64:65], v[144:145], v[160:161]
 v_cvt_pk_bf16_f32 v80, v64, v65
 v_pk_add_f32 v[66:67], v[66:67], v[216:217] op_sel_hi:[1,0]
 v_pk_mul_f32 v[66:67], v[66:67], v[216:217] op_sel:[0,1] op_sel_hi:[1,1]
 v_pk_fma_f32 v[66:67], v[66:67], v[146:147], v[162:163]
 v_cvt_pk_bf16_f32 v81, v66, v67
 v_pk_add_f32 v[68:69], v[68:69], v[216:217] op_sel_hi:[1,0]
 v_pk_mul_f32 v[68:69], v[68:69], v[216:217] op_sel:[0,1] op_sel_hi:[1,1]
 v_pk_fma_f32 v[68:69], v[68:69], v[148:149], v[164:165]
 v_cvt_pk_bf16_f32 v82, v68, v69
 v_pk_add_f32 v[70:71], v[70:71], v[216:217] op_sel_hi:[1,0]
 v_pk_mul_f32 v[70:71], v[70:71], v[216:217] op_sel:[0,1] op_sel_hi:[1,1]
 v_pk_fma_f32 v[70:71], v[70:71], v[150:151], v[166:167]
 v_cvt_pk_bf16_f32 v83, v70, v71
 v_pk_add_f32 v[72:73], v[72:73], v[216:217] op_sel_hi:[1,0]
 v_pk_mul_f32 v[72:73], v[72:73], v[216:217] op_sel:[0,1] op_sel_hi:[1,1]
 v_pk_fma_f32 v[72:73], v[72:73], v[152:153], v[168:169]
 v_cvt_pk_bf16_f32 v84, v72, v73
 v_pk_add_f32 v[74:75], v[74:75], v[216:217] op_sel_hi:[1,0]
 v_pk_mul_f32 v[74:75], v[74:75], v[216:217] op_sel:[0,1] op_sel_hi:[1,1]
 v_pk_fma_f32 v[74:75], v[74:75], v[154:155], v[170:171]
 v_cvt_pk_bf16_f32 v85, v74, v75
 v_pk_add_f32 v[76:77], v[76:77], v[216:217] op_sel_hi:[1,0]
 v_pk_mul_f32 v[76:77], v[76:77], v[216:217] op_sel:[0,1] op_sel_hi:[1,1]
 v_pk_fma_f32 v[76:77], v[76:77], v[156:157], v[172:173]
 v_cvt_pk_bf16_f32 v86, v76, v77
 v_pk_add_f32 v[78:79], v[78:79], v[216:217] op_sel_hi:[1,0]
 v_pk_mul_f32 v[78:79], v[78:79], v[216:217] op_sel:[0,1] op_sel_hi:[1,1]
 v_pk_fma_f32 v[78:79], v[78:79], v[158:159], v[174:175]
 v_cvt_pk_bf16_f32 v87, v78, v79
 s_mul_i32 s41, s33, 0
 s_add_u32 s41, s41, s46
 s_add_u32 s41, s41, 18874368
 buffer_store_dwordx4 v[80:83], v215, s[24:27], s41 offen offset:0 sc1
 buffer_store_dwordx4 v[84:87], v215, s[24:27], s41 offen offset:1024 sc1
 s_waitcnt vmcnt(0)
 s_barrier
 s_cmp_lg_u32 s3, 0
 s_cbranch_scc1 L_nosig1
  buffer_store_dword v212, v210, s[24:27], 0 offen offset:1024 sc1
L_nosig1:
 s_cmp_eq_u32 s3, 3
 s_cbranch_scc1 L_w3b
 s_mov_b32 s55, 196608
 buffer_load_dwordx4 a[0:3], v252, s[20:23], s55 offen offset:0 sc1
 buffer_load_dwordx4 a[4:7], v252, s[20:23], s55 offen offset:1024 sc1
 buffer_load_dwordx4 a[16:19], v252, s[20:23], s55 offen offset:2048 sc1
 buffer_load_dwordx4 a[20:23], v252, s[20:23], s55 offen offset:3072 sc1
 s_mov_b32 s54, 200704
 buffer_load_dwordx4 a[32:35], v252, s[20:23], s54 offen offset:0 sc1
 buffer_load_dwordx4 a[36:39], v252, s[20:23], s54 offen offset:1024 sc1
 buffer_load_dwordx4 a[48:51], v252, s[20:23], s54 offen offset:2048 sc1
 buffer_load_dwordx4 a[52:55], v252, s[20:23], s54 offen offset:3072 sc1
 s_mov_b32 s55, 204800
 buffer_load_dwordx4 a[64:67], v252, s[20:23], s55 offen offset:0 sc1
 buffer_load_dwordx4 a[68:71], v252, s[20:23], s55 offen offset:1024 sc1
 buffer_load_dwordx4 a[80:83], v252, s[20:23], s55 offen offset:2048 sc1
 buffer_load_dwordx4 a[84:87], v252, s[20:23], s55 offen offset:3072 sc1
 s_mov_b32 s54, 208896
 buffer_load_dwordx4 a[96:99], v252, s[20:23], s54 offen offset:0 sc1
 buffer_load_dwordx4 a[100:103], v252, s[20:23], s54 offen offset:1024 sc1
 buffer_load_dwordx4 a[112:115], v252, s[20:23], s54 offen offset:2048 sc1
 buffer_load_dwordx4 a[116:119], v252, s[20:23], s54 offen offset:3072 sc1
 s_mov_b32 s55, 229376
 buffer_load_dwordx4 a[8:11], v252, s[20:23], s55 offen offset:0 sc1
 buffer_load_dwordx4 a[12:15], v252, s[20:23], s55 offen offset:1024 sc1
 buffer_load_dwordx4 a[24:27], v252, s[20:23], s55 offen offset:2048 sc1
 buffer_load_dwordx4 a[28:31], v252, s[20:23], s55 offen offset:3072 sc1
 s_mov_b32 s54, 233472
 buffer_load_dwordx4 a[40:43], v252, s[20:23], s54 offen offset:0 sc1
 buffer_load_dwordx4 a[44:47], v252, s[20:23], s54 offen offset:1024 sc1
 buffer_load_dwordx4 a[56:59], v252, s[20:23], s54 offen offset:2048 sc1
 buffer_load_dwordx4 a[60:63], v252, s[20:23], s54 offen offset:3072 sc1
 s_mov_b32 s55, 237568
 buffer_load_dwordx4 a[72:75], v252, s[20:23], s55 offen offset:0 sc1
 buffer_load_dwordx4 a[76:79], v252, s[20:23], s55 offen offset:1024 sc1
 buffer_load_dwordx4 a[88:91], v252, s[20:23], s55 offen offset:2048 sc1
 buffer_load_dwordx4 a[92:95], v252, s[20:23], s55 offen offset:3072 sc1
 s_mov_b32 s54, 241664
 buffer_load_dwordx4 a[104:107], v252, s[20:23], s54 offen offset:0 sc1
 buffer_load_dwordx4 a[108:111], v252, s[20:23], s54 offen offset:1024 sc1
 buffer_load_dwordx4 a[120:123], v252, s[20:23], s54 offen offset:2048 sc1
 buffer_load_dwordx4 a[124:127], v252, s[20:23], s54 offen offset:3072 sc1
L_w3b:
 s_mul_i32 s41, s33, 65536
 s_lshl_b32 s42, s3, 14
 s_add_u32 s41, s41, s42
 s_add_u32 s41, s41, 18874368
 s_add_u32 s42, s42, 65536
 v_lshlrev_b32 v64, 4, v1
 s_cmp_lg_u32 s3, 3
 s_cbranch_scc1 L_pollx1
 s_mov_b32 s38, 0x100000
L_poll1:
  v_mov_b32 v238, 0
  buffer_atomic_or v238, v211, s[24:27], 0 offen offset:1024 sc0 sc1
 s_sub_u32 s38, s38, 1
 s_cbranch_scc1 L_pollx1
  s_waitcnt vmcnt(0)
 v_cmp_ne_u32 vcc, s94, v238
 s_and_b32 vcc_lo, vcc_lo, 0xff
 s_cbranch_scc1 L_poll1
L_pollx1:
 s_barrier
 s_add_u32 m0, s42, 0
 s_add_u32 s43, s41, 0
 buffer_load_dwordx4 v64, s[24:27], s43 offen offset:0 sc1 lds
 buffer_load_dwordx4 v64, s[24:27], s43 offen offset:1024 sc1 lds
 buffer_load_dwordx4 v64, s[24:27], s43 offen offset:2048 sc1 lds
 buffer_load_dwordx4 v64, s[24:27], s43 offen offset:3072 sc1 lds
 s_add_u32 m0, s42, 8192
 s_add_u32 s43, s41, 8192
 buffer_load_dwordx4 v64, s[24:27], s43 offen offset:0 sc1 lds
 buffer_load_dwordx4 v64, s[24:27], s43 offen offset:1024 sc1 lds
 buffer_load_dwordx4 v64, s[24:27], s43 offen offset:2048 sc1 lds
 buffer_load_dwordx4 v64, s[24:27], s43 offen offset:3072 sc1 lds
 s_add_u32 m0, s42, 4096
 s_add_u32 s43, s41, 4096
 buffer_load_dwordx4 v64, s[24:27], s43 offen offset:0 sc1 lds
 buffer_load_dwordx4 v64, s[24:27], s43 offen offset:1024 sc1 lds
 buffer_load_dwordx4 v64, s[24:27], s43 offen offset:2048 sc1 lds
 buffer_load_dwordx4 v64, s[24:27], s43 offen offset:3072 sc1 lds
 s_add_u32 m0, s42, 12288
 s_add_u32 s43, s41, 12288
 buffer_load_dwordx4 v64, s[24:27], s43 offen offset:0 sc1 lds
 buffer_load_dwordx4 v64, s[24:27], s43 offen offset:1024 sc1 lds
 buffer_load_dwordx4 v64, s[24:27], s43 offen offset:2048 sc1 lds
 buffer_load_dwordx4 v64, s[24:27], s43 offen offset:3072 sc1 lds
 s_waitcnt vmcnt(8) lgkmcnt(0)
 s_barrier
 ds_read_b128 v[128:131], v213 offset:0
 ds_read_b128 v[132:135], v213 offset:512
 ds_read_b128 v[136:139], v213 offset:1024
 ds_read_b128 v[140:143], v213 offset:1536
 s_waitcnt lgkmcnt(0)
 v_mfma_f32_16x16x32_bf16 v[64:67], a[0:3], v[128:131], 0
 ds_read_b128 v[144:147], v213 offset:16384
 v_mfma_f32_16x16x32_bf16 v[64:67], a[16:19], v[132:135], v[64:67]
 ds_read_b128 v[148:151], v213 offset:16896
 v_mfma_f32_16x16x32_bf16 v[64:67], a[32:35], v[136:139], v[64:67]
 ds_read_b128 v[152:155], v213 offset:17408
 v_mfma_f32_16x16x32_bf16 v[64:67], a[48:51], v[140:143], v[64:67]
 s_mov_b32 s55, 180224
 buffer_load_dwordx4 v[160:163], v252, s[20:23], s55 offen offset:0 sc1
 v_mfma_f32_16x16x32_bf16 v[80:83], a[4:7], v[128:131], 0
 ds_read_b128 v[156:159], v213 offset:17920
 v_mfma_f32_16x16x32_bf16 v[80:83], a[20:23], v[132:135], v[80:83]
 v_mfma_f32_16x16x32_bf16 v[80:83], a[36:39], v[136:139], v[80:83]
 v_mfma_f32_16x16x32_bf16 v[80:83], a[52:55], v[140:143], v[80:83]
 buffer_load_dwordx4 v[164:167], v252, s[20:23], s55 offen offset:1024 sc1
 v_mfma_f32_16x16x32_bf16 v[96:99], a[8:11], v[128:131], 0
 v_mfma_f32_16x16x32_bf16 v[96:99], a[24:27], v[132:135], v[96:99]
 v_mfma_f32_16x16x32_bf16 v[96:99], a[40:43], v[136:139], v[96:99]
 v_mfma_f32_16x16x32_bf16 v[96:99], a[56:59], v[140:143], v[96:99]
 buffer_load_dwordx4 v[168:171], v252, s[20:23], s55 offen offset:2048 sc1
 v_mfma_f32_16x16x32_bf16 v[112:115], a[12:15], v[128:131], 0
 v_mfma_f32_16x16x32_bf16 v[112:115], a[28:31], v[132:135], v[112:115]
 v_mfma_f32_16x16x32_bf16 v[112:115], a[44:47], v[136:139], v[112:115]
 v_mfma_f32_16x16x32_bf16 v[112:115], a[60:63], v[140:143], v[112:115]
 s_waitcnt lgkmcnt(0)
 buffer_load_dwordx4 v[172:175], v252, s[20:23], s55 offen offset:3072 sc1
 v_mfma_f32_16x16x32_bf16 v[68:71], a[0:3], v[144:147], 0
 ds_read_b128 v[128:131], v213 offset:32768
 v_mfma_f32_16x16x32_bf16 v[68:71], a[16:19], v[148:151], v[68:71]
 ds_read_b128 v[132:135], v213 offset:33280
 v_mfma_f32_16x16x32_bf16 v[68:71], a[32:35], v[152:155], v[68:71]
 ds_read_b128 v[136:139], v213 offset:33792
 v_mfma_f32_16x16x32_bf16 v[68:71], a[48:51], v[156:159], v[68:71]
 s_mov_b32 s54, 184320
 buffer_load_dwordx4 v[176:179], v252, s[20:23], s54 offen offset:0 sc1
 v_mfma_f32_16x16x32_bf16 v[84:87], a[4:7], v[144:147], 0
 ds_read_b128 v[140:143], v213 offset:34304
 v_mfma_f32_16x16x32_bf16 v[84:87], a[20:23], v[148:151], v[84:87]
 v_mfma_f32_16x16x32_bf16 v[84:87], a[36:39], v[152:155], v[84:87]
 v_mfma_f32_16x16x32_bf16 v[84:87], a[52:55], v[156:159], v[84:87]
 buffer_load_dwordx4 v[180:183], v252, s[20:23], s54 offen offset:1024 sc1
 v_mfma_f32_16x16x32_bf16 v[100:103], a[8:11], v[144:147], 0
 v_mfma_f32_16x16x32_bf16 v[100:103], a[24:27], v[148:151], v[100:103]
 v_mfma_f32_16x16x32_bf16 v[100:103], a[40:43], v[152:155], v[100:103]
 v_mfma_f32_16x16x32_bf16 v[100:103], a[56:59], v[156:159], v[100:103]
 buffer_load_dwordx4 v[184:187], v252, s[20:23], s54 offen offset:2048 sc1
 v_mfma_f32_16x16x32_bf16 v[116:119], a[12:15], v[144:147], 0
 v_mfma_f32_16x16x32_bf16 v[116:119], a[28:31], v[148:151], v[116:119]
 v_mfma_f32_16x16x32_bf16 v[116:119], a[44:47], v[152:155], v[116:119]
 v_mfma_f32_16x16x32_bf16 v[116:119], a[60:63], v[156:159], v[116:119]
 s_waitcnt lgkmcnt(0)
 buffer_load_dwordx4 v[188:191], v252, s[20:23], s54 offen offset:3072 sc1
 v_mfma_f32_16x16x32_bf16 v[72:75], a[0:3], v[128:131], 0
 ds_read_b128 v[144:147], v213 offset:49152
 v_mfma_f32_16x16x32_bf16 v[72:75], a[16:19], v[132:135], v[72:75]
 ds_read_b128 v[148:151], v213 offset:49664
 v_mfma_f32_16x16x32_bf16 v[72:75], a[32:35], v[136:139], v[72:75]
 ds_read_b128 v[152:155], v213 offset:50176
 v_mfma_f32_16x16x32_bf16 v[72:75], a[48:51], v[140:143], v[72:75]
 v_mfma_f32_16x16x32_bf16 v[88:91], a[4:7], v[128:131], 0
 ds_read_b128 v[156:159], v213 offset:50688
 v_mfma_f32_16x16x32_bf16 v[88:91], a[20:23], v[132:135], v[88:91]
 v_mfma_f32_16x16x32_bf16 v[88:91], a[36:39], v[136:139], v[88:91]
 v_mfma_f32_16x16x32_bf16 v[88:91], a[52:55], v[140:143], v[88:91]
 v_mfma_f32_16x16x32_bf16 v[104:107], a[8:11], v[128:131], 0
 v_mfma_f32_16x16x32_bf16 v[104:107], a[24:27], v[132:135], v[104:107]
 v_mfma_f32_16x16x32_bf16 v[104:107], a[40:43], v[136:139], v[104:107]
 v_mfma_f32_16x16x32_bf16 v[104:107], a[56:59], v[140:143], v[104:107]
 v_mfma_f32_16x16x32_bf16 v[120:123], a[12:15], v[128:131], 0
 v_mfma_f32_16x16x32_bf16 v[120:123], a[28:31], v[132:135], v[120:123]
 v_mfma_f32_16x16x32_bf16 v[120:123], a[44:47], v[136:139], v[120:123]
 v_mfma_f32_16x16x32_bf16 v[120:123], a[60:63], v[140:143], v[120:123]
 s_waitcnt lgkmcnt(0)
 v_mfma_f32_16x16x32_bf16 v[76:79], a[0:3], v[144:147], 0
 ds_read_b128 v[128:131], v213 offset:2048
 v_mfma_f32_16x16x32_bf16 v[76:79], a[16:19], v[148:151], v[76:79]
 ds_read_b128 v[132:135], v213 offset:2560
 v_mfma_f32_16x16x32_bf16 v[76:79], a[32:35], v[152:155], v[76:79]
 ds_read_b128 v[136:139], v213 offset:3072
 v_mfma_f32_16x16x32_bf16 v[76:79], a[48:51], v[156:159], v[76:79]
 v_mfma_f32_16x16x32_bf16 v[92:95], a[4:7], v[144:147], 0
 ds_read_b128 v[140:143], v213 offset:3584
 v_mfma_f32_16x16x32_bf16 v[92:95], a[20:23], v[148:151], v[92:95]
 v_mfma_f32_16x16x32_bf16 v[92:95], a[36:39], v[152:155], v[92:95]
 v_mfma_f32_16x16x32_bf16 v[92:95], a[52:55], v[156:159], v[92:95]
 v_mfma_f32_16x16x32_bf16 v[108:111], a[8:11], v[144:147], 0
 v_mfma_f32_16x16x32_bf16 v[108:111], a[24:27], v[148:151], v[108:111]
 v_mfma_f32_16x16x32_bf16 v[108:111], a[40:43], v[152:155], v[108:111]
 v_mfma_f32_16x16x32_bf16 v[108:111], a[56:59], v[156:159], v[108:111]
 v_mfma_f32_16x16x32_bf16 v[124:127], a[12:15], v[144:147], 0
 v_mfma_f32_16x16x32_bf16 v[124:127], a[28:31], v[148:151], v[124:127]
 v_mfma_f32_16x16x32_bf16 v[124:127], a[44:47], v[152:155], v[124:127]
 v_mfma_f32_16x16x32_bf16 v[124:127], a[60:63], v[156:159], v[124:127]
 s_waitcnt lgkmcnt(0)
 v_mfma_f32_16x16x32_bf16 v[64:67], a[64:67], v[128:131], v[64:67]
 ds_read_b128 v[144:147], v213 offset:18432
 v_mfma_f32_16x16x32_bf16 v[64:67], a[80:83], v[132:135], v[64:67]
 ds_read_b128 v[148:151], v213 offset:18944
 v_mfma_f32_16x16x32_bf16 v[64:67], a[96:99], v[136:139], v[64:67]
 ds_read_b128 v[152:155], v213 offset:19456
 v_mfma_f32_16x16x32_bf16 v[64:67], a[112:115], v[140:143], v[64:67]
 s_mov_b32 s55, 131072
 buffer_load_dwordx4 a[0:3], v252, s[20:23], s55 offen offset:0 sc1
 v_mfma_f32_16x16x32_bf16 v[80:83], a[68:71], v[128:131], v[80:83]
 ds_read_b128 v[156:159], v213 offset:19968
 v_mfma_f32_16x16x32_bf16 v[80:83], a[84:87], v[132:135], v[80:83]
 v_mfma_f32_16x16x32_bf16 v[80:83], a[100:103], v[136:139], v[80:83]
 v_mfma_f32_16x16x32_bf16 v[80:83], a[116:119], v[140:143], v[80:83]
 buffer_load_dwordx4 a[4:7], v252, s[20:23], s55 offen offset:1024 sc1
 v_mfma_f32_16x16x32_bf16 v[96:99], a[72:75], v[128:131], v[96:99]
 v_mfma_f32_16x16x32_bf16 v[96:99], a[88:91], v[132:135], v[96:99]
 v_mfma_f32_16x16x32_bf16 v[96:99], a[104:107], v[136:139], v[96:99]
 v_mfma_f32_16x16x32_bf16 v[96:99], a[120:123], v[140:143], v[96:99]
 buffer_load_dwordx4 a[8:11], v252, s[20:23], s55 offen offset:2048 sc1
 v_mfma_f32_16x16x32_bf16 v[112:115], a[76:79], v[128:131], v[112:115]
 v_mfma_f32_16x16x32_bf16 v[112:115], a[92:95], v[132:135], v[112:115]
 v_mfma_f32_16x16x32_bf16 v[112:115], a[108:111], v[136:139], v[112:115]
 v_mfma_f32_16x16x32_bf16 v[112:115], a[124:127], v[140:143], v[112:115]
 s_waitcnt lgkmcnt(0)
 buffer_load_dwordx4 a[12:15], v252, s[20:23], s55 offen offset:3072 sc1
 v_mfma_f32_16x16x32_bf16 v[68:71], a[64:67], v[144:147], v[68:71]
 ds_read_b128 v[128:131], v213 offset:34816
 v_mfma_f32_16x16x32_bf16 v[68:71], a[80:83], v[148:151], v[68:71]
 ds_read_b128 v[132:135], v213 offset:35328
 v_mfma_f32_16x16x32_bf16 v[68:71], a[96:99], v[152:155], v[68:71]
 ds_read_b128 v[136:139], v213 offset:35840
 v_mfma_f32_16x16x32_bf16 v[68:71], a[112:115], v[156:159], v[68:71]
 s_mov_b32 s54, 135168
 buffer_load_dwordx4 a[16:19], v252, s[20:23], s54 offen offset:0 sc1
 v_mfma_f32_16x16x32_bf16 v[84:87], a[68:71], v[144:147], v[84:87]
 ds_read_b128 v[140:143], v213 offset:36352
 v_mfma_f32_16x16x32_bf16 v[84:87], a[84:87], v[148:151], v[84:87]
 v_mfma_f32_16x16x32_bf16 v[84:87], a[100:103], v[152:155], v[84:87]
 v_mfma_f32_16x16x32_bf16 v[84:87], a[116:119], v[156:159], v[84:87]
 buffer_load_dwordx4 a[20:23], v252, s[20:23], s54 offen offset:1024 sc1
 v_mfma_f32_16x16x32_bf16 v[100:103], a[72:75], v[144:147], v[100:103]
 v_mfma_f32_16x16x32_bf16 v[100:103], a[88:91], v[148:151], v[100:103]
 v_mfma_f32_16x16x32_bf16 v[100:103], a[104:107], v[152:155], v[100:103]
 v_mfma_f32_16x16x32_bf16 v[100:103], a[120:123], v[156:159], v[100:103]
 buffer_load_dwordx4 a[24:27], v252, s[20:23], s54 offen offset:2048 sc1
 v_mfma_f32_16x16x32_bf16 v[116:119], a[76:79], v[144:147], v[116:119]
 v_mfma_f32_16x16x32_bf16 v[116:119], a[92:95], v[148:151], v[116:119]
 v_mfma_f32_16x16x32_bf16 v[116:119], a[108:111], v[152:155], v[116:119]
 v_mfma_f32_16x16x32_bf16 v[116:119], a[124:127], v[156:159], v[116:119]
 s_waitcnt lgkmcnt(0)
 buffer_load_dwordx4 a[28:31], v252, s[20:23], s54 offen offset:3072 sc1
 v_mfma_f32_16x16x32_bf16 v[72:75], a[64:67], v[128:131], v[72:75]
 ds_read_b128 v[144:147], v213 offset:51200
 v_mfma_f32_16x16x32_bf16 v[72:75], a[80:83], v[132:135], v[72:75]
 ds_read_b128 v[148:151], v213 offset:51712
 v_mfma_f32_16x16x32_bf16 v[72:75], a[96:99], v[136:139], v[72:75]
 ds_read_b128 v[152:155], v213 offset:52224
 v_mfma_f32_16x16x32_bf16 v[72:75], a[112:115], v[140:143], v[72:75]
 s_mov_b32 s55, 139264
 buffer_load_dwordx4 a[32:35], v252, s[20:23], s55 offen offset:0 sc1
 v_mfma_f32_16x16x32_bf16 v[88:91], a[68:71], v[128:131], v[88:91]
 ds_read_b128 v[156:159], v213 offset:52736
 v_mfma_f32_16x16x32_bf16 v[88:91], a[84:87], v[132:135], v[88:91]
 v_mfma_f32_16x16x32_bf16 v[88:91], a[100:103], v[136:139], v[88:91]
 v_mfma_f32_16x16x32_bf16 v[88:91], a[116:119], v[140:143], v[88:91]
 buffer_load_dwordx4 a[36:39], v252, s[20:23], s55 offen offset:1024 sc1
 v_mfma_f32_16x16x32_bf16 v[104:107], a[72:75], v[128:131], v[104:107]
 v_mfma_f32_16x16x32_bf16 v[104:107], a[88:91], v[132:135], v[104:107]
 v_mfma_f32_16x16x32_bf16 v[104:107], a[104:107], v[136:139], v[104:107]
 v_mfma_f32_16x16x32_bf16 v[104:107], a[120:123], v[140:143], v[104:107]
 buffer_load_dwordx4 a[40:43], v252, s[20:23], s55 offen offset:2048 sc1
 v_mfma_f32_16x16x32_bf16 v[120:123], a[76:79], v[128:131], v[120:123]
 v_mfma_f32_16x16x32_bf16 v[120:123], a[92:95], v[132:135], v[120:123]
 v_mfma_f32_16x16x32_bf16 v[120:123], a[108:111], v[136:139], v[120:123]
 s_waitcnt vmcnt(19)
 s_barrier
 v_mfma_f32_16x16x32_bf16 v[120:123], a[124:127], v[140:143], v[120:123]
 s_waitcnt lgkmcnt(0)
 buffer_load_dwordx4 a[44:47], v252, s[20:23], s55 offen offset:3072 sc1
 v_mfma_f32_16x16x32_bf16 v[76:79], a[64:67], v[144:147], v[76:79]
 ds_read_b128 v[128:131], v213 offset:4096
 v_mfma_f32_16x16x32_bf16 v[76:79], a[80:83], v[148:151], v[76:79]
 ds_read_b128 v[132:135], v213 offset:4608
 v_mfma_f32_16x16x32_bf16 v[76:79], a[96:99], v[152:155], v[76:79]
 ds_read_b128 v[136:139], v213 offset:5120
 v_mfma_f32_16x16x32_bf16 v[76:79], a[112:115], v[156:159], v[76:79]
 s_mov_b32 s54, 143360
 buffer_load_dwordx4 a[48:51], v252, s[20:23], s54 offen offset:0 sc1
 v_mfma_f32_16x16x32_bf16 v[92:95], a[68:71], v[144:147], v[92:95]
 ds_read_b128 v[140:143], v213 offset:5632
 v_mfma_f32_16x16x32_bf16 v[92:95], a[84:87], v[148:151], v[92:95]
 v_mfma_f32_16x16x32_bf16 v[92:95], a[100:103], v[152:155], v[92:95]
 v_mfma_f32_16x16x32_bf16 v[92:95], a[116:119], v[156:159], v[92:95]
 buffer_load_dwordx4 a[52:55], v252, s[20:23], s54 offen offset:1024 sc1
 v_mfma_f32_16x16x32_bf16 v[108:111], a[72:75], v[144:147], v[108:111]
 v_mfma_f32_16x16x32_bf16 v[108:111], a[88:91], v[148:151], v[108:111]
 v_mfma_f32_16x16x32_bf16 v[108:111], a[104:107], v[152:155], v[108:111]
 v_mfma_f32_16x16x32_bf16 v[108:111], a[120:123], v[156:159], v[108:111]
 buffer_load_dwordx4 a[56:59], v252, s[20:23], s54 offen offset:2048 sc1
 v_mfma_f32_16x16x32_bf16 v[124:127], a[76:79], v[144:147], v[124:127]
 v_mfma_f32_16x16x32_bf16 v[124:127], a[92:95], v[148:151], v[124:127]
 v_mfma_f32_16x16x32_bf16 v[124:127], a[108:111], v[152:155], v[124:127]
 v_mfma_f32_16x16x32_bf16 v[124:127], a[124:127], v[156:159], v[124:127]
 s_waitcnt lgkmcnt(0)
 buffer_load_dwordx4 a[60:63], v252, s[20:23], s54 offen offset:3072 sc1
 v_mfma_f32_16x16x32_bf16 v[64:67], a[128:131], v[128:131], v[64:67]
 ds_read_b128 v[144:147], v213 offset:20480
 v_mfma_f32_16x16x32_bf16 v[64:67], a[144:147], v[132:135], v[64:67]
 ds_read_b128 v[148:151], v213 offset:20992
 v_mfma_f32_16x16x32_bf16 v[64:67], a[160:163], v[136:139], v[64:67]
 ds_read_b128 v[152:155], v213 offset:21504
 v_mfma_f32_16x16x32_bf16 v[64:67], a[176:179], v[140:143], v[64:67]
 s_mov_b32 s55, 147456
 buffer_load_dwordx4 a[64:67], v252, s[20:23], s55 offen offset:0 sc1
 v_mfma_f32_16x16x32_bf16 v[80:83], a[132:135], v[128:131], v[80:83]
 ds_read_b128 v[156:159], v213 offset:22016
 v_mfma_f32_16x16x32_bf16 v[80:83], a[148:151], v[132:135], v[80:83]
 v_mfma_f32_16x16x32_bf16 v[80:83], a[164:167], v[136:139], v[80:83]
 v_mfma_f32_16x16x32_bf16 v[80:83], a[180:183], v[140:143], v[80:83]
 buffer_load_dwordx4 a[68:71], v252, s[20:23], s55 offen offset:1024 sc1
 v_mfma_f32_16x16x32_bf16 v[96:99], a[136:139], v[128:131], v[96:99]
 v_mfma_f32_16x16x32_bf16 v[96:99], a[152:155], v[132:135], v[96:99]
 v_mfma_f32_16x16x32_bf16 v[96:99], a[168:171], v[136:139], v[96:99]
 v_mfma_f32_16x16x32_bf16 v[96:99], a[184:187], v[140:143], v[96:99]
 buffer_load_dwordx4 a[72:75], v252, s[20:23], s55 offen offset:2048 sc1
 v_mfma_f32_16x16x32_bf16 v[112:115], a[140:143], v[128:131], v[112:115]
 v_mfma_f32_16x16x32_bf16 v[112:115], a[156:159], v[132:135], v[112:115]
 v_mfma_f32_16x16x32_bf16 v[112:115], a[172:175], v[136:139], v[112:115]
 v_mfma_f32_16x16x32_bf16 v[112:115], a[188:191], v[140:143], v[112:115]
 s_waitcnt lgkmcnt(0)
 buffer_load_dwordx4 a[76:79], v252, s[20:23], s55 offen offset:3072 sc1
 v_mfma_f32_16x16x32_bf16 v[68:71], a[128:131], v[144:147], v[68:71]
 ds_read_b128 v[128:131], v213 offset:36864
 v_mfma_f32_16x16x32_bf16 v[68:71], a[144:147], v[148:151], v[68:71]
 ds_read_b128 v[132:135], v213 offset:37376
 v_mfma_f32_16x16x32_bf16 v[68:71], a[160:163], v[152:155], v[68:71]
 ds_read_b128 v[136:139], v213 offset:37888
 v_mfma_f32_16x16x32_bf16 v[68:71], a[176:179], v[156:159], v[68:71]
 s_mov_b32 s54, 151552
 buffer_load_dwordx4 a[80:83], v252, s[20:23], s54 offen offset:0 sc1
 v_mfma_f32_16x16x32_bf16 v[84:87], a[132:135], v[144:147], v[84:87]
 ds_read_b128 v[140:143], v213 offset:38400
 v_mfma_f32_16x16x32_bf16 v[84:87], a[148:151], v[148:151], v[84:87]
 v_mfma_f32_16x16x32_bf16 v[84:87], a[164:167], v[152:155], v[84:87]
 v_mfma_f32_16x16x32_bf16 v[84:87], a[180:183], v[156:159], v[84:87]
 buffer_load_dwordx4 a[84:87], v252, s[20:23], s54 offen offset:1024 sc1
 v_mfma_f32_16x16x32_bf16 v[100:103], a[136:139], v[144:147], v[100:103]
 v_mfma_f32_16x16x32_bf16 v[100:103], a[152:155], v[148:151], v[100:103]
 v_mfma_f32_16x16x32_bf16 v[100:103], a[168:171], v[152:155], v[100:103]
 v_mfma_f32_16x16x32_bf16 v[100:103], a[184:187], v[156:159], v[100:103]
 buffer_load_dwordx4 a[88:91], v252, s[20:23], s54 offen offset:2048 sc1
 v_mfma_f32_16x16x32_bf16 v[116:119], a[140:143], v[144:147], v[116:119]
 v_mfma_f32_16x16x32_bf16 v[116:119], a[156:159], v[148:151], v[116:119]
 v_mfma_f32_16x16x32_bf16 v[116:119], a[172:175], v[152:155], v[116:119]
 v_mfma_f32_16x16x32_bf16 v[116:119], a[188:191], v[156:159], v[116:119]
 s_waitcnt lgkmcnt(0)
 buffer_load_dwordx4 a[92:95], v252, s[20:23], s54 offen offset:3072 sc1
 v_mfma_f32_16x16x32_bf16 v[72:75], a[128:131], v[128:131], v[72:75]
 ds_read_b128 v[144:147], v213 offset:53248
 v_mfma_f32_16x16x32_bf16 v[72:75], a[144:147], v[132:135], v[72:75]
 ds_read_b128 v[148:151], v213 offset:53760
 v_mfma_f32_16x16x32_bf16 v[72:75], a[160:163], v[136:139], v[72:75]
 ds_read_b128 v[152:155], v213 offset:54272
 v_mfma_f32_16x16x32_bf16 v[72:75], a[176:179], v[140:143], v[72:75]
 s_mov_b32 s55, 155648
 buffer_load_dwordx4 a[96:99], v252, s[20:23], s55 offen offset:0 sc1
 v_mfma_f32_16x16x32_bf16 v[88:91], a[132:135], v[128:131], v[88:91]
 ds_read_b128 v[156:159], v213 offset:54784
 v_mfma_f32_16x16x32_bf16 v[88:91], a[148:151], v[132:135], v[88:91]
 v_mfma_f32_16x16x32_bf16 v[88:91], a[164:167], v[136:139], v[88:91]
 v_mfma_f32_16x16x32_bf16 v[88:91], a[180:183], v[140:143], v[88:91]
 buffer_load_dwordx4 a[100:103], v252, s[20:23], s55 offen offset:1024 sc1
 v_mfma_f32_16x16x32_bf16 v[104:107], a[136:139], v[128:131], v[104:107]
 v_mfma_f32_16x16x32_bf16 v[104:107], a[152:155], v[132:135], v[104:107]
 v_mfma_f32_16x16x32_bf16 v[104:107], a[168:171], v[136:139], v[104:107]
 v_mfma_f32_16x16x32_bf16 v[104:107], a[184:187], v[140:143], v[104:107]
 buffer_load_dwordx4 a[104:107], v252, s[20:23], s55 offen offset:2048 sc1
 v_mfma_f32_16x16x32_bf16 v[120:123], a[140:143], v[128:131], v[120:123]
 v_mfma_f32_16x16x32_bf16 v[120:123], a[156:159], v[132:135], v[120:123]
 v_mfma_f32_16x16x32_bf16 v[120:123], a[172:175], v[136:139], v[120:123]
 v_mfma_f32_16x16x32_bf16 v[120:123], a[188:191], v[140:143], v[120:123]
 s_waitcnt lgkmcnt(0)
 buffer_load_dwordx4 a[108:111], v252, s[20:23], s55 offen offset:3072 sc1
 v_mfma_f32_16x16x32_bf16 v[76:79], a[128:131], v[144:147], v[76:79]
 ds_read_b128 v[128:131], v213 offset:6144
 v_mfma_f32_16x16x32_bf16 v[76:79], a[144:147], v[148:151], v[76:79]
 ds_read_b128 v[132:135], v213 offset:6656
 v_mfma_f32_16x16x32_bf16 v[76:79], a[160:163], v[152:155], v[76:79]
 ds_read_b128 v[136:139], v213 offset:7168
 v_mfma_f32_16x16x32_bf16 v[76:79], a[176:179], v[156:159], v[76:79]
 s_mov_b32 s54, 159744
 buffer_load_dwordx4 a[112:115], v252, s[20:23], s54 offen offset:0 sc1
 v_mfma_f32_16x16x32_bf16 v[92:95], a[132:135], v[144:147], v[92:95]
 ds_read_b128 v[140:143], v213 offset:7680
 v_mfma_f32_16x16x32_bf16 v[92:95], a[148:151], v[148:151], v[92:95]
 v_mfma_f32_16x16x32_bf16 v[92:95], a[164:167], v[152:155], v[92:95]
 v_mfma_f32_16x16x32_bf16 v[92:95], a[180:183], v[156:159], v[92:95]
 buffer_load_dwordx4 a[116:119], v252, s[20:23], s54 offen offset:1024 sc1
 v_mfma_f32_16x16x32_bf16 v[108:111], a[136:139], v[144:147], v[108:111]
 v_mfma_f32_16x16x32_bf16 v[108:111], a[152:155], v[148:151], v[108:111]
 v_mfma_f32_16x16x32_bf16 v[108:111], a[168:171], v[152:155], v[108:111]
 v_mfma_f32_16x16x32_bf16 v[108:111], a[184:187], v[156:159], v[108:111]
 buffer_load_dwordx4 a[120:123], v252, s[20:23], s54 offen offset:2048 sc1
 v_mfma_f32_16x16x32_bf16 v[124:127], a[140:143], v[144:147], v[124:127]
 v_mfma_f32_16x16x32_bf16 v[124:127], a[156:159], v[148:151], v[124:127]
 v_mfma_f32_16x16x32_bf16 v[124:127], a[172:175], v[152:155], v[124:127]
 v_mfma_f32_16x16x32_bf16 v[124:127], a[188:191], v[156:159], v[124:127]
 s_waitcnt lgkmcnt(0)
 buffer_load_dwordx4 a[124:127], v252, s[20:23], s54 offen offset:3072 sc1
 v_mfma_f32_16x16x32_bf16 v[64:67], a[192:195], v[128:131], v[64:67]
 ds_read_b128 v[144:147], v213 offset:22528
 v_mfma_f32_16x16x32_bf16 v[64:67], a[208:211], v[132:135], v[64:67]
 ds_read_b128 v[148:151], v213 offset:23040
 v_mfma_f32_16x16x32_bf16 v[64:67], a[224:227], v[136:139], v[64:67]
 ds_read_b128 v[152:155], v213 offset:23552
 v_mfma_f32_16x16x32_bf16 v[64:67], a[240:243], v[140:143], v[64:67]
 s_mov_b32 s55, 163840
 buffer_load_dwordx4 a[128:131], v252, s[20:23], s55 offen offset:0 sc1
 v_mfma_f32_16x16x32_bf16 v[80:83], a[196:199], v[128:131], v[80:83]
 ds_read_b128 v[156:159], v213 offset:24064
 v_mfma_f32_16x16x32_bf16 v[80:83], a[212:215], v[132:135], v[80:83]
 v_mfma_f32_16x16x32_bf16 v[80:83], a[228:231], v[136:139], v[80:83]
 v_mfma_f32_16x16x32_bf16 v[80:83], a[244:247], v[140:143], v[80:83]
 buffer_load_dwordx4 a[132:135], v252, s[20:23], s55 offen offset:1024 sc1
 v_mfma_f32_16x16x32_bf16 v[96:99], a[200:203], v[128:131], v[96:99]
 v_mfma_f32_16x16x32_bf16 v[96:99], a[216:219], v[132:135], v[96:99]
 v_mfma_f32_16x16x32_bf16 v[96:99], a[232:235], v[136:139], v[96:99]
 v_mfma_f32_16x16x32_bf16 v[96:99], a[248:251], v[140:143], v[96:99]
 buffer_load_dwordx4 a[136:139], v252, s[20:23], s55 offen offset:2048 sc1
 v_mfma_f32_16x16x32_bf16 v[112:115], a[204:207], v[128:131], v[112:115]
 v_mfma_f32_16x16x32_bf16 v[112:115], a[220:223], v[132:135], v[112:115]
 v_mfma_f32_16x16x32_bf16 v[112:115], a[236:239], v[136:139], v[112:115]
 v_mfma_f32_16x16x32_bf16 v[112:115], a[252:255], v[140:143], v[112:115]
 s_waitcnt lgkmcnt(0)
 buffer_load_dwordx4 a[140:143], v252, s[20:23], s55 offen offset:3072 sc1
 v_mfma_f32_16x16x32_bf16 v[68:71], a[192:195], v[144:147], v[68:71]
 ds_read_b128 v[128:131], v213 offset:38912
 v_mfma_f32_16x16x32_bf16 v[68:71], a[208:211], v[148:151], v[68:71]
 ds_read_b128 v[132:135], v213 offset:39424
 v_mfma_f32_16x16x32_bf16 v[68:71], a[224:227], v[152:155], v[68:71]
 ds_read_b128 v[136:139], v213 offset:39936
 v_mfma_f32_16x16x32_bf16 v[68:71], a[240:243], v[156:159], v[68:71]
 s_mov_b32 s54, 167936
 buffer_load_dwordx4 a[144:147], v252, s[20:23], s54 offen offset:0 sc1
 v_mfma_f32_16x16x32_bf16 v[84:87], a[196:199], v[144:147], v[84:87]
 ds_read_b128 v[140:143], v213 offset:40448
 v_mfma_f32_16x16x32_bf16 v[84:87], a[212:215], v[148:151], v[84:87]
 v_cvt_pk_bf16_f32 v216, v64, v65
 v_cvt_pk_bf16_f32 v217, v66, v67
 v_mfma_f32_16x16x32_bf16 v[84:87], a[228:231], v[152:155], v[84:87]
 v_cvt_pk_bf16_f32 v218, v80, v81
 v_cvt_pk_bf16_f32 v219, v82, v83
 v_mfma_f32_16x16x32_bf16 v[84:87], a[244:247], v[156:159], v[84:87]
 buffer_load_dwordx4 a[148:151], v252, s[20:23], s54 offen offset:1024 sc1
 v_pk_max_i16 v216, v216, 0
 v_pk_max_i16 v217, v217, 0
 v_mfma_f32_16x16x32_bf16 v[100:103], a[200:203], v[144:147], v[100:103]
 v_pk_max_i16 v218, v218, 0
 v_pk_max_i16 v219, v219, 0
 v_mfma_f32_16x16x32_bf16 v[100:103], a[216:219], v[148:151], v[100:103]
 ds_write_b128 v205, v[216:219] offset:0
 v_cvt_pk_bf16_f32 v220, v96, v97
 v_mfma_f32_16x16x32_bf16 v[100:103], a[232:235], v[152:155], v[100:103]
 v_cvt_pk_bf16_f32 v221, v98, v99
 v_cvt_pk_bf16_f32 v222, v112, v113
 v_mfma_f32_16x16x32_bf16 v[100:103], a[248:251], v[156:159], v[100:103]
 buffer_load_dwordx4 a[152:155], v252, s[20:23], s54 offen offset:2048 sc1
 v_cvt_pk_bf16_f32 v223, v114, v115
 v_pk_max_i16 v220, v220, 0
 v_mfma_f32_16x16x32_bf16 v[116:119], a[204:207], v[144:147], v[116:119]
 v_pk_max_i16 v221, v221, 0
 v_pk_max_i16 v222, v222, 0
 v_mfma_f32_16x16x32_bf16 v[116:119], a[220:223], v[148:151], v[116:119]
 v_pk_max_i16 v223, v223, 0
 ds_write_b128 v205, v[220:223] offset:512
 v_mfma_f32_16x16x32_bf16 v[116:119], a[236:239], v[152:155], v[116:119]
 v_mfma_f32_16x16x32_bf16 v[116:119], a[252:255], v[156:159], v[116:119]
 s_waitcnt lgkmcnt(2)
 buffer_load_dwordx4 a[156:159], v252, s[20:23], s54 offen offset:3072 sc1
 v_mfma_f32_16x16x32_bf16 v[72:75], a[192:195], v[128:131], v[72:75]
 ds_read_b128 v[144:147], v213 offset:55296
 v_mfma_f32_16x16x32_bf16 v[72:75], a[208:211], v[132:135], v[72:75]
 ds_read_b128 v[148:151], v213 offset:55808
 v_mfma_f32_16x16x32_bf16 v[72:75], a[224:227], v[136:139], v[72:75]
 ds_read_b128 v[152:155], v213 offset:56320
 v_mfma_f32_16x16x32_bf16 v[72:75], a[240:243], v[140:143], v[72:75]
 s_mov_b32 s55, 172032
 buffer_load_dwordx4 a[160:163], v252, s[20:23], s55 offen offset:0 sc1
 v_mfma_f32_16x16x32_bf16 v[88:91], a[196:199], v[128:131], v[88:91]
 ds_read_b128 v[156:159], v213 offset:56832
 v_mfma_f32_16x16x32_bf16 v[88:91], a[212:215], v[132:135], v[88:91]
 v_cvt_pk_bf16_f32 v192, v68, v69
 v_cvt_pk_bf16_f32 v193, v70, v71
 v_mfma_f32_16x16x32_bf16 v[88:91], a[228:231], v[136:139], v[88:91]
 v_cvt_pk_bf16_f32 v194, v84, v85
 v_cvt_pk_bf16_f32 v195, v86, v87
 v_mfma_f32_16x16x32_bf16 v[88:91], a[244:247], v[140:143], v[88:91]
 buffer_load_dwordx4 a[164:167], v252, s[20:23], s55 offen offset:1024 sc1
 v_pk_max_i16 v192, v192, 0
 v_pk_max_i16 v193, v193, 0
 v_mfma_f32_16x16x32_bf16 v[104:107], a[200:203], v[128:131], v[104:107]
 v_pk_max_i16 v194, v194, 0
 v_pk_max_i16 v195, v195, 0
 v_mfma_f32_16x16x32_bf16 v[104:107], a[216:219], v[132:135], v[104:107]
 ds_write_b128 v205, v[192:195] offset:8192
 v_cvt_pk_bf16_f32 v196, v100, v101
 v_mfma_f32_16x16x32_bf16 v[104:107], a[232:235], v[136:139], v[104:107]
 v_cvt_pk_bf16_f32 v197, v102, v103
 v_cvt_pk_bf16_f32 v198, v116, v117
 v_mfma_f32_16x16x32_bf16 v[104:107], a[248:251], v[140:143], v[104:107]
 buffer_load_dwordx4 a[168:171], v252, s[20:23], s55 offen offset:2048 sc1
 v_cvt_pk_bf16_f32 v199, v118, v119
 v_pk_max_i16 v196, v196, 0
 v_mfma_f32_16x16x32_bf16 v[120:123], a[204:207], v[128:131], v[120:123]
 v_pk_max_i16 v197, v197, 0
 v_pk_max_i16 v198, v198, 0
 v_mfma_f32_16x16x32_bf16 v[120:123], a[220:223], v[132:135], v[120:123]
 v_pk_max_i16 v199, v199, 0
 ds_write_b128 v205, v[196:199] offset:8704
 v_mfma_f32_16x16x32_bf16 v[120:123], a[236:239], v[136:139], v[120:123]
 v_mfma_f32_16x16x32_bf16 v[120:123], a[252:255], v[140:143], v[120:123]
 s_waitcnt lgkmcnt(2)
 buffer_load_dwordx4 a[172:175], v252, s[20:23], s55 offen offset:3072 sc1
 v_mfma_f32_16x16x32_bf16 v[76:79], a[192:195], v[144:147], v[76:79]
 v_mfma_f32_16x16x32_bf16 v[76:79], a[208:211], v[148:151], v[76:79]
 v_mfma_f32_16x16x32_bf16 v[76:79], a[224:227], v[152:155], v[76:79]
 v_mfma_f32_16x16x32_bf16 v[76:79], a[240:243], v[156:159], v[76:79]
 s_mov_b32 s54, 176128
 buffer_load_dwordx4 a[176:179], v252, s[20:23], s54 offen offset:0 sc1
 v_mfma_f32_16x16x32_bf16 v[92:95], a[196:199], v[144:147], v[92:95]
 v_mfma_f32_16x16x32_bf16 v[92:95], a[212:215], v[148:151], v[92:95]
 v_cvt_pk_bf16_f32 v216, v72, v73
 v_cvt_pk_bf16_f32 v217, v74, v75
 v_mfma_f32_16x16x32_bf16 v[92:95], a[228:231], v[152:155], v[92:95]
 v_cvt_pk_bf16_f32 v218, v88, v89
 v_cvt_pk_bf16_f32 v219, v90, v91
 v_mfma_f32_16x16x32_bf16 v[92:95], a[244:247], v[156:159], v[92:95]
 buffer_load_dwordx4 a[180:183], v252, s[20:23], s54 offen offset:1024 sc1
 v_pk_max_i16 v216, v216, 0
 v_pk_max_i16 v217, v217, 0
 v_mfma_f32_16x16x32_bf16 v[108:111], a[200:203], v[144:147], v[108:111]
 v_pk_max_i16 v218, v218, 0
 v_pk_max_i16 v219, v219, 0
 v_mfma_f32_16x16x32_bf16 v[108:111], a[216:219], v[148:151], v[108:111]
 ds_write_b128 v205, v[216:219] offset:16384
 v_cvt_pk_bf16_f32 v220, v104, v105
 v_mfma_f32_16x16x32_bf16 v[108:111], a[232:235], v[152:155], v[108:111]
 v_cvt_pk_bf16_f32 v221, v106, v107
 v_cvt_pk_bf16_f32 v222, v120, v121
 v_mfma_f32_16x16x32_bf16 v[108:111], a[248:251], v[156:159], v[108:111]
 buffer_load_dwordx4 a[184:187], v252, s[20:23], s54 offen offset:2048 sc1
 v_cvt_pk_bf16_f32 v223, v122, v123
 v_pk_max_i16 v220, v220, 0
 v_mfma_f32_16x16x32_bf16 v[124:127], a[204:207], v[144:147], v[124:127]
 v_pk_max_i16 v221, v221, 0
 v_pk_max_i16 v222, v222, 0
 v_mfma_f32_16x16x32_bf16 v[124:127], a[220:223], v[148:151], v[124:127]
 v_pk_max_i16 v223, v223, 0
 ds_write_b128 v205, v[220:223] offset:16896
 v_mfma_f32_16x16x32_bf16 v[124:127], a[236:239], v[152:155], v[124:127]
 v_mfma_f32_16x16x32_bf16 v[124:127], a[252:255], v[156:159], v[124:127]
 buffer_load_dwordx4 a[188:191], v252, s[20:23], s54 offen offset:3072 sc1
 s_nop 5
 v_cvt_pk_bf16_f32 v192, v76, v77
 v_cvt_pk_bf16_f32 v193, v78, v79
 v_cvt_pk_bf16_f32 v194, v92, v93
 v_cvt_pk_bf16_f32 v195, v94, v95
 v_pk_max_i16 v192, v192, 0
 v_pk_max_i16 v193, v193, 0
 v_pk_max_i16 v194, v194, 0
 v_pk_max_i16 v195, v195, 0
 ds_write_b128 v205, v[192:195] offset:24576
 v_cvt_pk_bf16_f32 v196, v108, v109
 v_cvt_pk_bf16_f32 v197, v110, v111
 v_cvt_pk_bf16_f32 v198, v124, v125
 v_cvt_pk_bf16_f32 v199, v126, v127
 v_pk_max_i16 v196, v196, 0
 v_pk_max_i16 v197, v197, 0
 v_pk_max_i16 v198, v198, 0
 v_pk_max_i16 v199, v199, 0
 ds_write_b128 v205, v[196:199] offset:25088
 s_waitcnt lgkmcnt(0)
 s_barrier
 ds_read_b128 a[192:195], v52 offset:0
 ds_read_b128 a[196:199], v52 offset:512
 ds_read_b128 a[200:203], v52 offset:1024
 ds_read_b128 a[204:207], v52 offset:1536
 ds_read_b128 a[208:211], v52 offset:2048
 ds_read_b128 a[212:215], v52 offset:2560
 ds_read_b128 a[216:219], v52 offset:3072
 s_mul_i32 s41, s33, 524288
 s_lshl_b32 s42, s32, 13
 s_add_u32 s41, s41, s42
 s_lshr_b32 s42, s32, 1
 s_add_u32 s42, s42, 0
 s_and_b32 s42, s42, 3
 s_lshl_b32 s42, s42, 17
 s_add_u32 s42, s42, s41
 s_add_u32 s42, s42, 22020096
 s_lshr_b32 s43, s32, 1
 s_add_u32 s43, s43, 1
 s_and_b32 s43, s43, 3
 s_lshl_b32 s43, s43, 17
 s_add_u32 s43, s43, s41
 s_add_u32 s43, s43, 22020096
 s_lshr_b32 s44, s32, 1
 s_add_u32 s44, s44, 2
 s_and_b32 s44, s44, 3
 s_lshl_b32 s44, s44, 17
 s_add_u32 s44, s44, s41
 s_add_u32 s44, s44, 22020096
 s_lshr_b32 s45, s32, 1
 s_add_u32 s45, s45, 3
 s_and_b32 s45, s45, 3
 s_lshl_b32 s45, s45, 17
 s_add_u32 s45, s45, s41
 s_add_u32 s45, s45, 22020096
 s_waitcnt vmcnt(0) lgkmcnt(0)
 v_mfma_f32_16x16x32_bf16 v[64:67], a[0:3], a[192:195], 0
 ds_read_b128 a[220:223], v53 offset:0
 v_mfma_f32_16x16x32_bf16 v[64:67], a[32:35], a[196:199], v[64:67]
 ds_read_b128 a[224:227], v53 offset:512
 v_mfma_f32_16x16x32_bf16 v[64:67], a[64:67], a[200:203], v[64:67]
 ds_read_b128 a[228:231], v53 offset:1024
 v_mfma_f32_16x16x32_bf16 v[64:67], a[96:99], a[204:207], v[64:67]
 ds_read_b128 a[232:235], v53 offset:1536
 v_mfma_f32_16x16x32_bf16 v[64:67], a[128:131], a[208:211], v[64:67]
 ds_read_b128 a[236:239], v53 offset:2048
 v_mfma_f32_16x16x32_bf16 v[64:67], a[160:163], a[212:215], v[64:67]
 ds_read_b128 a[240:243], v53 offset:2560
 v_mfma_f32_16x16x32_bf16 v[64:67], v[160:163], a[216:219], v[64:67]
 ds_read_b128 a[244:247], v53 offset:3072
 v_mfma_f32_16x16x32_bf16 v[68:71], a[4:7], a[192:195], 0
 v_mfma_f32_16x16x32_bf16 v[68:71], a[36:39], a[196:199], v[68:71]
 v_mfma_f32_16x16x32_bf16 v[68:71], a[68:71], a[200:203], v[68:71]
 v_mfma_f32_16x16x32_bf16 v[68:71], a[100:103], a[204:207], v[68:71]
 v_mfma_f32_16x16x32_bf16 v[68:71], a[132:135], a[208:211], v[68:71]
 v_mfma_f32_16x16x32_bf16 v[68:71], a[164:167], a[212:215], v[68:71]
 v_mfma_f32_16x16x32_bf16 v[68:71], v[164:167], a[216:219], v[68:71]
 s_waitcnt lgkmcnt(0)
 v_mfma_f32_16x16x32_bf16 v[72:75], a[0:3], a[220:223], 0
 ds_read_b128 a[248:251], v54 offset:0
 v_mfma_f32_16x16x32_bf16 v[72:75], a[32:35], a[224:227], v[72:75]
 ds_read_b128 a[252:255], v54 offset:512
 v_mfma_f32_16x16x32_bf16 v[72:75], a[64:67], a[228:231], v[72:75]
 ds_read_b128 v[128:131], v54 offset:1024
 v_mfma_f32_16x16x32_bf16 v[72:75], a[96:99], a[232:235], v[72:75]
 ds_read_b128 v[132:135], v54 offset:1536
 v_mfma_f32_16x16x32_bf16 v[72:75], a[128:131], a[236:239], v[72:75]
 ds_read_b128 v[136:139], v54 offset:2048
 v_mfma_f32_16x16x32_bf16 v[72:75], a[160:163], a[240:243], v[72:75]
 ds_read_b128 v[140:143], v54 offset:2560
 v_mfma_f32_16x16x32_bf16 v[72:75], v[160:163], a[244:247], v[72:75]
 ds_read_b128 v[144:147], v54 offset:3072
 v_mfma_f32_16x16x32_bf16 v[76:79], a[4:7], a[220:223], 0
 v_cvt_pk_bf16_f32 v232, v64, v65
 v_mfma_f32_16x16x32_bf16 v[76:79], a[36:39], a[224:227], v[76:79]
 v_cvt_pk_bf16_f32 v233, v66, v67
 v_mfma_f32_16x16x32_bf16 v[76:79], a[68:71], a[228:231], v[76:79]
 v_cvt_pk_bf16_f32 v234, v68, v69
 v_mfma_f32_16x16x32_bf16 v[76:79], a[100:103], a[232:235], v[76:79]
 v_cvt_pk_bf16_f32 v235, v70, v71
 v_mfma_f32_16x16x32_bf16 v[76:79], a[132:135], a[236:239], v[76:79]
 buffer_store_dwordx4 v[232:235], v56, s[24:27], s42 offen offset:0 sc1
 v_mfma_f32_16x16x32_bf16 v[76:79], a[164:167], a[240:243], v[76:79]
 ds_write_b128 v57, v[232:235] offset:0
 v_mfma_f32_16x16x32_bf16 v[76:79], v[164:167], a[244:247], v[76:79]
 s_waitcnt lgkmcnt(0)
 v_mfma_f32_16x16x32_bf16 v[80:83], a[0:3], a[248:251], 0
 ds_read_b128 v[148:151], v55 offset:0
 v_mfma_f32_16x16x32_bf16 v[80:83], a[32:35], a[252:255], v[80:83]
 ds_read_b128 v[152:155], v55 offset:512
 v_mfma_f32_16x16x32_bf16 v[80:83], a[64:67], v[128:131], v[80:83]
 ds_read_b128 v[156:159], v55 offset:1024
 v_mfma_f32_16x16x32_bf16 v[80:83], a[96:99], v[132:135], v[80:83]
 ds_read_b128 v[216:219], v55 offset:1536
 v_mfma_f32_16x16x32_bf16 v[80:83], a[128:131], v[136:139], v[80:83]
 ds_read_b128 v[220:223], v55 offset:2048
 v_mfma_f32_16x16x32_bf16 v[80:83], a[160:163], v[140:143], v[80:83]
 ds_read_b128 v[224:227], v55 offset:2560
 v_mfma_f32_16x16x32_bf16 v[80:83], v[160:163], v[144:147], v[80:83]
 ds_read_b128 v[228:231], v55 offset:3072
 v_mfma_f32_16x16x32_bf16 v[84:87], a[4:7], a[248:251], 0
 v_cvt_pk_bf16_f32 v236, v72, v73
 v_mfma_f32_16x16x32_bf16 v[84:87], a[36:39], a[252:255], v[84:87]
 v_cvt_pk_bf16_f32 v237, v74, v75
 v_mfma_f32_16x16x32_bf16 v[84:87], a[68:71], v[128:131], v[84:87]
 v_cvt_pk_bf16_f32 v238, v76, v77
 v_mfma_f32_16x16x32_bf16 v[84:87], a[100:103], v[132:135], v[84:87]
 v_cvt_pk_bf16_f32 v239, v78, v79
 v_mfma_f32_16x16x32_bf16 v[84:87], a[132:135], v[136:139], v[84:87]
 buffer_store_dwordx4 v[236:239], v214, s[24:27], s43 offen offset:0 sc1
 v_mfma_f32_16x16x32_bf16 v[84:87], a[164:167], v[140:143], v[84:87]
 v_mfma_f32_16x16x32_bf16 v[84:87], v[164:167], v[144:147], v[84:87]
 s_waitcnt lgkmcnt(0)
 v_mfma_f32_16x16x32_bf16 v[88:91], a[0:3], v[148:151], 0
 v_mfma_f32_16x16x32_bf16 v[88:91], a[32:35], v[152:155], v[88:91]
 v_mfma_f32_16x16x32_bf16 v[88:91], a[64:67], v[156:159], v[88:91]
 v_mfma_f32_16x16x32_bf16 v[88:91], a[96:99], v[216:219], v[88:91]
 v_mfma_f32_16x16x32_bf16 v[88:91], a[128:131], v[220:223], v[88:91]
 v_mfma_f32_16x16x32_bf16 v[88:91], a[160:163], v[224:227], v[88:91]
 v_mfma_f32_16x16x32_bf16 v[88:91], v[160:163], v[228:231], v[88:91]
 v_mfma_f32_16x16x32_bf16 v[92:95], a[4:7], v[148:151], 0
 v_cvt_pk_bf16_f32 v192, v80, v81
 v_mfma_f32_16x16x32_bf16 v[92:95], a[36:39], v[152:155], v[92:95]
 v_cvt_pk_bf16_f32 v193, v82, v83
 v_mfma_f32_16x16x32_bf16 v[92:95], a[68:71], v[156:159], v[92:95]
 v_cvt_pk_bf16_f32 v194, v84, v85
 v_mfma_f32_16x16x32_bf16 v[92:95], a[100:103], v[216:219], v[92:95]
 v_cvt_pk_bf16_f32 v195, v86, v87
 v_mfma_f32_16x16x32_bf16 v[92:95], a[132:135], v[220:223], v[92:95]
 buffer_store_dwordx4 v[192:195], v214, s[24:27], s44 offen offset:0 sc1
 v_mfma_f32_16x16x32_bf16 v[92:95], a[164:167], v[224:227], v[92:95]
 v_mfma_f32_16x16x32_bf16 v[92:95], v[164:167], v[228:231], v[92:95]
 v_mfma_f32_16x16x32_bf16 v[96:99], a[8:11], a[192:195], 0
 v_mfma_f32_16x16x32_bf16 v[96:99], a[40:43], a[196:199], v[96:99]
 v_mfma_f32_16x16x32_bf16 v[96:99], a[72:75], a[200:203], v[96:99]
 v_mfma_f32_16x16x32_bf16 v[96:99], a[104:107], a[204:207], v[96:99]
 v_mfma_f32_16x16x32_bf16 v[96:99], a[136:139], a[208:211], v[96:99]
 v_mfma_f32_16x16x32_bf16 v[96:99], a[168:171], a[212:215], v[96:99]
 v_mfma_f32_16x16x32_bf16 v[96:99], v[168:171], a[216:219], v[96:99]
 v_mfma_f32_16x16x32_bf16 v[100:103], a[12:15], a[192:195], 0
 v_cvt_pk_bf16_f32 v196, v88, v89
 v_mfma_f32_16x16x32_bf16 v[100:103], a[44:47], a[196:199], v[100:103]
 v_cvt_pk_bf16_f32 v197, v90, v91
 v_mfma_f32_16x16x32_bf16 v[100:103], a[76:79], a[200:203], v[100:103]
 v_cvt_pk_bf16_f32 v198, v92, v93
 v_mfma_f32_16x16x32_bf16 v[100:103], a[108:111], a[204:207], v[100:103]
 v_cvt_pk_bf16_f32 v199, v94, v95
 v_mfma_f32_16x16x32_bf16 v[100:103], a[140:143], a[208:211], v[100:103]
 buffer_store_dwordx4 v[196:199], v214, s[24:27], s45 offen offset:0 sc1
 v_mfma_f32_16x16x32_bf16 v[100:103], a[172:175], a[212:215], v[100:103]
 v_mfma_f32_16x16x32_bf16 v[100:103], v[172:175], a[216:219], v[100:103]
 v_mfma_f32_16x16x32_bf16 v[104:107], a[8:11], a[220:223], 0
 v_mfma_f32_16x16x32_bf16 v[104:107], a[40:43], a[224:227], v[104:107]
 v_mfma_f32_16x16x32_bf16 v[104:107], a[72:75], a[228:231], v[104:107]
 v_mfma_f32_16x16x32_bf16 v[104:107], a[104:107], a[232:235], v[104:107]
 v_mfma_f32_16x16x32_bf16 v[104:107], a[136:139], a[236:239], v[104:107]
 v_mfma_f32_16x16x32_bf16 v[104:107], a[168:171], a[240:243], v[104:107]
 v_mfma_f32_16x16x32_bf16 v[104:107], v[168:171], a[244:247], v[104:107]
 v_mfma_f32_16x16x32_bf16 v[108:111], a[12:15], a[220:223], 0
 v_cvt_pk_bf16_f32 v232, v96, v97
 v_mfma_f32_16x16x32_bf16 v[108:111], a[44:47], a[224:227], v[108:111]
 v_cvt_pk_bf16_f32 v233, v98, v99
 v_mfma_f32_16x16x32_bf16 v[108:111], a[76:79], a[228:231], v[108:111]
 v_cvt_pk_bf16_f32 v234, v100, v101
 v_mfma_f32_16x16x32_bf16 v[108:111], a[108:111], a[232:235], v[108:111]
 v_cvt_pk_bf16_f32 v235, v102, v103
 v_mfma_f32_16x16x32_bf16 v[108:111], a[140:143], a[236:239], v[108:111]
 buffer_store_dwordx4 v[232:235], v56, s[24:27], s42 offen offset:512 sc1
 v_mfma_f32_16x16x32_bf16 v[108:111], a[172:175], a[240:243], v[108:111]
 ds_write_b128 v57, v[232:235] offset:512
 v_mfma_f32_16x16x32_bf16 v[108:111], v[172:175], a[244:247], v[108:111]
 v_mfma_f32_16x16x32_bf16 v[112:115], a[8:11], a[248:251], 0
 v_mfma_f32_16x16x32_bf16 v[112:115], a[40:43], a[252:255], v[112:115]
 v_mfma_f32_16x16x32_bf16 v[112:115], a[72:75], v[128:131], v[112:115]
 v_mfma_f32_16x16x32_bf16 v[112:115], a[104:107], v[132:135], v[112:115]
 v_mfma_f32_16x16x32_bf16 v[112:115], a[136:139], v[136:139], v[112:115]
 v_mfma_f32_16x16x32_bf16 v[112:115], a[168:171], v[140:143], v[112:115]
 v_mfma_f32_16x16x32_bf16 v[112:115], v[168:171], v[144:147], v[112:115]
 v_mfma_f32_16x16x32_bf16 v[116:119], a[12:15], a[248:251], 0
 v_cvt_pk_bf16_f32 v236, v104, v105
 v_mfma_f32_16x16x32_bf16 v[116:119], a[44:47], a[252:255], v[116:119]
 v_cvt_pk_bf16_f32 v237, v106, v107
 v_mfma_f32_16x16x32_bf16 v[116:119], a[76:79], v[128:131], v[116:119]
 v_cvt_pk_bf16_f32 v238, v108, v109
 v_mfma_f32_16x16x32_bf16 v[116:119], a[108:111], v[132:135], v[116:119]
 v_cvt_pk_bf16_f32 v239, v110, v111
 v_mfma_f32_16x16x32_bf16 v[116:119], a[140:143], v[136:139], v[116:119]
 buffer_store_dwordx4 v[236:239], v214, s[24:27], s43 offen offset:512 sc1
 v_mfma_f32_16x16x32_bf16 v[116:119], a[172:175], v[140:143], v[116:119]
 v_mfma_f32_16x16x32_bf16 v[116:119], v[172:175], v[144:147], v[116:119]
 v_mfma_f32_16x16x32_bf16 v[120:123], a[8:11], v[148:151], 0
 v_mfma_f32_16x16x32_bf16 v[120:123], a[40:43], v[152:155], v[120:123]
 v_mfma_f32_16x16x32_bf16 v[120:123], a[72:75], v[156:159], v[120:123]
 v_mfma_f32_16x16x32_bf16 v[120:123], a[104:107], v[216:219], v[120:123]
 v_mfma_f32_16x16x32_bf16 v[120:123], a[136:139], v[220:223], v[120:123]
 v_mfma_f32_16x16x32_bf16 v[120:123], a[168:171], v[224:227], v[120:123]
 v_mfma_f32_16x16x32_bf16 v[120:123], v[168:171], v[228:231], v[120:123]
 v_mfma_f32_16x16x32_bf16 v[124:127], a[12:15], v[148:151], 0
 v_cvt_pk_bf16_f32 v192, v112, v113
 v_mfma_f32_16x16x32_bf16 v[124:127], a[44:47], v[152:155], v[124:127]
 v_cvt_pk_bf16_f32 v193, v114, v115
 v_mfma_f32_16x16x32_bf16 v[124:127], a[76:79], v[156:159], v[124:127]
 v_cvt_pk_bf16_f32 v194, v116, v117
 v_mfma_f32_16x16x32_bf16 v[124:127], a[108:111], v[216:219], v[124:127]
 v_cvt_pk_bf16_f32 v195, v118, v119
 v_mfma_f32_16x16x32_bf16 v[124:127], a[140:143], v[220:223], v[124:127]
 buffer_store_dwordx4 v[192:195], v214, s[24:27], s44 offen offset:512 sc1
 v_mfma_f32_16x16x32_bf16 v[124:127], a[172:175], v[224:227], v[124:127]
 v_mfma_f32_16x16x32_bf16 v[124:127], v[172:175], v[228:231], v[124:127]
 v_mfma_f32_16x16x32_bf16 v[64:67], a[16:19], a[192:195], 0
 v_mfma_f32_16x16x32_bf16 v[64:67], a[48:51], a[196:199], v[64:67]
 v_mfma_f32_16x16x32_bf16 v[64:67], a[80:83], a[200:203], v[64:67]
 v_mfma_f32_16x16x32_bf16 v[64:67], a[112:115], a[204:207], v[64:67]
 v_mfma_f32_16x16x32_bf16 v[64:67], a[144:147], a[208:211], v[64:67]
 v_mfma_f32_16x16x32_bf16 v[64:67], a[176:179], a[212:215], v[64:67]
 v_mfma_f32_16x16x32_bf16 v[64:67], v[176:179], a[216:219], v[64:67]
 v_mfma_f32_16x16x32_bf16 v[68:71], a[20:23], a[192:195], 0
 v_cvt_pk_bf16_f32 v196, v120, v121
 v_mfma_f32_16x16x32_bf16 v[68:71], a[52:55], a[196:199], v[68:71]
 v_cvt_pk_bf16_f32 v197, v122, v123
 v_mfma_f32_16x16x32_bf16 v[68:71], a[84:87], a[200:203], v[68:71]
 v_cvt_pk_bf16_f32 v198, v124, v125
 v_mfma_f32_16x16x32_bf16 v[68:71], a[116:119], a[204:207], v[68:71]
 v_cvt_pk_bf16_f32 v199, v126, v127
 v_mfma_f32_16x16x32_bf16 v[68:71], a[148:151], a[208:211], v[68:71]
 buffer_store_dwordx4 v[196:199], v214, s[24:27], s45 offen offset:512 sc1
 v_mfma_f32_16x16x32_bf16 v[68:71], a[180:183], a[212:215], v[68:71]
 v_mfma_f32_16x16x32_bf16 v[68:71], v[180:183], a[216:219], v[68:71]
 v_mfma_f32_16x16x32_bf16 v[72:75], a[16:19], a[220:223], 0
 v_mfma_f32_16x16x32_bf16 v[72:75], a[48:51], a[224:227], v[72:75]
 v_mfma_f32_16x16x32_bf16 v[72:75], a[80:83], a[228:231], v[72:75]
 v_mfma_f32_16x16x32_bf16 v[72:75], a[112:115], a[232:235], v[72:75]
 v_mfma_f32_16x16x32_bf16 v[72:75], a[144:147], a[236:239], v[72:75]
 v_mfma_f32_16x16x32_bf16 v[72:75], a[176:179], a[240:243], v[72:75]
 v_mfma_f32_16x16x32_bf16 v[72:75], v[176:179], a[244:247], v[72:75]
 v_mfma_f32_16x16x32_bf16 v[76:79], a[20:23], a[220:223], 0
 v_cvt_pk_bf16_f32 v232, v64, v65
 v_mfma_f32_16x16x32_bf16 v[76:79], a[52:55], a[224:227], v[76:79]
 v_cvt_pk_bf16_f32 v233, v66, v67
 v_mfma_f32_16x16x32_bf16 v[76:79], a[84:87], a[228:231], v[76:79]
 v_cvt_pk_bf16_f32 v234, v68, v69
 v_mfma_f32_16x16x32_bf16 v[76:79], a[116:119], a[232:235], v[76:79]
 v_cvt_pk_bf16_f32 v235, v70, v71
 v_mfma_f32_16x16x32_bf16 v[76:79], a[148:151], a[236:239], v[76:79]
 buffer_store_dwordx4 v[232:235], v56, s[24:27], s42 offen offset:1024 sc1
 v_mfma_f32_16x16x32_bf16 v[76:79], a[180:183], a[240:243], v[76:79]
 ds_write_b128 v57, v[232:235] offset:1024
 v_mfma_f32_16x16x32_bf16 v[76:79], v[180:183], a[244:247], v[76:79]
 v_mfma_f32_16x16x32_bf16 v[80:83], a[16:19], a[248:251], 0
 v_mfma_f32_16x16x32_bf16 v[80:83], a[48:51], a[252:255], v[80:83]
 v_mfma_f32_16x16x32_bf16 v[80:83], a[80:83], v[128:131], v[80:83]
 v_mfma_f32_16x16x32_bf16 v[80:83], a[112:115], v[132:135], v[80:83]
 v_mfma_f32_16x16x32_bf16 v[80:83], a[144:147], v[136:139], v[80:83]
 v_mfma_f32_16x16x32_bf16 v[80:83], a[176:179], v[140:143], v[80:83]
 v_mfma_f32_16x16x32_bf16 v[80:83], v[176:179], v[144:147], v[80:83]
 v_mfma_f32_16x16x32_bf16 v[84:87], a[20:23], a[248:251], 0
 v_cvt_pk_bf16_f32 v236, v72, v73
 v_mfma_f32_16x16x32_bf16 v[84:87], a[52:55], a[252:255], v[84:87]
 v_cvt_pk_bf16_f32 v237, v74, v75
 v_mfma_f32_16x16x32_bf16 v[84:87], a[84:87], v[128:131], v[84:87]
 v_cvt_pk_bf16_f32 v238, v76, v77
 v_mfma_f32_16x16x32_bf16 v[84:87], a[116:119], v[132:135], v[84:87]
 v_cvt_pk_bf16_f32 v239, v78, v79
 v_mfma_f32_16x16x32_bf16 v[84:87], a[148:151], v[136:139], v[84:87]
 buffer_store_dwordx4 v[236:239], v214, s[24:27], s43 offen offset:1024 sc1
 v_mfma_f32_16x16x32_bf16 v[84:87], a[180:183], v[140:143], v[84:87]
 v_mfma_f32_16x16x32_bf16 v[84:87], v[180:183], v[144:147], v[84:87]
 v_mfma_f32_16x16x32_bf16 v[88:91], a[16:19], v[148:151], 0
 v_mfma_f32_16x16x32_bf16 v[88:91], a[48:51], v[152:155], v[88:91]
 v_mfma_f32_16x16x32_bf16 v[88:91], a[80:83], v[156:159], v[88:91]
 v_mfma_f32_16x16x32_bf16 v[88:91], a[112:115], v[216:219], v[88:91]
 v_mfma_f32_16x16x32_bf16 v[88:91], a[144:147], v[220:223], v[88:91]
 v_mfma_f32_16x16x32_bf16 v[88:91], a[176:179], v[224:227], v[88:91]
 v_mfma_f32_16x16x32_bf16 v[88:91], v[176:179], v[228:231], v[88:91]
 v_mfma_f32_16x16x32_bf16 v[92:95], a[20:23], v[148:151], 0
 v_cvt_pk_bf16_f32 v192, v80, v81
 v_mfma_f32_16x16x32_bf16 v[92:95], a[52:55], v[152:155], v[92:95]
 v_cvt_pk_bf16_f32 v193, v82, v83
 v_mfma_f32_16x16x32_bf16 v[92:95], a[84:87], v[156:159], v[92:95]
 v_cvt_pk_bf16_f32 v194, v84, v85
 v_mfma_f32_16x16x32_bf16 v[92:95], a[116:119], v[216:219], v[92:95]
 v_cvt_pk_bf16_f32 v195, v86, v87
 v_mfma_f32_16x16x32_bf16 v[92:95], a[148:151], v[220:223], v[92:95]
 buffer_store_dwordx4 v[192:195], v214, s[24:27], s44 offen offset:1024 sc1
 v_mfma_f32_16x16x32_bf16 v[92:95], a[180:183], v[224:227], v[92:95]
 v_mfma_f32_16x16x32_bf16 v[92:95], v[180:183], v[228:231], v[92:95]
 v_mfma_f32_16x16x32_bf16 v[96:99], a[24:27], a[192:195], 0
 v_mfma_f32_16x16x32_bf16 v[96:99], a[56:59], a[196:199], v[96:99]
 v_mfma_f32_16x16x32_bf16 v[96:99], a[88:91], a[200:203], v[96:99]
 v_mfma_f32_16x16x32_bf16 v[96:99], a[120:123], a[204:207], v[96:99]
 v_mfma_f32_16x16x32_bf16 v[96:99], a[152:155], a[208:211], v[96:99]
 v_mfma_f32_16x16x32_bf16 v[96:99], a[184:187], a[212:215], v[96:99]
 v_mfma_f32_16x16x32_bf16 v[96:99], v[184:187], a[216:219], v[96:99]
 v_mfma_f32_16x16x32_bf16 v[100:103], a[28:31], a[192:195], 0
 v_cvt_pk_bf16_f32 v196, v88, v89
 v_mfma_f32_16x16x32_bf16 v[100:103], a[60:63], a[196:199], v[100:103]
 v_cvt_pk_bf16_f32 v197, v90, v91
 v_mfma_f32_16x16x32_bf16 v[100:103], a[92:95], a[200:203], v[100:103]
 v_cvt_pk_bf16_f32 v198, v92, v93
 v_mfma_f32_16x16x32_bf16 v[100:103], a[124:127], a[204:207], v[100:103]
 v_cvt_pk_bf16_f32 v199, v94, v95
 v_mfma_f32_16x16x32_bf16 v[100:103], a[156:159], a[208:211], v[100:103]
 buffer_store_dwordx4 v[196:199], v214, s[24:27], s45 offen offset:1024 sc1
 v_mfma_f32_16x16x32_bf16 v[100:103], a[188:191], a[212:215], v[100:103]
 v_mfma_f32_16x16x32_bf16 v[100:103], v[188:191], a[216:219], v[100:103]
 v_mfma_f32_16x16x32_bf16 v[104:107], a[24:27], a[220:223], 0
 v_mfma_f32_16x16x32_bf16 v[104:107], a[56:59], a[224:227], v[104:107]
 v_mfma_f32_16x16x32_bf16 v[104:107], a[88:91], a[228:231], v[104:107]
 v_mfma_f32_16x16x32_bf16 v[104:107], a[120:123], a[232:235], v[104:107]
 v_mfma_f32_16x16x32_bf16 v[104:107], a[152:155], a[236:239], v[104:107]
 v_mfma_f32_16x16x32_bf16 v[104:107], a[184:187], a[240:243], v[104:107]
 v_mfma_f32_16x16x32_bf16 v[104:107], v[184:187], a[244:247], v[104:107]
 v_mfma_f32_16x16x32_bf16 v[108:111], a[28:31], a[220:223], 0
 v_cvt_pk_bf16_f32 v232, v96, v97
 v_mfma_f32_16x16x32_bf16 v[108:111], a[60:63], a[224:227], v[108:111]
 v_cvt_pk_bf16_f32 v233, v98, v99
 v_mfma_f32_16x16x32_bf16 v[108:111], a[92:95], a[228:231], v[108:111]
 v_cvt_pk_bf16_f32 v234, v100, v101
 v_mfma_f32_16x16x32_bf16 v[108:111], a[124:127], a[232:235], v[108:111]
 v_cvt_pk_bf16_f32 v235, v102, v103
 v_mfma_f32_16x16x32_bf16 v[108:111], a[156:159], a[236:239], v[108:111]
 buffer_store_dwordx4 v[232:235], v56, s[24:27], s42 offen offset:1536 sc1
 v_mfma_f32_16x16x32_bf16 v[108:111], a[188:191], a[240:243], v[108:111]
 ds_write_b128 v57, v[232:235] offset:1536
 v_mfma_f32_16x16x32_bf16 v[108:111], v[188:191], a[244:247], v[108:111]
 v_mfma_f32_16x16x32_bf16 v[112:115], a[24:27], a[248:251], 0
 v_mfma_f32_16x16x32_bf16 v[112:115], a[56:59], a[252:255], v[112:115]
 v_mfma_f32_16x16x32_bf16 v[112:115], a[88:91], v[128:131], v[112:115]
 v_mfma_f32_16x16x32_bf16 v[112:115], a[120:123], v[132:135], v[112:115]
 v_mfma_f32_16x16x32_bf16 v[112:115], a[152:155], v[136:139], v[112:115]
 v_mfma_f32_16x16x32_bf16 v[112:115], a[184:187], v[140:143], v[112:115]
 v_mfma_f32_16x16x32_bf16 v[112:115], v[184:187], v[144:147], v[112:115]
 v_mfma_f32_16x16x32_bf16 v[116:119], a[28:31], a[248:251], 0
 v_cvt_pk_bf16_f32 v236, v104, v105
 v_mfma_f32_16x16x32_bf16 v[116:119], a[60:63], a[252:255], v[116:119]
 v_cvt_pk_bf16_f32 v237, v106, v107
 v_mfma_f32_16x16x32_bf16 v[116:119], a[92:95], v[128:131], v[116:119]
 v_cvt_pk_bf16_f32 v238, v108, v109
 v_mfma_f32_16x16x32_bf16 v[116:119], a[124:127], v[132:135], v[116:119]
 v_cvt_pk_bf16_f32 v239, v110, v111
 v_mfma_f32_16x16x32_bf16 v[116:119], a[156:159], v[136:139], v[116:119]
 buffer_store_dwordx4 v[236:239], v214, s[24:27], s43 offen offset:1536 sc1
 v_mfma_f32_16x16x32_bf16 v[116:119], a[188:191], v[140:143], v[116:119]
 v_mfma_f32_16x16x32_bf16 v[116:119], v[188:191], v[144:147], v[116:119]
 v_mfma_f32_16x16x32_bf16 v[120:123], a[24:27], v[148:151], 0
 v_mfma_f32_16x16x32_bf16 v[120:123], a[56:59], v[152:155], v[120:123]
 v_mfma_f32_16x16x32_bf16 v[120:123], a[88:91], v[156:159], v[120:123]
 v_mfma_f32_16x16x32_bf16 v[120:123], a[120:123], v[216:219], v[120:123]
 v_mfma_f32_16x16x32_bf16 v[120:123], a[152:155], v[220:223], v[120:123]
 v_mfma_f32_16x16x32_bf16 v[120:123], a[184:187], v[224:227], v[120:123]
 v_mfma_f32_16x16x32_bf16 v[120:123], v[184:187], v[228:231], v[120:123]
 v_mfma_f32_16x16x32_bf16 v[124:127], a[28:31], v[148:151], 0
 v_cvt_pk_bf16_f32 v192, v112, v113
 v_mfma_f32_16x16x32_bf16 v[124:127], a[60:63], v[152:155], v[124:127]
 v_cvt_pk_bf16_f32 v193, v114, v115
 v_mfma_f32_16x16x32_bf16 v[124:127], a[92:95], v[156:159], v[124:127]
 v_cvt_pk_bf16_f32 v194, v116, v117
 v_mfma_f32_16x16x32_bf16 v[124:127], a[124:127], v[216:219], v[124:127]
 v_cvt_pk_bf16_f32 v195, v118, v119
 v_mfma_f32_16x16x32_bf16 v[124:127], a[156:159], v[220:223], v[124:127]
 buffer_store_dwordx4 v[192:195], v214, s[24:27], s44 offen offset:1536 sc1
 v_mfma_f32_16x16x32_bf16 v[124:127], a[188:191], v[224:227], v[124:127]
 v_mfma_f32_16x16x32_bf16 v[124:127], v[188:191], v[228:231], v[124:127]
 s_nop 5
 v_cvt_pk_bf16_f32 v196, v120, v121
 v_cvt_pk_bf16_f32 v197, v122, v123
 v_cvt_pk_bf16_f32 v198, v124, v125
 v_cvt_pk_bf16_f32 v199, v126, v127
 buffer_store_dwordx4 v[196:199], v214, s[24:27], s45 offen offset:1536 sc1
 s_mov_b32 s4, s84
 s_mov_b32 s5, s85
 s_mov_b32 s6, 2097152
 s_mov_b32 s7, 0x20000
 s_waitcnt vmcnt(0)
 s_barrier
 s_cmp_lg_u32 s3, 0
 s_cbranch_scc1 L_nosig2
  buffer_store_dword v212, v210, s[24:27], 0 offen offset:2048 sc1
L_nosig2:
 s_cmp_lg_u32 s3, 3
 s_cbranch_scc1 L_pollx2
 s_mov_b32 s38, 0x100000
L_poll2:
  v_mov_b32 v238, 0
  buffer_atomic_or v238, v211, s[24:27], 0 offen offset:2048 sc0 sc1
 s_sub_u32 s38, s38, 1
 s_cbranch_scc1 L_pollx2
  s_waitcnt vmcnt(0)
 v_cmp_ne_u32 vcc, s94, v238
 s_and_b32 vcc_lo, vcc_lo, 0xff
 s_cbranch_scc1 L_poll2
L_pollx2:
 s_barrier
 s_lshl_b32 s41, s33, 3
 s_add_u32 s41, s41, s32
 s_mul_i32 s41, s41, 65536
 s_add_u32 s41, s41, 22020096
 ds_read_b128 v[64:67], v58 offset:0
 ds_read_b128 v[68:71], v58 offset:1024
 s_add_u32 s42, s32, 1
 s_and_b32 s42, s42, 7
 s_lshl_b32 s42, s42, 13
 s_add_u32 s42, s42, s41
 buffer_load_dwordx4 v[72:75], v215, s[24:27], s42 offen offset:0 sc1
 buffer_load_dwordx4 v[76:79], v215, s[24:27], s42 offen offset:1024 sc1
 s_add_u32 s42, s32, 2
 s_and_b32 s42, s42, 7
 s_lshl_b32 s42, s42, 13
 s_add_u32 s42, s42, s41
 buffer_load_dwordx4 v[80:83], v215, s[24:27], s42 offen offset:0 sc1
 buffer_load_dwordx4 v[84:87], v215, s[24:27], s42 offen offset:1024 sc1
 s_add_u32 s42, s32, 3
 s_and_b32 s42, s42, 7
 s_lshl_b32 s42, s42, 13
 s_add_u32 s42, s42, s41
 buffer_load_dwordx4 v[88:91], v215, s[24:27], s42 offen offset:0 sc1
 buffer_load_dwordx4 v[92:95], v215, s[24:27], s42 offen offset:1024 sc1
 s_add_u32 s42, s32, 4
 s_and_b32 s42, s42, 7
 s_lshl_b32 s42, s42, 13
 s_add_u32 s42, s42, s41
 buffer_load_dwordx4 v[96:99], v215, s[24:27], s42 offen offset:0 sc1
 buffer_load_dwordx4 v[100:103], v215, s[24:27], s42 offen offset:1024 sc1
 s_add_u32 s42, s32, 5
 s_and_b32 s42, s42, 7
 s_lshl_b32 s42, s42, 13
 s_add_u32 s42, s42, s41
 buffer_load_dwordx4 v[104:107], v215, s[24:27], s42 offen offset:0 sc1
 buffer_load_dwordx4 v[108:111], v215, s[24:27], s42 offen offset:1024 sc1
 s_add_u32 s42, s32, 6
 s_and_b32 s42, s42, 7
 s_lshl_b32 s42, s42, 13
 s_add_u32 s42, s42, s41
 buffer_load_dwordx4 v[112:115], v215, s[24:27], s42 offen offset:0 sc1
 buffer_load_dwordx4 v[116:119], v215, s[24:27], s42 offen offset:1024 sc1
 s_add_u32 s42, s32, 7
 s_and_b32 s42, s42, 7
 s_lshl_b32 s42, s42, 13
 s_add_u32 s42, s42, s41
 buffer_load_dwordx4 v[120:123], v215, s[24:27], s42 offen offset:0 sc1
 buffer_load_dwordx4 v[124:127], v215, s[24:27], s42 offen offset:1024 sc1
 s_waitcnt lgkmcnt(0)
 v_lshlrev_b32 v184, 16, v64
 v_and_b32 v185, 0xffff0000, v64
 v_lshlrev_b32 v186, 16, v65
 v_and_b32 v187, 0xffff0000, v65
 v_lshlrev_b32 v188, 16, v66
 v_and_b32 v189, 0xffff0000, v66
 v_lshlrev_b32 v190, 16, v67
 v_and_b32 v191, 0xffff0000, v67
 v_lshlrev_b32 v192, 16, v68
 v_and_b32 v193, 0xffff0000, v68
 v_lshlrev_b32 v194, 16, v69
 v_and_b32 v195, 0xffff0000, v69
 v_lshlrev_b32 v196, 16, v70
 v_and_b32 v197, 0xffff0000, v70
 v_lshlrev_b32 v198, 16, v71
 v_and_b32 v199, 0xffff0000, v71
 s_waitcnt vmcnt(12)
 v_lshlrev_b32 v216, 16, v72
 v_and_b32 v217, 0xffff0000, v72
 v_pk_add_f32 v[184:185], v[184:185], v[216:217]
 v_lshlrev_b32 v218, 16, v73
 v_and_b32 v219, 0xffff0000, v73
 v_pk_add_f32 v[186:187], v[186:187], v[218:219]
 v_lshlrev_b32 v220, 16, v74
 v_and_b32 v221, 0xffff0000, v74
 v_pk_add_f32 v[188:189], v[188:189], v[220:221]
 v_lshlrev_b32 v222, 16, v75
 v_and_b32 v223, 0xffff0000, v75
 v_pk_add_f32 v[190:191], v[190:191], v[222:223]
 v_lshlrev_b32 v216, 16, v76
 v_and_b32 v217, 0xffff0000, v76
 v_pk_add_f32 v[192:193], v[192:193], v[216:217]
 v_lshlrev_b32 v218, 16, v77
 v_and_b32 v219, 0xffff0000, v77
 v_pk_add_f32 v[194:195], v[194:195], v[218:219]
 v_lshlrev_b32 v220, 16, v78
 v_and_b32 v221, 0xffff0000, v78
 v_pk_add_f32 v[196:197], v[196:197], v[220:221]
 v_lshlrev_b32 v222, 16, v79
 v_and_b32 v223, 0xffff0000, v79
 v_pk_add_f32 v[198:199], v[198:199], v[222:223]
 s_waitcnt vmcnt(10)
 v_lshlrev_b32 v216, 16, v80
 v_and_b32 v217, 0xffff0000, v80
 v_pk_add_f32 v[184:185], v[184:185], v[216:217]
 v_lshlrev_b32 v218, 16, v81
 v_and_b32 v219, 0xffff0000, v81
 v_pk_add_f32 v[186:187], v[186:187], v[218:219]
 v_lshlrev_b32 v220, 16, v82
 v_and_b32 v221, 0xffff0000, v82
 v_pk_add_f32 v[188:189], v[188:189], v[220:221]
 v_lshlrev_b32 v222, 16, v83
 v_and_b32 v223, 0xffff0000, v83
 v_pk_add_f32 v[190:191], v[190:191], v[222:223]
 v_lshlrev_b32 v216, 16, v84
 v_and_b32 v217, 0xffff0000, v84
 v_pk_add_f32 v[192:193], v[192:193], v[216:217]
 v_lshlrev_b32 v218, 16, v85
 v_and_b32 v219, 0xffff0000, v85
 v_pk_add_f32 v[194:195], v[194:195], v[218:219]
 v_lshlrev_b32 v220, 16, v86
 v_and_b32 v221, 0xffff0000, v86
 v_pk_add_f32 v[196:197], v[196:197], v[220:221]
 v_lshlrev_b32 v222, 16, v87
 v_and_b32 v223, 0xffff0000, v87
 v_pk_add_f32 v[198:199], v[198:199], v[222:223]
 s_waitcnt vmcnt(8)
 v_lshlrev_b32 v216, 16, v88
 v_and_b32 v217, 0xffff0000, v88
 v_pk_add_f32 v[184:185], v[184:185], v[216:217]
 v_lshlrev_b32 v218, 16, v89
 v_and_b32 v219, 0xffff0000, v89
 v_pk_add_f32 v[186:187], v[186:187], v[218:219]
 v_lshlrev_b32 v220, 16, v90
 v_and_b32 v221, 0xffff0000, v90
 v_pk_add_f32 v[188:189], v[188:189], v[220:221]
 v_lshlrev_b32 v222, 16, v91
 v_and_b32 v223, 0xffff0000, v91
 v_pk_add_f32 v[190:191], v[190:191], v[222:223]
 v_lshlrev_b32 v216, 16, v92
 v_and_b32 v217, 0xffff0000, v92
 v_pk_add_f32 v[192:193], v[192:193], v[216:217]
 v_lshlrev_b32 v218, 16, v93
 v_and_b32 v219, 0xffff0000, v93
 v_pk_add_f32 v[194:195], v[194:195], v[218:219]
 v_lshlrev_b32 v220, 16, v94
 v_and_b32 v221, 0xffff0000, v94
 v_pk_add_f32 v[196:197], v[196:197], v[220:221]
 v_lshlrev_b32 v222, 16, v95
 v_and_b32 v223, 0xffff0000, v95
 v_pk_add_f32 v[198:199], v[198:199], v[222:223]
 s_waitcnt vmcnt(6)
 v_lshlrev_b32 v216, 16, v96
 v_and_b32 v217, 0xffff0000, v96
 v_pk_add_f32 v[184:185], v[184:185], v[216:217]
 v_lshlrev_b32 v218, 16, v97
 v_and_b32 v219, 0xffff0000, v97
 v_pk_add_f32 v[186:187], v[186:187], v[218:219]
 v_lshlrev_b32 v220, 16, v98
 v_and_b32 v221, 0xffff0000, v98
 v_pk_add_f32 v[188:189], v[188:189], v[220:221]
 v_lshlrev_b32 v222, 16, v99
 v_and_b32 v223, 0xffff0000, v99
 v_pk_add_f32 v[190:191], v[190:191], v[222:223]
 v_lshlrev_b32 v216, 16, v100
 v_and_b32 v217, 0xffff0000, v100
 v_pk_add_f32 v[192:193], v[192:193], v[216:217]
 v_lshlrev_b32 v218, 16, v101
 v_and_b32 v219, 0xffff0000, v101
 v_pk_add_f32 v[194:195], v[194:195], v[218:219]
 v_lshlrev_b32 v220, 16, v102
 v_and_b32 v221, 0xffff0000, v102
 v_pk_add_f32 v[196:197], v[196:197], v[220:221]
 v_lshlrev_b32 v222, 16, v103
 v_and_b32 v223, 0xffff0000, v103
 v_pk_add_f32 v[198:199], v[198:199], v[222:223]
 s_waitcnt vmcnt(4)
 v_lshlrev_b32 v216, 16, v104
 v_and_b32 v217, 0xffff0000, v104
 v_pk_add_f32 v[184:185], v[184:185], v[216:217]
 v_lshlrev_b32 v218, 16, v105
 v_and_b32 v219, 0xffff0000, v105
 v_pk_add_f32 v[186:187], v[186:187], v[218:219]
 v_lshlrev_b32 v220, 16, v106
 v_and_b32 v221, 0xffff0000, v106
 v_pk_add_f32 v[188:189], v[188:189], v[220:221]
 v_lshlrev_b32 v222, 16, v107
 v_and_b32 v223, 0xffff0000, v107
 v_pk_add_f32 v[190:191], v[190:191], v[222:223]
 v_lshlrev_b32 v216, 16, v108
 v_and_b32 v217, 0xffff0000, v108
 v_pk_add_f32 v[192:193], v[192:193], v[216:217]
 v_lshlrev_b32 v218, 16, v109
 v_and_b32 v219, 0xffff0000, v109
 v_pk_add_f32 v[194:195], v[194:195], v[218:219]
 v_lshlrev_b32 v220, 16, v110
 v_and_b32 v221, 0xffff0000, v110
 v_pk_add_f32 v[196:197], v[196:197], v[220:221]
 v_lshlrev_b32 v222, 16, v111
 v_and_b32 v223, 0xffff0000, v111
 v_pk_add_f32 v[198:199], v[198:199], v[222:223]
 s_waitcnt vmcnt(2)
 v_lshlrev_b32 v216, 16, v112
 v_and_b32 v217, 0xffff0000, v112
 v_pk_add_f32 v[184:185], v[184:185], v[216:217]
 v_lshlrev_b32 v218, 16, v113
 v_and_b32 v219, 0xffff0000, v113
 v_pk_add_f32 v[186:187], v[186:187], v[218:219]
 v_lshlrev_b32 v220, 16, v114
 v_and_b32 v221, 0xffff0000, v114
 v_pk_add_f32 v[188:189], v[188:189], v[220:221]
 v_lshlrev_b32 v222, 16, v115
 v_and_b32 v223, 0xffff0000, v115
 v_pk_add_f32 v[190:191], v[190:191], v[222:223]
 v_lshlrev_b32 v216, 16, v116
 v_and_b32 v217, 0xffff0000, v116
 v_pk_add_f32 v[192:193], v[192:193], v[216:217]
 v_lshlrev_b32 v218, 16, v117
 v_and_b32 v219, 0xffff0000, v117
 v_pk_add_f32 v[194:195], v[194:195], v[218:219]
 v_lshlrev_b32 v220, 16, v118
 v_and_b32 v221, 0xffff0000, v118
 v_pk_add_f32 v[196:197], v[196:197], v[220:221]
 v_lshlrev_b32 v222, 16, v119
 v_and_b32 v223, 0xffff0000, v119
 v_pk_add_f32 v[198:199], v[198:199], v[222:223]
 s_waitcnt vmcnt(0)
 v_lshlrev_b32 v216, 16, v120
 v_and_b32 v217, 0xffff0000, v120
 v_pk_add_f32 v[184:185], v[184:185], v[216:217]
 v_lshlrev_b32 v218, 16, v121
 v_and_b32 v219, 0xffff0000, v121
 v_pk_add_f32 v[186:187], v[186:187], v[218:219]
 v_lshlrev_b32 v220, 16, v122
 v_and_b32 v221, 0xffff0000, v122
 v_pk_add_f32 v[188:189], v[188:189], v[220:221]
 v_lshlrev_b32 v222, 16, v123
 v_and_b32 v223, 0xffff0000, v123
 v_pk_add_f32 v[190:191], v[190:191], v[222:223]
 v_lshlrev_b32 v216, 16, v124
 v_and_b32 v217, 0xffff0000, v124
 v_pk_add_f32 v[192:193], v[192:193], v[216:217]
 v_lshlrev_b32 v218, 16, v125
 v_and_b32 v219, 0xffff0000, v125
 v_pk_add_f32 v[194:195], v[194:195], v[218:219]
 v_lshlrev_b32 v220, 16, v126
 v_and_b32 v221, 0xffff0000, v126
 v_pk_add_f32 v[196:197], v[196:197], v[220:221]
 v_lshlrev_b32 v222, 16, v127
 v_and_b32 v223, 0xffff0000, v127
 v_pk_add_f32 v[198:199], v[198:199], v[222:223]
 v_pk_fma_f32 v[16:17], v[184:185], v[32:33], v[16:17]
 v_cvt_pk_bf16_f32 v64, v16, v17
 v_pk_fma_f32 v[18:19], v[186:187], v[34:35], v[18:19]
 v_cvt_pk_bf16_f32 v65, v18, v19
 v_pk_fma_f32 v[20:21], v[188:189], v[36:37], v[20:21]
 v_cvt_pk_bf16_f32 v66, v20, v21
 v_pk_fma_f32 v[22:23], v[190:191], v[38:39], v[22:23]
 v_cvt_pk_bf16_f32 v67, v22, v23
 v_pk_fma_f32 v[24:25], v[192:193], v[40:41], v[24:25]
 v_cvt_pk_bf16_f32 v68, v24, v25
 v_pk_fma_f32 v[26:27], v[194:195], v[42:43], v[26:27]
 v_cvt_pk_bf16_f32 v69, v26, v27
 v_pk_fma_f32 v[28:29], v[196:197], v[44:45], v[28:29]
 v_cvt_pk_bf16_f32 v70, v28, v29
 v_pk_fma_f32 v[30:31], v[198:199], v[46:47], v[30:31]
 v_cvt_pk_bf16_f32 v71, v30, v31
 ds_write_b64 v206, v[64:65] offset:0
 ds_write_b64 v206, v[66:67] offset:32
 ds_write_b64 v206, v[68:69] offset:128
 ds_write_b64 v206, v[70:71] offset:160
 s_mul_i32 s41, s3, 2112
 v_lshl_add_u32 v72, v1, 4, s41
 s_waitcnt lgkmcnt(0)
 s_barrier
 ds_read_b128 v[76:79], v72 offset:49152
 ds_read_b128 v[80:83], v72 offset:50208
 s_waitcnt lgkmcnt(1)
 buffer_store_dwordx4 v[76:79], v215, s[4:7], s46 offen sc1
 s_waitcnt lgkmcnt(0)
 buffer_store_dwordx4 v[80:83], v215, s[4:7], s46 offen offset:1024 sc1
 s_or_b32 s41, s2, s3
 s_cselect_b32 s41, 0x40000000, 0
 v_mov_b32 v64, 0
 buffer_store_dword v64, off, s[56:59], s41 sc0 sc1
L_end:
 s_endpgm
L_tr_m2:
 s_call_b64 s[50:51], L_rare_2
 s_branch L_back_m2
L_tr_m3:
 s_call_b64 s[50:51], L_rare_3
 s_branch L_back_m3
L_tr_m4:
 s_call_b64 s[50:51], L_rare_0
 s_branch L_back_m4
L_tr_m5:
 s_call_b64 s[50:51], L_rare_1
 s_branch L_back_m5
L_tr_m6:
 s_call_b64 s[50:51], L_rare_2
 s_branch L_back_m6
L_tr_m7:
 s_call_b64 s[50:51], L_rare_3
 s_branch L_back_m7
L_tr_m8:
 s_call_b64 s[50:51], L_rare_0
 s_branch L_back_m8
L_tr_m9:
 s_call_b64 s[50:51], L_rare_1
 s_branch L_back_m9
L_tr_e58:
 s_call_b64 s[50:51], L_rare_2
 s_branch L_back_e58
L_tr_e59:
 s_call_b64 s[50:51], L_rare_3
 s_branch L_back_e59
L_tr_e60:
 s_call_b64 s[50:51], L_rare_0
 s_branch L_back_e60
L_tr_e61:
 s_call_b64 s[50:51], L_rare_1
 s_branch L_back_e61
L_tr_e62:
 s_call_b64 s[50:51], L_rare_2
 s_branch L_back_e62
L_tr_e63:
 s_call_b64 s[50:51], L_rare_3
 s_branch L_back_e63
L_rare_0:
 s_nop 15
 v_log_f32 v216, v253
 v_max3_f32 v217, v64, v65, v66
 v_max3_f32 v217, v217, v67, v80
 v_max3_f32 v217, v217, v81, v82
 v_max3_f32 v216, v216, v217, v83
 v_mov_b32 v217, v216
 s_nop 1
 v_permlane32_swap_b32 v217, v216
 s_nop 0
 v_max_f32 v216, v216, v217
 v_mov_b32 v217, v216
 s_nop 1
 v_permlane16_swap_b32 v217, v216
 s_nop 0
 v_max_f32 v216, v216, v217
 v_ceil_f32 v216, v216
 v_add_f32 v216, 1120534528, v216
 v_max_f32 v216, 0, v216
 v_exp_f32 v217, -v216
 v_sub_f32 v192, v192, v216
 v_sub_f32 v193, v193, v216
 v_sub_f32 v194, v194, v216
 v_sub_f32 v195, v195, v216
 v_sub_f32 v64, v64, v216
 v_sub_f32 v65, v65, v216
 v_sub_f32 v66, v66, v216
 v_sub_f32 v67, v67, v216
 v_sub_f32 v80, v80, v216
 v_sub_f32 v81, v81, v216
 v_sub_f32 v82, v82, v216
 v_sub_f32 v83, v83, v216
 v_sub_f32 v96, v96, v216
 v_sub_f32 v97, v97, v216
 v_sub_f32 v98, v98, v216
 v_sub_f32 v99, v99, v216
 v_sub_f32 v112, v112, v216
 v_sub_f32 v113, v113, v216
 v_sub_f32 v114, v114, v216
 v_sub_f32 v115, v115, v216
 v_mul_f32 v253, v253, v217
 v_accvgpr_read_b32 v218, a0
 v_accvgpr_read_b32 v219, a1
 v_accvgpr_read_b32 v220, a2
 v_accvgpr_read_b32 v221, a3
 v_mul_f32 v218, v218, v217
 v_mul_f32 v219, v219, v217
 v_mul_f32 v220, v220, v217
 v_mul_f32 v221, v221, v217
 v_accvgpr_write_b32 a0, v218
 v_accvgpr_write_b32 a1, v219
 v_accvgpr_write_b32 a2, v220
 v_accvgpr_write_b32 a3, v221
 v_accvgpr_read_b32 v218, a16
 v_accvgpr_read_b32 v219, a17
 v_accvgpr_read_b32 v220, a18
 v_accvgpr_read_b32 v221, a19
 v_mul_f32 v218, v218, v217
 v_mul_f32 v219, v219, v217
 v_mul_f32 v220, v220, v217
 v_mul_f32 v221, v221, v217
 v_accvgpr_write_b32 a16, v218
 v_accvgpr_write_b32 a17, v219
 v_accvgpr_write_b32 a18, v220
 v_accvgpr_write_b32 a19, v221
 v_accvgpr_read_b32 v218, a32
 v_accvgpr_read_b32 v219, a33
 v_accvgpr_read_b32 v220, a34
 v_accvgpr_read_b32 v221, a35
 v_mul_f32 v218, v218, v217
 v_mul_f32 v219, v219, v217
 v_mul_f32 v220, v220, v217
 v_mul_f32 v221, v221, v217
 v_accvgpr_write_b32 a32, v218
 v_accvgpr_write_b32 a33, v219
 v_accvgpr_write_b32 a34, v220
 v_accvgpr_write_b32 a35, v221
 v_accvgpr_read_b32 v218, a48
 v_accvgpr_read_b32 v219, a49
 v_accvgpr_read_b32 v220, a50
 v_accvgpr_read_b32 v221, a51
 v_mul_f32 v218, v218, v217
 v_mul_f32 v219, v219, v217
 v_mul_f32 v220, v220, v217
 v_mul_f32 v221, v221, v217
 v_accvgpr_write_b32 a48, v218
 v_accvgpr_write_b32 a49, v219
 v_accvgpr_write_b32 a50, v220
 v_accvgpr_write_b32 a51, v221
 v_accvgpr_read_b32 v218, a64
 v_accvgpr_read_b32 v219, a65
 v_accvgpr_read_b32 v220, a66
 v_accvgpr_read_b32 v221, a67
 v_mul_f32 v218, v218, v217
 v_mul_f32 v219, v219, v217
 v_mul_f32 v220, v220, v217
 v_mul_f32 v221, v221, v217
 v_accvgpr_write_b32 a64, v218
 v_accvgpr_write_b32 a65, v219
 v_accvgpr_write_b32 a66, v220
 v_accvgpr_write_b32 a67, v221
 v_accvgpr_read_b32 v218, a80
 v_accvgpr_read_b32 v219, a81
 v_accvgpr_read_b32 v220, a82
 v_accvgpr_read_b32 v221, a83
 v_mul_f32 v218, v218, v217
 v_mul_f32 v219, v219, v217
 v_mul_f32 v220, v220, v217
 v_mul_f32 v221, v221, v217
 v_accvgpr_write_b32 a80, v218
 v_accvgpr_write_b32 a81, v219
 v_accvgpr_write_b32 a82, v220
 v_accvgpr_write_b32 a83, v221
 v_accvgpr_read_b32 v218, a96
 v_accvgpr_read_b32 v219, a97
 v_accvgpr_read_b32 v220, a98
 v_accvgpr_read_b32 v221, a99
 v_mul_f32 v218, v218, v217
 v_mul_f32 v219, v219, v217
 v_mul_f32 v220, v220, v217
 v_mul_f32 v221, v221, v217
 v_accvgpr_write_b32 a96, v218
 v_accvgpr_write_b32 a97, v219
 v_accvgpr_write_b32 a98, v220
 v_accvgpr_write_b32 a99, v221
 v_accvgpr_read_b32 v218, a112
 v_accvgpr_read_b32 v219, a113
 v_accvgpr_read_b32 v220, a114
 v_accvgpr_read_b32 v221, a115
 v_mul_f32 v218, v218, v217
 v_mul_f32 v219, v219, v217
 v_mul_f32 v220, v220, v217
 v_mul_f32 v221, v221, v217
 v_accvgpr_write_b32 a112, v218
 v_accvgpr_write_b32 a113, v219
 v_accvgpr_write_b32 a114, v220
 v_accvgpr_write_b32 a115, v221
 v_lshlrev_b32 v218, 16, v160
 v_and_b32 v219, 0xffff0000, v160
 v_mul_f32 v218, v218, v217
 v_mul_f32 v219, v219, v217
 v_cvt_pk_bf16_f32 v160, v218, v219
 v_lshlrev_b32 v218, 16, v161
 v_and_b32 v219, 0xffff0000, v161
 v_mul_f32 v218, v218, v217
 v_mul_f32 v219, v219, v217
 v_cvt_pk_bf16_f32 v161, v218, v219
 v_lshlrev_b32 v218, 16, v162
 v_and_b32 v219, 0xffff0000, v162
 v_mul_f32 v218, v218, v217
 v_mul_f32 v219, v219, v217
 v_cvt_pk_bf16_f32 v162, v218, v219
 v_lshlrev_b32 v218, 16, v163
 v_and_b32 v219, 0xffff0000, v163
 v_mul_f32 v218, v218, v217
 v_mul_f32 v219, v219, v217
 v_cvt_pk_bf16_f32 v163, v218, v219
 v_lshlrev_b32 v218, 16, v176
 v_and_b32 v219, 0xffff0000, v176
 v_mul_f32 v218, v218, v217
 v_mul_f32 v219, v219, v217
 v_cvt_pk_bf16_f32 v176, v218, v219
 v_lshlrev_b32 v218, 16, v177
 v_and_b32 v219, 0xffff0000, v177
 v_mul_f32 v218, v218, v217
 v_mul_f32 v219, v219, v217
 v_cvt_pk_bf16_f32 v177, v218, v219
 v_lshlrev_b32 v218, 16, v178
 v_and_b32 v219, 0xffff0000, v178
 v_mul_f32 v218, v218, v217
 v_mul_f32 v219, v219, v217
 v_cvt_pk_bf16_f32 v178, v218, v219
 v_lshlrev_b32 v218, 16, v179
 v_and_b32 v219, 0xffff0000, v179
 v_mul_f32 v218, v218, v217
 v_mul_f32 v219, v219, v217
 v_cvt_pk_bf16_f32 v179, v218, v219
 v_exp_f32 v16, v64
 v_exp_f32 v17, v65
 v_exp_f32 v18, v66
 v_exp_f32 v19, v67
 s_nop 0
 v_cvt_pk_bf16_f32 v128, v16, v17
 v_cvt_pk_bf16_f32 v129, v18, v19
 v_exp_f32 v32, v80
 v_exp_f32 v33, v81
 v_exp_f32 v34, v82
 v_exp_f32 v35, v83
 s_nop 0
 v_cvt_pk_bf16_f32 v130, v32, v33
 v_cvt_pk_bf16_f32 v131, v34, v35
 v_add_f32 v255, v16, v17
 v_add_f32 v255, v255, v18
 v_add_f32 v255, v255, v19
 v_add_f32 v255, v255, v32
 v_add_f32 v255, v255, v33
 v_add_f32 v255, v255, v34
 v_add_f32 v255, v255, v35
 v_log_f32 v216, v36
 v_max3_f32 v217, v68, v69, v70
 v_max3_f32 v217, v217, v71, v84
 v_max3_f32 v217, v217, v85, v86
 v_max3_f32 v216, v216, v217, v87
 v_mov_b32 v217, v216
 s_nop 1
 v_permlane32_swap_b32 v217, v216
 s_nop 0
 v_max_f32 v216, v216, v217
 v_mov_b32 v217, v216
 s_nop 1
 v_permlane16_swap_b32 v217, v216
 s_nop 0
 v_max_f32 v216, v216, v217
 v_ceil_f32 v216, v216
 v_add_f32 v216, 1120534528, v216
 v_max_f32 v216, 0, v216
 v_exp_f32 v217, -v216
 v_sub_f32 v196, v196, v216
 v_sub_f32 v197, v197, v216
 v_sub_f32 v198, v198, v216
 v_sub_f32 v199, v199, v216
 v_sub_f32 v68, v68, v216
 v_sub_f32 v69, v69, v216
 v_sub_f32 v70, v70, v216
 v_sub_f32 v71, v71, v216
 v_sub_f32 v84, v84, v216
 v_sub_f32 v85, v85, v216
 v_sub_f32 v86, v86, v216
 v_sub_f32 v87, v87, v216
 v_sub_f32 v100, v100, v216
 v_sub_f32 v101, v101, v216
 v_sub_f32 v102, v102, v216
 v_sub_f32 v103, v103, v216
 v_sub_f32 v116, v116, v216
 v_sub_f32 v117, v117, v216
 v_sub_f32 v118, v118, v216
 v_sub_f32 v119, v119, v216
 v_mul_f32 v36, v36, v217
 v_mul_f32 v37, v37, v217
 v_mul_f32 v38, v38, v217
 v_mul_f32 v39, v39, v217
 v_accvgpr_read_b32 v218, a4
 v_accvgpr_read_b32 v219, a5
 v_accvgpr_read_b32 v220, a6
 v_accvgpr_read_b32 v221, a7
 v_mul_f32 v218, v218, v217
 v_mul_f32 v219, v219, v217
 v_mul_f32 v220, v220, v217
 v_mul_f32 v221, v221, v217
 v_accvgpr_write_b32 a4, v218
 v_accvgpr_write_b32 a5, v219
 v_accvgpr_write_b32 a6, v220
 v_accvgpr_write_b32 a7, v221
 v_accvgpr_read_b32 v218, a20
 v_accvgpr_read_b32 v219, a21
 v_accvgpr_read_b32 v220, a22
 v_accvgpr_read_b32 v221, a23
 v_mul_f32 v218, v218, v217
 v_mul_f32 v219, v219, v217
 v_mul_f32 v220, v220, v217
 v_mul_f32 v221, v221, v217
 v_accvgpr_write_b32 a20, v218
 v_accvgpr_write_b32 a21, v219
 v_accvgpr_write_b32 a22, v220
 v_accvgpr_write_b32 a23, v221
 v_accvgpr_read_b32 v218, a36
 v_accvgpr_read_b32 v219, a37
 v_accvgpr_read_b32 v220, a38
 v_accvgpr_read_b32 v221, a39
 v_mul_f32 v218, v218, v217
 v_mul_f32 v219, v219, v217
 v_mul_f32 v220, v220, v217
 v_mul_f32 v221, v221, v217
 v_accvgpr_write_b32 a36, v218
 v_accvgpr_write_b32 a37, v219
 v_accvgpr_write_b32 a38, v220
 v_accvgpr_write_b32 a39, v221
 v_accvgpr_read_b32 v218, a52
 v_accvgpr_read_b32 v219, a53
 v_accvgpr_read_b32 v220, a54
 v_accvgpr_read_b32 v221, a55
 v_mul_f32 v218, v218, v217
 v_mul_f32 v219, v219, v217
 v_mul_f32 v220, v220, v217
 v_mul_f32 v221, v221, v217
 v_accvgpr_write_b32 a52, v218
 v_accvgpr_write_b32 a53, v219
 v_accvgpr_write_b32 a54, v220
 v_accvgpr_write_b32 a55, v221
 v_accvgpr_read_b32 v218, a68
 v_accvgpr_read_b32 v219, a69
 v_accvgpr_read_b32 v220, a70
 v_accvgpr_read_b32 v221, a71
 v_mul_f32 v218, v218, v217
 v_mul_f32 v219, v219, v217
 v_mul_f32 v220, v220, v217
 v_mul_f32 v221, v221, v217
 v_accvgpr_write_b32 a68, v218
 v_accvgpr_write_b32 a69, v219
 v_accvgpr_write_b32 a70, v220
 v_accvgpr_write_b32 a71, v221
 v_accvgpr_read_b32 v218, a84
 v_accvgpr_read_b32 v219, a85
 v_accvgpr_read_b32 v220, a86
 v_accvgpr_read_b32 v221, a87
 v_mul_f32 v218, v218, v217
 v_mul_f32 v219, v219, v217
 v_mul_f32 v220, v220, v217
 v_mul_f32 v221, v221, v217
 v_accvgpr_write_b32 a84, v218
 v_accvgpr_write_b32 a85, v219
 v_accvgpr_write_b32 a86, v220
 v_accvgpr_write_b32 a87, v221
 v_accvgpr_read_b32 v218, a100
 v_accvgpr_read_b32 v219, a101
 v_accvgpr_read_b32 v220, a102
 v_accvgpr_read_b32 v221, a103
 v_mul_f32 v218, v218, v217
 v_mul_f32 v219, v219, v217
 v_mul_f32 v220, v220, v217
 v_mul_f32 v221, v221, v217
 v_accvgpr_write_b32 a100, v218
 v_accvgpr_write_b32 a101, v219
 v_accvgpr_write_b32 a102, v220
 v_accvgpr_write_b32 a103, v221
 v_accvgpr_read_b32 v218, a116
 v_accvgpr_read_b32 v219, a117
 v_accvgpr_read_b32 v220, a118
 v_accvgpr_read_b32 v221, a119
 v_mul_f32 v218, v218, v217
 v_mul_f32 v219, v219, v217
 v_mul_f32 v220, v220, v217
 v_mul_f32 v221, v221, v217
 v_accvgpr_write_b32 a116, v218
 v_accvgpr_write_b32 a117, v219
 v_accvgpr_write_b32 a118, v220
 v_accvgpr_write_b32 a119, v221
 v_lshlrev_b32 v218, 16, v164
 v_and_b32 v219, 0xffff0000, v164
 v_mul_f32 v218, v218, v217
 v_mul_f32 v219, v219, v217
 v_cvt_pk_bf16_f32 v164, v218, v219
 v_lshlrev_b32 v218, 16, v165
 v_and_b32 v219, 0xffff0000, v165
 v_mul_f32 v218, v218, v217
 v_mul_f32 v219, v219, v217
 v_cvt_pk_bf16_f32 v165, v218, v219
 v_lshlrev_b32 v218, 16, v166
 v_and_b32 v219, 0xffff0000, v166
 v_mul_f32 v218, v218, v217
 v_mul_f32 v219, v219, v217
 v_cvt_pk_bf16_f32 v166, v218, v219
 v_lshlrev_b32 v218, 16, v167
 v_and_b32 v219, 0xffff0000, v167
 v_mul_f32 v218, v218, v217
 v_mul_f32 v219, v219, v217
 v_cvt_pk_bf16_f32 v167, v218, v219
 v_lshlrev_b32 v218, 16, v180
 v_and_b32 v219, 0xffff0000, v180
 v_mul_f32 v218, v218, v217
 v_mul_f32 v219, v219, v217
 v_cvt_pk_bf16_f32 v180, v218, v219
 v_lshlrev_b32 v218, 16, v181
 v_and_b32 v219, 0xffff0000, v181
 v_mul_f32 v218, v218, v217
 v_mul_f32 v219, v219, v217
 v_cvt_pk_bf16_f32 v181, v218, v219
 v_lshlrev_b32 v218, 16, v182
 v_and_b32 v219, 0xffff0000, v182
 v_mul_f32 v218, v218, v217
 v_mul_f32 v219, v219, v217
 v_cvt_pk_bf16_f32 v182, v218, v219
 v_lshlrev_b32 v218, 16, v183
 v_and_b32 v219, 0xffff0000, v183
 v_mul_f32 v218, v218, v217
 v_mul_f32 v219, v219, v217
 v_cvt_pk_bf16_f32 v183, v218, v219
 v_exp_f32 v208, v68
 v_exp_f32 v209, v69
 v_exp_f32 v210, v70
 v_exp_f32 v211, v71
 s_nop 0
 v_cvt_pk_bf16_f32 v132, v208, v209
 v_cvt_pk_bf16_f32 v133, v210, v211
 v_exp_f32 v208, v84
 v_exp_f32 v209, v85
 v_exp_f32 v210, v86
 v_exp_f32 v211, v87
 s_nop 0
 v_cvt_pk_bf16_f32 v134, v208, v209
 v_cvt_pk_bf16_f32 v135, v210, v211
 s_nop 1
 v_mfma_f32_16x16x32_bf16 v[20:23], v[240:243], v[132:135], v[36:39]
 v_log_f32 v216, v254
 v_max3_f32 v217, v72, v73, v74
 v_max3_f32 v217, v217, v75, v88
 v_max3_f32 v217, v217, v89, v90
 v_max3_f32 v216, v216, v217, v91
 v_mov_b32 v217, v216
 s_nop 1
 v_permlane32_swap_b32 v217, v216
 s_nop 0
 v_max_f32 v216, v216, v217
 v_mov_b32 v217, v216
 s_nop 1
 v_permlane16_swap_b32 v217, v216
 s_nop 0
 v_max_f32 v216, v216, v217
 v_ceil_f32 v216, v216
 v_add_f32 v216, 1120534528, v216
 v_max_f32 v216, 0, v216
 v_exp_f32 v217, -v216
 v_sub_f32 v200, v200, v216
 v_sub_f32 v201, v201, v216
 v_sub_f32 v202, v202, v216
 v_sub_f32 v203, v203, v216
 v_sub_f32 v72, v72, v216
 v_sub_f32 v73, v73, v216
 v_sub_f32 v74, v74, v216
 v_sub_f32 v75, v75, v216
 v_sub_f32 v88, v88, v216
 v_sub_f32 v89, v89, v216
 v_sub_f32 v90, v90, v216
 v_sub_f32 v91, v91, v216
 v_sub_f32 v104, v104, v216
 v_sub_f32 v105, v105, v216
 v_sub_f32 v106, v106, v216
 v_sub_f32 v107, v107, v216
 v_sub_f32 v120, v120, v216
 v_sub_f32 v121, v121, v216
 v_sub_f32 v122, v122, v216
 v_sub_f32 v123, v123, v216
 v_mul_f32 v254, v254, v217
 v_accvgpr_read_b32 v218, a8
 v_accvgpr_read_b32 v219, a9
 v_accvgpr_read_b32 v220, a10
 v_accvgpr_read_b32 v221, a11
 v_mul_f32 v218, v218, v217
 v_mul_f32 v219, v219, v217
 v_mul_f32 v220, v220, v217
 v_mul_f32 v221, v221, v217
 v_accvgpr_write_b32 a8, v218
 v_accvgpr_write_b32 a9, v219
 v_accvgpr_write_b32 a10, v220
 v_accvgpr_write_b32 a11, v221
 v_accvgpr_read_b32 v218, a24
 v_accvgpr_read_b32 v219, a25
 v_accvgpr_read_b32 v220, a26
 v_accvgpr_read_b32 v221, a27
 v_mul_f32 v218, v218, v217
 v_mul_f32 v219, v219, v217
 v_mul_f32 v220, v220, v217
 v_mul_f32 v221, v221, v217
 v_accvgpr_write_b32 a24, v218
 v_accvgpr_write_b32 a25, v219
 v_accvgpr_write_b32 a26, v220
 v_accvgpr_write_b32 a27, v221
 v_accvgpr_read_b32 v218, a40
 v_accvgpr_read_b32 v219, a41
 v_accvgpr_read_b32 v220, a42
 v_accvgpr_read_b32 v221, a43
 v_mul_f32 v218, v218, v217
 v_mul_f32 v219, v219, v217
 v_mul_f32 v220, v220, v217
 v_mul_f32 v221, v221, v217
 v_accvgpr_write_b32 a40, v218
 v_accvgpr_write_b32 a41, v219
 v_accvgpr_write_b32 a42, v220
 v_accvgpr_write_b32 a43, v221
 v_accvgpr_read_b32 v218, a56
 v_accvgpr_read_b32 v219, a57
 v_accvgpr_read_b32 v220, a58
 v_accvgpr_read_b32 v221, a59
 v_mul_f32 v218, v218, v217
 v_mul_f32 v219, v219, v217
 v_mul_f32 v220, v220, v217
 v_mul_f32 v221, v221, v217
 v_accvgpr_write_b32 a56, v218
 v_accvgpr_write_b32 a57, v219
 v_accvgpr_write_b32 a58, v220
 v_accvgpr_write_b32 a59, v221
 v_accvgpr_read_b32 v218, a72
 v_accvgpr_read_b32 v219, a73
 v_accvgpr_read_b32 v220, a74
 v_accvgpr_read_b32 v221, a75
 v_mul_f32 v218, v218, v217
 v_mul_f32 v219, v219, v217
 v_mul_f32 v220, v220, v217
 v_mul_f32 v221, v221, v217
 v_accvgpr_write_b32 a72, v218
 v_accvgpr_write_b32 a73, v219
 v_accvgpr_write_b32 a74, v220
 v_accvgpr_write_b32 a75, v221
 v_accvgpr_read_b32 v218, a88
 v_accvgpr_read_b32 v219, a89
 v_accvgpr_read_b32 v220, a90
 v_accvgpr_read_b32 v221, a91
 v_mul_f32 v218, v218, v217
 v_mul_f32 v219, v219, v217
 v_mul_f32 v220, v220, v217
 v_mul_f32 v221, v221, v217
 v_accvgpr_write_b32 a88, v218
 v_accvgpr_write_b32 a89, v219
 v_accvgpr_write_b32 a90, v220
 v_accvgpr_write_b32 a91, v221
 v_accvgpr_read_b32 v218, a104
 v_accvgpr_read_b32 v219, a105
 v_accvgpr_read_b32 v220, a106
 v_accvgpr_read_b32 v221, a107
 v_mul_f32 v218, v218, v217
 v_mul_f32 v219, v219, v217
 v_mul_f32 v220, v220, v217
 v_mul_f32 v221, v221, v217
 v_accvgpr_write_b32 a104, v218
 v_accvgpr_write_b32 a105, v219
 v_accvgpr_write_b32 a106, v220
 v_accvgpr_write_b32 a107, v221
 v_accvgpr_read_b32 v218, a120
 v_accvgpr_read_b32 v219, a121
 v_accvgpr_read_b32 v220, a122
 v_accvgpr_read_b32 v221, a123
 v_mul_f32 v218, v218, v217
 v_mul_f32 v219, v219, v217
 v_mul_f32 v220, v220, v217
 v_mul_f32 v221, v221, v217
 v_accvgpr_write_b32 a120, v218
 v_accvgpr_write_b32 a121, v219
 v_accvgpr_write_b32 a122, v220
 v_accvgpr_write_b32 a123, v221
 v_lshlrev_b32 v218, 16, v168
 v_and_b32 v219, 0xffff0000, v168
 v_mul_f32 v218, v218, v217
 v_mul_f32 v219, v219, v217
 v_cvt_pk_bf16_f32 v168, v218, v219
 v_lshlrev_b32 v218, 16, v169
 v_and_b32 v219, 0xffff0000, v169
 v_mul_f32 v218, v218, v217
 v_mul_f32 v219, v219, v217
 v_cvt_pk_bf16_f32 v169, v218, v219
 v_lshlrev_b32 v218, 16, v170
 v_and_b32 v219, 0xffff0000, v170
 v_mul_f32 v218, v218, v217
 v_mul_f32 v219, v219, v217
 v_cvt_pk_bf16_f32 v170, v218, v219
 v_lshlrev_b32 v218, 16, v171
 v_and_b32 v219, 0xffff0000, v171
 v_mul_f32 v218, v218, v217
 v_mul_f32 v219, v219, v217
 v_cvt_pk_bf16_f32 v171, v218, v219
 v_lshlrev_b32 v218, 16, v184
 v_and_b32 v219, 0xffff0000, v184
 v_mul_f32 v218, v218, v217
 v_mul_f32 v219, v219, v217
 v_cvt_pk_bf16_f32 v184, v218, v219
 v_lshlrev_b32 v218, 16, v185
 v_and_b32 v219, 0xffff0000, v185
 v_mul_f32 v218, v218, v217
 v_mul_f32 v219, v219, v217
 v_cvt_pk_bf16_f32 v185, v218, v219
 v_lshlrev_b32 v218, 16, v186
 v_and_b32 v219, 0xffff0000, v186
 v_mul_f32 v218, v218, v217
 v_mul_f32 v219, v219, v217
 v_cvt_pk_bf16_f32 v186, v218, v219
 v_lshlrev_b32 v218, 16, v187
 v_and_b32 v219, 0xffff0000, v187
 v_mul_f32 v218, v218, v217
 v_mul_f32 v219, v219, v217
 v_cvt_pk_bf16_f32 v187, v218, v219
 v_exp_f32 v24, v72
 v_exp_f32 v25, v73
 v_exp_f32 v26, v74
 v_exp_f32 v27, v75
 s_nop 0
 v_cvt_pk_bf16_f32 v136, v24, v25
 v_cvt_pk_bf16_f32 v137, v26, v27
 v_exp_f32 v40, v88
 v_exp_f32 v41, v89
 v_exp_f32 v42, v90
 v_exp_f32 v43, v91
 s_nop 0
 v_cvt_pk_bf16_f32 v138, v40, v41
 v_cvt_pk_bf16_f32 v139, v42, v43
 v_add_f32 v215, v24, v25
 v_add_f32 v215, v215, v26
 v_add_f32 v215, v215, v27
 v_add_f32 v215, v215, v40
 v_add_f32 v215, v215, v41
 v_add_f32 v215, v215, v42
 v_add_f32 v215, v215, v43
 v_log_f32 v216, v44
 v_max3_f32 v217, v76, v77, v78
 v_max3_f32 v217, v217, v79, v92
 v_max3_f32 v217, v217, v93, v94
 v_max3_f32 v216, v216, v217, v95
 v_mov_b32 v217, v216
 s_nop 1
 v_permlane32_swap_b32 v217, v216
 s_nop 0
 v_max_f32 v216, v216, v217
 v_mov_b32 v217, v216
 s_nop 1
 v_permlane16_swap_b32 v217, v216
 s_nop 0
 v_max_f32 v216, v216, v217
 v_ceil_f32 v216, v216
 v_add_f32 v216, 1120534528, v216
 v_max_f32 v216, 0, v216
 v_exp_f32 v217, -v216
 v_sub_f32 v204, v204, v216
 v_sub_f32 v205, v205, v216
 v_sub_f32 v206, v206, v216
 v_sub_f32 v207, v207, v216
 v_sub_f32 v76, v76, v216
 v_sub_f32 v77, v77, v216
 v_sub_f32 v78, v78, v216
 v_sub_f32 v79, v79, v216
 v_sub_f32 v92, v92, v216
 v_sub_f32 v93, v93, v216
 v_sub_f32 v94, v94, v216
 v_sub_f32 v95, v95, v216
 v_sub_f32 v108, v108, v216
 v_sub_f32 v109, v109, v216
 v_sub_f32 v110, v110, v216
 v_sub_f32 v111, v111, v216
 v_sub_f32 v124, v124, v216
 v_sub_f32 v125, v125, v216
 v_sub_f32 v126, v126, v216
 v_sub_f32 v127, v127, v216
 v_mul_f32 v44, v44, v217
 v_mul_f32 v45, v45, v217
 v_mul_f32 v46, v46, v217
 v_mul_f32 v47, v47, v217
 v_accvgpr_read_b32 v218, a12
 v_accvgpr_read_b32 v219, a13
 v_accvgpr_read_b32 v220, a14
 v_accvgpr_read_b32 v221, a15
 v_mul_f32 v218, v218, v217
 v_mul_f32 v219, v219, v217
 v_mul_f32 v220, v220, v217
 v_mul_f32 v221, v221, v217
 v_accvgpr_write_b32 a12, v218
 v_accvgpr_write_b32 a13, v219
 v_accvgpr_write_b32 a14, v220
 v_accvgpr_write_b32 a15, v221
 v_accvgpr_read_b32 v218, a28
 v_accvgpr_read_b32 v219, a29
 v_accvgpr_read_b32 v220, a30
 v_accvgpr_read_b32 v221, a31
 v_mul_f32 v218, v218, v217
 v_mul_f32 v219, v219, v217
 v_mul_f32 v220, v220, v217
 v_mul_f32 v221, v221, v217
 v_accvgpr_write_b32 a28, v218
 v_accvgpr_write_b32 a29, v219
 v_accvgpr_write_b32 a30, v220
 v_accvgpr_write_b32 a31, v221
 v_accvgpr_read_b32 v218, a44
 v_accvgpr_read_b32 v219, a45
 v_accvgpr_read_b32 v220, a46
 v_accvgpr_read_b32 v221, a47
 v_mul_f32 v218, v218, v217
 v_mul_f32 v219, v219, v217
 v_mul_f32 v220, v220, v217
 v_mul_f32 v221, v221, v217
 v_accvgpr_write_b32 a44, v218
 v_accvgpr_write_b32 a45, v219
 v_accvgpr_write_b32 a46, v220
 v_accvgpr_write_b32 a47, v221
 v_accvgpr_read_b32 v218, a60
 v_accvgpr_read_b32 v219, a61
 v_accvgpr_read_b32 v220, a62
 v_accvgpr_read_b32 v221, a63
 v_mul_f32 v218, v218, v217
 v_mul_f32 v219, v219, v217
 v_mul_f32 v220, v220, v217
 v_mul_f32 v221, v221, v217
 v_accvgpr_write_b32 a60, v218
 v_accvgpr_write_b32 a61, v219
 v_accvgpr_write_b32 a62, v220
 v_accvgpr_write_b32 a63, v221
 v_accvgpr_read_b32 v218, a76
 v_accvgpr_read_b32 v219, a77
 v_accvgpr_read_b32 v220, a78
 v_accvgpr_read_b32 v221, a79
 v_mul_f32 v218, v218, v217
 v_mul_f32 v219, v219, v217
 v_mul_f32 v220, v220, v217
 v_mul_f32 v221, v221, v217
 v_accvgpr_write_b32 a76, v218
 v_accvgpr_write_b32 a77, v219
 v_accvgpr_write_b32 a78, v220
 v_accvgpr_write_b32 a79, v221
 v_accvgpr_read_b32 v218, a92
 v_accvgpr_read_b32 v219, a93
 v_accvgpr_read_b32 v220, a94
 v_accvgpr_read_b32 v221, a95
 v_mul_f32 v218, v218, v217
 v_mul_f32 v219, v219, v217
 v_mul_f32 v220, v220, v217
 v_mul_f32 v221, v221, v217
 v_accvgpr_write_b32 a92, v218
 v_accvgpr_write_b32 a93, v219
 v_accvgpr_write_b32 a94, v220
 v_accvgpr_write_b32 a95, v221
 v_accvgpr_read_b32 v218, a108
 v_accvgpr_read_b32 v219, a109
 v_accvgpr_read_b32 v220, a110
 v_accvgpr_read_b32 v221, a111
 v_mul_f32 v218, v218, v217
 v_mul_f32 v219, v219, v217
 v_mul_f32 v220, v220, v217
 v_mul_f32 v221, v221, v217
 v_accvgpr_write_b32 a108, v218
 v_accvgpr_write_b32 a109, v219
 v_accvgpr_write_b32 a110, v220
 v_accvgpr_write_b32 a111, v221
 v_accvgpr_read_b32 v218, a124
 v_accvgpr_read_b32 v219, a125
 v_accvgpr_read_b32 v220, a126
 v_accvgpr_read_b32 v221, a127
 v_mul_f32 v218, v218, v217
 v_mul_f32 v219, v219, v217
 v_mul_f32 v220, v220, v217
 v_mul_f32 v221, v221, v217
 v_accvgpr_write_b32 a124, v218
 v_accvgpr_write_b32 a125, v219
 v_accvgpr_write_b32 a126, v220
 v_accvgpr_write_b32 a127, v221
 v_lshlrev_b32 v218, 16, v172
 v_and_b32 v219, 0xffff0000, v172
 v_mul_f32 v218, v218, v217
 v_mul_f32 v219, v219, v217
 v_cvt_pk_bf16_f32 v172, v218, v219
 v_lshlrev_b32 v218, 16, v173
 v_and_b32 v219, 0xffff0000, v173
 v_mul_f32 v218, v218, v217
 v_mul_f32 v219, v219, v217
 v_cvt_pk_bf16_f32 v173, v218, v219
 v_lshlrev_b32 v218, 16, v174
 v_and_b32 v219, 0xffff0000, v174
 v_mul_f32 v218, v218, v217
 v_mul_f32 v219, v219, v217
 v_cvt_pk_bf16_f32 v174, v218, v219
 v_lshlrev_b32 v218, 16, v175
 v_and_b32 v219, 0xffff0000, v175
 v_mul_f32 v218, v218, v217
 v_mul_f32 v219, v219, v217
 v_cvt_pk_bf16_f32 v175, v218, v219
 v_lshlrev_b32 v218, 16, v188
 v_and_b32 v219, 0xffff0000, v188
 v_mul_f32 v218, v218, v217
 v_mul_f32 v219, v219, v217
 v_cvt_pk_bf16_f32 v188, v218, v219
 v_lshlrev_b32 v218, 16, v189
 v_and_b32 v219, 0xffff0000, v189
 v_mul_f32 v218, v218, v217
 v_mul_f32 v219, v219, v217
 v_cvt_pk_bf16_f32 v189, v218, v219
 v_lshlrev_b32 v218, 16, v190
 v_and_b32 v219, 0xffff0000, v190
 v_mul_f32 v218, v218, v217
 v_mul_f32 v219, v219, v217
 v_cvt_pk_bf16_f32 v190, v218, v219
 v_lshlrev_b32 v218, 16, v191
 v_and_b32 v219, 0xffff0000, v191
 v_mul_f32 v218, v218, v217
 v_mul_f32 v219, v219, v217
 v_cvt_pk_bf16_f32 v191, v218, v219
 v_exp_f32 v208, v76
 v_exp_f32 v209, v77
 v_exp_f32 v210, v78
 v_exp_f32 v211, v79
 s_nop 0
 v_cvt_pk_bf16_f32 v140, v208, v209
 v_cvt_pk_bf16_f32 v141, v210, v211
 v_exp_f32 v208, v92
 v_exp_f32 v209, v93
 v_exp_f32 v210, v94
 v_exp_f32 v211, v95
 s_nop 0
 v_cvt_pk_bf16_f32 v142, v208, v209
 v_cvt_pk_bf16_f32 v143, v210, v211
 s_nop 1
 v_mfma_f32_16x16x32_bf16 v[28:31], v[240:243], v[140:143], v[44:47]
 v_exp_f32 v16, v96
 v_exp_f32 v17, v97
 v_exp_f32 v18, v98
 v_exp_f32 v19, v99
 s_nop 0
 v_cvt_pk_bf16_f32 v144, v16, v17
 v_cvt_pk_bf16_f32 v145, v18, v19
 v_exp_f32 v32, v112
 v_exp_f32 v33, v113
 v_exp_f32 v34, v114
 v_exp_f32 v35, v115
 s_nop 0
 v_cvt_pk_bf16_f32 v146, v32, v33
 s_nop 11
 s_setpc_b64 s[50:51]
L_rare_1:
 s_nop 15
 v_log_f32 v216, v253
 v_max3_f32 v217, v96, v97, v98
 v_max3_f32 v217, v217, v99, v112
 v_max3_f32 v217, v217, v113, v114
 v_max3_f32 v216, v216, v217, v115
 v_mov_b32 v217, v216
 s_nop 1
 v_permlane32_swap_b32 v217, v216
 s_nop 0
 v_max_f32 v216, v216, v217
 v_mov_b32 v217, v216
 s_nop 1
 v_permlane16_swap_b32 v217, v216
 s_nop 0
 v_max_f32 v216, v216, v217
 v_ceil_f32 v216, v216
 v_add_f32 v216, 1120534528, v216
 v_max_f32 v216, 0, v216
 v_exp_f32 v217, -v216
 v_sub_f32 v192, v192, v216
 v_sub_f32 v193, v193, v216
 v_sub_f32 v194, v194, v216
 v_sub_f32 v195, v195, v216
 v_sub_f32 v64, v64, v216
 v_sub_f32 v65, v65, v216
 v_sub_f32 v66, v66, v216
 v_sub_f32 v67, v67, v216
 v_sub_f32 v80, v80, v216
 v_sub_f32 v81, v81, v216
 v_sub_f32 v82, v82, v216
 v_sub_f32 v83, v83, v216
 v_sub_f32 v96, v96, v216
 v_sub_f32 v97, v97, v216
 v_sub_f32 v98, v98, v216
 v_sub_f32 v99, v99, v216
 v_sub_f32 v112, v112, v216
 v_sub_f32 v113, v113, v216
 v_sub_f32 v114, v114, v216
 v_sub_f32 v115, v115, v216
 v_mul_f32 v253, v253, v217
 v_accvgpr_read_b32 v218, a0
 v_accvgpr_read_b32 v219, a1
 v_accvgpr_read_b32 v220, a2
 v_accvgpr_read_b32 v221, a3
 v_mul_f32 v218, v218, v217
 v_mul_f32 v219, v219, v217
 v_mul_f32 v220, v220, v217
 v_mul_f32 v221, v221, v217
 v_accvgpr_write_b32 a0, v218
 v_accvgpr_write_b32 a1, v219
 v_accvgpr_write_b32 a2, v220
 v_accvgpr_write_b32 a3, v221
 v_accvgpr_read_b32 v218, a16
 v_accvgpr_read_b32 v219, a17
 v_accvgpr_read_b32 v220, a18
 v_accvgpr_read_b32 v221, a19
 v_mul_f32 v218, v218, v217
 v_mul_f32 v219, v219, v217
 v_mul_f32 v220, v220, v217
 v_mul_f32 v221, v221, v217
 v_accvgpr_write_b32 a16, v218
 v_accvgpr_write_b32 a17, v219
 v_accvgpr_write_b32 a18, v220
 v_accvgpr_write_b32 a19, v221
 v_accvgpr_read_b32 v218, a32
 v_accvgpr_read_b32 v219, a33
 v_accvgpr_read_b32 v220, a34
 v_accvgpr_read_b32 v221, a35
 v_mul_f32 v218, v218, v217
 v_mul_f32 v219, v219, v217
 v_mul_f32 v220, v220, v217
 v_mul_f32 v221, v221, v217
 v_accvgpr_write_b32 a32, v218
 v_accvgpr_write_b32 a33, v219
 v_accvgpr_write_b32 a34, v220
 v_accvgpr_write_b32 a35, v221
 v_accvgpr_read_b32 v218, a48
 v_accvgpr_read_b32 v219, a49
 v_accvgpr_read_b32 v220, a50
 v_accvgpr_read_b32 v221, a51
 v_mul_f32 v218, v218, v217
 v_mul_f32 v219, v219, v217
 v_mul_f32 v220, v220, v217
 v_mul_f32 v221, v221, v217
 v_accvgpr_write_b32 a48, v218
 v_accvgpr_write_b32 a49, v219
 v_accvgpr_write_b32 a50, v220
 v_accvgpr_write_b32 a51, v221
 v_accvgpr_read_b32 v218, a64
 v_accvgpr_read_b32 v219, a65
 v_accvgpr_read_b32 v220, a66
 v_accvgpr_read_b32 v221, a67
 v_mul_f32 v218, v218, v217
 v_mul_f32 v219, v219, v217
 v_mul_f32 v220, v220, v217
 v_mul_f32 v221, v221, v217
 v_accvgpr_write_b32 a64, v218
 v_accvgpr_write_b32 a65, v219
 v_accvgpr_write_b32 a66, v220
 v_accvgpr_write_b32 a67, v221
 v_accvgpr_read_b32 v218, a80
 v_accvgpr_read_b32 v219, a81
 v_accvgpr_read_b32 v220, a82
 v_accvgpr_read_b32 v221, a83
 v_mul_f32 v218, v218, v217
 v_mul_f32 v219, v219, v217
 v_mul_f32 v220, v220, v217
 v_mul_f32 v221, v221, v217
 v_accvgpr_write_b32 a80, v218
 v_accvgpr_write_b32 a81, v219
 v_accvgpr_write_b32 a82, v220
 v_accvgpr_write_b32 a83, v221
 v_accvgpr_read_b32 v218, a96
 v_accvgpr_read_b32 v219, a97
 v_accvgpr_read_b32 v220, a98
 v_accvgpr_read_b32 v221, a99
 v_mul_f32 v218, v218, v217
 v_mul_f32 v219, v219, v217
 v_mul_f32 v220, v220, v217
 v_mul_f32 v221, v221, v217
 v_accvgpr_write_b32 a96, v218
 v_accvgpr_write_b32 a97, v219
 v_accvgpr_write_b32 a98, v220
 v_accvgpr_write_b32 a99, v221
 v_accvgpr_read_b32 v218, a112
 v_accvgpr_read_b32 v219, a113
 v_accvgpr_read_b32 v220, a114
 v_accvgpr_read_b32 v221, a115
 v_mul_f32 v218, v218, v217
 v_mul_f32 v219, v219, v217
 v_mul_f32 v220, v220, v217
 v_mul_f32 v221, v221, v217
 v_accvgpr_write_b32 a112, v218
 v_accvgpr_write_b32 a113, v219
 v_accvgpr_write_b32 a114, v220
 v_accvgpr_write_b32 a115, v221
 v_lshlrev_b32 v218, 16, v128
 v_and_b32 v219, 0xffff0000, v128
 v_mul_f32 v218, v218, v217
 v_mul_f32 v219, v219, v217
 v_cvt_pk_bf16_f32 v128, v218, v219
 v_lshlrev_b32 v218, 16, v129
 v_and_b32 v219, 0xffff0000, v129
 v_mul_f32 v218, v218, v217
 v_mul_f32 v219, v219, v217
 v_cvt_pk_bf16_f32 v129, v218, v219
 v_lshlrev_b32 v218, 16, v130
 v_and_b32 v219, 0xffff0000, v130
 v_mul_f32 v218, v218, v217
 v_mul_f32 v219, v219, v217
 v_cvt_pk_bf16_f32 v130, v218, v219
 v_lshlrev_b32 v218, 16, v131
 v_and_b32 v219, 0xffff0000, v131
 v_mul_f32 v218, v218, v217
 v_mul_f32 v219, v219, v217
 v_cvt_pk_bf16_f32 v131, v218, v219
 v_exp_f32 v16, v96
 v_exp_f32 v17, v97
 v_exp_f32 v18, v98
 v_exp_f32 v19, v99
 s_nop 0
 v_cvt_pk_bf16_f32 v144, v16, v17
 v_cvt_pk_bf16_f32 v145, v18, v19
 v_exp_f32 v32, v112
 v_exp_f32 v33, v113
 v_exp_f32 v34, v114
 v_exp_f32 v35, v115
 s_nop 0
 v_cvt_pk_bf16_f32 v146, v32, v33
 v_cvt_pk_bf16_f32 v147, v34, v35
 v_add_f32 v255, v16, v17
 v_add_f32 v255, v255, v18
 v_add_f32 v255, v255, v19
 v_add_f32 v255, v255, v32
 v_add_f32 v255, v255, v33
 v_add_f32 v255, v255, v34
 v_add_f32 v255, v255, v35
 v_log_f32 v216, v20
 v_max3_f32 v217, v100, v101, v102
 v_max3_f32 v217, v217, v103, v116
 v_max3_f32 v217, v217, v117, v118
 v_max3_f32 v216, v216, v217, v119
 v_mov_b32 v217, v216
 s_nop 1
 v_permlane32_swap_b32 v217, v216
 s_nop 0
 v_max_f32 v216, v216, v217
 v_mov_b32 v217, v216
 s_nop 1
 v_permlane16_swap_b32 v217, v216
 s_nop 0
 v_max_f32 v216, v216, v217
 v_ceil_f32 v216, v216
 v_add_f32 v216, 1120534528, v216
 v_max_f32 v216, 0, v216
 v_exp_f32 v217, -v216
 v_sub_f32 v196, v196, v216
 v_sub_f32 v197, v197, v216
 v_sub_f32 v198, v198, v216
 v_sub_f32 v199, v199, v216
 v_sub_f32 v68, v68, v216
 v_sub_f32 v69, v69, v216
 v_sub_f32 v70, v70, v216
 v_sub_f32 v71, v71, v216
 v_sub_f32 v84, v84, v216
 v_sub_f32 v85, v85, v216
 v_sub_f32 v86, v86, v216
 v_sub_f32 v87, v87, v216
 v_sub_f32 v100, v100, v216
 v_sub_f32 v101, v101, v216
 v_sub_f32 v102, v102, v216
 v_sub_f32 v103, v103, v216
 v_sub_f32 v116, v116, v216
 v_sub_f32 v117, v117, v216
 v_sub_f32 v118, v118, v216
 v_sub_f32 v119, v119, v216
 v_mul_f32 v20, v20, v217
 v_mul_f32 v21, v21, v217
 v_mul_f32 v22, v22, v217
 v_mul_f32 v23, v23, v217
 v_accvgpr_read_b32 v218, a4
 v_accvgpr_read_b32 v219, a5
 v_accvgpr_read_b32 v220, a6
 v_accvgpr_read_b32 v221, a7
 v_mul_f32 v218, v218, v217
 v_mul_f32 v219, v219, v217
 v_mul_f32 v220, v220, v217
 v_mul_f32 v221, v221, v217
 v_accvgpr_write_b32 a4, v218
 v_accvgpr_write_b32 a5, v219
 v_accvgpr_write_b32 a6, v220
 v_accvgpr_write_b32 a7, v221
 v_accvgpr_read_b32 v218, a20
 v_accvgpr_read_b32 v219, a21
 v_accvgpr_read_b32 v220, a22
 v_accvgpr_read_b32 v221, a23
 v_mul_f32 v218, v218, v217
 v_mul_f32 v219, v219, v217
 v_mul_f32 v220, v220, v217
 v_mul_f32 v221, v221, v217
 v_accvgpr_write_b32 a20, v218
 v_accvgpr_write_b32 a21, v219
 v_accvgpr_write_b32 a22, v220
 v_accvgpr_write_b32 a23, v221
 v_accvgpr_read_b32 v218, a36
 v_accvgpr_read_b32 v219, a37
 v_accvgpr_read_b32 v220, a38
 v_accvgpr_read_b32 v221, a39
 v_mul_f32 v218, v218, v217
 v_mul_f32 v219, v219, v217
 v_mul_f32 v220, v220, v217
 v_mul_f32 v221, v221, v217
 v_accvgpr_write_b32 a36, v218
 v_accvgpr_write_b32 a37, v219
 v_accvgpr_write_b32 a38, v220
 v_accvgpr_write_b32 a39, v221
 v_accvgpr_read_b32 v218, a52
 v_accvgpr_read_b32 v219, a53
 v_accvgpr_read_b32 v220, a54
 v_accvgpr_read_b32 v221, a55
 v_mul_f32 v218, v218, v217
 v_mul_f32 v219, v219, v217
 v_mul_f32 v220, v220, v217
 v_mul_f32 v221, v221, v217
 v_accvgpr_write_b32 a52, v218
 v_accvgpr_write_b32 a53, v219
 v_accvgpr_write_b32 a54, v220
 v_accvgpr_write_b32 a55, v221
 v_accvgpr_read_b32 v218, a68
 v_accvgpr_read_b32 v219, a69
 v_accvgpr_read_b32 v220, a70
 v_accvgpr_read_b32 v221, a71
 v_mul_f32 v218, v218, v217
 v_mul_f32 v219, v219, v217
 v_mul_f32 v220, v220, v217
 v_mul_f32 v221, v221, v217
 v_accvgpr_write_b32 a68, v218
 v_accvgpr_write_b32 a69, v219
 v_accvgpr_write_b32 a70, v220
 v_accvgpr_write_b32 a71, v221
 v_accvgpr_read_b32 v218, a84
 v_accvgpr_read_b32 v219, a85
 v_accvgpr_read_b32 v220, a86
 v_accvgpr_read_b32 v221, a87
 v_mul_f32 v218, v218, v217
 v_mul_f32 v219, v219, v217
 v_mul_f32 v220, v220, v217
 v_mul_f32 v221, v221, v217
 v_accvgpr_write_b32 a84, v218
 v_accvgpr_write_b32 a85, v219
 v_accvgpr_write_b32 a86, v220
 v_accvgpr_write_b32 a87, v221
 v_accvgpr_read_b32 v218, a100
 v_accvgpr_read_b32 v219, a101
 v_accvgpr_read_b32 v220, a102
 v_accvgpr_read_b32 v221, a103
 v_mul_f32 v218, v218, v217
 v_mul_f32 v219, v219, v217
 v_mul_f32 v220, v220, v217
 v_mul_f32 v221, v221, v217
 v_accvgpr_write_b32 a100, v218
 v_accvgpr_write_b32 a101, v219
 v_accvgpr_write_b32 a102, v220
 v_accvgpr_write_b32 a103, v221
 v_accvgpr_read_b32 v218, a116
 v_accvgpr_read_b32 v219, a117
 v_accvgpr_read_b32 v220, a118
 v_accvgpr_read_b32 v221, a119
 v_mul_f32 v218, v218, v217
 v_mul_f32 v219, v219, v217
 v_mul_f32 v220, v220, v217
 v_mul_f32 v221, v221, v217
 v_accvgpr_write_b32 a116, v218
 v_accvgpr_write_b32 a117, v219
 v_accvgpr_write_b32 a118, v220
 v_accvgpr_write_b32 a119, v221
 v_lshlrev_b32 v218, 16, v132
 v_and_b32 v219, 0xffff0000, v132
 v_mul_f32 v218, v218, v217
 v_mul_f32 v219, v219, v217
 v_cvt_pk_bf16_f32 v132, v218, v219
 v_lshlrev_b32 v218, 16, v133
 v_and_b32 v219, 0xffff0000, v133
 v_mul_f32 v218, v218, v217
 v_mul_f32 v219, v219, v217
 v_cvt_pk_bf16_f32 v133, v218, v219
 v_lshlrev_b32 v218, 16, v134
 v_and_b32 v219, 0xffff0000, v134
 v_mul_f32 v218, v218, v217
 v_mul_f32 v219, v219, v217
 v_cvt_pk_bf16_f32 v134, v218, v219
 v_lshlrev_b32 v218, 16, v135
 v_and_b32 v219, 0xffff0000, v135
 v_mul_f32 v218, v218, v217
 v_mul_f32 v219, v219, v217
 v_cvt_pk_bf16_f32 v135, v218, v219
 v_exp_f32 v208, v100
 v_exp_f32 v209, v101
 v_exp_f32 v210, v102
 v_exp_f32 v211, v103
 s_nop 0
 v_cvt_pk_bf16_f32 v148, v208, v209
 v_cvt_pk_bf16_f32 v149, v210, v211
 v_exp_f32 v208, v116
 v_exp_f32 v209, v117
 v_exp_f32 v210, v118
 v_exp_f32 v211, v119
 s_nop 0
 v_cvt_pk_bf16_f32 v150, v208, v209
 v_cvt_pk_bf16_f32 v151, v210, v211
 s_nop 1
 v_mfma_f32_16x16x32_bf16 v[36:39], v[240:243], v[148:151], v[20:23]
 v_log_f32 v216, v254
 v_max3_f32 v217, v104, v105, v106
 v_max3_f32 v217, v217, v107, v120
 v_max3_f32 v217, v217, v121, v122
 v_max3_f32 v216, v216, v217, v123
 v_mov_b32 v217, v216
 s_nop 1
 v_permlane32_swap_b32 v217, v216
 s_nop 0
 v_max_f32 v216, v216, v217
 v_mov_b32 v217, v216
 s_nop 1
 v_permlane16_swap_b32 v217, v216
 s_nop 0
 v_max_f32 v216, v216, v217
 v_ceil_f32 v216, v216
 v_add_f32 v216, 1120534528, v216
 v_max_f32 v216, 0, v216
 v_exp_f32 v217, -v216
 v_sub_f32 v200, v200, v216
 v_sub_f32 v201, v201, v216
 v_sub_f32 v202, v202, v216
 v_sub_f32 v203, v203, v216
 v_sub_f32 v72, v72, v216
 v_sub_f32 v73, v73, v216
 v_sub_f32 v74, v74, v216
 v_sub_f32 v75, v75, v216
 v_sub_f32 v88, v88, v216
 v_sub_f32 v89, v89, v216
 v_sub_f32 v90, v90, v216
 v_sub_f32 v91, v91, v216
 v_sub_f32 v104, v104, v216
 v_sub_f32 v105, v105, v216
 v_sub_f32 v106, v106, v216
 v_sub_f32 v107, v107, v216
 v_sub_f32 v120, v120, v216
 v_sub_f32 v121, v121, v216
 v_sub_f32 v122, v122, v216
 v_sub_f32 v123, v123, v216
 v_mul_f32 v254, v254, v217
 v_accvgpr_read_b32 v218, a8
 v_accvgpr_read_b32 v219, a9
 v_accvgpr_read_b32 v220, a10
 v_accvgpr_read_b32 v221, a11
 v_mul_f32 v218, v218, v217
 v_mul_f32 v219, v219, v217
 v_mul_f32 v220, v220, v217
 v_mul_f32 v221, v221, v217
 v_accvgpr_write_b32 a8, v218
 v_accvgpr_write_b32 a9, v219
 v_accvgpr_write_b32 a10, v220
 v_accvgpr_write_b32 a11, v221
 v_accvgpr_read_b32 v218, a24
 v_accvgpr_read_b32 v219, a25
 v_accvgpr_read_b32 v220, a26
 v_accvgpr_read_b32 v221, a27
 v_mul_f32 v218, v218, v217
 v_mul_f32 v219, v219, v217
 v_mul_f32 v220, v220, v217
 v_mul_f32 v221, v221, v217
 v_accvgpr_write_b32 a24, v218
 v_accvgpr_write_b32 a25, v219
 v_accvgpr_write_b32 a26, v220
 v_accvgpr_write_b32 a27, v221
 v_accvgpr_read_b32 v218, a40
 v_accvgpr_read_b32 v219, a41
 v_accvgpr_read_b32 v220, a42
 v_accvgpr_read_b32 v221, a43
 v_mul_f32 v218, v218, v217
 v_mul_f32 v219, v219, v217
 v_mul_f32 v220, v220, v217
 v_mul_f32 v221, v221, v217
 v_accvgpr_write_b32 a40, v218
 v_accvgpr_write_b32 a41, v219
 v_accvgpr_write_b32 a42, v220
 v_accvgpr_write_b32 a43, v221
 v_accvgpr_read_b32 v218, a56
 v_accvgpr_read_b32 v219, a57
 v_accvgpr_read_b32 v220, a58
 v_accvgpr_read_b32 v221, a59
 v_mul_f32 v218, v218, v217
 v_mul_f32 v219, v219, v217
 v_mul_f32 v220, v220, v217
 v_mul_f32 v221, v221, v217
 v_accvgpr_write_b32 a56, v218
 v_accvgpr_write_b32 a57, v219
 v_accvgpr_write_b32 a58, v220
 v_accvgpr_write_b32 a59, v221
 v_accvgpr_read_b32 v218, a72
 v_accvgpr_read_b32 v219, a73
 v_accvgpr_read_b32 v220, a74
 v_accvgpr_read_b32 v221, a75
 v_mul_f32 v218, v218, v217
 v_mul_f32 v219, v219, v217
 v_mul_f32 v220, v220, v217
 v_mul_f32 v221, v221, v217
 v_accvgpr_write_b32 a72, v218
 v_accvgpr_write_b32 a73, v219
 v_accvgpr_write_b32 a74, v220
 v_accvgpr_write_b32 a75, v221
 v_accvgpr_read_b32 v218, a88
 v_accvgpr_read_b32 v219, a89
 v_accvgpr_read_b32 v220, a90
 v_accvgpr_read_b32 v221, a91
 v_mul_f32 v218, v218, v217
 v_mul_f32 v219, v219, v217
 v_mul_f32 v220, v220, v217
 v_mul_f32 v221, v221, v217
 v_accvgpr_write_b32 a88, v218
 v_accvgpr_write_b32 a89, v219
 v_accvgpr_write_b32 a90, v220
 v_accvgpr_write_b32 a91, v221
 v_accvgpr_read_b32 v218, a104
 v_accvgpr_read_b32 v219, a105
 v_accvgpr_read_b32 v220, a106
 v_accvgpr_read_b32 v221, a107
 v_mul_f32 v218, v218, v217
 v_mul_f32 v219, v219, v217
 v_mul_f32 v220, v220, v217
 v_mul_f32 v221, v221, v217
 v_accvgpr_write_b32 a104, v218
 v_accvgpr_write_b32 a105, v219
 v_accvgpr_write_b32 a106, v220
 v_accvgpr_write_b32 a107, v221
 v_accvgpr_read_b32 v218, a120
 v_accvgpr_read_b32 v219, a121
 v_accvgpr_read_b32 v220, a122
 v_accvgpr_read_b32 v221, a123
 v_mul_f32 v218, v218, v217
 v_mul_f32 v219, v219, v217
 v_mul_f32 v220, v220, v217
 v_mul_f32 v221, v221, v217
 v_accvgpr_write_b32 a120, v218
 v_accvgpr_write_b32 a121, v219
 v_accvgpr_write_b32 a122, v220
 v_accvgpr_write_b32 a123, v221
 v_lshlrev_b32 v218, 16, v136
 v_and_b32 v219, 0xffff0000, v136
 v_mul_f32 v218, v218, v217
 v_mul_f32 v219, v219, v217
 v_cvt_pk_bf16_f32 v136, v218, v219
 v_lshlrev_b32 v218, 16, v137
 v_and_b32 v219, 0xffff0000, v137
 v_mul_f32 v218, v218, v217
 v_mul_f32 v219, v219, v217
 v_cvt_pk_bf16_f32 v137, v218, v219
 v_lshlrev_b32 v218, 16, v138
 v_and_b32 v219, 0xffff0000, v138
 v_mul_f32 v218, v218, v217
 v_mul_f32 v219, v219, v217
 v_cvt_pk_bf16_f32 v138, v218, v219
 v_lshlrev_b32 v218, 16, v139
 v_and_b32 v219, 0xffff0000, v139
 v_mul_f32 v218, v218, v217
 v_mul_f32 v219, v219, v217
 v_cvt_pk_bf16_f32 v139, v218, v219
 v_exp_f32 v24, v104
 v_exp_f32 v25, v105
 v_exp_f32 v26, v106
 v_exp_f32 v27, v107
 s_nop 0
 v_cvt_pk_bf16_f32 v152, v24, v25
 v_cvt_pk_bf16_f32 v153, v26, v27
 v_exp_f32 v40, v120
 v_exp_f32 v41, v121
 v_exp_f32 v42, v122
 v_exp_f32 v43, v123
 s_nop 0
 v_cvt_pk_bf16_f32 v154, v40, v41
 v_cvt_pk_bf16_f32 v155, v42, v43
 v_add_f32 v215, v24, v25
 v_add_f32 v215, v215, v26
 v_add_f32 v215, v215, v27
 v_add_f32 v215, v215, v40
 v_add_f32 v215, v215, v41
 v_add_f32 v215, v215, v42
 v_add_f32 v215, v215, v43
 v_log_f32 v216, v28
 v_max3_f32 v217, v108, v109, v110
 v_max3_f32 v217, v217, v111, v124
 v_max3_f32 v217, v217, v125, v126
 v_max3_f32 v216, v216, v217, v127
 v_mov_b32 v217, v216
 s_nop 1
 v_permlane32_swap_b32 v217, v216
 s_nop 0
 v_max_f32 v216, v216, v217
 v_mov_b32 v217, v216
 s_nop 1
 v_permlane16_swap_b32 v217, v216
 s_nop 0
 v_max_f32 v216, v216, v217
 v_ceil_f32 v216, v216
 v_add_f32 v216, 1120534528, v216
 v_max_f32 v216, 0, v216
 v_exp_f32 v217, -v216
 v_sub_f32 v204, v204, v216
 v_sub_f32 v205, v205, v216
 v_sub_f32 v206, v206, v216
 v_sub_f32 v207, v207, v216
 v_sub_f32 v76, v76, v216
 v_sub_f32 v77, v77, v216
 v_sub_f32 v78, v78, v216
 v_sub_f32 v79, v79, v216
 v_sub_f32 v92, v92, v216
 v_sub_f32 v93, v93, v216
 v_sub_f32 v94, v94, v216
 v_sub_f32 v95, v95, v216
 v_sub_f32 v108, v108, v216
 v_sub_f32 v109, v109, v216
 v_sub_f32 v110, v110, v216
 v_sub_f32 v111, v111, v216
 v_sub_f32 v124, v124, v216
 v_sub_f32 v125, v125, v216
 v_sub_f32 v126, v126, v216
 v_sub_f32 v127, v127, v216
 v_mul_f32 v28, v28, v217
 v_mul_f32 v29, v29, v217
 v_mul_f32 v30, v30, v217
 v_mul_f32 v31, v31, v217
 v_accvgpr_read_b32 v218, a12
 v_accvgpr_read_b32 v219, a13
 v_accvgpr_read_b32 v220, a14
 v_accvgpr_read_b32 v221, a15
 v_mul_f32 v218, v218, v217
 v_mul_f32 v219, v219, v217
 v_mul_f32 v220, v220, v217
 v_mul_f32 v221, v221, v217
 v_accvgpr_write_b32 a12, v218
 v_accvgpr_write_b32 a13, v219
 v_accvgpr_write_b32 a14, v220
 v_accvgpr_write_b32 a15, v221
 v_accvgpr_read_b32 v218, a28
 v_accvgpr_read_b32 v219, a29
 v_accvgpr_read_b32 v220, a30
 v_accvgpr_read_b32 v221, a31
 v_mul_f32 v218, v218, v217
 v_mul_f32 v219, v219, v217
 v_mul_f32 v220, v220, v217
 v_mul_f32 v221, v221, v217
 v_accvgpr_write_b32 a28, v218
 v_accvgpr_write_b32 a29, v219
 v_accvgpr_write_b32 a30, v220
 v_accvgpr_write_b32 a31, v221
 v_accvgpr_read_b32 v218, a44
 v_accvgpr_read_b32 v219, a45
 v_accvgpr_read_b32 v220, a46
 v_accvgpr_read_b32 v221, a47
 v_mul_f32 v218, v218, v217
 v_mul_f32 v219, v219, v217
 v_mul_f32 v220, v220, v217
 v_mul_f32 v221, v221, v217
 v_accvgpr_write_b32 a44, v218
 v_accvgpr_write_b32 a45, v219
 v_accvgpr_write_b32 a46, v220
 v_accvgpr_write_b32 a47, v221
 v_accvgpr_read_b32 v218, a60
 v_accvgpr_read_b32 v219, a61
 v_accvgpr_read_b32 v220, a62
 v_accvgpr_read_b32 v221, a63
 v_mul_f32 v218, v218, v217
 v_mul_f32 v219, v219, v217
 v_mul_f32 v220, v220, v217
 v_mul_f32 v221, v221, v217
 v_accvgpr_write_b32 a60, v218
 v_accvgpr_write_b32 a61, v219
 v_accvgpr_write_b32 a62, v220
 v_accvgpr_write_b32 a63, v221
 v_accvgpr_read_b32 v218, a76
 v_accvgpr_read_b32 v219, a77
 v_accvgpr_read_b32 v220, a78
 v_accvgpr_read_b32 v221, a79
 v_mul_f32 v218, v218, v217
 v_mul_f32 v219, v219, v217
 v_mul_f32 v220, v220, v217
 v_mul_f32 v221, v221, v217
 v_accvgpr_write_b32 a76, v218
 v_accvgpr_write_b32 a77, v219
 v_accvgpr_write_b32 a78, v220
 v_accvgpr_write_b32 a79, v221
 v_accvgpr_read_b32 v218, a92
 v_accvgpr_read_b32 v219, a93
 v_accvgpr_read_b32 v220, a94
 v_accvgpr_read_b32 v221, a95
 v_mul_f32 v218, v218, v217
 v_mul_f32 v219, v219, v217
 v_mul_f32 v220, v220, v217
 v_mul_f32 v221, v221, v217
 v_accvgpr_write_b32 a92, v218
 v_accvgpr_write_b32 a93, v219
 v_accvgpr_write_b32 a94, v220
 v_accvgpr_write_b32 a95, v221
 v_accvgpr_read_b32 v218, a108
 v_accvgpr_read_b32 v219, a109
 v_accvgpr_read_b32 v220, a110
 v_accvgpr_read_b32 v221, a111
 v_mul_f32 v218, v218, v217
 v_mul_f32 v219, v219, v217
 v_mul_f32 v220, v220, v217
 v_mul_f32 v221, v221, v217
 v_accvgpr_write_b32 a108, v218
 v_accvgpr_write_b32 a109, v219
 v_accvgpr_write_b32 a110, v220
 v_accvgpr_write_b32 a111, v221
 v_accvgpr_read_b32 v218, a124
 v_accvgpr_read_b32 v219, a125
 v_accvgpr_read_b32 v220, a126
 v_accvgpr_read_b32 v221, a127
 v_mul_f32 v218, v218, v217
 v_mul_f32 v219, v219, v217
 v_mul_f32 v220, v220, v217
 v_mul_f32 v221, v221, v217
 v_accvgpr_write_b32 a124, v218
 v_accvgpr_write_b32 a125, v219
 v_accvgpr_write_b32 a126, v220
 v_accvgpr_write_b32 a127, v221
 v_lshlrev_b32 v218, 16, v140
 v_and_b32 v219, 0xffff0000, v140
 v_mul_f32 v218, v218, v217
 v_mul_f32 v219, v219, v217
 v_cvt_pk_bf16_f32 v140, v218, v219
 v_lshlrev_b32 v218, 16, v141
 v_and_b32 v219, 0xffff0000, v141
 v_mul_f32 v218, v218, v217
 v_mul_f32 v219, v219, v217
 v_cvt_pk_bf16_f32 v141, v218, v219
 v_lshlrev_b32 v218, 16, v142
 v_and_b32 v219, 0xffff0000, v142
 v_mul_f32 v218, v218, v217
 v_mul_f32 v219, v219, v217
 v_cvt_pk_bf16_f32 v142, v218, v219
 v_lshlrev_b32 v218, 16, v143
 v_and_b32 v219, 0xffff0000, v143
 v_mul_f32 v218, v218, v217
 v_mul_f32 v219, v219, v217
 v_cvt_pk_bf16_f32 v143, v218, v219
 v_lshlrev_b32 v218, 16, v188
 v_and_b32 v219, 0xffff0000, v188
 v_mul_f32 v218, v218, v217
 v_mul_f32 v219, v219, v217
 v_cvt_pk_bf16_f32 v188, v218, v219
 v_lshlrev_b32 v218, 16, v189
 v_and_b32 v219, 0xffff0000, v189
 v_mul_f32 v218, v218, v217
 v_mul_f32 v219, v219, v217
 v_cvt_pk_bf16_f32 v189, v218, v219
 v_lshlrev_b32 v218, 16, v190
 v_and_b32 v219, 0xffff0000, v190
 v_mul_f32 v218, v218, v217
 v_mul_f32 v219, v219, v217
 v_cvt_pk_bf16_f32 v190, v218, v219
 v_lshlrev_b32 v218, 16, v191
 v_and_b32 v219, 0xffff0000, v191
 v_mul_f32 v218, v218, v217
 v_mul_f32 v219, v219, v217
 v_cvt_pk_bf16_f32 v191, v218, v219
 v_exp_f32 v208, v108
 v_exp_f32 v209, v109
 v_exp_f32 v210, v110
 v_exp_f32 v211, v111
 s_nop 0
 v_cvt_pk_bf16_f32 v156, v208, v209
 v_cvt_pk_bf16_f32 v157, v210, v211
 v_exp_f32 v208, v124
 v_exp_f32 v209, v125
 v_exp_f32 v210, v126
 v_exp_f32 v211, v127
 s_nop 0
 v_cvt_pk_bf16_f32 v158, v208, v209
 v_cvt_pk_bf16_f32 v159, v210, v211
 s_nop 1
 v_mfma_f32_16x16x32_bf16 v[44:47], v[240:243], v[156:159], v[28:31]
 v_exp_f32 v16, v64
 v_exp_f32 v17, v65
 v_exp_f32 v18, v66
 v_exp_f32 v19, v67
 s_nop 0
 v_cvt_pk_bf16_f32 v160, v16, v17
 v_cvt_pk_bf16_f32 v161, v18, v19
 v_exp_f32 v32, v80
 v_exp_f32 v33, v81
 v_exp_f32 v34, v82
 v_exp_f32 v35, v83
 s_nop 0
 v_cvt_pk_bf16_f32 v162, v32, v33
 s_nop 11
 s_setpc_b64 s[50:51]
L_rare_2:
 s_nop 15
 v_log_f32 v216, v253
 v_max3_f32 v217, v64, v65, v66
 v_max3_f32 v217, v217, v67, v80
 v_max3_f32 v217, v217, v81, v82
 v_max3_f32 v216, v216, v217, v83
 v_mov_b32 v217, v216
 s_nop 1
 v_permlane32_swap_b32 v217, v216
 s_nop 0
 v_max_f32 v216, v216, v217
 v_mov_b32 v217, v216
 s_nop 1
 v_permlane16_swap_b32 v217, v216
 s_nop 0
 v_max_f32 v216, v216, v217
 v_ceil_f32 v216, v216
 v_add_f32 v216, 1120534528, v216
 v_max_f32 v216, 0, v216
 v_exp_f32 v217, -v216
 v_sub_f32 v192, v192, v216
 v_sub_f32 v193, v193, v216
 v_sub_f32 v194, v194, v216
 v_sub_f32 v195, v195, v216
 v_sub_f32 v64, v64, v216
 v_sub_f32 v65, v65, v216
 v_sub_f32 v66, v66, v216
 v_sub_f32 v67, v67, v216
 v_sub_f32 v80, v80, v216
 v_sub_f32 v81, v81, v216
 v_sub_f32 v82, v82, v216
 v_sub_f32 v83, v83, v216
 v_sub_f32 v96, v96, v216
 v_sub_f32 v97, v97, v216
 v_sub_f32 v98, v98, v216
 v_sub_f32 v99, v99, v216
 v_sub_f32 v112, v112, v216
 v_sub_f32 v113, v113, v216
 v_sub_f32 v114, v114, v216
 v_sub_f32 v115, v115, v216
 v_mul_f32 v253, v253, v217
 v_accvgpr_read_b32 v218, a0
 v_accvgpr_read_b32 v219, a1
 v_accvgpr_read_b32 v220, a2
 v_accvgpr_read_b32 v221, a3
 v_mul_f32 v218, v218, v217
 v_mul_f32 v219, v219, v217
 v_mul_f32 v220, v220, v217
 v_mul_f32 v221, v221, v217
 v_accvgpr_write_b32 a0, v218
 v_accvgpr_write_b32 a1, v219
 v_accvgpr_write_b32 a2, v220
 v_accvgpr_write_b32 a3, v221
 v_accvgpr_read_b32 v218, a16
 v_accvgpr_read_b32 v219, a17
 v_accvgpr_read_b32 v220, a18
 v_accvgpr_read_b32 v221, a19
 v_mul_f32 v218, v218, v217
 v_mul_f32 v219, v219, v217
 v_mul_f32 v220, v220, v217
 v_mul_f32 v221, v221, v217
 v_accvgpr_write_b32 a16, v218
 v_accvgpr_write_b32 a17, v219
 v_accvgpr_write_b32 a18, v220
 v_accvgpr_write_b32 a19, v221
 v_accvgpr_read_b32 v218, a32
 v_accvgpr_read_b32 v219, a33
 v_accvgpr_read_b32 v220, a34
 v_accvgpr_read_b32 v221, a35
 v_mul_f32 v218, v218, v217
 v_mul_f32 v219, v219, v217
 v_mul_f32 v220, v220, v217
 v_mul_f32 v221, v221, v217
 v_accvgpr_write_b32 a32, v218
 v_accvgpr_write_b32 a33, v219
 v_accvgpr_write_b32 a34, v220
 v_accvgpr_write_b32 a35, v221
 v_accvgpr_read_b32 v218, a48
 v_accvgpr_read_b32 v219, a49
 v_accvgpr_read_b32 v220, a50
 v_accvgpr_read_b32 v221, a51
 v_mul_f32 v218, v218, v217
 v_mul_f32 v219, v219, v217
 v_mul_f32 v220, v220, v217
 v_mul_f32 v221, v221, v217
 v_accvgpr_write_b32 a48, v218
 v_accvgpr_write_b32 a49, v219
 v_accvgpr_write_b32 a50, v220
 v_accvgpr_write_b32 a51, v221
 v_accvgpr_read_b32 v218, a64
 v_accvgpr_read_b32 v219, a65
 v_accvgpr_read_b32 v220, a66
 v_accvgpr_read_b32 v221, a67
 v_mul_f32 v218, v218, v217
 v_mul_f32 v219, v219, v217
 v_mul_f32 v220, v220, v217
 v_mul_f32 v221, v221, v217
 v_accvgpr_write_b32 a64, v218
 v_accvgpr_write_b32 a65, v219
 v_accvgpr_write_b32 a66, v220
 v_accvgpr_write_b32 a67, v221
 v_accvgpr_read_b32 v218, a80
 v_accvgpr_read_b32 v219, a81
 v_accvgpr_read_b32 v220, a82
 v_accvgpr_read_b32 v221, a83
 v_mul_f32 v218, v218, v217
 v_mul_f32 v219, v219, v217
 v_mul_f32 v220, v220, v217
 v_mul_f32 v221, v221, v217
 v_accvgpr_write_b32 a80, v218
 v_accvgpr_write_b32 a81, v219
 v_accvgpr_write_b32 a82, v220
 v_accvgpr_write_b32 a83, v221
 v_accvgpr_read_b32 v218, a96
 v_accvgpr_read_b32 v219, a97
 v_accvgpr_read_b32 v220, a98
 v_accvgpr_read_b32 v221, a99
 v_mul_f32 v218, v218, v217
 v_mul_f32 v219, v219, v217
 v_mul_f32 v220, v220, v217
 v_mul_f32 v221, v221, v217
 v_accvgpr_write_b32 a96, v218
 v_accvgpr_write_b32 a97, v219
 v_accvgpr_write_b32 a98, v220
 v_accvgpr_write_b32 a99, v221
 v_accvgpr_read_b32 v218, a112
 v_accvgpr_read_b32 v219, a113
 v_accvgpr_read_b32 v220, a114
 v_accvgpr_read_b32 v221, a115
 v_mul_f32 v218, v218, v217
 v_mul_f32 v219, v219, v217
 v_mul_f32 v220, v220, v217
 v_mul_f32 v221, v221, v217
 v_accvgpr_write_b32 a112, v218
 v_accvgpr_write_b32 a113, v219
 v_accvgpr_write_b32 a114, v220
 v_accvgpr_write_b32 a115, v221
 v_lshlrev_b32 v218, 16, v128
 v_and_b32 v219, 0xffff0000, v128
 v_mul_f32 v218, v218, v217
 v_mul_f32 v219, v219, v217
 v_cvt_pk_bf16_f32 v128, v218, v219
 v_lshlrev_b32 v218, 16, v129
 v_and_b32 v219, 0xffff0000, v129
 v_mul_f32 v218, v218, v217
 v_mul_f32 v219, v219, v217
 v_cvt_pk_bf16_f32 v129, v218, v219
 v_lshlrev_b32 v218, 16, v130
 v_and_b32 v219, 0xffff0000, v130
 v_mul_f32 v218, v218, v217
 v_mul_f32 v219, v219, v217
 v_cvt_pk_bf16_f32 v130, v218, v219
 v_lshlrev_b32 v218, 16, v131
 v_and_b32 v219, 0xffff0000, v131
 v_mul_f32 v218, v218, v217
 v_mul_f32 v219, v219, v217
 v_cvt_pk_bf16_f32 v131, v218, v219
 v_lshlrev_b32 v218, 16, v144
 v_and_b32 v219, 0xffff0000, v144
 v_mul_f32 v218, v218, v217
 v_mul_f32 v219, v219, v217
 v_cvt_pk_bf16_f32 v144, v218, v219
 v_lshlrev_b32 v218, 16, v145
 v_and_b32 v219, 0xffff0000, v145
 v_mul_f32 v218, v218, v217
 v_mul_f32 v219, v219, v217
 v_cvt_pk_bf16_f32 v145, v218, v219
 v_lshlrev_b32 v218, 16, v146
 v_and_b32 v219, 0xffff0000, v146
 v_mul_f32 v218, v218, v217
 v_mul_f32 v219, v219, v217
 v_cvt_pk_bf16_f32 v146, v218, v219
 v_lshlrev_b32 v218, 16, v147
 v_and_b32 v219, 0xffff0000, v147
 v_mul_f32 v218, v218, v217
 v_mul_f32 v219, v219, v217
 v_cvt_pk_bf16_f32 v147, v218, v219
 v_exp_f32 v16, v64
 v_exp_f32 v17, v65
 v_exp_f32 v18, v66
 v_exp_f32 v19, v67
 s_nop 0
 v_cvt_pk_bf16_f32 v160, v16, v17
 v_cvt_pk_bf16_f32 v161, v18, v19
 v_exp_f32 v32, v80
 v_exp_f32 v33, v81
 v_exp_f32 v34, v82
 v_exp_f32 v35, v83
 s_nop 0
 v_cvt_pk_bf16_f32 v162, v32, v33
 v_cvt_pk_bf16_f32 v163, v34, v35
 v_add_f32 v255, v16, v17
 v_add_f32 v255, v255, v18
 v_add_f32 v255, v255, v19
 v_add_f32 v255, v255, v32
 v_add_f32 v255, v255, v33
 v_add_f32 v255, v255, v34
 v_add_f32 v255, v255, v35
 v_log_f32 v216, v36
 v_max3_f32 v217, v68, v69, v70
 v_max3_f32 v217, v217, v71, v84
 v_max3_f32 v217, v217, v85, v86
 v_max3_f32 v216, v216, v217, v87
 v_mov_b32 v217, v216
 s_nop 1
 v_permlane32_swap_b32 v217, v216
 s_nop 0
 v_max_f32 v216, v216, v217
 v_mov_b32 v217, v216
 s_nop 1
 v_permlane16_swap_b32 v217, v216
 s_nop 0
 v_max_f32 v216, v216, v217
 v_ceil_f32 v216, v216
 v_add_f32 v216, 1120534528, v216
 v_max_f32 v216, 0, v216
 v_exp_f32 v217, -v216
 v_sub_f32 v196, v196, v216
 v_sub_f32 v197, v197, v216
 v_sub_f32 v198, v198, v216
 v_sub_f32 v199, v199, v216
 v_sub_f32 v68, v68, v216
 v_sub_f32 v69, v69, v216
 v_sub_f32 v70, v70, v216
 v_sub_f32 v71, v71, v216
 v_sub_f32 v84, v84, v216
 v_sub_f32 v85, v85, v216
 v_sub_f32 v86, v86, v216
 v_sub_f32 v87, v87, v216
 v_sub_f32 v100, v100, v216
 v_sub_f32 v101, v101, v216
 v_sub_f32 v102, v102, v216
 v_sub_f32 v103, v103, v216
 v_sub_f32 v116, v116, v216
 v_sub_f32 v117, v117, v216
 v_sub_f32 v118, v118, v216
 v_sub_f32 v119, v119, v216
 v_mul_f32 v36, v36, v217
 v_mul_f32 v37, v37, v217
 v_mul_f32 v38, v38, v217
 v_mul_f32 v39, v39, v217
 v_accvgpr_read_b32 v218, a4
 v_accvgpr_read_b32 v219, a5
 v_accvgpr_read_b32 v220, a6
 v_accvgpr_read_b32 v221, a7
 v_mul_f32 v218, v218, v217
 v_mul_f32 v219, v219, v217
 v_mul_f32 v220, v220, v217
 v_mul_f32 v221, v221, v217
 v_accvgpr_write_b32 a4, v218
 v_accvgpr_write_b32 a5, v219
 v_accvgpr_write_b32 a6, v220
 v_accvgpr_write_b32 a7, v221
 v_accvgpr_read_b32 v218, a20
 v_accvgpr_read_b32 v219, a21
 v_accvgpr_read_b32 v220, a22
 v_accvgpr_read_b32 v221, a23
 v_mul_f32 v218, v218, v217
 v_mul_f32 v219, v219, v217
 v_mul_f32 v220, v220, v217
 v_mul_f32 v221, v221, v217
 v_accvgpr_write_b32 a20, v218
 v_accvgpr_write_b32 a21, v219
 v_accvgpr_write_b32 a22, v220
 v_accvgpr_write_b32 a23, v221
 v_accvgpr_read_b32 v218, a36
 v_accvgpr_read_b32 v219, a37
 v_accvgpr_read_b32 v220, a38
 v_accvgpr_read_b32 v221, a39
 v_mul_f32 v218, v218, v217
 v_mul_f32 v219, v219, v217
 v_mul_f32 v220, v220, v217
 v_mul_f32 v221, v221, v217
 v_accvgpr_write_b32 a36, v218
 v_accvgpr_write_b32 a37, v219
 v_accvgpr_write_b32 a38, v220
 v_accvgpr_write_b32 a39, v221
 v_accvgpr_read_b32 v218, a52
 v_accvgpr_read_b32 v219, a53
 v_accvgpr_read_b32 v220, a54
 v_accvgpr_read_b32 v221, a55
 v_mul_f32 v218, v218, v217
 v_mul_f32 v219, v219, v217
 v_mul_f32 v220, v220, v217
 v_mul_f32 v221, v221, v217
 v_accvgpr_write_b32 a52, v218
 v_accvgpr_write_b32 a53, v219
 v_accvgpr_write_b32 a54, v220
 v_accvgpr_write_b32 a55, v221
 v_accvgpr_read_b32 v218, a68
 v_accvgpr_read_b32 v219, a69
 v_accvgpr_read_b32 v220, a70
 v_accvgpr_read_b32 v221, a71
 v_mul_f32 v218, v218, v217
 v_mul_f32 v219, v219, v217
 v_mul_f32 v220, v220, v217
 v_mul_f32 v221, v221, v217
 v_accvgpr_write_b32 a68, v218
 v_accvgpr_write_b32 a69, v219
 v_accvgpr_write_b32 a70, v220
 v_accvgpr_write_b32 a71, v221
 v_accvgpr_read_b32 v218, a84
 v_accvgpr_read_b32 v219, a85
 v_accvgpr_read_b32 v220, a86
 v_accvgpr_read_b32 v221, a87
 v_mul_f32 v218, v218, v217
 v_mul_f32 v219, v219, v217
 v_mul_f32 v220, v220, v217
 v_mul_f32 v221, v221, v217
 v_accvgpr_write_b32 a84, v218
 v_accvgpr_write_b32 a85, v219
 v_accvgpr_write_b32 a86, v220
 v_accvgpr_write_b32 a87, v221
 v_accvgpr_read_b32 v218, a100
 v_accvgpr_read_b32 v219, a101
 v_accvgpr_read_b32 v220, a102
 v_accvgpr_read_b32 v221, a103
 v_mul_f32 v218, v218, v217
 v_mul_f32 v219, v219, v217
 v_mul_f32 v220, v220, v217
 v_mul_f32 v221, v221, v217
 v_accvgpr_write_b32 a100, v218
 v_accvgpr_write_b32 a101, v219
 v_accvgpr_write_b32 a102, v220
 v_accvgpr_write_b32 a103, v221
 v_accvgpr_read_b32 v218, a116
 v_accvgpr_read_b32 v219, a117
 v_accvgpr_read_b32 v220, a118
 v_accvgpr_read_b32 v221, a119
 v_mul_f32 v218, v218, v217
 v_mul_f32 v219, v219, v217
 v_mul_f32 v220, v220, v217
 v_mul_f32 v221, v221, v217
 v_accvgpr_write_b32 a116, v218
 v_accvgpr_write_b32 a117, v219
 v_accvgpr_write_b32 a118, v220
 v_accvgpr_write_b32 a119, v221
 v_lshlrev_b32 v218, 16, v132
 v_and_b32 v219, 0xffff0000, v132
 v_mul_f32 v218, v218, v217
 v_mul_f32 v219, v219, v217
 v_cvt_pk_bf16_f32 v132, v218, v219
 v_lshlrev_b32 v218, 16, v133
 v_and_b32 v219, 0xffff0000, v133
 v_mul_f32 v218, v218, v217
 v_mul_f32 v219, v219, v217
 v_cvt_pk_bf16_f32 v133, v218, v219
 v_lshlrev_b32 v218, 16, v134
 v_and_b32 v219, 0xffff0000, v134
 v_mul_f32 v218, v218, v217
 v_mul_f32 v219, v219, v217
 v_cvt_pk_bf16_f32 v134, v218, v219
 v_lshlrev_b32 v218, 16, v135
 v_and_b32 v219, 0xffff0000, v135
 v_mul_f32 v218, v218, v217
 v_mul_f32 v219, v219, v217
 v_cvt_pk_bf16_f32 v135, v218, v219
 v_lshlrev_b32 v218, 16, v148
 v_and_b32 v219, 0xffff0000, v148
 v_mul_f32 v218, v218, v217
 v_mul_f32 v219, v219, v217
 v_cvt_pk_bf16_f32 v148, v218, v219
 v_lshlrev_b32 v218, 16, v149
 v_and_b32 v219, 0xffff0000, v149
 v_mul_f32 v218, v218, v217
 v_mul_f32 v219, v219, v217
 v_cvt_pk_bf16_f32 v149, v218, v219
 v_lshlrev_b32 v218, 16, v150
 v_and_b32 v219, 0xffff0000, v150
 v_mul_f32 v218, v218, v217
 v_mul_f32 v219, v219, v217
 v_cvt_pk_bf16_f32 v150, v218, v219
 v_lshlrev_b32 v218, 16, v151
 v_and_b32 v219, 0xffff0000, v151
 v_mul_f32 v218, v218, v217
 v_mul_f32 v219, v219, v217
 v_cvt_pk_bf16_f32 v151, v218, v219
 v_exp_f32 v208, v68
 v_exp_f32 v209, v69
 v_exp_f32 v210, v70
 v_exp_f32 v211, v71
 s_nop 0
 v_cvt_pk_bf16_f32 v164, v208, v209
 v_cvt_pk_bf16_f32 v165, v210, v211
 v_exp_f32 v208, v84
 v_exp_f32 v209, v85
 v_exp_f32 v210, v86
 v_exp_f32 v211, v87
 s_nop 0
 v_cvt_pk_bf16_f32 v166, v208, v209
 v_cvt_pk_bf16_f32 v167, v210, v211
 s_nop 1
 v_mfma_f32_16x16x32_bf16 v[20:23], v[240:243], v[164:167], v[36:39]
 v_log_f32 v216, v254
 v_max3_f32 v217, v72, v73, v74
 v_max3_f32 v217, v217, v75, v88
 v_max3_f32 v217, v217, v89, v90
 v_max3_f32 v216, v216, v217, v91
 v_mov_b32 v217, v216
 s_nop 1
 v_permlane32_swap_b32 v217, v216
 s_nop 0
 v_max_f32 v216, v216, v217
 v_mov_b32 v217, v216
 s_nop 1
 v_permlane16_swap_b32 v217, v216
 s_nop 0
 v_max_f32 v216, v216, v217
 v_ceil_f32 v216, v216
 v_add_f32 v216, 1120534528, v216
 v_max_f32 v216, 0, v216
 v_exp_f32 v217, -v216
 v_sub_f32 v200, v200, v216
 v_sub_f32 v201, v201, v216
 v_sub_f32 v202, v202, v216
 v_sub_f32 v203, v203, v216
 v_sub_f32 v72, v72, v216
 v_sub_f32 v73, v73, v216
 v_sub_f32 v74, v74, v216
 v_sub_f32 v75, v75, v216
 v_sub_f32 v88, v88, v216
 v_sub_f32 v89, v89, v216
 v_sub_f32 v90, v90, v216
 v_sub_f32 v91, v91, v216
 v_sub_f32 v104, v104, v216
 v_sub_f32 v105, v105, v216
 v_sub_f32 v106, v106, v216
 v_sub_f32 v107, v107, v216
 v_sub_f32 v120, v120, v216
 v_sub_f32 v121, v121, v216
 v_sub_f32 v122, v122, v216
 v_sub_f32 v123, v123, v216
 v_mul_f32 v254, v254, v217
 v_accvgpr_read_b32 v218, a8
 v_accvgpr_read_b32 v219, a9
 v_accvgpr_read_b32 v220, a10
 v_accvgpr_read_b32 v221, a11
 v_mul_f32 v218, v218, v217
 v_mul_f32 v219, v219, v217
 v_mul_f32 v220, v220, v217
 v_mul_f32 v221, v221, v217
 v_accvgpr_write_b32 a8, v218
 v_accvgpr_write_b32 a9, v219
 v_accvgpr_write_b32 a10, v220
 v_accvgpr_write_b32 a11, v221
 v_accvgpr_read_b32 v218, a24
 v_accvgpr_read_b32 v219, a25
 v_accvgpr_read_b32 v220, a26
 v_accvgpr_read_b32 v221, a27
 v_mul_f32 v218, v218, v217
 v_mul_f32 v219, v219, v217
 v_mul_f32 v220, v220, v217
 v_mul_f32 v221, v221, v217
 v_accvgpr_write_b32 a24, v218
 v_accvgpr_write_b32 a25, v219
 v_accvgpr_write_b32 a26, v220
 v_accvgpr_write_b32 a27, v221
 v_accvgpr_read_b32 v218, a40
 v_accvgpr_read_b32 v219, a41
 v_accvgpr_read_b32 v220, a42
 v_accvgpr_read_b32 v221, a43
 v_mul_f32 v218, v218, v217
 v_mul_f32 v219, v219, v217
 v_mul_f32 v220, v220, v217
 v_mul_f32 v221, v221, v217
 v_accvgpr_write_b32 a40, v218
 v_accvgpr_write_b32 a41, v219
 v_accvgpr_write_b32 a42, v220
 v_accvgpr_write_b32 a43, v221
 v_accvgpr_read_b32 v218, a56
 v_accvgpr_read_b32 v219, a57
 v_accvgpr_read_b32 v220, a58
 v_accvgpr_read_b32 v221, a59
 v_mul_f32 v218, v218, v217
 v_mul_f32 v219, v219, v217
 v_mul_f32 v220, v220, v217
 v_mul_f32 v221, v221, v217
 v_accvgpr_write_b32 a56, v218
 v_accvgpr_write_b32 a57, v219
 v_accvgpr_write_b32 a58, v220
 v_accvgpr_write_b32 a59, v221
 v_accvgpr_read_b32 v218, a72
 v_accvgpr_read_b32 v219, a73
 v_accvgpr_read_b32 v220, a74
 v_accvgpr_read_b32 v221, a75
 v_mul_f32 v218, v218, v217
 v_mul_f32 v219, v219, v217
 v_mul_f32 v220, v220, v217
 v_mul_f32 v221, v221, v217
 v_accvgpr_write_b32 a72, v218
 v_accvgpr_write_b32 a73, v219
 v_accvgpr_write_b32 a74, v220
 v_accvgpr_write_b32 a75, v221
 v_accvgpr_read_b32 v218, a88
 v_accvgpr_read_b32 v219, a89
 v_accvgpr_read_b32 v220, a90
 v_accvgpr_read_b32 v221, a91
 v_mul_f32 v218, v218, v217
 v_mul_f32 v219, v219, v217
 v_mul_f32 v220, v220, v217
 v_mul_f32 v221, v221, v217
 v_accvgpr_write_b32 a88, v218
 v_accvgpr_write_b32 a89, v219
 v_accvgpr_write_b32 a90, v220
 v_accvgpr_write_b32 a91, v221
 v_accvgpr_read_b32 v218, a104
 v_accvgpr_read_b32 v219, a105
 v_accvgpr_read_b32 v220, a106
 v_accvgpr_read_b32 v221, a107
 v_mul_f32 v218, v218, v217
 v_mul_f32 v219, v219, v217
 v_mul_f32 v220, v220, v217
 v_mul_f32 v221, v221, v217
 v_accvgpr_write_b32 a104, v218
 v_accvgpr_write_b32 a105, v219
 v_accvgpr_write_b32 a106, v220
 v_accvgpr_write_b32 a107, v221
 v_accvgpr_read_b32 v218, a120
 v_accvgpr_read_b32 v219, a121
 v_accvgpr_read_b32 v220, a122
 v_accvgpr_read_b32 v221, a123
 v_mul_f32 v218, v218, v217
 v_mul_f32 v219, v219, v217
 v_mul_f32 v220, v220, v217
 v_mul_f32 v221, v221, v217
 v_accvgpr_write_b32 a120, v218
 v_accvgpr_write_b32 a121, v219
 v_accvgpr_write_b32 a122, v220
 v_accvgpr_write_b32 a123, v221
 v_lshlrev_b32 v218, 16, v136
 v_and_b32 v219, 0xffff0000, v136
 v_mul_f32 v218, v218, v217
 v_mul_f32 v219, v219, v217
 v_cvt_pk_bf16_f32 v136, v218, v219
 v_lshlrev_b32 v218, 16, v137
 v_and_b32 v219, 0xffff0000, v137
 v_mul_f32 v218, v218, v217
 v_mul_f32 v219, v219, v217
 v_cvt_pk_bf16_f32 v137, v218, v219
 v_lshlrev_b32 v218, 16, v138
 v_and_b32 v219, 0xffff0000, v138
 v_mul_f32 v218, v218, v217
 v_mul_f32 v219, v219, v217
 v_cvt_pk_bf16_f32 v138, v218, v219
 v_lshlrev_b32 v218, 16, v139
 v_and_b32 v219, 0xffff0000, v139
 v_mul_f32 v218, v218, v217
 v_mul_f32 v219, v219, v217
 v_cvt_pk_bf16_f32 v139, v218, v219
 v_lshlrev_b32 v218, 16, v152
 v_and_b32 v219, 0xffff0000, v152
 v_mul_f32 v218, v218, v217
 v_mul_f32 v219, v219, v217
 v_cvt_pk_bf16_f32 v152, v218, v219
 v_lshlrev_b32 v218, 16, v153
 v_and_b32 v219, 0xffff0000, v153
 v_mul_f32 v218, v218, v217
 v_mul_f32 v219, v219, v217
 v_cvt_pk_bf16_f32 v153, v218, v219
 v_lshlrev_b32 v218, 16, v154
 v_and_b32 v219, 0xffff0000, v154
 v_mul_f32 v218, v218, v217
 v_mul_f32 v219, v219, v217
 v_cvt_pk_bf16_f32 v154, v218, v219
 v_lshlrev_b32 v218, 16, v155
 v_and_b32 v219, 0xffff0000, v155
 v_mul_f32 v218, v218, v217
 v_mul_f32 v219, v219, v217
 v_cvt_pk_bf16_f32 v155, v218, v219
 v_exp_f32 v24, v72
 v_exp_f32 v25, v73
 v_exp_f32 v26, v74
 v_exp_f32 v27, v75
 s_nop 0
 v_cvt_pk_bf16_f32 v168, v24, v25
 v_cvt_pk_bf16_f32 v169, v26, v27
 v_exp_f32 v40, v88
 v_exp_f32 v41, v89
 v_exp_f32 v42, v90
 v_exp_f32 v43, v91
 s_nop 0
 v_cvt_pk_bf16_f32 v170, v40, v41
 v_cvt_pk_bf16_f32 v171, v42, v43
 v_add_f32 v215, v24, v25
 v_add_f32 v215, v215, v26
 v_add_f32 v215, v215, v27
 v_add_f32 v215, v215, v40
 v_add_f32 v215, v215, v41
 v_add_f32 v215, v215, v42
 v_add_f32 v215, v215, v43
 v_log_f32 v216, v44
 v_max3_f32 v217, v76, v77, v78
 v_max3_f32 v217, v217, v79, v92
 v_max3_f32 v217, v217, v93, v94
 v_max3_f32 v216, v216, v217, v95
 v_mov_b32 v217, v216
 s_nop 1
 v_permlane32_swap_b32 v217, v216
 s_nop 0
 v_max_f32 v216, v216, v217
 v_mov_b32 v217, v216
 s_nop 1
 v_permlane16_swap_b32 v217, v216
 s_nop 0
 v_max_f32 v216, v216, v217
 v_ceil_f32 v216, v216
 v_add_f32 v216, 1120534528, v216
 v_max_f32 v216, 0, v216
 v_exp_f32 v217, -v216
 v_sub_f32 v204, v204, v216
 v_sub_f32 v205, v205, v216
 v_sub_f32 v206, v206, v216
 v_sub_f32 v207, v207, v216
 v_sub_f32 v76, v76, v216
 v_sub_f32 v77, v77, v216
 v_sub_f32 v78, v78, v216
 v_sub_f32 v79, v79, v216
 v_sub_f32 v92, v92, v216
 v_sub_f32 v93, v93, v216
 v_sub_f32 v94, v94, v216
 v_sub_f32 v95, v95, v216
 v_sub_f32 v108, v108, v216
 v_sub_f32 v109, v109, v216
 v_sub_f32 v110, v110, v216
 v_sub_f32 v111, v111, v216
 v_sub_f32 v124, v124, v216
 v_sub_f32 v125, v125, v216
 v_sub_f32 v126, v126, v216
 v_sub_f32 v127, v127, v216
 v_mul_f32 v44, v44, v217
 v_mul_f32 v45, v45, v217
 v_mul_f32 v46, v46, v217
 v_mul_f32 v47, v47, v217
 v_accvgpr_read_b32 v218, a12
 v_accvgpr_read_b32 v219, a13
 v_accvgpr_read_b32 v220, a14
 v_accvgpr_read_b32 v221, a15
 v_mul_f32 v218, v218, v217
 v_mul_f32 v219, v219, v217
 v_mul_f32 v220, v220, v217
 v_mul_f32 v221, v221, v217
 v_accvgpr_write_b32 a12, v218
 v_accvgpr_write_b32 a13, v219
 v_accvgpr_write_b32 a14, v220
 v_accvgpr_write_b32 a15, v221
 v_accvgpr_read_b32 v218, a28
 v_accvgpr_read_b32 v219, a29
 v_accvgpr_read_b32 v220, a30
 v_accvgpr_read_b32 v221, a31
 v_mul_f32 v218, v218, v217
 v_mul_f32 v219, v219, v217
 v_mul_f32 v220, v220, v217
 v_mul_f32 v221, v221, v217
 v_accvgpr_write_b32 a28, v218
 v_accvgpr_write_b32 a29, v219
 v_accvgpr_write_b32 a30, v220
 v_accvgpr_write_b32 a31, v221
 v_accvgpr_read_b32 v218, a44
 v_accvgpr_read_b32 v219, a45
 v_accvgpr_read_b32 v220, a46
 v_accvgpr_read_b32 v221, a47
 v_mul_f32 v218, v218, v217
 v_mul_f32 v219, v219, v217
 v_mul_f32 v220, v220, v217
 v_mul_f32 v221, v221, v217
 v_accvgpr_write_b32 a44, v218
 v_accvgpr_write_b32 a45, v219
 v_accvgpr_write_b32 a46, v220
 v_accvgpr_write_b32 a47, v221
 v_accvgpr_read_b32 v218, a60
 v_accvgpr_read_b32 v219, a61
 v_accvgpr_read_b32 v220, a62
 v_accvgpr_read_b32 v221, a63
 v_mul_f32 v218, v218, v217
 v_mul_f32 v219, v219, v217
 v_mul_f32 v220, v220, v217
 v_mul_f32 v221, v221, v217
 v_accvgpr_write_b32 a60, v218
 v_accvgpr_write_b32 a61, v219
 v_accvgpr_write_b32 a62, v220
 v_accvgpr_write_b32 a63, v221
 v_accvgpr_read_b32 v218, a76
 v_accvgpr_read_b32 v219, a77
 v_accvgpr_read_b32 v220, a78
 v_accvgpr_read_b32 v221, a79
 v_mul_f32 v218, v218, v217
 v_mul_f32 v219, v219, v217
 v_mul_f32 v220, v220, v217
 v_mul_f32 v221, v221, v217
 v_accvgpr_write_b32 a76, v218
 v_accvgpr_write_b32 a77, v219
 v_accvgpr_write_b32 a78, v220
 v_accvgpr_write_b32 a79, v221
 v_accvgpr_read_b32 v218, a92
 v_accvgpr_read_b32 v219, a93
 v_accvgpr_read_b32 v220, a94
 v_accvgpr_read_b32 v221, a95
 v_mul_f32 v218, v218, v217
 v_mul_f32 v219, v219, v217
 v_mul_f32 v220, v220, v217
 v_mul_f32 v221, v221, v217
 v_accvgpr_write_b32 a92, v218
 v_accvgpr_write_b32 a93, v219
 v_accvgpr_write_b32 a94, v220
 v_accvgpr_write_b32 a95, v221
 v_accvgpr_read_b32 v218, a108
 v_accvgpr_read_b32 v219, a109
 v_accvgpr_read_b32 v220, a110
 v_accvgpr_read_b32 v221, a111
 v_mul_f32 v218, v218, v217
 v_mul_f32 v219, v219, v217
 v_mul_f32 v220, v220, v217
 v_mul_f32 v221, v221, v217
 v_accvgpr_write_b32 a108, v218
 v_accvgpr_write_b32 a109, v219
 v_accvgpr_write_b32 a110, v220
 v_accvgpr_write_b32 a111, v221
 v_accvgpr_read_b32 v218, a124
 v_accvgpr_read_b32 v219, a125
 v_accvgpr_read_b32 v220, a126
 v_accvgpr_read_b32 v221, a127
 v_mul_f32 v218, v218, v217
 v_mul_f32 v219, v219, v217
 v_mul_f32 v220, v220, v217
 v_mul_f32 v221, v221, v217
 v_accvgpr_write_b32 a124, v218
 v_accvgpr_write_b32 a125, v219
 v_accvgpr_write_b32 a126, v220
 v_accvgpr_write_b32 a127, v221
 v_lshlrev_b32 v218, 16, v140
 v_and_b32 v219, 0xffff0000, v140
 v_mul_f32 v218, v218, v217
 v_mul_f32 v219, v219, v217
 v_cvt_pk_bf16_f32 v140, v218, v219
 v_lshlrev_b32 v218, 16, v141
 v_and_b32 v219, 0xffff0000, v141
 v_mul_f32 v218, v218, v217
 v_mul_f32 v219, v219, v217
 v_cvt_pk_bf16_f32 v141, v218, v219
 v_lshlrev_b32 v218, 16, v142
 v_and_b32 v219, 0xffff0000, v142
 v_mul_f32 v218, v218, v217
 v_mul_f32 v219, v219, v217
 v_cvt_pk_bf16_f32 v142, v218, v219
 v_lshlrev_b32 v218, 16, v143
 v_and_b32 v219, 0xffff0000, v143
 v_mul_f32 v218, v218, v217
 v_mul_f32 v219, v219, v217
 v_cvt_pk_bf16_f32 v143, v218, v219
 v_lshlrev_b32 v218, 16, v156
 v_and_b32 v219, 0xffff0000, v156
 v_mul_f32 v218, v218, v217
 v_mul_f32 v219, v219, v217
 v_cvt_pk_bf16_f32 v156, v218, v219
 v_lshlrev_b32 v218, 16, v157
 v_and_b32 v219, 0xffff0000, v157
 v_mul_f32 v218, v218, v217
 v_mul_f32 v219, v219, v217
 v_cvt_pk_bf16_f32 v157, v218, v219
 v_lshlrev_b32 v218, 16, v158
 v_and_b32 v219, 0xffff0000, v158
 v_mul_f32 v218, v218, v217
 v_mul_f32 v219, v219, v217
 v_cvt_pk_bf16_f32 v158, v218, v219
 v_lshlrev_b32 v218, 16, v159
 v_and_b32 v219, 0xffff0000, v159
 v_mul_f32 v218, v218, v217
 v_mul_f32 v219, v219, v217
 v_cvt_pk_bf16_f32 v159, v218, v219
 v_exp_f32 v208, v76
 v_exp_f32 v209, v77
 v_exp_f32 v210, v78
 v_exp_f32 v211, v79
 s_nop 0
 v_cvt_pk_bf16_f32 v172, v208, v209
 v_cvt_pk_bf16_f32 v173, v210, v211
 v_exp_f32 v208, v92
 v_exp_f32 v209, v93
 v_exp_f32 v210, v94
 v_exp_f32 v211, v95
 s_nop 0
 v_cvt_pk_bf16_f32 v174, v208, v209
 v_cvt_pk_bf16_f32 v175, v210, v211
 s_nop 1
 v_mfma_f32_16x16x32_bf16 v[28:31], v[240:243], v[172:175], v[44:47]
 v_exp_f32 v16, v96
 v_exp_f32 v17, v97
 v_exp_f32 v18, v98
 v_exp_f32 v19, v99
 s_nop 0
 v_cvt_pk_bf16_f32 v176, v16, v17
 v_cvt_pk_bf16_f32 v177, v18, v19
 v_exp_f32 v32, v112
 v_exp_f32 v33, v113
 v_exp_f32 v34, v114
 v_exp_f32 v35, v115
 s_nop 0
 v_cvt_pk_bf16_f32 v178, v32, v33
 s_nop 11
 s_setpc_b64 s[50:51]
L_rare_3:
 s_nop 15
 v_log_f32 v216, v253
 v_max3_f32 v217, v96, v97, v98
 v_max3_f32 v217, v217, v99, v112
 v_max3_f32 v217, v217, v113, v114
 v_max3_f32 v216, v216, v217, v115
 v_mov_b32 v217, v216
 s_nop 1
 v_permlane32_swap_b32 v217, v216
 s_nop 0
 v_max_f32 v216, v216, v217
 v_mov_b32 v217, v216
 s_nop 1
 v_permlane16_swap_b32 v217, v216
 s_nop 0
 v_max_f32 v216, v216, v217
 v_ceil_f32 v216, v216
 v_add_f32 v216, 1120534528, v216
 v_max_f32 v216, 0, v216
 v_exp_f32 v217, -v216
 v_sub_f32 v192, v192, v216
 v_sub_f32 v193, v193, v216
 v_sub_f32 v194, v194, v216
 v_sub_f32 v195, v195, v216
 v_sub_f32 v64, v64, v216
 v_sub_f32 v65, v65, v216
 v_sub_f32 v66, v66, v216
 v_sub_f32 v67, v67, v216
 v_sub_f32 v80, v80, v216
 v_sub_f32 v81, v81, v216
 v_sub_f32 v82, v82, v216
 v_sub_f32 v83, v83, v216
 v_sub_f32 v96, v96, v216
 v_sub_f32 v97, v97, v216
 v_sub_f32 v98, v98, v216
 v_sub_f32 v99, v99, v216
 v_sub_f32 v112, v112, v216
 v_sub_f32 v113, v113, v216
 v_sub_f32 v114, v114, v216
 v_sub_f32 v115, v115, v216
 v_mul_f32 v253, v253, v217
 v_accvgpr_read_b32 v218, a0
 v_accvgpr_read_b32 v219, a1
 v_accvgpr_read_b32 v220, a2
 v_accvgpr_read_b32 v221, a3
 v_mul_f32 v218, v218, v217
 v_mul_f32 v219, v219, v217
 v_mul_f32 v220, v220, v217
 v_mul_f32 v221, v221, v217
 v_accvgpr_write_b32 a0, v218
 v_accvgpr_write_b32 a1, v219
 v_accvgpr_write_b32 a2, v220
 v_accvgpr_write_b32 a3, v221
 v_accvgpr_read_b32 v218, a16
 v_accvgpr_read_b32 v219, a17
 v_accvgpr_read_b32 v220, a18
 v_accvgpr_read_b32 v221, a19
 v_mul_f32 v218, v218, v217
 v_mul_f32 v219, v219, v217
 v_mul_f32 v220, v220, v217
 v_mul_f32 v221, v221, v217
 v_accvgpr_write_b32 a16, v218
 v_accvgpr_write_b32 a17, v219
 v_accvgpr_write_b32 a18, v220
 v_accvgpr_write_b32 a19, v221
 v_accvgpr_read_b32 v218, a32
 v_accvgpr_read_b32 v219, a33
 v_accvgpr_read_b32 v220, a34
 v_accvgpr_read_b32 v221, a35
 v_mul_f32 v218, v218, v217
 v_mul_f32 v219, v219, v217
 v_mul_f32 v220, v220, v217
 v_mul_f32 v221, v221, v217
 v_accvgpr_write_b32 a32, v218
 v_accvgpr_write_b32 a33, v219
 v_accvgpr_write_b32 a34, v220
 v_accvgpr_write_b32 a35, v221
 v_accvgpr_read_b32 v218, a48
 v_accvgpr_read_b32 v219, a49
 v_accvgpr_read_b32 v220, a50
 v_accvgpr_read_b32 v221, a51
 v_mul_f32 v218, v218, v217
 v_mul_f32 v219, v219, v217
 v_mul_f32 v220, v220, v217
 v_mul_f32 v221, v221, v217
 v_accvgpr_write_b32 a48, v218
 v_accvgpr_write_b32 a49, v219
 v_accvgpr_write_b32 a50, v220
 v_accvgpr_write_b32 a51, v221
 v_accvgpr_read_b32 v218, a64
 v_accvgpr_read_b32 v219, a65
 v_accvgpr_read_b32 v220, a66
 v_accvgpr_read_b32 v221, a67
 v_mul_f32 v218, v218, v217
 v_mul_f32 v219, v219, v217
 v_mul_f32 v220, v220, v217
 v_mul_f32 v221, v221, v217
 v_accvgpr_write_b32 a64, v218
 v_accvgpr_write_b32 a65, v219
 v_accvgpr_write_b32 a66, v220
 v_accvgpr_write_b32 a67, v221
 v_accvgpr_read_b32 v218, a80
 v_accvgpr_read_b32 v219, a81
 v_accvgpr_read_b32 v220, a82
 v_accvgpr_read_b32 v221, a83
 v_mul_f32 v218, v218, v217
 v_mul_f32 v219, v219, v217
 v_mul_f32 v220, v220, v217
 v_mul_f32 v221, v221, v217
 v_accvgpr_write_b32 a80, v218
 v_accvgpr_write_b32 a81, v219
 v_accvgpr_write_b32 a82, v220
 v_accvgpr_write_b32 a83, v221
 v_accvgpr_read_b32 v218, a96
 v_accvgpr_read_b32 v219, a97
 v_accvgpr_read_b32 v220, a98
 v_accvgpr_read_b32 v221, a99
 v_mul_f32 v218, v218, v217
 v_mul_f32 v219, v219, v217
 v_mul_f32 v220, v220, v217
 v_mul_f32 v221, v221, v217
 v_accvgpr_write_b32 a96, v218
 v_accvgpr_write_b32 a97, v219
 v_accvgpr_write_b32 a98, v220
 v_accvgpr_write_b32 a99, v221
 v_accvgpr_read_b32 v218, a112
 v_accvgpr_read_b32 v219, a113
 v_accvgpr_read_b32 v220, a114
 v_accvgpr_read_b32 v221, a115
 v_mul_f32 v218, v218, v217
 v_mul_f32 v219, v219, v217
 v_mul_f32 v220, v220, v217
 v_mul_f32 v221, v221, v217
 v_accvgpr_write_b32 a112, v218
 v_accvgpr_write_b32 a113, v219
 v_accvgpr_write_b32 a114, v220
 v_accvgpr_write_b32 a115, v221
 v_lshlrev_b32 v218, 16, v160
 v_and_b32 v219, 0xffff0000, v160
 v_mul_f32 v218, v218, v217
 v_mul_f32 v219, v219, v217
 v_cvt_pk_bf16_f32 v160, v218, v219
 v_lshlrev_b32 v218, 16, v161
 v_and_b32 v219, 0xffff0000, v161
 v_mul_f32 v218, v218, v217
 v_mul_f32 v219, v219, v217
 v_cvt_pk_bf16_f32 v161, v218, v219
 v_lshlrev_b32 v218, 16, v162
 v_and_b32 v219, 0xffff0000, v162
 v_mul_f32 v218, v218, v217
 v_mul_f32 v219, v219, v217
 v_cvt_pk_bf16_f32 v162, v218, v219
 v_lshlrev_b32 v218, 16, v163
 v_and_b32 v219, 0xffff0000, v163
 v_mul_f32 v218, v218, v217
 v_mul_f32 v219, v219, v217
 v_cvt_pk_bf16_f32 v163, v218, v219
 v_exp_f32 v16, v96
 v_exp_f32 v17, v97
 v_exp_f32 v18, v98
 v_exp_f32 v19, v99
 s_nop 0
 v_cvt_pk_bf16_f32 v176, v16, v17
 v_cvt_pk_bf16_f32 v177, v18, v19
 v_exp_f32 v32, v112
 v_exp_f32 v33, v113
 v_exp_f32 v34, v114
 v_exp_f32 v35, v115
 s_nop 0
 v_cvt_pk_bf16_f32 v178, v32, v33
 v_cvt_pk_bf16_f32 v179, v34, v35
 v_add_f32 v255, v16, v17
 v_add_f32 v255, v255, v18
 v_add_f32 v255, v255, v19
 v_add_f32 v255, v255, v32
 v_add_f32 v255, v255, v33
 v_add_f32 v255, v255, v34
 v_add_f32 v255, v255, v35
 v_log_f32 v216, v20
 v_max3_f32 v217, v100, v101, v102
 v_max3_f32 v217, v217, v103, v116
 v_max3_f32 v217, v217, v117, v118
 v_max3_f32 v216, v216, v217, v119
 v_mov_b32 v217, v216
 s_nop 1
 v_permlane32_swap_b32 v217, v216
 s_nop 0
 v_max_f32 v216, v216, v217
 v_mov_b32 v217, v216
 s_nop 1
 v_permlane16_swap_b32 v217, v216
 s_nop 0
 v_max_f32 v216, v216, v217
 v_ceil_f32 v216, v216
 v_add_f32 v216, 1120534528, v216
 v_max_f32 v216, 0, v216
 v_exp_f32 v217, -v216
 v_sub_f32 v196, v196, v216
 v_sub_f32 v197, v197, v216
 v_sub_f32 v198, v198, v216
 v_sub_f32 v199, v199, v216
 v_sub_f32 v68, v68, v216
 v_sub_f32 v69, v69, v216
 v_sub_f32 v70, v70, v216
 v_sub_f32 v71, v71, v216
 v_sub_f32 v84, v84, v216
 v_sub_f32 v85, v85, v216
 v_sub_f32 v86, v86, v216
 v_sub_f32 v87, v87, v216
 v_sub_f32 v100, v100, v216
 v_sub_f32 v101, v101, v216
 v_sub_f32 v102, v102, v216
 v_sub_f32 v103, v103, v216
 v_sub_f32 v116, v116, v216
 v_sub_f32 v117, v117, v216
 v_sub_f32 v118, v118, v216
 v_sub_f32 v119, v119, v216
 v_mul_f32 v20, v20, v217
 v_mul_f32 v21, v21, v217
 v_mul_f32 v22, v22, v217
 v_mul_f32 v23, v23, v217
 v_accvgpr_read_b32 v218, a4
 v_accvgpr_read_b32 v219, a5
 v_accvgpr_read_b32 v220, a6
 v_accvgpr_read_b32 v221, a7
 v_mul_f32 v218, v218, v217
 v_mul_f32 v219, v219, v217
 v_mul_f32 v220, v220, v217
 v_mul_f32 v221, v221, v217
 v_accvgpr_write_b32 a4, v218
 v_accvgpr_write_b32 a5, v219
 v_accvgpr_write_b32 a6, v220
 v_accvgpr_write_b32 a7, v221
 v_accvgpr_read_b32 v218, a20
 v_accvgpr_read_b32 v219, a21
 v_accvgpr_read_b32 v220, a22
 v_accvgpr_read_b32 v221, a23
 v_mul_f32 v218, v218, v217
 v_mul_f32 v219, v219, v217
 v_mul_f32 v220, v220, v217
 v_mul_f32 v221, v221, v217
 v_accvgpr_write_b32 a20, v218
 v_accvgpr_write_b32 a21, v219
 v_accvgpr_write_b32 a22, v220
 v_accvgpr_write_b32 a23, v221
 v_accvgpr_read_b32 v218, a36
 v_accvgpr_read_b32 v219, a37
 v_accvgpr_read_b32 v220, a38
 v_accvgpr_read_b32 v221, a39
 v_mul_f32 v218, v218, v217
 v_mul_f32 v219, v219, v217
 v_mul_f32 v220, v220, v217
 v_mul_f32 v221, v221, v217
 v_accvgpr_write_b32 a36, v218
 v_accvgpr_write_b32 a37, v219
 v_accvgpr_write_b32 a38, v220
 v_accvgpr_write_b32 a39, v221
 v_accvgpr_read_b32 v218, a52
 v_accvgpr_read_b32 v219, a53
 v_accvgpr_read_b32 v220, a54
 v_accvgpr_read_b32 v221, a55
 v_mul_f32 v218, v218, v217
 v_mul_f32 v219, v219, v217
 v_mul_f32 v220, v220, v217
 v_mul_f32 v221, v221, v217
 v_accvgpr_write_b32 a52, v218
 v_accvgpr_write_b32 a53, v219
 v_accvgpr_write_b32 a54, v220
 v_accvgpr_write_b32 a55, v221
 v_accvgpr_read_b32 v218, a68
 v_accvgpr_read_b32 v219, a69
 v_accvgpr_read_b32 v220, a70
 v_accvgpr_read_b32 v221, a71
 v_mul_f32 v218, v218, v217
 v_mul_f32 v219, v219, v217
 v_mul_f32 v220, v220, v217
 v_mul_f32 v221, v221, v217
 v_accvgpr_write_b32 a68, v218
 v_accvgpr_write_b32 a69, v219
 v_accvgpr_write_b32 a70, v220
 v_accvgpr_write_b32 a71, v221
 v_accvgpr_read_b32 v218, a84
 v_accvgpr_read_b32 v219, a85
 v_accvgpr_read_b32 v220, a86
 v_accvgpr_read_b32 v221, a87
 v_mul_f32 v218, v218, v217
 v_mul_f32 v219, v219, v217
 v_mul_f32 v220, v220, v217
 v_mul_f32 v221, v221, v217
 v_accvgpr_write_b32 a84, v218
 v_accvgpr_write_b32 a85, v219
 v_accvgpr_write_b32 a86, v220
 v_accvgpr_write_b32 a87, v221
 v_accvgpr_read_b32 v218, a100
 v_accvgpr_read_b32 v219, a101
 v_accvgpr_read_b32 v220, a102
 v_accvgpr_read_b32 v221, a103
 v_mul_f32 v218, v218, v217
 v_mul_f32 v219, v219, v217
 v_mul_f32 v220, v220, v217
 v_mul_f32 v221, v221, v217
 v_accvgpr_write_b32 a100, v218
 v_accvgpr_write_b32 a101, v219
 v_accvgpr_write_b32 a102, v220
 v_accvgpr_write_b32 a103, v221
 v_accvgpr_read_b32 v218, a116
 v_accvgpr_read_b32 v219, a117
 v_accvgpr_read_b32 v220, a118
 v_accvgpr_read_b32 v221, a119
 v_mul_f32 v218, v218, v217
 v_mul_f32 v219, v219, v217
 v_mul_f32 v220, v220, v217
 v_mul_f32 v221, v221, v217
 v_accvgpr_write_b32 a116, v218
 v_accvgpr_write_b32 a117, v219
 v_accvgpr_write_b32 a118, v220
 v_accvgpr_write_b32 a119, v221
 v_lshlrev_b32 v218, 16, v164
 v_and_b32 v219, 0xffff0000, v164
 v_mul_f32 v218, v218, v217
 v_mul_f32 v219, v219, v217
 v_cvt_pk_bf16_f32 v164, v218, v219
 v_lshlrev_b32 v218, 16, v165
 v_and_b32 v219, 0xffff0000, v165
 v_mul_f32 v218, v218, v217
 v_mul_f32 v219, v219, v217
 v_cvt_pk_bf16_f32 v165, v218, v219
 v_lshlrev_b32 v218, 16, v166
 v_and_b32 v219, 0xffff0000, v166
 v_mul_f32 v218, v218, v217
 v_mul_f32 v219, v219, v217
 v_cvt_pk_bf16_f32 v166, v218, v219
 v_lshlrev_b32 v218, 16, v167
 v_and_b32 v219, 0xffff0000, v167
 v_mul_f32 v218, v218, v217
 v_mul_f32 v219, v219, v217
 v_cvt_pk_bf16_f32 v167, v218, v219
 v_exp_f32 v208, v100
 v_exp_f32 v209, v101
 v_exp_f32 v210, v102
 v_exp_f32 v211, v103
 s_nop 0
 v_cvt_pk_bf16_f32 v180, v208, v209
 v_cvt_pk_bf16_f32 v181, v210, v211
 v_exp_f32 v208, v116
 v_exp_f32 v209, v117
 v_exp_f32 v210, v118
 v_exp_f32 v211, v119
 s_nop 0
 v_cvt_pk_bf16_f32 v182, v208, v209
 v_cvt_pk_bf16_f32 v183, v210, v211
 s_nop 1
 v_mfma_f32_16x16x32_bf16 v[36:39], v[240:243], v[180:183], v[20:23]
 v_log_f32 v216, v254
 v_max3_f32 v217, v104, v105, v106
 v_max3_f32 v217, v217, v107, v120
 v_max3_f32 v217, v217, v121, v122
 v_max3_f32 v216, v216, v217, v123
 v_mov_b32 v217, v216
 s_nop 1
 v_permlane32_swap_b32 v217, v216
 s_nop 0
 v_max_f32 v216, v216, v217
 v_mov_b32 v217, v216
 s_nop 1
 v_permlane16_swap_b32 v217, v216
 s_nop 0
 v_max_f32 v216, v216, v217
 v_ceil_f32 v216, v216
 v_add_f32 v216, 1120534528, v216
 v_max_f32 v216, 0, v216
 v_exp_f32 v217, -v216
 v_sub_f32 v200, v200, v216
 v_sub_f32 v201, v201, v216
 v_sub_f32 v202, v202, v216
 v_sub_f32 v203, v203, v216
 v_sub_f32 v72, v72, v216
 v_sub_f32 v73, v73, v216
 v_sub_f32 v74, v74, v216
 v_sub_f32 v75, v75, v216
 v_sub_f32 v88, v88, v216
 v_sub_f32 v89, v89, v216
 v_sub_f32 v90, v90, v216
 v_sub_f32 v91, v91, v216
 v_sub_f32 v104, v104, v216
 v_sub_f32 v105, v105, v216
 v_sub_f32 v106, v106, v216
 v_sub_f32 v107, v107, v216
 v_sub_f32 v120, v120, v216
 v_sub_f32 v121, v121, v216
 v_sub_f32 v122, v122, v216
 v_sub_f32 v123, v123, v216
 v_mul_f32 v254, v254, v217
 v_accvgpr_read_b32 v218, a8
 v_accvgpr_read_b32 v219, a9
 v_accvgpr_read_b32 v220, a10
 v_accvgpr_read_b32 v221, a11
 v_mul_f32 v218, v218, v217
 v_mul_f32 v219, v219, v217
 v_mul_f32 v220, v220, v217
 v_mul_f32 v221, v221, v217
 v_accvgpr_write_b32 a8, v218
 v_accvgpr_write_b32 a9, v219
 v_accvgpr_write_b32 a10, v220
 v_accvgpr_write_b32 a11, v221
 v_accvgpr_read_b32 v218, a24
 v_accvgpr_read_b32 v219, a25
 v_accvgpr_read_b32 v220, a26
 v_accvgpr_read_b32 v221, a27
 v_mul_f32 v218, v218, v217
 v_mul_f32 v219, v219, v217
 v_mul_f32 v220, v220, v217
 v_mul_f32 v221, v221, v217
 v_accvgpr_write_b32 a24, v218
 v_accvgpr_write_b32 a25, v219
 v_accvgpr_write_b32 a26, v220
 v_accvgpr_write_b32 a27, v221
 v_accvgpr_read_b32 v218, a40
 v_accvgpr_read_b32 v219, a41
 v_accvgpr_read_b32 v220, a42
 v_accvgpr_read_b32 v221, a43
 v_mul_f32 v218, v218, v217
 v_mul_f32 v219, v219, v217
 v_mul_f32 v220, v220, v217
 v_mul_f32 v221, v221, v217
 v_accvgpr_write_b32 a40, v218
 v_accvgpr_write_b32 a41, v219
 v_accvgpr_write_b32 a42, v220
 v_accvgpr_write_b32 a43, v221
 v_accvgpr_read_b32 v218, a56
 v_accvgpr_read_b32 v219, a57
 v_accvgpr_read_b32 v220, a58
 v_accvgpr_read_b32 v221, a59
 v_mul_f32 v218, v218, v217
 v_mul_f32 v219, v219, v217
 v_mul_f32 v220, v220, v217
 v_mul_f32 v221, v221, v217
 v_accvgpr_write_b32 a56, v218
 v_accvgpr_write_b32 a57, v219
 v_accvgpr_write_b32 a58, v220
 v_accvgpr_write_b32 a59, v221
 v_accvgpr_read_b32 v218, a72
 v_accvgpr_read_b32 v219, a73
 v_accvgpr_read_b32 v220, a74
 v_accvgpr_read_b32 v221, a75
 v_mul_f32 v218, v218, v217
 v_mul_f32 v219, v219, v217
 v_mul_f32 v220, v220, v217
 v_mul_f32 v221, v221, v217
 v_accvgpr_write_b32 a72, v218
 v_accvgpr_write_b32 a73, v219
 v_accvgpr_write_b32 a74, v220
 v_accvgpr_write_b32 a75, v221
 v_accvgpr_read_b32 v218, a88
 v_accvgpr_read_b32 v219, a89
 v_accvgpr_read_b32 v220, a90
 v_accvgpr_read_b32 v221, a91
 v_mul_f32 v218, v218, v217
 v_mul_f32 v219, v219, v217
 v_mul_f32 v220, v220, v217
 v_mul_f32 v221, v221, v217
 v_accvgpr_write_b32 a88, v218
 v_accvgpr_write_b32 a89, v219
 v_accvgpr_write_b32 a90, v220
 v_accvgpr_write_b32 a91, v221
 v_accvgpr_read_b32 v218, a104
 v_accvgpr_read_b32 v219, a105
 v_accvgpr_read_b32 v220, a106
 v_accvgpr_read_b32 v221, a107
 v_mul_f32 v218, v218, v217
 v_mul_f32 v219, v219, v217
 v_mul_f32 v220, v220, v217
 v_mul_f32 v221, v221, v217
 v_accvgpr_write_b32 a104, v218
 v_accvgpr_write_b32 a105, v219
 v_accvgpr_write_b32 a106, v220
 v_accvgpr_write_b32 a107, v221
 v_accvgpr_read_b32 v218, a120
 v_accvgpr_read_b32 v219, a121
 v_accvgpr_read_b32 v220, a122
 v_accvgpr_read_b32 v221, a123
 v_mul_f32 v218, v218, v217
 v_mul_f32 v219, v219, v217
 v_mul_f32 v220, v220, v217
 v_mul_f32 v221, v221, v217
 v_accvgpr_write_b32 a120, v218
 v_accvgpr_write_b32 a121, v219
 v_accvgpr_write_b32 a122, v220
 v_accvgpr_write_b32 a123, v221
 v_lshlrev_b32 v218, 16, v168
 v_and_b32 v219, 0xffff0000, v168
 v_mul_f32 v218, v218, v217
 v_mul_f32 v219, v219, v217
 v_cvt_pk_bf16_f32 v168, v218, v219
 v_lshlrev_b32 v218, 16, v169
 v_and_b32 v219, 0xffff0000, v169
 v_mul_f32 v218, v218, v217
 v_mul_f32 v219, v219, v217
 v_cvt_pk_bf16_f32 v169, v218, v219
 v_lshlrev_b32 v218, 16, v170
 v_and_b32 v219, 0xffff0000, v170
 v_mul_f32 v218, v218, v217
 v_mul_f32 v219, v219, v217
 v_cvt_pk_bf16_f32 v170, v218, v219
 v_lshlrev_b32 v218, 16, v171
 v_and_b32 v219, 0xffff0000, v171
 v_mul_f32 v218, v218, v217
 v_mul_f32 v219, v219, v217
 v_cvt_pk_bf16_f32 v171, v218, v219
 v_exp_f32 v24, v104
 v_exp_f32 v25, v105
 v_exp_f32 v26, v106
 v_exp_f32 v27, v107
 s_nop 0
 v_cvt_pk_bf16_f32 v184, v24, v25
 v_cvt_pk_bf16_f32 v185, v26, v27
 v_exp_f32 v40, v120
 v_exp_f32 v41, v121
 v_exp_f32 v42, v122
 v_exp_f32 v43, v123
 s_nop 0
 v_cvt_pk_bf16_f32 v186, v40, v41
 v_cvt_pk_bf16_f32 v187, v42, v43
 v_add_f32 v215, v24, v25
 v_add_f32 v215, v215, v26
 v_add_f32 v215, v215, v27
 v_add_f32 v215, v215, v40
 v_add_f32 v215, v215, v41
 v_add_f32 v215, v215, v42
 v_add_f32 v215, v215, v43
 v_log_f32 v216, v28
 v_max3_f32 v217, v108, v109, v110
 v_max3_f32 v217, v217, v111, v124
 v_max3_f32 v217, v217, v125, v126
 v_max3_f32 v216, v216, v217, v127
 v_mov_b32 v217, v216
 s_nop 1
 v_permlane32_swap_b32 v217, v216
 s_nop 0
 v_max_f32 v216, v216, v217
 v_mov_b32 v217, v216
 s_nop 1
 v_permlane16_swap_b32 v217, v216
 s_nop 0
 v_max_f32 v216, v216, v217
 v_ceil_f32 v216, v216
 v_add_f32 v216, 1120534528, v216
 v_max_f32 v216, 0, v216
 v_exp_f32 v217, -v216
 v_sub_f32 v204, v204, v216
 v_sub_f32 v205, v205, v216
 v_sub_f32 v206, v206, v216
 v_sub_f32 v207, v207, v216
 v_sub_f32 v76, v76, v216
 v_sub_f32 v77, v77, v216
 v_sub_f32 v78, v78, v216
 v_sub_f32 v79, v79, v216
 v_sub_f32 v92, v92, v216
 v_sub_f32 v93, v93, v216
 v_sub_f32 v94, v94, v216
 v_sub_f32 v95, v95, v216
 v_sub_f32 v108, v108, v216
 v_sub_f32 v109, v109, v216
 v_sub_f32 v110, v110, v216
 v_sub_f32 v111, v111, v216
 v_sub_f32 v124, v124, v216
 v_sub_f32 v125, v125, v216
 v_sub_f32 v126, v126, v216
 v_sub_f32 v127, v127, v216
 v_mul_f32 v28, v28, v217
 v_mul_f32 v29, v29, v217
 v_mul_f32 v30, v30, v217
 v_mul_f32 v31, v31, v217
 v_accvgpr_read_b32 v218, a12
 v_accvgpr_read_b32 v219, a13
 v_accvgpr_read_b32 v220, a14
 v_accvgpr_read_b32 v221, a15
 v_mul_f32 v218, v218, v217
 v_mul_f32 v219, v219, v217
 v_mul_f32 v220, v220, v217
 v_mul_f32 v221, v221, v217
 v_accvgpr_write_b32 a12, v218
 v_accvgpr_write_b32 a13, v219
 v_accvgpr_write_b32 a14, v220
 v_accvgpr_write_b32 a15, v221
 v_accvgpr_read_b32 v218, a28
 v_accvgpr_read_b32 v219, a29
 v_accvgpr_read_b32 v220, a30
 v_accvgpr_read_b32 v221, a31
 v_mul_f32 v218, v218, v217
 v_mul_f32 v219, v219, v217
 v_mul_f32 v220, v220, v217
 v_mul_f32 v221, v221, v217
 v_accvgpr_write_b32 a28, v218
 v_accvgpr_write_b32 a29, v219
 v_accvgpr_write_b32 a30, v220
 v_accvgpr_write_b32 a31, v221
 v_accvgpr_read_b32 v218, a44
 v_accvgpr_read_b32 v219, a45
 v_accvgpr_read_b32 v220, a46
 v_accvgpr_read_b32 v221, a47
 v_mul_f32 v218, v218, v217
 v_mul_f32 v219, v219, v217
 v_mul_f32 v220, v220, v217
 v_mul_f32 v221, v221, v217
 v_accvgpr_write_b32 a44, v218
 v_accvgpr_write_b32 a45, v219
 v_accvgpr_write_b32 a46, v220
 v_accvgpr_write_b32 a47, v221
 v_accvgpr_read_b32 v218, a60
 v_accvgpr_read_b32 v219, a61
 v_accvgpr_read_b32 v220, a62
 v_accvgpr_read_b32 v221, a63
 v_mul_f32 v218, v218, v217
 v_mul_f32 v219, v219, v217
 v_mul_f32 v220, v220, v217
 v_mul_f32 v221, v221, v217
 v_accvgpr_write_b32 a60, v218
 v_accvgpr_write_b32 a61, v219
 v_accvgpr_write_b32 a62, v220
 v_accvgpr_write_b32 a63, v221
 v_accvgpr_read_b32 v218, a76
 v_accvgpr_read_b32 v219, a77
 v_accvgpr_read_b32 v220, a78
 v_accvgpr_read_b32 v221, a79
 v_mul_f32 v218, v218, v217
 v_mul_f32 v219, v219, v217
 v_mul_f32 v220, v220, v217
 v_mul_f32 v221, v221, v217
 v_accvgpr_write_b32 a76, v218
 v_accvgpr_write_b32 a77, v219
 v_accvgpr_write_b32 a78, v220
 v_accvgpr_write_b32 a79, v221
 v_accvgpr_read_b32 v218, a92
 v_accvgpr_read_b32 v219, a93
 v_accvgpr_read_b32 v220, a94
 v_accvgpr_read_b32 v221, a95
 v_mul_f32 v218, v218, v217
 v_mul_f32 v219, v219, v217
 v_mul_f32 v220, v220, v217
 v_mul_f32 v221, v221, v217
 v_accvgpr_write_b32 a92, v218
 v_accvgpr_write_b32 a93, v219
 v_accvgpr_write_b32 a94, v220
 v_accvgpr_write_b32 a95, v221
 v_accvgpr_read_b32 v218, a108
 v_accvgpr_read_b32 v219, a109
 v_accvgpr_read_b32 v220, a110
 v_accvgpr_read_b32 v221, a111
 v_mul_f32 v218, v218, v217
 v_mul_f32 v219, v219, v217
 v_mul_f32 v220, v220, v217
 v_mul_f32 v221, v221, v217
 v_accvgpr_write_b32 a108, v218
 v_accvgpr_write_b32 a109, v219
 v_accvgpr_write_b32 a110, v220
 v_accvgpr_write_b32 a111, v221
 v_accvgpr_read_b32 v218, a124
 v_accvgpr_read_b32 v219, a125
 v_accvgpr_read_b32 v220, a126
 v_accvgpr_read_b32 v221, a127
 v_mul_f32 v218, v218, v217
 v_mul_f32 v219, v219, v217
 v_mul_f32 v220, v220, v217
 v_mul_f32 v221, v221, v217
 v_accvgpr_write_b32 a124, v218
 v_accvgpr_write_b32 a125, v219
 v_accvgpr_write_b32 a126, v220
 v_accvgpr_write_b32 a127, v221
 v_lshlrev_b32 v218, 16, v172
 v_and_b32 v219, 0xffff0000, v172
 v_mul_f32 v218, v218, v217
 v_mul_f32 v219, v219, v217
 v_cvt_pk_bf16_f32 v172, v218, v219
 v_lshlrev_b32 v218, 16, v173
 v_and_b32 v219, 0xffff0000, v173
 v_mul_f32 v218, v218, v217
 v_mul_f32 v219, v219, v217
 v_cvt_pk_bf16_f32 v173, v218, v219
 v_lshlrev_b32 v218, 16, v174
 v_and_b32 v219, 0xffff0000, v174
 v_mul_f32 v218, v218, v217
 v_mul_f32 v219, v219, v217
 v_cvt_pk_bf16_f32 v174, v218, v219
 v_lshlrev_b32 v218, 16, v175
 v_and_b32 v219, 0xffff0000, v175
 v_mul_f32 v218, v218, v217
 v_mul_f32 v219, v219, v217
 v_cvt_pk_bf16_f32 v175, v218, v219
 v_lshlrev_b32 v218, 16, v156
 v_and_b32 v219, 0xffff0000, v156
 v_mul_f32 v218, v218, v217
 v_mul_f32 v219, v219, v217
 v_cvt_pk_bf16_f32 v156, v218, v219
 v_lshlrev_b32 v218, 16, v157
 v_and_b32 v219, 0xffff0000, v157
 v_mul_f32 v218, v218, v217
 v_mul_f32 v219, v219, v217
 v_cvt_pk_bf16_f32 v157, v218, v219
 v_lshlrev_b32 v218, 16, v158
 v_and_b32 v219, 0xffff0000, v158
 v_mul_f32 v218, v218, v217
 v_mul_f32 v219, v219, v217
 v_cvt_pk_bf16_f32 v158, v218, v219
 v_lshlrev_b32 v218, 16, v159
 v_and_b32 v219, 0xffff0000, v159
 v_mul_f32 v218, v218, v217
 v_mul_f32 v219, v219, v217
 v_cvt_pk_bf16_f32 v159, v218, v219
 v_exp_f32 v208, v108
 v_exp_f32 v209, v109
 v_exp_f32 v210, v110
 v_exp_f32 v211, v111
 s_nop 0
 v_cvt_pk_bf16_f32 v188, v208, v209
 v_cvt_pk_bf16_f32 v189, v210, v211
 v_exp_f32 v208, v124
 v_exp_f32 v209, v125
 v_exp_f32 v210, v126
 v_exp_f32 v211, v127
 s_nop 0
 v_cvt_pk_bf16_f32 v190, v208, v209
 v_cvt_pk_bf16_f32 v191, v210, v211
 s_nop 1
 v_mfma_f32_16x16x32_bf16 v[44:47], v[240:243], v[188:191], v[28:31]
 v_exp_f32 v16, v64
 v_exp_f32 v17, v65
 v_exp_f32 v18, v66
 v_exp_f32 v19, v67
 s_nop 0
 v_cvt_pk_bf16_f32 v128, v16, v17
 v_cvt_pk_bf16_f32 v129, v18, v19
 v_exp_f32 v32, v80
 v_exp_f32 v33, v81
 v_exp_f32 v34, v82
 v_exp_f32 v35, v83
 s_nop 0
 v_cvt_pk_bf16_f32 v130, v32, v33
 s_nop 11
 s_setpc_b64 s[50:51]
.section .rodata,"a"
.p2align 6
.amdhsa_kernel adaLN_cond__gqa_block_cached__dense_activation_relu__prompt_kernel
  .amdhsa_next_free_vgpr 512
  .amdhsa_next_free_sgpr 102
  .amdhsa_accum_offset 256
  .amdhsa_group_segment_fixed_size 0
  .amdhsa_kernarg_size 104
  .amdhsa_user_sgpr_count 2
  .amdhsa_user_sgpr_kernarg_segment_ptr 1
  .amdhsa_system_sgpr_workgroup_id_x 1
.end_amdhsa_kernel
```
